```python
import torch

def _softmax(x, axis=-1):
    return torch.softmax(x, dim=axis)
def _gelu(x):
    return torch.nn.functional.gelu(x, approximate="tanh")
def _silu(x):
    return torch.nn.functional.silu(x)
def _sigmoid(x):
    return torch.sigmoid(x)
def _layernorm(x, axis=-1, eps=1e-5):
    m = x.mean(dim=axis, keepdim=True)
    v = x.var(dim=axis, keepdim=True, unbiased=False)
    return (x - m) / torch.sqrt(v + eps)
def _scatter_add(tgt, idx, src, axis=0):
    return tgt.clone().index_add_(axis, idx, src)
def _segment_sum(src, seg, n):
    out = torch.zeros((n,) + src.shape[1:], dtype=src.dtype)
    return out.index_add_(0, seg, src)
def _pad(x, pw):
    flat = tuple(v for pair in reversed(pw) for v in pair)
    return torch.nn.functional.pad(x, flat)

kernel_name = 'sequential_preLN__ssm_conv_s4d__geglu_ffn__prompt'

def setup_inputs():

    _w = (lambda a: (lambda t: t.to(torch.bfloat16) if t.is_floating_point() else t)(torch.as_tensor(a)))
    def _A_setup():
        Bsz, L, D, N = 1, 2048, 576, 128
        return {
            "u": _w((lambda *s: torch.randn(*s, dtype=torch.bfloat16) * 0.05)(Bsz, L, D)),
            "log_A_real": _w((lambda *s: torch.randn(*s, dtype=torch.bfloat16) * 6.4)(D, N) * 0.5),
            "A_imag": _w((lambda *s: torch.randn(*s, dtype=torch.bfloat16) * 0.05)(D, N) * 3.14),
            "C_real": _w((lambda *s: torch.randn(*s, dtype=torch.bfloat16) * 0.05)(D, N) / N ** 0.5),
            "C_imag": _w((lambda *s: torch.randn(*s, dtype=torch.bfloat16) * 0.05)(D, N) / N ** 0.5),
            "log_dt": _w((lambda *s: torch.randn(*s, dtype=torch.bfloat16) * 0.05)(D) * 0.5 - 4.0),
            "D_skip": _w((lambda *s: torch.randn(*s, dtype=torch.bfloat16) * 0.05)(D)),
        }
    _A_in = _A_setup()

    def _B_setup():
        B, S, D, F = 1, 2048, 576, 4608
        return {
            "x": _w((lambda *s: torch.randn(*s, dtype=torch.bfloat16) * 0.05)(B, S, D)),
            "w_gate": _w((lambda *s: torch.randn(*s, dtype=torch.bfloat16) * 0.05)(D, F)),
            "w_up": _w((lambda *s: torch.randn(*s, dtype=torch.bfloat16) * 0.05)(D, F)),
            "w_down": _w((lambda *s: torch.randn(*s, dtype=torch.bfloat16) * 0.05)(F, D)),
        }
    _B_in = _B_setup()

    return {
        "A_u": _A_in["u"],
        "A_log_A_real": _A_in["log_A_real"],
        "A_A_imag": _A_in["A_imag"],
        "A_C_real": _A_in["C_real"],
        "A_C_imag": _A_in["C_imag"],
        "A_log_dt": _A_in["log_dt"],
        "A_D_skip": _A_in["D_skip"],
        "B_x": _B_in["x"],
        "B_w_gate": _B_in["w_gate"],
        "B_w_up": _B_in["w_up"],
        "B_w_down": _B_in["w_down"],
    }

def reference(A_u, A_log_A_real, A_A_imag, A_C_real, A_C_imag, A_log_dt, A_D_skip, B_x, B_w_gate, B_w_up, B_w_down):
    def _A_ref(u, log_A_real, A_imag, C_real, C_imag, log_dt, D_skip):
        L = u.shape[1]
        dt = torch.exp(log_dt)
        A = -torch.exp(log_A_real) + 1j * A_imag
        C = (C_real + 1j * C_imag) * dt[:, None]
        pos = (lambda x, dt: x.to(dt))(torch.arange(L), log_dt.dtype)
        P = torch.exp((A * dt[:, None])[:, :, None] * pos[None, None, :])
        K = 2.0 * torch.einsum("dn,dnl->dl", C, P).real
        L2 = 2 * L
        u_t = (lambda x, *d: x.permute(*d))(u, 0, 2, 1)
        Kf = (lambda x, *a, **k: torch.fft.rfft(x.float(), *a, **k))(K, L2)
        Uf = (lambda x, *a, **k: torch.fft.rfft(x.float(), *a, **k))(u_t, L2)
        y = (lambda x, *a, **k: torch.fft.irfft(x, *a, **k).to(torch.bfloat16))(Uf * Kf[None, :, :], L2)[:, :, :L]
        y = (lambda x, *d: x.permute(*d))(y, 0, 2, 1)
        return y + u * D_skip[None, None, :]

    def _B_ref(x, w_gate, w_up, w_down):
        return (_gelu(x @ w_gate) * (x @ w_up)) @ w_down

    x = A_u
    h = x + _A_ref(_layernorm(x, axis=-1), A_log_A_real, A_A_imag, A_C_real, A_C_imag, A_log_dt, A_D_skip)
    h2 = h + _B_ref(_layernorm(h, axis=-1), B_w_gate, B_w_up, B_w_down)
    return h2
```

```asm
; @launch kernel=ka_kernel grid=(976,1,1) block=(256,1,1) lds=40960
; @launch kernel=k3_kernel grid=(256,1,1) block=(256,1,1) lds=147456
; @launch kernel=k4_kernel grid=(256,1,1) block=(576,1,1) lds=98304
.amdgcn_target "amdgcn-amd-amdhsa--gfx950"
.text
.globl ka_kernel
.p2align 8
.type ka_kernel,@function
ka_kernel:
    s_getpc_b64 s[4:5]
Lka_kernel_pc0:
    v_lshlrev_b32 v1, 7, v0
    v_min_u32 v1, 14208, v1
    global_load_dword v127, v1, s[4:5]

    s_cmp_ge_u32 s2, 976
    s_cbranch_scc1 Lka_kernel_end
    s_cmp_ge_u32 s2, 832
    s_cbranch_scc1 Lka_kernel_B
    s_cmp_ge_u32 s2, 256
    s_cbranch_scc1 Lka_kernel_V

    s_setprio 3
    s_load_dwordx2 s[4:5], s[0:1], 0
    s_load_dwordx4 s[24:27], s[0:1], 96
    s_load_dwordx4 s[36:39], s[0:1], 80
    s_and_b32 s16, s2, 7
    s_lshl_b32 s16, s16, 5
    s_lshr_b32 s17, s2, 3
    s_add_u32 s16, s16, s17
    v_and_b32 v1, 63, v0
    v_lshrrev_b32 v2, 6, v0
    v_lshrrev_b32 v3, 5, v1
    v_and_b32 v4, 31, v1
    v_lshl_add_u32 v5, v2, 1, v3
    v_mul_u32_u24 v6, 1152, v5
    v_lshl_add_u32 v6, v4, 4, v6
    s_mul_i32 s17, s16, 9216
    v_cmp_gt_u32 vcc, 8, v4
    v_add_u32 v7, 1024, v6
    v_mov_b32 v8, 0x7fffffff
    v_cndmask_b32 v7, v8, v7, vcc
    v_readfirstlane_b32 s21, v2
    s_waitcnt lgkmcnt(0)

    s_mov_b32 s8, s4
    s_mov_b32 s9, s5
    s_mov_b32 s10, 2359296
    s_mov_b32 s11, 0x20000
    buffer_load_dwordx4 v[16:19], v6, s[8:11], s17 offen offset:0
    buffer_load_dwordx4 v[20:23], v6, s[8:11], s17 offen offset:512
    buffer_load_dwordx4 v[24:27], v7, s[8:11], s17 offen
    s_mov_b32 s12, s26
    s_mov_b32 s13, s27
    s_mov_b32 s14, 48107520
    s_mov_b32 s15, 0x20000
    s_mov_b32 s28, s24
    s_mov_b32 s29, s25
    s_mov_b32 s30, 256
    s_mov_b32 s31, 0x20000
    s_or_b32 s34, s21, s2
    s_cmp_lg_u32 s34, 0
    s_cbranch_scc1 Lka_kernel_P_nononce
    s_memrealtime s[32:33]
    s_waitcnt lgkmcnt(0)
    s_or_b32 s32, s32, 1
    v_mov_b32 v12, s32
    v_mov_b32 v13, 0
    buffer_store_dword v12, v13, s[28:31], 0 offen sc1

Lka_kernel_P_nononce:
    s_cmp_ge_u32 s2, 16
    s_cbranch_scc1 Lka_kernel_P_nozero
    v_mov_b32 v12, 0
    v_and_b32 v13, 31, v0
    v_lshlrev_b32 v13, 2, v13
    s_lshl_b32 s34, s2, 7
    s_add_u32 s34, s34, 7667712
    buffer_store_dword v12, v13, s[12:15], s34 offen

Lka_kernel_P_nozero:
    v_mul_u32_u24 v6, 1216, v5
    v_lshl_add_u32 v6, v4, 4, v6
    v_mov_b32 v9, 0x3f803f80
    v_mov_b32 v10, 0
    v_mov_b32 v11, 0
    v_mov_b32 v99, 0
    s_waitcnt vmcnt(0)

    v_dot2_f32_bf16 v10, v16, v9, v10
    v_lshlrev_b32 v40, 16, v16
    v_and_b32 v41, 0xffff0000, v16
    v_dot2_f32_bf16 v11, v17, v9, v11
    v_lshlrev_b32 v42, 16, v17
    v_and_b32 v43, 0xffff0000, v17
    v_dot2_f32_bf16 v10, v18, v9, v10
    v_lshlrev_b32 v44, 16, v18
    v_and_b32 v45, 0xffff0000, v18
    v_dot2_f32_bf16 v11, v19, v9, v11
    v_lshlrev_b32 v46, 16, v19
    v_and_b32 v47, 0xffff0000, v19
    v_dot2_f32_bf16 v10, v20, v9, v10
    v_lshlrev_b32 v48, 16, v20
    v_and_b32 v49, 0xffff0000, v20
    v_dot2_f32_bf16 v11, v21, v9, v11
    v_lshlrev_b32 v50, 16, v21
    v_and_b32 v51, 0xffff0000, v21
    v_dot2_f32_bf16 v10, v22, v9, v10
    v_lshlrev_b32 v52, 16, v22
    v_and_b32 v53, 0xffff0000, v22
    v_dot2_f32_bf16 v11, v23, v9, v11
    v_lshlrev_b32 v54, 16, v23
    v_and_b32 v55, 0xffff0000, v23
    v_dot2_f32_bf16 v10, v24, v9, v10
    v_lshlrev_b32 v56, 16, v24
    v_and_b32 v57, 0xffff0000, v24
    v_dot2_f32_bf16 v11, v25, v9, v11
    v_lshlrev_b32 v58, 16, v25
    v_and_b32 v59, 0xffff0000, v25
    v_dot2_f32_bf16 v10, v26, v9, v10
    v_lshlrev_b32 v60, 16, v26
    v_and_b32 v61, 0xffff0000, v26
    v_dot2_f32_bf16 v11, v27, v9, v11
    v_lshlrev_b32 v62, 16, v27
    v_and_b32 v63, 0xffff0000, v27
    ds_write_b128 v6, v[16:19] offset:0
    ds_write_b128 v6, v[20:23] offset:512
    s_nop 0
    v_add_f32 v10, v10, v11
    s_nop 1
    v_add_f32_dpp v10, v10, v10 quad_perm:[1,0,3,2] row_mask:0xf bank_mask:0xf
    s_nop 1
    v_add_f32_dpp v10, v10, v10 quad_perm:[2,3,0,1] row_mask:0xf bank_mask:0xf
    s_nop 1
    v_add_f32_dpp v10, v10, v10 row_half_mirror row_mask:0xf bank_mask:0xf
    s_nop 1
    v_add_f32_dpp v10, v10, v10 row_mirror row_mask:0xf bank_mask:0xf
    v_mov_b32 v14, v10
    s_nop 1
    v_permlane16_swap_b32 v10, v14
    s_nop 1
    v_add_f32 v10, v10, v14

    v_mul_f32 v10, 0x3ae38e39, v10
    v_mov_b32 v11, 0
    v_mov_b32 v12, 0
    v_mov_b32 v15, 0
    v_sub_f32 v13, v40, v10
    v_fmac_f32 v11, v13, v13
    v_sub_f32 v14, v41, v10
    v_fmac_f32 v12, v14, v14
    v_sub_f32 v13, v42, v10
    v_fmac_f32 v11, v13, v13
    v_sub_f32 v14, v43, v10
    v_fmac_f32 v12, v14, v14
    v_sub_f32 v13, v44, v10
    v_fmac_f32 v11, v13, v13
    v_sub_f32 v14, v45, v10
    v_fmac_f32 v12, v14, v14
    v_sub_f32 v13, v46, v10
    v_fmac_f32 v11, v13, v13
    v_sub_f32 v14, v47, v10
    v_fmac_f32 v12, v14, v14
    v_sub_f32 v13, v48, v10
    v_fmac_f32 v11, v13, v13
    v_sub_f32 v14, v49, v10
    v_fmac_f32 v12, v14, v14
    v_sub_f32 v13, v50, v10
    v_fmac_f32 v11, v13, v13
    v_sub_f32 v14, v51, v10
    v_fmac_f32 v12, v14, v14
    v_sub_f32 v13, v52, v10
    v_fmac_f32 v11, v13, v13
    v_sub_f32 v14, v53, v10
    v_fmac_f32 v12, v14, v14
    v_sub_f32 v13, v54, v10
    v_fmac_f32 v11, v13, v13
    v_sub_f32 v14, v55, v10
    v_fmac_f32 v12, v14, v14
    v_sub_f32 v13, v56, v10
    v_fmac_f32 v15, v13, v13
    v_sub_f32 v14, v57, v10
    v_fmac_f32 v15, v14, v14
    v_sub_f32 v13, v58, v10
    v_fmac_f32 v15, v13, v13
    v_sub_f32 v14, v59, v10
    v_fmac_f32 v15, v14, v14
    v_sub_f32 v13, v60, v10
    v_fmac_f32 v15, v13, v13
    v_sub_f32 v14, v61, v10
    v_fmac_f32 v15, v14, v14
    v_sub_f32 v13, v62, v10
    v_fmac_f32 v15, v13, v13
    v_sub_f32 v14, v63, v10
    v_fmac_f32 v15, v14, v14
    v_add_f32 v11, v11, v12
    v_cndmask_b32 v15, 0, v15, vcc
    v_add_f32 v11, v11, v15

    s_nop 1
    v_add_f32_dpp v11, v11, v11 quad_perm:[1,0,3,2] row_mask:0xf bank_mask:0xf
    s_nop 1
    v_add_f32_dpp v11, v11, v11 quad_perm:[2,3,0,1] row_mask:0xf bank_mask:0xf
    s_nop 1
    v_add_f32_dpp v11, v11, v11 row_half_mirror row_mask:0xf bank_mask:0xf
    s_nop 1
    v_add_f32_dpp v11, v11, v11 row_mirror row_mask:0xf bank_mask:0xf
    v_mov_b32 v14, v11
    s_nop 1
    v_permlane16_swap_b32 v11, v14
    s_nop 1
    v_add_f32 v11, v11, v14

    v_mul_f32 v11, 0x3ae38e39, v11
    v_cvt_pk_bf16_f32 v12, v10, v11
    v_lshlrev_b32 v10, 16, v12
    v_and_b32 v11, 0xffff0000, v12
    v_add_f32 v11, 0x3727c5ac, v11

    v_cvt_pk_bf16_f32 v11, v11, v11
    v_and_b32 v11, 0xffff0000, v11
    v_sqrt_f32 v11, v11
    s_nop 0
    v_cvt_pk_bf16_f32 v11, v11, v11
    v_and_b32 v11, 0xffff0000, v11
    v_rcp_f32 v11, v11
    s_nop 0
    v_sub_f32 v40, v40, v10
    v_sub_f32 v41, v41, v10
    v_cvt_pk_bf16_f32 v13, v40, v41
    v_lshlrev_b32 v40, 16, v13
    v_and_b32 v41, 0xffff0000, v13
    v_mul_f32 v40, v40, v11
    v_mul_f32 v41, v41, v11
    v_cvt_pk_bf16_f32 v13, v40, v41
    v_lshlrev_b32 v40, 16, v13
    v_and_b32 v41, 0xffff0000, v13
    v_cvt_pk_f16_f32 v80, v40, v41

    v_sub_f32 v42, v42, v10
    v_sub_f32 v43, v43, v10
    v_cvt_pk_bf16_f32 v14, v42, v43
    v_lshlrev_b32 v42, 16, v14
    v_and_b32 v43, 0xffff0000, v14
    v_mul_f32 v42, v42, v11
    v_mul_f32 v43, v43, v11
    v_cvt_pk_bf16_f32 v14, v42, v43
    v_lshlrev_b32 v42, 16, v14
    v_and_b32 v43, 0xffff0000, v14
    v_cvt_pk_f16_f32 v81, v42, v43

    v_sub_f32 v44, v44, v10
    v_sub_f32 v45, v45, v10
    v_cvt_pk_bf16_f32 v13, v44, v45
    v_lshlrev_b32 v44, 16, v13
    v_and_b32 v45, 0xffff0000, v13
    v_mul_f32 v44, v44, v11
    v_mul_f32 v45, v45, v11
    v_cvt_pk_bf16_f32 v13, v44, v45
    v_lshlrev_b32 v44, 16, v13
    v_and_b32 v45, 0xffff0000, v13
    v_cvt_pk_f16_f32 v82, v44, v45

    v_sub_f32 v46, v46, v10
    v_sub_f32 v47, v47, v10
    v_cvt_pk_bf16_f32 v14, v46, v47
    v_lshlrev_b32 v46, 16, v14
    v_and_b32 v47, 0xffff0000, v14
    v_mul_f32 v46, v46, v11
    v_mul_f32 v47, v47, v11
    v_cvt_pk_bf16_f32 v14, v46, v47
    v_lshlrev_b32 v46, 16, v14
    v_and_b32 v47, 0xffff0000, v14
    v_cvt_pk_f16_f32 v83, v46, v47

    ds_write_b128 v6, v[80:83] offset:9728
    v_sub_f32 v48, v48, v10
    v_sub_f32 v49, v49, v10
    v_cvt_pk_bf16_f32 v13, v48, v49
    v_lshlrev_b32 v48, 16, v13
    v_and_b32 v49, 0xffff0000, v13
    v_mul_f32 v48, v48, v11
    v_mul_f32 v49, v49, v11
    v_cvt_pk_bf16_f32 v13, v48, v49
    v_lshlrev_b32 v48, 16, v13
    v_and_b32 v49, 0xffff0000, v13
    v_cvt_pk_f16_f32 v84, v48, v49

    v_sub_f32 v50, v50, v10
    v_sub_f32 v51, v51, v10
    v_cvt_pk_bf16_f32 v14, v50, v51
    v_lshlrev_b32 v50, 16, v14
    v_and_b32 v51, 0xffff0000, v14
    v_mul_f32 v50, v50, v11
    v_mul_f32 v51, v51, v11
    v_cvt_pk_bf16_f32 v14, v50, v51
    v_lshlrev_b32 v50, 16, v14
    v_and_b32 v51, 0xffff0000, v14
    v_cvt_pk_f16_f32 v85, v50, v51

    v_sub_f32 v52, v52, v10
    v_sub_f32 v53, v53, v10
    v_cvt_pk_bf16_f32 v13, v52, v53
    v_lshlrev_b32 v52, 16, v13
    v_and_b32 v53, 0xffff0000, v13
    v_mul_f32 v52, v52, v11
    v_mul_f32 v53, v53, v11
    v_cvt_pk_bf16_f32 v13, v52, v53
    v_lshlrev_b32 v52, 16, v13
    v_and_b32 v53, 0xffff0000, v13
    v_cvt_pk_f16_f32 v86, v52, v53

    v_sub_f32 v54, v54, v10
    v_sub_f32 v55, v55, v10
    v_cvt_pk_bf16_f32 v14, v54, v55
    v_lshlrev_b32 v54, 16, v14
    v_and_b32 v55, 0xffff0000, v14
    v_mul_f32 v54, v54, v11
    v_mul_f32 v55, v55, v11
    v_cvt_pk_bf16_f32 v14, v54, v55
    v_lshlrev_b32 v54, 16, v14
    v_and_b32 v55, 0xffff0000, v14
    v_cvt_pk_f16_f32 v87, v54, v55

    ds_write_b128 v6, v[84:87] offset:10240
    v_sub_f32 v56, v56, v10
    v_sub_f32 v57, v57, v10
    v_cvt_pk_bf16_f32 v13, v56, v57
    v_lshlrev_b32 v56, 16, v13
    v_and_b32 v57, 0xffff0000, v13
    v_mul_f32 v56, v56, v11
    v_mul_f32 v57, v57, v11
    v_cvt_pk_bf16_f32 v13, v56, v57
    v_lshlrev_b32 v56, 16, v13
    v_and_b32 v57, 0xffff0000, v13
    v_cvt_pk_f16_f32 v88, v56, v57

    v_sub_f32 v58, v58, v10
    v_sub_f32 v59, v59, v10
    v_cvt_pk_bf16_f32 v14, v58, v59
    v_lshlrev_b32 v58, 16, v14
    v_and_b32 v59, 0xffff0000, v14
    v_mul_f32 v58, v58, v11
    v_mul_f32 v59, v59, v11
    v_cvt_pk_bf16_f32 v14, v58, v59
    v_lshlrev_b32 v58, 16, v14
    v_and_b32 v59, 0xffff0000, v14
    v_cvt_pk_f16_f32 v89, v58, v59

    v_sub_f32 v60, v60, v10
    v_sub_f32 v61, v61, v10
    v_cvt_pk_bf16_f32 v13, v60, v61
    v_lshlrev_b32 v60, 16, v13
    v_and_b32 v61, 0xffff0000, v13
    v_mul_f32 v60, v60, v11
    v_mul_f32 v61, v61, v11
    v_cvt_pk_bf16_f32 v13, v60, v61
    v_lshlrev_b32 v60, 16, v13
    v_and_b32 v61, 0xffff0000, v13
    v_cvt_pk_f16_f32 v90, v60, v61

    v_sub_f32 v62, v62, v10
    v_sub_f32 v63, v63, v10
    v_cvt_pk_bf16_f32 v14, v62, v63
    v_lshlrev_b32 v62, 16, v14
    v_and_b32 v63, 0xffff0000, v14
    v_mul_f32 v62, v62, v11
    v_mul_f32 v63, v63, v11
    v_cvt_pk_bf16_f32 v14, v62, v63
    v_lshlrev_b32 v62, 16, v14
    v_and_b32 v63, 0xffff0000, v14
    v_cvt_pk_f16_f32 v91, v62, v63

    s_and_saveexec_b64 s[18:19], vcc
    ds_write_b128 v6, v[24:27] offset:1024
    ds_write_b128 v6, v[88:91] offset:10752
    s_mov_b64 exec, s[18:19]
    v_bfe_u32 v6, v1, 2, 2
    v_mul_u32_u24 v6, 1216, v6
    v_and_b32 v7, 3, v1
    v_lshl_add_u32 v6, v7, 3, v6
    v_bfe_u32 v7, v1, 4, 1
    v_xor_b32 v8, 1, v7
    v_mul_u32_u24 v8, 9728, v8
    v_add_u32 v6, v6, v8
    v_lshrrev_b32 v8, 5, v1
    v_lshl_add_u32 v6, v8, 5, v6
    v_lshl_add_u32 v6, v2, 6, v6
    v_and_b32 v9, 15, v1
    v_lshl_add_u32 v9, v8, 4, v9
    v_lshl_add_u32 v9, v2, 5, v9
    v_lshlrev_b32 v9, 5, v9
    v_lshl_add_u32 v8, v7, 4, v9
    s_mul_i32 s18, s16, 18432
    s_add_u32 s18, s18, 0
    v_mov_b32 v13, 0
    s_waitcnt lgkmcnt(0)
    s_barrier

    ds_read_b64_tr_b16 v[16:17], v6 offset:0
    ds_read_b64_tr_b16 v[18:19], v6 offset:4864
    ds_read_b64_tr_b16 v[20:21], v6 offset:256
    ds_read_b64_tr_b16 v[22:23], v6 offset:5120
    ds_read_b64_tr_b16 v[24:25], v6 offset:512
    ds_read_b64_tr_b16 v[26:27], v6 offset:5376
    ds_read_b64_tr_b16 v[28:29], v6 offset:768
    ds_read_b64_tr_b16 v[30:31], v6 offset:5632
    s_cmp_ge_u32 s21, 2
    s_cbranch_scc1 Lka_kernel_P_st
    ds_read_b64_tr_b16 v[32:33], v6 offset:1024
    ds_read_b64_tr_b16 v[34:35], v6 offset:5888
    s_waitcnt lgkmcnt(0)
    s_add_u32 s22, s18, 16384
    buffer_store_dwordx4 v[32:35], v8, s[12:15], s22 offen sc1
Lka_kernel_P_st:
    s_waitcnt lgkmcnt(0)
    buffer_store_dwordx4 v[16:19], v8, s[12:15], s18 offen sc1
    s_add_u32 s18, s18, 4096
    buffer_store_dwordx4 v[20:23], v8, s[12:15], s18 offen sc1
    s_add_u32 s18, s18, 4096
    buffer_store_dwordx4 v[24:27], v8, s[12:15], s18 offen sc1
    s_add_u32 s18, s18, 4096
    buffer_store_dwordx4 v[28:31], v8, s[12:15], s18 offen sc1
    s_add_u32 s18, s18, 4096
Lka_kernel_P_sig:
    s_cmp_lg_u32 s21, 0
    s_cbranch_scc1 Lka_kernel_P_w
    s_mov_b32 s22, 0

Lka_kernel_P_np:
    buffer_load_dword v12, v13, s[28:31], 0 offen sc1
    s_waitcnt vmcnt(0)
    v_readfirstlane_b32 s23, v12
    s_cmp_lg_u32 s23, 0
    s_cbranch_scc1 Lka_kernel_P_w
    s_add_u32 s22, s22, 1
    s_cmp_lt_u32 s22, 0x40000
    s_cbranch_scc0 Lka_kernel_P_w
    s_sleep 4
    s_branch Lka_kernel_P_np

Lka_kernel_P_w:
    s_waitcnt vmcnt(0)
    s_barrier
    s_cmp_lg_u32 s21, 0
    s_cbranch_scc1 Lka_kernel_P_pf
    v_cmp_gt_u32 vcc, 8, v1
    s_and_saveexec_b64 s[18:19], vcc
    v_lshlrev_b32 v6, 10, v1
    s_lshl_b32 s22, s2, 2
    s_add_u32 s22, s22, 5308416
    buffer_store_dword v12, v6, s[12:15], s22 offen sc1
    s_mov_b64 exec, s[18:19]
Lka_kernel_P_pf:

    s_branch Lka_kernel_end

Lka_kernel_B:
    s_load_dwordx4 s[4:7], s[0:1], 64
    s_load_dwordx2 s[24:25], s[0:1], 80
    s_load_dwordx4 s[32:35], s[0:1], 96
    s_sub_u32 s26, s2, 832
    s_mov_b32 s28, 0
    s_and_b32 s18, s26, 7
    s_mul_i32 s18, s18, 9
    s_lshr_b32 s19, s26, 3
    s_cmp_ge_u32 s19, 9
    s_cselect_b32 s20, 1, 0
    s_cselect_b32 s27, 9, 0
    s_sub_u32 s19, s19, s27
    s_add_u32 s18, s18, s19
    v_lshrrev_b32 v1, 3, v0
    v_and_b32 v2, 7, v0
    v_mul_u32_u24 v3, 9216, v1
    v_lshl_add_u32 v3, v2, 4, v3
    s_waitcnt lgkmcnt(0)
    s_cmp_eq_u32 s20, 1
    s_cselect_b32 s8, s6, s4
    s_cselect_b32 s9, s7, s5
    s_mov_b32 s10, 5308416
    s_mov_b32 s11, 0x20000

    s_mov_b32 s12, s34
    s_mov_b32 s13, s35
    s_mov_b32 s14, 48107520
    s_mov_b32 s15, 0x20000
    s_getpc_b64 s[44:45]
Lka_kernel_pc:
    s_add_u32 s44, s44, k3_kernel-Lka_kernel_pc
    s_addc_u32 s45, s45, 0
    s_lshr_b32 s46, s26, 3
    s_min_u32 s46, s46, 6
    s_lshl_b32 s46, s46, 13
    v_and_b32 v60, 63, v0
    v_lshlrev_b32 v60, 7, v60
    v_add_u32 v60, s46, v60
    global_load_dword v92, v60, s[44:45]

    s_mov_b32 s36, s32
    s_mov_b32 s37, s33
    s_mov_b32 s38, 256
    s_mov_b32 s39, 0x20000
    v_and_b32 v1, 63, v0
    v_lshrrev_b32 v60, 6, v0
    s_nop 0
    v_readfirstlane_b32 s40, v60
    s_nop 3
    s_cmp_lg_u32 s40, 0
    s_cbranch_scc1 Lka_kernel_B_nopoll
    v_mov_b32 v64, 0
    s_mov_b32 s41, 0

Lka_kernel_B1_nc:
    buffer_load_dword v60, v64, s[36:39], 0 offen sc1
    s_waitcnt vmcnt(0)
    v_readfirstlane_b32 s42, v60
    s_cmp_lg_u32 s42, 0
    s_cbranch_scc1 Lka_kernel_B1_ok
    s_add_u32 s41, s41, 1
    s_cmp_lt_u32 s41, 0x10000
    s_cbranch_scc0 Lka_kernel_B1_ok
    s_sleep 8
    s_branch Lka_kernel_B1_nc

Lka_kernel_B1_ok:
    s_and_b32 s43, s2, 7
    s_lshl_b32 s43, s43, 10
    s_add_u32 s43, s43, 5308416
    v_and_b32 v64, 0, v1
    s_and_b32 s44, s26, 31
    s_lshl_b32 s44, s44, 3
    v_add_u32 v64, s44, v64
    v_and_b32 v64, 255, v64
    v_lshlrev_b32 v64, 2, v64

Lka_kernel_B1_pl:
    buffer_load_dword v60, v64, s[12:15], s43 offen sc1
    s_waitcnt vmcnt(0)
    v_cmp_ne_u32 vcc, s42, v60
    s_cbranch_vccz Lka_kernel_B1_go
    s_add_u32 s41, s41, 1
    s_cmp_lt_u32 s41, 0x10000
    s_cbranch_scc0 Lka_kernel_B1_go
    s_sleep 24
    s_branch Lka_kernel_B1_pl

Lka_kernel_B1_go:
Lka_kernel_B_nopoll:
    s_barrier
    v_lshrrev_b32 v1, 3, v0
    s_lshl_b32 s21, s18, 7
    buffer_load_dwordx4 v[16:19], v3, s[8:11], s21 offen
    s_add_u32 s21, s21, 294912
    buffer_load_dwordx4 v[20:23], v3, s[8:11], s21 offen
    s_add_u32 s21, s21, 294912
    buffer_load_dwordx4 v[24:27], v3, s[8:11], s21 offen
    s_add_u32 s21, s21, 294912
    buffer_load_dwordx4 v[28:31], v3, s[8:11], s21 offen
    s_add_u32 s21, s21, 294912
    buffer_load_dwordx4 v[32:35], v3, s[8:11], s21 offen
    s_add_u32 s21, s21, 294912
    buffer_load_dwordx4 v[36:39], v3, s[8:11], s21 offen
    s_add_u32 s21, s21, 294912
    buffer_load_dwordx4 v[40:43], v3, s[8:11], s21 offen
    s_add_u32 s21, s21, 294912
    buffer_load_dwordx4 v[44:47], v3, s[8:11], s21 offen
    s_add_u32 s21, s21, 294912
    buffer_load_dwordx4 v[48:51], v3, s[8:11], s21 offen
    s_add_u32 s21, s21, 294912
    buffer_load_dwordx4 v[52:55], v3, s[8:11], s21 offen
    s_add_u32 s21, s21, 294912
    buffer_load_dwordx4 v[56:59], v3, s[8:11], s21 offen
    s_add_u32 s21, s21, 294912
    buffer_load_dwordx4 v[60:63], v3, s[8:11], s21 offen
    s_add_u32 s21, s21, 294912
    buffer_load_dwordx4 v[64:67], v3, s[8:11], s21 offen
    s_add_u32 s21, s21, 294912
    buffer_load_dwordx4 v[68:71], v3, s[8:11], s21 offen
    s_add_u32 s21, s21, 294912
    buffer_load_dwordx4 v[72:75], v3, s[8:11], s21 offen
    s_add_u32 s21, s21, 294912
    buffer_load_dwordx4 v[76:79], v3, s[8:11], s21 offen
    s_add_u32 s21, s21, 294912
    buffer_load_dwordx4 v[80:83], v3, s[8:11], s21 offen
    s_add_u32 s21, s21, 294912
    buffer_load_dwordx4 v[84:87], v3, s[8:11], s21 offen
    s_waitcnt vmcnt(17)
    v_lshlrev_b32 v4, 16, v16
    v_and_b32 v5, 0xffff0000, v16
    v_lshlrev_b32 v6, 16, v17
    v_and_b32 v7, 0xffff0000, v17
    v_lshlrev_b32 v8, 16, v18
    v_and_b32 v9, 0xffff0000, v18
    v_lshlrev_b32 v10, 16, v19
    v_and_b32 v11, 0xffff0000, v19
    s_waitcnt vmcnt(16)
    v_lshlrev_b32 v12, 16, v20
    v_and_b32 v13, 0xffff0000, v20
    v_add_f32 v4, v4, v12
    v_add_f32 v5, v5, v13
    v_lshlrev_b32 v12, 16, v21
    v_and_b32 v13, 0xffff0000, v21
    v_add_f32 v6, v6, v12
    v_add_f32 v7, v7, v13
    v_lshlrev_b32 v12, 16, v22
    v_and_b32 v13, 0xffff0000, v22
    v_add_f32 v8, v8, v12
    v_add_f32 v9, v9, v13
    v_lshlrev_b32 v12, 16, v23
    v_and_b32 v13, 0xffff0000, v23
    v_add_f32 v10, v10, v12
    v_add_f32 v11, v11, v13
    s_waitcnt vmcnt(15)
    v_lshlrev_b32 v12, 16, v24
    v_and_b32 v13, 0xffff0000, v24
    v_add_f32 v4, v4, v12
    v_add_f32 v5, v5, v13
    v_lshlrev_b32 v12, 16, v25
    v_and_b32 v13, 0xffff0000, v25
    v_add_f32 v6, v6, v12
    v_add_f32 v7, v7, v13
    v_lshlrev_b32 v12, 16, v26
    v_and_b32 v13, 0xffff0000, v26
    v_add_f32 v8, v8, v12
    v_add_f32 v9, v9, v13
    v_lshlrev_b32 v12, 16, v27
    v_and_b32 v13, 0xffff0000, v27
    v_add_f32 v10, v10, v12
    v_add_f32 v11, v11, v13
    s_waitcnt vmcnt(14)
    v_lshlrev_b32 v12, 16, v28
    v_and_b32 v13, 0xffff0000, v28
    v_add_f32 v4, v4, v12
    v_add_f32 v5, v5, v13
    v_lshlrev_b32 v12, 16, v29
    v_and_b32 v13, 0xffff0000, v29
    v_add_f32 v6, v6, v12
    v_add_f32 v7, v7, v13
    v_lshlrev_b32 v12, 16, v30
    v_and_b32 v13, 0xffff0000, v30
    v_add_f32 v8, v8, v12
    v_add_f32 v9, v9, v13
    v_lshlrev_b32 v12, 16, v31
    v_and_b32 v13, 0xffff0000, v31
    v_add_f32 v10, v10, v12
    v_add_f32 v11, v11, v13
    s_waitcnt vmcnt(13)
    v_lshlrev_b32 v12, 16, v32
    v_and_b32 v13, 0xffff0000, v32
    v_add_f32 v4, v4, v12
    v_add_f32 v5, v5, v13
    v_lshlrev_b32 v12, 16, v33
    v_and_b32 v13, 0xffff0000, v33
    v_add_f32 v6, v6, v12
    v_add_f32 v7, v7, v13
    v_lshlrev_b32 v12, 16, v34
    v_and_b32 v13, 0xffff0000, v34
    v_add_f32 v8, v8, v12
    v_add_f32 v9, v9, v13
    v_lshlrev_b32 v12, 16, v35
    v_and_b32 v13, 0xffff0000, v35
    v_add_f32 v10, v10, v12
    v_add_f32 v11, v11, v13
    s_waitcnt vmcnt(12)
    v_lshlrev_b32 v12, 16, v36
    v_and_b32 v13, 0xffff0000, v36
    v_add_f32 v4, v4, v12
    v_add_f32 v5, v5, v13
    v_lshlrev_b32 v12, 16, v37
    v_and_b32 v13, 0xffff0000, v37
    v_add_f32 v6, v6, v12
    v_add_f32 v7, v7, v13
    v_lshlrev_b32 v12, 16, v38
    v_and_b32 v13, 0xffff0000, v38
    v_add_f32 v8, v8, v12
    v_add_f32 v9, v9, v13
    v_lshlrev_b32 v12, 16, v39
    v_and_b32 v13, 0xffff0000, v39
    v_add_f32 v10, v10, v12
    v_add_f32 v11, v11, v13
    s_waitcnt vmcnt(11)
    v_lshlrev_b32 v12, 16, v40
    v_and_b32 v13, 0xffff0000, v40
    v_add_f32 v4, v4, v12
    v_add_f32 v5, v5, v13
    v_lshlrev_b32 v12, 16, v41
    v_and_b32 v13, 0xffff0000, v41
    v_add_f32 v6, v6, v12
    v_add_f32 v7, v7, v13
    v_lshlrev_b32 v12, 16, v42
    v_and_b32 v13, 0xffff0000, v42
    v_add_f32 v8, v8, v12
    v_add_f32 v9, v9, v13
    v_lshlrev_b32 v12, 16, v43
    v_and_b32 v13, 0xffff0000, v43
    v_add_f32 v10, v10, v12
    v_add_f32 v11, v11, v13
    s_waitcnt vmcnt(10)
    v_lshlrev_b32 v12, 16, v44
    v_and_b32 v13, 0xffff0000, v44
    v_add_f32 v4, v4, v12
    v_add_f32 v5, v5, v13
    v_lshlrev_b32 v12, 16, v45
    v_and_b32 v13, 0xffff0000, v45
    v_add_f32 v6, v6, v12
    v_add_f32 v7, v7, v13
    v_lshlrev_b32 v12, 16, v46
    v_and_b32 v13, 0xffff0000, v46
    v_add_f32 v8, v8, v12
    v_add_f32 v9, v9, v13
    v_lshlrev_b32 v12, 16, v47
    v_and_b32 v13, 0xffff0000, v47
    v_add_f32 v10, v10, v12
    v_add_f32 v11, v11, v13
    s_waitcnt vmcnt(9)
    v_lshlrev_b32 v12, 16, v48
    v_and_b32 v13, 0xffff0000, v48
    v_add_f32 v4, v4, v12
    v_add_f32 v5, v5, v13
    v_lshlrev_b32 v12, 16, v49
    v_and_b32 v13, 0xffff0000, v49
    v_add_f32 v6, v6, v12
    v_add_f32 v7, v7, v13
    v_lshlrev_b32 v12, 16, v50
    v_and_b32 v13, 0xffff0000, v50
    v_add_f32 v8, v8, v12
    v_add_f32 v9, v9, v13
    v_lshlrev_b32 v12, 16, v51
    v_and_b32 v13, 0xffff0000, v51
    v_add_f32 v10, v10, v12
    v_add_f32 v11, v11, v13
    s_waitcnt vmcnt(8)
    v_lshlrev_b32 v12, 16, v52
    v_and_b32 v13, 0xffff0000, v52
    v_add_f32 v4, v4, v12
    v_add_f32 v5, v5, v13
    v_lshlrev_b32 v12, 16, v53
    v_and_b32 v13, 0xffff0000, v53
    v_add_f32 v6, v6, v12
    v_add_f32 v7, v7, v13
    v_lshlrev_b32 v12, 16, v54
    v_and_b32 v13, 0xffff0000, v54
    v_add_f32 v8, v8, v12
    v_add_f32 v9, v9, v13
    v_lshlrev_b32 v12, 16, v55
    v_and_b32 v13, 0xffff0000, v55
    v_add_f32 v10, v10, v12
    v_add_f32 v11, v11, v13
    s_waitcnt vmcnt(7)
    v_lshlrev_b32 v12, 16, v56
    v_and_b32 v13, 0xffff0000, v56
    v_add_f32 v4, v4, v12
    v_add_f32 v5, v5, v13
    v_lshlrev_b32 v12, 16, v57
    v_and_b32 v13, 0xffff0000, v57
    v_add_f32 v6, v6, v12
    v_add_f32 v7, v7, v13
    v_lshlrev_b32 v12, 16, v58
    v_and_b32 v13, 0xffff0000, v58
    v_add_f32 v8, v8, v12
    v_add_f32 v9, v9, v13
    v_lshlrev_b32 v12, 16, v59
    v_and_b32 v13, 0xffff0000, v59
    v_add_f32 v10, v10, v12
    v_add_f32 v11, v11, v13
    s_waitcnt vmcnt(6)
    v_lshlrev_b32 v12, 16, v60
    v_and_b32 v13, 0xffff0000, v60
    v_add_f32 v4, v4, v12
    v_add_f32 v5, v5, v13
    v_lshlrev_b32 v12, 16, v61
    v_and_b32 v13, 0xffff0000, v61
    v_add_f32 v6, v6, v12
    v_add_f32 v7, v7, v13
    v_lshlrev_b32 v12, 16, v62
    v_and_b32 v13, 0xffff0000, v62
    v_add_f32 v8, v8, v12
    v_add_f32 v9, v9, v13
    v_lshlrev_b32 v12, 16, v63
    v_and_b32 v13, 0xffff0000, v63
    v_add_f32 v10, v10, v12
    v_add_f32 v11, v11, v13
    s_waitcnt vmcnt(5)
    v_lshlrev_b32 v12, 16, v64
    v_and_b32 v13, 0xffff0000, v64
    v_add_f32 v4, v4, v12
    v_add_f32 v5, v5, v13
    v_lshlrev_b32 v12, 16, v65
    v_and_b32 v13, 0xffff0000, v65
    v_add_f32 v6, v6, v12
    v_add_f32 v7, v7, v13
    v_lshlrev_b32 v12, 16, v66
    v_and_b32 v13, 0xffff0000, v66
    v_add_f32 v8, v8, v12
    v_add_f32 v9, v9, v13
    v_lshlrev_b32 v12, 16, v67
    v_and_b32 v13, 0xffff0000, v67
    v_add_f32 v10, v10, v12
    v_add_f32 v11, v11, v13
    s_waitcnt vmcnt(4)
    v_lshlrev_b32 v12, 16, v68
    v_and_b32 v13, 0xffff0000, v68
    v_add_f32 v4, v4, v12
    v_add_f32 v5, v5, v13
    v_lshlrev_b32 v12, 16, v69
    v_and_b32 v13, 0xffff0000, v69
    v_add_f32 v6, v6, v12
    v_add_f32 v7, v7, v13
    v_lshlrev_b32 v12, 16, v70
    v_and_b32 v13, 0xffff0000, v70
    v_add_f32 v8, v8, v12
    v_add_f32 v9, v9, v13
    v_lshlrev_b32 v12, 16, v71
    v_and_b32 v13, 0xffff0000, v71
    v_add_f32 v10, v10, v12
    v_add_f32 v11, v11, v13
    s_waitcnt vmcnt(3)
    v_lshlrev_b32 v12, 16, v72
    v_and_b32 v13, 0xffff0000, v72
    v_add_f32 v4, v4, v12
    v_add_f32 v5, v5, v13
    v_lshlrev_b32 v12, 16, v73
    v_and_b32 v13, 0xffff0000, v73
    v_add_f32 v6, v6, v12
    v_add_f32 v7, v7, v13
    v_lshlrev_b32 v12, 16, v74
    v_and_b32 v13, 0xffff0000, v74
    v_add_f32 v8, v8, v12
    v_add_f32 v9, v9, v13
    v_lshlrev_b32 v12, 16, v75
    v_and_b32 v13, 0xffff0000, v75
    v_add_f32 v10, v10, v12
    v_add_f32 v11, v11, v13
    s_waitcnt vmcnt(2)
    v_lshlrev_b32 v12, 16, v76
    v_and_b32 v13, 0xffff0000, v76
    v_add_f32 v4, v4, v12
    v_add_f32 v5, v5, v13
    v_lshlrev_b32 v12, 16, v77
    v_and_b32 v13, 0xffff0000, v77
    v_add_f32 v6, v6, v12
    v_add_f32 v7, v7, v13
    v_lshlrev_b32 v12, 16, v78
    v_and_b32 v13, 0xffff0000, v78
    v_add_f32 v8, v8, v12
    v_add_f32 v9, v9, v13
    v_lshlrev_b32 v12, 16, v79
    v_and_b32 v13, 0xffff0000, v79
    v_add_f32 v10, v10, v12
    v_add_f32 v11, v11, v13
    s_waitcnt vmcnt(1)
    v_lshlrev_b32 v12, 16, v80
    v_and_b32 v13, 0xffff0000, v80
    v_add_f32 v4, v4, v12
    v_add_f32 v5, v5, v13
    v_lshlrev_b32 v12, 16, v81
    v_and_b32 v13, 0xffff0000, v81
    v_add_f32 v6, v6, v12
    v_add_f32 v7, v7, v13
    v_lshlrev_b32 v12, 16, v82
    v_and_b32 v13, 0xffff0000, v82
    v_add_f32 v8, v8, v12
    v_add_f32 v9, v9, v13
    v_lshlrev_b32 v12, 16, v83
    v_and_b32 v13, 0xffff0000, v83
    v_add_f32 v10, v10, v12
    v_add_f32 v11, v11, v13
    s_waitcnt vmcnt(0)
    v_lshlrev_b32 v12, 16, v84
    v_and_b32 v13, 0xffff0000, v84
    v_add_f32 v4, v4, v12
    v_add_f32 v5, v5, v13
    v_lshlrev_b32 v12, 16, v85
    v_and_b32 v13, 0xffff0000, v85
    v_add_f32 v6, v6, v12
    v_add_f32 v7, v7, v13
    v_lshlrev_b32 v12, 16, v86
    v_and_b32 v13, 0xffff0000, v86
    v_add_f32 v8, v8, v12
    v_add_f32 v9, v9, v13
    v_lshlrev_b32 v12, 16, v87
    v_and_b32 v13, 0xffff0000, v87
    v_add_f32 v10, v10, v12
    v_add_f32 v11, v11, v13
    v_lshlrev_b32 v12, 8, v1
    v_lshl_add_u32 v12, v2, 5, v12
    ds_write_b128 v12, v[4:7]
    ds_write_b128 v12, v[8:11] offset:16
    s_waitcnt lgkmcnt(0)
    s_barrier
    v_cmp_gt_u32 vcc, 64, v0
    s_and_saveexec_b64 s[22:23], vcc
    s_cbranch_execz Lka_kernel_end
    v_lshlrev_b32 v12, 2, v0

    ds_read_b32 v16, v12 offset:0
    ds_read_b32 v17, v12 offset:256
    ds_read_b32 v18, v12 offset:512
    ds_read_b32 v19, v12 offset:768
    ds_read_b32 v20, v12 offset:1024
    ds_read_b32 v21, v12 offset:1280
    ds_read_b32 v22, v12 offset:1536
    ds_read_b32 v23, v12 offset:1792
    ds_read_b32 v24, v12 offset:2048
    ds_read_b32 v25, v12 offset:2304
    ds_read_b32 v26, v12 offset:2560
    ds_read_b32 v27, v12 offset:2816
    ds_read_b32 v28, v12 offset:3072
    ds_read_b32 v29, v12 offset:3328
    ds_read_b32 v30, v12 offset:3584
    s_waitcnt lgkmcnt(0)
    ds_read_b32 v31, v12 offset:3840
    ds_read_b32 v32, v12 offset:4096
    ds_read_b32 v33, v12 offset:4352
    ds_read_b32 v34, v12 offset:4608
    ds_read_b32 v35, v12 offset:4864
    ds_read_b32 v36, v12 offset:5120
    ds_read_b32 v37, v12 offset:5376
    ds_read_b32 v38, v12 offset:5632
    ds_read_b32 v39, v12 offset:5888
    ds_read_b32 v40, v12 offset:6144
    ds_read_b32 v41, v12 offset:6400
    ds_read_b32 v42, v12 offset:6656
    ds_read_b32 v43, v12 offset:6912
    ds_read_b32 v44, v12 offset:7168
    ds_read_b32 v45, v12 offset:7424
    s_waitcnt lgkmcnt(0)
    ds_read_b32 v46, v12 offset:7680
    ds_read_b32 v47, v12 offset:7936
    s_waitcnt lgkmcnt(0)
    v_add_f32 v16, v16, v32
    v_add_f32 v17, v17, v33
    v_add_f32 v18, v18, v34
    v_add_f32 v19, v19, v35
    v_add_f32 v20, v20, v36
    v_add_f32 v21, v21, v37
    v_add_f32 v22, v22, v38
    v_add_f32 v23, v23, v39
    v_add_f32 v24, v24, v40
    v_add_f32 v25, v25, v41
    v_add_f32 v26, v26, v42
    v_add_f32 v27, v27, v43
    v_add_f32 v28, v28, v44
    v_add_f32 v29, v29, v45
    v_add_f32 v30, v30, v46
    v_add_f32 v31, v31, v47
    v_add_f32 v16, v16, v24
    v_add_f32 v17, v17, v25
    v_add_f32 v18, v18, v26
    v_add_f32 v19, v19, v27
    v_add_f32 v20, v20, v28
    v_add_f32 v21, v21, v29
    v_add_f32 v22, v22, v30
    v_add_f32 v23, v23, v31
    v_add_f32 v16, v16, v20
    v_add_f32 v17, v17, v21
    v_add_f32 v18, v18, v22
    v_add_f32 v19, v19, v23
    v_add_f32 v16, v16, v18
    v_add_f32 v17, v17, v19
    v_add_f32 v16, v16, v17
    v_cvt_pk_bf16_f32 v13, v16, v16
    v_and_b32 v14, 0xffff0000, v13
    v_sub_f32 v14, v16, v14
    v_cvt_pk_bf16_f32 v14, v14, v14
    v_and_b32 v13, 0xffff, v13
    v_and_b32 v14, 0xffff0000, v14
    v_or_b32 v13, v13, v14
    s_lshl_b32 s22, s18, 6
    v_add_u32 v15, s22, v0
    s_mov_b32 s22, 14913081
    v_mul_hi_u32 v16, v15, s22
    v_mul_u32_u24 v17, 288, v16
    v_sub_u32 v17, v15, v17
    v_and_b32 v18, 1, v16
    v_lshlrev_b32 v19, 5, v18
    v_sub_u32 v19, v17, v19
    v_cmp_gt_i32 vcc, 0, v19
    v_add_u32 v20, 288, v19
    s_nop 0
    v_cndmask_b32 v19, v19, v20, vcc
    v_lshrrev_b32 v20, 4, v19
    v_and_b32 v19, 15, v19
    v_lshl_add_u32 v19, v16, 4, v19
    v_mul_u32_u24 v19, 36, v19
    v_lshl_add_u32 v19, v20, 1, v19
    v_add_u32 v19, s20, v19

    v_lshlrev_b32 v12, 2, v19
    s_mov_b32 s21, 10031104
    buffer_store_dword v13, v12, s[12:15], s21 offen
    s_branch Lka_kernel_end

Lka_kernel_V:
    s_load_dwordx4 s[4:7], s[0:1], 8
    s_load_dwordx4 s[24:27], s[0:1], 24
    s_load_dwordx4 s[28:31], s[0:1], 40
    s_load_dwordx4 s[48:51], s[0:1], 96
    s_sub_u32 s16, s2, 256
    s_and_b32 s18, s16, 7
    s_mul_i32 s18, s18, 72
    s_lshr_b32 s16, s16, 3
    s_add_u32 s16, s16, s18
    v_and_b32 v1, 63, v0
    v_lshrrev_b32 v2, 6, v0
    v_and_b32 v3, 1, v2
    v_lshl_add_u32 v4, v3, 6, v1
    v_lshlrev_b32 v5, 1, v4
    v_xor_b32 v6, 128, v5
    v_readfirstlane_b32 s17, v2
    s_lshl_b32 s18, s16, 8
    s_lshl_b32 s19, s16, 1
    v_mov_b32 v7, s19
    s_waitcnt lgkmcnt(0)

    s_mov_b32 s8, s4
    s_mov_b32 s9, s5
    s_mov_b32 s10, 147456
    s_mov_b32 s11, 0x20000
    s_mov_b32 s12, s6
    s_mov_b32 s13, s7
    s_mov_b32 s14, 147456
    s_mov_b32 s15, 0x20000
    s_mov_b32 s32, s24
    s_mov_b32 s33, s25
    s_mov_b32 s34, 147456
    s_mov_b32 s35, 0x20000
    s_mov_b32 s36, s26
    s_mov_b32 s37, s27
    s_mov_b32 s38, 147456
    s_mov_b32 s39, 0x20000
    s_mov_b32 s40, s28
    s_mov_b32 s41, s29
    s_mov_b32 s42, 1152
    s_mov_b32 s43, 0x20000
    s_mov_b32 s52, s30
    s_mov_b32 s53, s31
    s_mov_b32 s54, 1152
    s_mov_b32 s55, 0x20000
    s_mov_b32 s44, s50
    s_mov_b32 s45, s51
    s_mov_b32 s46, 48107520
    s_mov_b32 s47, 0x20000
    s_mov_b32 s56, s48
    s_mov_b32 s57, s49
    s_mov_b32 s58, 256
    s_mov_b32 s59, 0x20000
    buffer_load_ushort v8, v5, s[8:11], s18 offen
    buffer_load_ushort v14, v7, s[40:43], 0 offen
    buffer_load_ushort v9, v5, s[12:15], s18 offen
    buffer_load_ushort v10, v5, s[32:35], s18 offen
    buffer_load_ushort v11, v5, s[36:39], s18 offen
    buffer_load_ushort v12, v6, s[32:35], s18 offen
    buffer_load_ushort v13, v6, s[36:39], s18 offen
    buffer_load_ushort v62, v7, s[52:55], 0 offen

    v_lshlrev_b32 v40, 2, v0
    v_add_u32 v38, 256, v0
    v_bfe_u32 v39, v38, 1, 1
    v_add_u32 v38, v38, v39
    v_add_u32 v38, 0, v38
    v_lshrrev_b32 v38, 1, v38
    v_lshlrev_b32 v41, 3, v38

    v_add_u32 v38, 512, v0
    v_bfe_u32 v39, v38, 2, 1
    v_add_u32 v38, v38, v39
    v_add_u32 v38, 1, v38
    v_lshrrev_b32 v38, 2, v38
    v_lshlrev_b32 v42, 4, v38

    v_add_u32 v38, 768, v0
    v_bfe_u32 v39, v38, 2, 1
    v_add_u32 v38, v38, v39
    v_add_u32 v38, 1, v38
    v_lshrrev_b32 v38, 2, v38
    v_lshlrev_b32 v43, 4, v38

    v_add_u32 v38, 1024, v0
    v_bfe_u32 v39, v38, 3, 1
    v_add_u32 v38, v38, v39
    v_add_u32 v38, 3, v38
    v_lshrrev_b32 v38, 3, v38
    v_lshlrev_b32 v44, 5, v38

    v_add_u32 v38, 1280, v0
    v_bfe_u32 v39, v38, 3, 1
    v_add_u32 v38, v38, v39
    v_add_u32 v38, 3, v38
    v_lshrrev_b32 v38, 3, v38
    v_lshlrev_b32 v45, 5, v38

    v_add_u32 v38, 1536, v0
    v_bfe_u32 v39, v38, 3, 1
    v_add_u32 v38, v38, v39
    v_add_u32 v38, 3, v38
    v_lshrrev_b32 v38, 3, v38
    v_lshlrev_b32 v46, 5, v38

    v_add_u32 v38, 1792, v0
    v_bfe_u32 v39, v38, 3, 1
    v_add_u32 v38, v38, v39
    v_add_u32 v38, 3, v38
    v_lshrrev_b32 v38, 3, v38
    v_lshlrev_b32 v47, 5, v38

    s_waitcnt vmcnt(0)
    v_lshlrev_b32 v8, 16, v8
    v_lshlrev_b32 v9, 16, v9
    v_lshlrev_b32 v10, 16, v10
    v_lshlrev_b32 v11, 16, v11
    v_lshlrev_b32 v12, 16, v12
    v_lshlrev_b32 v13, 16, v13
    v_lshlrev_b32 v14, 16, v14
    v_lshlrev_b32 v62, 16, v62
    v_mul_f32 v14, 0x3fb8aa3b, v14
    v_mul_f32 v8, 0x3fb8aa3b, v8
    v_exp_f32 v14, v14
    v_exp_f32 v8, v8
    v_add_f32 v15, |v10|, |v11|
    v_add_f32 v16, |v12|, |v13|
    v_add_f32 v15, v15, v16

    v_cvt_pk_bf16_f32 v14, v14, v14
    v_and_b32 v14, 0xffff0000, v14
    v_cvt_pk_bf16_f32 v8, v8, v8
    v_and_b32 v8, 0xffff0000, v8
    s_nop 1
    v_add_f32_dpp v15, v15, v15 quad_perm:[1,0,3,2] row_mask:0xf bank_mask:0xf
    s_nop 1
    v_add_f32_dpp v15, v15, v15 quad_perm:[2,3,0,1] row_mask:0xf bank_mask:0xf
    s_nop 1
    v_add_f32_dpp v15, v15, v15 row_half_mirror row_mask:0xf bank_mask:0xf
    s_nop 1
    v_add_f32_dpp v15, v15, v15 row_mirror row_mask:0xf bank_mask:0xf
    s_nop 1
    v_readlane_b32 s20, v15, 0
    v_readlane_b32 s21, v15, 16
    v_readlane_b32 s22, v15, 32
    v_readlane_b32 s23, v15, 48
    s_nop 1
    v_mov_b32 v15, s20
    v_add_f32 v15, s21, v15
    v_add_f32 v15, s22, v15
    v_add_f32 v15, s23, v15
    v_mul_f32 v15, v15, v14
    v_add_f32 v15, v15, v15
    v_frexp_exp_i32_f32 v16, v15
    v_sub_u32 v17, 13, v16
    v_mov_b32 v18, 1.0
    v_ldexp_f32 v19, v18, v17
    v_sub_u32 v17, 0, v17
    v_ldexp_f32 v63, v18, v17

    v_mul_f32 v8, v8, v14
    v_mul_f32 v9, v9, v14
    v_mul_f32 v8, 0xbfb8aa3b, v8
    v_mul_f32 v9, 0.15915494, v9

    v_lshlrev_b32 v23, 2, v4
    s_cmp_ge_u32 s17, 2
    s_cbranch_scc1 Lka_kernel_V_part1
    v_mul_f32 v21, 0x3f800000, v8
    v_mul_f32 v22, 0x3f800000, v9
    v_exp_f32 v21, v21
    v_fract_f32 v22, v22
    s_nop 0
    v_cos_f32 v30, v22
    v_sin_f32 v31, v22
    s_nop 0
    v_mul_f32 v30, v30, v21
    v_mul_f32 v31, v31, v21

    v_mul_f32 v21, 0x41800000, v8
    v_mul_f32 v22, 0x41800000, v9
    v_exp_f32 v21, v21
    v_fract_f32 v22, v22
    s_nop 0
    v_cos_f32 v32, v22
    v_sin_f32 v33, v22
    s_nop 0
    v_mul_f32 v32, v32, v21
    v_mul_f32 v33, v33, v21

    v_mul_f32 v25, v19, v14
    v_add_f32 v25, v25, v25
    v_mul_f32 v34, v10, v25
    v_mul_f32 v35, v11, v25
    v_mov_b32 v26, 1.0
    v_mov_b32 v27, 0

    v_cvt_pk_f16_f32 v24, v34, -v35
    ds_write_b32 v23, v24 offset:0
    v_cvt_pk_f16_f32 v25, v26, v27
    ds_write_b32 v23, v25 offset:8704
    v_mul_f32 v36, v34, v32
    v_mul_f32 v37, v34, v33
    v_fma_f32 v36, -v35, v33, v36
    v_fma_f32 v37, v35, v32, v37
    v_mul_f32 v28, v26, v30
    v_mul_f32 v29, v26, v31
    v_fma_f32 v28, -v27, v31, v28
    v_fma_f32 v29, v27, v30, v29
    v_cvt_pk_f16_f32 v24, v36, -v37
    ds_write_b32 v23, v24 offset:544
    v_cvt_pk_f16_f32 v25, v28, v29
    ds_write_b32 v23, v25 offset:9248
    v_mul_f32 v34, v36, v32
    v_mul_f32 v35, v36, v33
    v_fma_f32 v34, -v37, v33, v34
    v_fma_f32 v35, v37, v32, v35
    v_mul_f32 v26, v28, v30
    v_mul_f32 v27, v28, v31
    v_fma_f32 v26, -v29, v31, v26
    v_fma_f32 v27, v29, v30, v27
    v_cvt_pk_f16_f32 v24, v34, -v35
    ds_write_b32 v23, v24 offset:1088
    v_cvt_pk_f16_f32 v25, v26, v27
    ds_write_b32 v23, v25 offset:9792
    v_mul_f32 v36, v34, v32
    v_mul_f32 v37, v34, v33
    v_fma_f32 v36, -v35, v33, v36
    v_fma_f32 v37, v35, v32, v37
    v_mul_f32 v28, v26, v30
    v_mul_f32 v29, v26, v31
    v_fma_f32 v28, -v27, v31, v28
    v_fma_f32 v29, v27, v30, v29
    v_cvt_pk_f16_f32 v24, v36, -v37
    ds_write_b32 v23, v24 offset:1632
    v_cvt_pk_f16_f32 v25, v28, v29
    ds_write_b32 v23, v25 offset:10336
    v_mul_f32 v34, v36, v32
    v_mul_f32 v35, v36, v33
    v_fma_f32 v34, -v37, v33, v34
    v_fma_f32 v35, v37, v32, v35
    v_mul_f32 v26, v28, v30
    v_mul_f32 v27, v28, v31
    v_fma_f32 v26, -v29, v31, v26
    v_fma_f32 v27, v29, v30, v27
    v_cvt_pk_f16_f32 v24, v34, -v35
    ds_write_b32 v23, v24 offset:2176
    v_cvt_pk_f16_f32 v25, v26, v27
    ds_write_b32 v23, v25 offset:10880
    v_mul_f32 v36, v34, v32
    v_mul_f32 v37, v34, v33
    v_fma_f32 v36, -v35, v33, v36
    v_fma_f32 v37, v35, v32, v37
    v_mul_f32 v28, v26, v30
    v_mul_f32 v29, v26, v31
    v_fma_f32 v28, -v27, v31, v28
    v_fma_f32 v29, v27, v30, v29
    v_cvt_pk_f16_f32 v24, v36, -v37
    ds_write_b32 v23, v24 offset:2720
    v_cvt_pk_f16_f32 v25, v28, v29
    ds_write_b32 v23, v25 offset:11424
    v_mul_f32 v34, v36, v32
    v_mul_f32 v35, v36, v33
    v_fma_f32 v34, -v37, v33, v34
    v_fma_f32 v35, v37, v32, v35
    v_mul_f32 v26, v28, v30
    v_mul_f32 v27, v28, v31
    v_fma_f32 v26, -v29, v31, v26
    v_fma_f32 v27, v29, v30, v27
    v_cvt_pk_f16_f32 v24, v34, -v35
    ds_write_b32 v23, v24 offset:3264
    v_cvt_pk_f16_f32 v25, v26, v27
    ds_write_b32 v23, v25 offset:11968
    v_mul_f32 v36, v34, v32
    v_mul_f32 v37, v34, v33
    v_fma_f32 v36, -v35, v33, v36
    v_fma_f32 v37, v35, v32, v37
    v_mul_f32 v28, v26, v30
    v_mul_f32 v29, v26, v31
    v_fma_f32 v28, -v27, v31, v28
    v_fma_f32 v29, v27, v30, v29
    v_cvt_pk_f16_f32 v24, v36, -v37
    ds_write_b32 v23, v24 offset:3808
    v_cvt_pk_f16_f32 v25, v28, v29
    ds_write_b32 v23, v25 offset:12512
    v_mul_f32 v34, v36, v32
    v_mul_f32 v35, v36, v33
    v_fma_f32 v34, -v37, v33, v34
    v_fma_f32 v35, v37, v32, v35
    v_mul_f32 v26, v28, v30
    v_mul_f32 v27, v28, v31
    v_fma_f32 v26, -v29, v31, v26
    v_fma_f32 v27, v29, v30, v27
    v_cvt_pk_f16_f32 v24, v34, -v35
    ds_write_b32 v23, v24 offset:4352
    v_cvt_pk_f16_f32 v25, v26, v27
    ds_write_b32 v23, v25 offset:13056
    v_mul_f32 v36, v34, v32
    v_mul_f32 v37, v34, v33
    v_fma_f32 v36, -v35, v33, v36
    v_fma_f32 v37, v35, v32, v37
    v_mul_f32 v28, v26, v30
    v_mul_f32 v29, v26, v31
    v_fma_f32 v28, -v27, v31, v28
    v_fma_f32 v29, v27, v30, v29
    v_cvt_pk_f16_f32 v24, v36, -v37
    ds_write_b32 v23, v24 offset:4896
    v_cvt_pk_f16_f32 v25, v28, v29
    ds_write_b32 v23, v25 offset:13600
    v_mul_f32 v34, v36, v32
    v_mul_f32 v35, v36, v33
    v_fma_f32 v34, -v37, v33, v34
    v_fma_f32 v35, v37, v32, v35
    v_mul_f32 v26, v28, v30
    v_mul_f32 v27, v28, v31
    v_fma_f32 v26, -v29, v31, v26
    v_fma_f32 v27, v29, v30, v27
    v_cvt_pk_f16_f32 v24, v34, -v35
    ds_write_b32 v23, v24 offset:5440
    v_cvt_pk_f16_f32 v25, v26, v27
    ds_write_b32 v23, v25 offset:14144
    v_mul_f32 v36, v34, v32
    v_mul_f32 v37, v34, v33
    v_fma_f32 v36, -v35, v33, v36
    v_fma_f32 v37, v35, v32, v37
    v_mul_f32 v28, v26, v30
    v_mul_f32 v29, v26, v31
    v_fma_f32 v28, -v27, v31, v28
    v_fma_f32 v29, v27, v30, v29
    v_cvt_pk_f16_f32 v24, v36, -v37
    ds_write_b32 v23, v24 offset:5984
    v_cvt_pk_f16_f32 v25, v28, v29
    ds_write_b32 v23, v25 offset:14688
    v_mul_f32 v34, v36, v32
    v_mul_f32 v35, v36, v33
    v_fma_f32 v34, -v37, v33, v34
    v_fma_f32 v35, v37, v32, v35
    v_mul_f32 v26, v28, v30
    v_mul_f32 v27, v28, v31
    v_fma_f32 v26, -v29, v31, v26
    v_fma_f32 v27, v29, v30, v27
    v_cvt_pk_f16_f32 v24, v34, -v35
    ds_write_b32 v23, v24 offset:6528
    v_cvt_pk_f16_f32 v25, v26, v27
    ds_write_b32 v23, v25 offset:15232
    v_mul_f32 v36, v34, v32
    v_mul_f32 v37, v34, v33
    v_fma_f32 v36, -v35, v33, v36
    v_fma_f32 v37, v35, v32, v37
    v_mul_f32 v28, v26, v30
    v_mul_f32 v29, v26, v31
    v_fma_f32 v28, -v27, v31, v28
    v_fma_f32 v29, v27, v30, v29
    v_cvt_pk_f16_f32 v24, v36, -v37
    ds_write_b32 v23, v24 offset:7072
    v_cvt_pk_f16_f32 v25, v28, v29
    ds_write_b32 v23, v25 offset:15776
    v_mul_f32 v34, v36, v32
    v_mul_f32 v35, v36, v33
    v_fma_f32 v34, -v37, v33, v34
    v_fma_f32 v35, v37, v32, v35
    v_mul_f32 v26, v28, v30
    v_mul_f32 v27, v28, v31
    v_fma_f32 v26, -v29, v31, v26
    v_fma_f32 v27, v29, v30, v27
    v_cvt_pk_f16_f32 v24, v34, -v35
    ds_write_b32 v23, v24 offset:7616
    v_cvt_pk_f16_f32 v25, v26, v27
    ds_write_b32 v23, v25 offset:16320
    v_mul_f32 v36, v34, v32
    v_mul_f32 v37, v34, v33
    v_fma_f32 v36, -v35, v33, v36
    v_fma_f32 v37, v35, v32, v37
    v_mul_f32 v28, v26, v30
    v_mul_f32 v29, v26, v31
    v_fma_f32 v28, -v27, v31, v28
    v_fma_f32 v29, v27, v30, v29
    v_cvt_pk_f16_f32 v24, v36, -v37
    ds_write_b32 v23, v24 offset:8160
    v_cvt_pk_f16_f32 v25, v28, v29
    ds_write_b32 v23, v25 offset:16864
    s_branch Lka_kernel_V_join
Lka_kernel_V_part1:
    v_mul_f32 v21, 0x40000000, v8
    v_mul_f32 v22, 0x40000000, v9
    v_exp_f32 v21, v21
    v_fract_f32 v22, v22
    s_nop 0
    v_cos_f32 v30, v22
    v_sin_f32 v31, v22
    s_nop 0
    v_mul_f32 v30, v30, v21
    v_mul_f32 v31, v31, v21

    v_mul_f32 v21, 0x43800000, v8
    v_mul_f32 v22, 0x43800000, v9
    v_exp_f32 v21, v21
    v_fract_f32 v22, v22
    s_nop 0
    v_cos_f32 v32, v22
    v_sin_f32 v33, v22
    s_nop 0
    v_mul_f32 v32, v32, v21
    v_mul_f32 v33, v33, v21

    v_mul_f32 v34, v30, v30
    v_mul_f32 v35, v30, v31
    v_fma_f32 v34, -v31, v31, v34
    v_fma_f32 v35, v31, v30, v35
    v_mul_f32 v36, v34, v34
    v_mul_f32 v37, v34, v35
    v_fma_f32 v36, -v35, v35, v36
    v_fma_f32 v37, v35, v34, v37
    v_mul_f32 v38, v32, v32
    v_mul_f32 v39, v32, v33
    v_fma_f32 v38, -v33, v33, v38
    v_fma_f32 v39, v33, v32, v39
    v_mul_f32 v48, v38, v38
    v_mul_f32 v49, v38, v39
    v_fma_f32 v48, -v39, v39, v48
    v_fma_f32 v49, v39, v38, v49
    v_mul_f32 v50, v48, v48
    v_mul_f32 v51, v48, v49
    v_fma_f32 v50, -v49, v49, v50
    v_fma_f32 v51, v49, v48, v51
    v_cvt_pk_f16_f32 v24, v50, v51
    ds_write_b32 v23, v24 offset:30464
    v_cvt_pk_f16_f32 v24, v32, v33
    ds_write_b32 v23, v24 offset:17408
    v_mul_f32 v52, v32, v30
    v_mul_f32 v53, v32, v31
    v_fma_f32 v52, -v33, v31, v52
    v_fma_f32 v53, v33, v30, v53
    v_cvt_pk_f16_f32 v25, v52, v53
    ds_write_b32 v23, v25 offset:17952
    v_mul_f32 v54, v52, v30
    v_mul_f32 v55, v52, v31
    v_fma_f32 v54, -v53, v31, v54
    v_fma_f32 v55, v53, v30, v55
    v_cvt_pk_f16_f32 v24, v54, v55
    ds_write_b32 v23, v24 offset:18496
    v_mul_f32 v52, v54, v30
    v_mul_f32 v53, v54, v31
    v_fma_f32 v52, -v55, v31, v52
    v_fma_f32 v53, v55, v30, v53
    v_cvt_pk_f16_f32 v25, v52, v53
    ds_write_b32 v23, v25 offset:19040
    v_mul_f32 v54, v52, v30
    v_mul_f32 v55, v52, v31
    v_fma_f32 v54, -v53, v31, v54
    v_fma_f32 v55, v53, v30, v55
    v_cvt_pk_f16_f32 v24, v54, v55
    ds_write_b32 v23, v24 offset:19584
    v_mul_f32 v52, v54, v30
    v_mul_f32 v53, v54, v31
    v_fma_f32 v52, -v55, v31, v52
    v_fma_f32 v53, v55, v30, v53
    v_cvt_pk_f16_f32 v25, v52, v53
    ds_write_b32 v23, v25 offset:20128
    v_mul_f32 v54, v52, v30
    v_mul_f32 v55, v52, v31
    v_fma_f32 v54, -v53, v31, v54
    v_fma_f32 v55, v53, v30, v55
    v_cvt_pk_f16_f32 v24, v54, v55
    ds_write_b32 v23, v24 offset:20672
    v_mul_f32 v52, v54, v30
    v_mul_f32 v53, v54, v31
    v_fma_f32 v52, -v55, v31, v52
    v_fma_f32 v53, v55, v30, v53
    v_cvt_pk_f16_f32 v25, v52, v53
    ds_write_b32 v23, v25 offset:21216
    v_mul_f32 v56, v38, v32
    v_mul_f32 v57, v38, v33
    v_fma_f32 v56, -v39, v33, v56
    v_fma_f32 v57, v39, v32, v57
    v_cvt_pk_f16_f32 v24, v38, v39
    ds_write_b32 v23, v24 offset:21760
    v_mul_f32 v52, v38, v34
    v_mul_f32 v53, v38, v35
    v_fma_f32 v52, -v39, v35, v52
    v_fma_f32 v53, v39, v34, v53
    v_cvt_pk_f16_f32 v25, v52, v53
    ds_write_b32 v23, v25 offset:22304
    v_mul_f32 v54, v52, v34
    v_mul_f32 v55, v52, v35
    v_fma_f32 v54, -v53, v35, v54
    v_fma_f32 v55, v53, v34, v55
    v_cvt_pk_f16_f32 v24, v54, v55
    ds_write_b32 v23, v24 offset:22848
    v_mul_f32 v52, v54, v34
    v_mul_f32 v53, v54, v35
    v_fma_f32 v52, -v55, v35, v52
    v_fma_f32 v53, v55, v34, v53
    v_cvt_pk_f16_f32 v25, v52, v53
    ds_write_b32 v23, v25 offset:23392
    v_cvt_pk_f16_f32 v24, v56, v57
    ds_write_b32 v23, v24 offset:23936
    v_mul_f32 v52, v56, v34
    v_mul_f32 v53, v56, v35
    v_fma_f32 v52, -v57, v35, v52
    v_fma_f32 v53, v57, v34, v53
    v_cvt_pk_f16_f32 v25, v52, v53
    ds_write_b32 v23, v25 offset:24480
    v_mul_f32 v54, v52, v34
    v_mul_f32 v55, v52, v35
    v_fma_f32 v54, -v53, v35, v54
    v_fma_f32 v55, v53, v34, v55
    v_cvt_pk_f16_f32 v24, v54, v55
    ds_write_b32 v23, v24 offset:25024
    v_mul_f32 v52, v54, v34
    v_mul_f32 v53, v54, v35
    v_fma_f32 v52, -v55, v35, v52
    v_fma_f32 v53, v55, v34, v53
    v_cvt_pk_f16_f32 v25, v52, v53
    ds_write_b32 v23, v25 offset:25568
    v_cvt_pk_f16_f32 v24, v48, v49
    ds_write_b32 v23, v24 offset:26112
    v_mul_f32 v58, v48, v36
    v_mul_f32 v59, v48, v37
    v_fma_f32 v58, -v49, v37, v58
    v_fma_f32 v59, v49, v36, v59
    v_cvt_pk_f16_f32 v25, v58, v59
    ds_write_b32 v23, v25 offset:26656
    v_mul_f32 v52, v48, v32
    v_mul_f32 v53, v48, v33
    v_fma_f32 v52, -v49, v33, v52
    v_fma_f32 v53, v49, v32, v53
    v_cvt_pk_f16_f32 v24, v52, v53
    ds_write_b32 v23, v24 offset:27200
    v_mul_f32 v58, v52, v36
    v_mul_f32 v59, v52, v37
    v_fma_f32 v58, -v53, v37, v58
    v_fma_f32 v59, v53, v36, v59
    v_cvt_pk_f16_f32 v25, v58, v59
    ds_write_b32 v23, v25 offset:27744
    v_mul_f32 v54, v52, v32
    v_mul_f32 v55, v52, v33
    v_fma_f32 v54, -v53, v33, v54
    v_fma_f32 v55, v53, v32, v55
    v_cvt_pk_f16_f32 v24, v54, v55
    ds_write_b32 v23, v24 offset:28288
    v_mul_f32 v58, v54, v36
    v_mul_f32 v59, v54, v37
    v_fma_f32 v58, -v55, v37, v58
    v_fma_f32 v59, v55, v36, v59
    v_cvt_pk_f16_f32 v25, v58, v59
    ds_write_b32 v23, v25 offset:28832
    v_mul_f32 v52, v54, v32
    v_mul_f32 v53, v54, v33
    v_fma_f32 v52, -v55, v33, v52
    v_fma_f32 v53, v55, v32, v53
    v_cvt_pk_f16_f32 v24, v52, v53
    ds_write_b32 v23, v24 offset:29376
    v_mul_f32 v58, v52, v36
    v_mul_f32 v59, v52, v37
    v_fma_f32 v58, -v53, v37, v58
    v_fma_f32 v59, v53, v36, v59
    v_cvt_pk_f16_f32 v25, v58, v59
    ds_write_b32 v23, v25 offset:29920
Lka_kernel_V_join:
    s_waitcnt lgkmcnt(0)
    s_barrier
    v_and_b32 v4, 15, v1
    v_lshrrev_b32 v5, 4, v1
    s_cmp_ge_u32 s17, 3
    s_cbranch_scc1 Lka_kernel_V_skipmm
    v_mul_u32_u24 v26, 544, v4
    v_lshl_add_u32 v26, v5, 4, v26
    s_mul_i32 s20, s17, 8704
    v_add_u32 v27, s20, v26

    ds_read_b128 v[64:67], v26 offset:0
    ds_read_b128 v[68:71], v27 offset:8704
    ds_read_b128 v[72:75], v26 offset:64
    ds_read_b128 v[76:79], v27 offset:8768
    ds_read_b128 v[80:83], v26 offset:128
    ds_read_b128 v[84:87], v27 offset:8832
    ds_read_b128 v[88:91], v26 offset:192
    ds_read_b128 v[92:95], v27 offset:8896
    ds_read_b128 v[96:99], v26 offset:256
    ds_read_b128 v[100:103], v27 offset:8960
    ds_read_b128 v[104:107], v26 offset:320
    ds_read_b128 v[108:111], v27 offset:9024
    ds_read_b128 v[112:115], v26 offset:384
    ds_read_b128 v[116:119], v27 offset:9088
    s_waitcnt lgkmcnt(8)
    ds_read_b128 v[120:123], v26 offset:448
    ds_read_b128 v[124:127], v27 offset:9152
    v_mov_b32 v32, v4
    s_cmp_eq_u32 s17, 0
    s_cbranch_scc1 Lka_kernel_V_oready
    s_cmp_eq_u32 s17, 1
    s_cbranch_scc0 Lka_kernel_V_t2
    v_lshlrev_b32 v33, 1, v4
    v_add_u32 v33, 256, v33
    v_and_b32 v34, 3, v4
    v_lshlrev_b32 v34, 2, v34
    v_bfe_u32 v35, v4, 2, 1
    v_lshlrev_b32 v35, 8, v35
    v_add_u32 v34, v34, v35
    v_add_u32 v34, 512, v34
    v_cmp_gt_u32 vcc, 8, v4
    s_nop 1
    v_cndmask_b32 v32, v34, v33, vcc
    s_branch Lka_kernel_V_oready

Lka_kernel_V_t2:
    v_lshrrev_b32 v33, 1, v4
    v_lshlrev_b32 v33, 8, v33
    v_and_b32 v34, 1, v4
    v_lshl_add_u32 v33, v34, 3, v33
    v_add_u32 v33, 1024, v33
    v_cmp_gt_u32 vcc, 9, v4
    v_mov_b32 v34, 2052
    s_nop 0
    v_cndmask_b32 v32, v34, v33, vcc

Lka_kernel_V_oready:
    v_lshl_add_u32 v33, v5, 6, v32
    v_min_u32 v34, 2100, v33
    v_add_u32 v35, 16, v33
    v_min_u32 v35, 2100, v35
    v_add_u32 v36, 32, v33
    v_min_u32 v36, 2100, v36
    v_add_u32 v37, 48, v33
    v_min_u32 v37, 2100, v37
    v_lshlrev_b32 v34, 2, v34
    v_lshlrev_b32 v35, 2, v35
    v_lshlrev_b32 v36, 2, v36
    v_lshlrev_b32 v37, 2, v37

    s_waitcnt lgkmcnt(14)
    v_mfma_f32_16x16x32_f16 v[28:31], v[64:67], v[68:71], 0
    s_waitcnt lgkmcnt(12)
    v_mfma_f32_16x16x32_f16 v[28:31], v[72:75], v[76:79], v[28:31]
    s_waitcnt lgkmcnt(10)
    v_mfma_f32_16x16x32_f16 v[28:31], v[80:83], v[84:87], v[28:31]
    s_waitcnt lgkmcnt(8)
    v_mfma_f32_16x16x32_f16 v[28:31], v[88:91], v[92:95], v[28:31]
    s_waitcnt lgkmcnt(6)
    v_mfma_f32_16x16x32_f16 v[28:31], v[96:99], v[100:103], v[28:31]
    s_waitcnt lgkmcnt(4)
    v_mfma_f32_16x16x32_f16 v[28:31], v[104:107], v[108:111], v[28:31]
    s_waitcnt lgkmcnt(2)
    v_mfma_f32_16x16x32_f16 v[28:31], v[112:115], v[116:119], v[28:31]
    s_waitcnt lgkmcnt(0)
    v_mfma_f32_16x16x32_f16 v[28:31], v[120:123], v[124:127], v[28:31]
    s_nop 7
    ds_write_b32 v34, v28 offset:31008
    ds_write_b32 v35, v29 offset:31008
    ds_write_b32 v36, v30 offset:31008
    ds_write_b32 v37, v31 offset:31008

Lka_kernel_V_skipmm:
    s_waitcnt lgkmcnt(0)
    s_barrier
    ds_read_b32 v48, v40 offset:31008
    ds_read_b32 v49, v41 offset:31008
    ds_read_b32 v50, v42 offset:31008
    ds_read_b32 v51, v43 offset:31008
    ds_read_b32 v52, v44 offset:31008
    ds_read_b32 v53, v45 offset:31008
    ds_read_b32 v54, v46 offset:31008
    ds_read_b32 v55, v47 offset:31008
    v_mov_b32 v16, 0
    v_mov_b32 v17, 0
    v_mov_b32 v18, 0
    v_mov_b32 v19, 0
    v_lshlrev_b32 v14, 4, v0
    v_cmp_gt_u32 vcc, 160, v0
    s_and_saveexec_b64 s[22:23], vcc
    ds_write_b128 v14, v[16:19]
    s_mov_b64 exec, s[22:23]
    v_cmp_gt_u32 vcc, 32, v0
    v_lshrrev_b32 v15, 3, v0
    v_mul_u32_u24 v15, 4416, v15
    v_and_b32 v20, 7, v0
    v_lshl_add_u32 v15, v20, 4, v15
    s_and_saveexec_b64 s[22:23], vcc
    ds_write_b128 v15, v[16:19] offset:7680
    s_mov_b64 exec, s[22:23]
    v_lshlrev_b32 v15, 1, v0
    s_waitcnt lgkmcnt(0)

    v_cvt_f16_f32 v48, v48
    ds_write_b16 v15, v48 offset:7808
    v_cvt_f16_f32 v49, v49
    ds_write_b16 v15, v49 offset:8320
    v_cvt_f16_f32 v50, v50
    ds_write_b16 v15, v50 offset:8832
    v_cvt_f16_f32 v51, v51
    ds_write_b16 v15, v51 offset:9344
    v_cvt_f16_f32 v52, v52
    ds_write_b16 v15, v52 offset:9856
    v_cvt_f16_f32 v53, v53
    ds_write_b16 v15, v53 offset:10368
    v_cvt_f16_f32 v54, v54
    ds_write_b16 v15, v54 offset:10880
    v_cvt_f16_f32 v55, v55
    ds_write_b16 v15, v55 offset:11392
    s_waitcnt lgkmcnt(0)
    s_barrier
    ds_read_b128 v[24:27], v14 offset:7808
    ds_read_b64 v[22:23], v14 offset:7800

    s_cmp_lg_u32 s17, 0
    s_cbranch_scc1 Lka_kernel_V_nopoll

    v_mov_b32 v21, 0
    s_mov_b32 s60, 0

Lka_kernel_V_np:
    buffer_load_dword v56, v21, s[56:59], 0 offen sc1
    s_waitcnt vmcnt(0)
    v_readfirstlane_b32 s61, v56
    s_cmp_lg_u32 s61, 0
    s_cbranch_scc1 Lka_kernel_V_gotn
    s_add_u32 s60, s60, 1
    s_cmp_lt_u32 s60, 0x40000
    s_cbranch_scc0 Lka_kernel_V_gotn
    s_sleep 4
    s_branch Lka_kernel_V_np

Lka_kernel_V_gotn:
    s_and_b32 s62, s2, 7
    s_lshl_b32 s62, s62, 10
    s_add_u32 s62, s62, 5308416
    v_lshlrev_b32 v21, 4, v1

Lka_kernel_V_poll:
    buffer_load_dwordx4 v[56:59], v21, s[44:47], s62 offen sc1
    s_waitcnt vmcnt(0)
    v_cmp_ne_u32 vcc, s61, v56
    v_cmp_ne_u32 s[64:65], s61, v57
    s_or_b64 vcc, vcc, s[64:65]
    v_cmp_ne_u32 s[64:65], s61, v58
    s_or_b64 vcc, vcc, s[64:65]
    v_cmp_ne_u32 s[64:65], s61, v59
    s_or_b64 vcc, vcc, s[64:65]

    s_cbranch_vccz Lka_kernel_V_go
    s_add_u32 s60, s60, 1
    s_cmp_lt_u32 s60, 0x40000
    s_cbranch_scc0 Lka_kernel_V_go
    s_sleep 8
    s_branch Lka_kernel_V_poll

Lka_kernel_V_go:
Lka_kernel_V_nopoll:
    s_waitcnt lgkmcnt(0)
    v_alignbit_b32 v28, v23, v22, 16
    v_alignbit_b32 v29, v24, v23, 16
    v_alignbit_b32 v30, v25, v24, 16
    v_alignbit_b32 v31, v26, v25, 16
    v_alignbit_b32 v32, v27, v26, 16
    v_mov_b32 v36, v29
    v_mov_b32 v37, v30
    v_mov_b32 v38, v31
    v_mov_b32 v39, v32
    v_mov_b32 v40, v23
    v_mov_b32 v41, v24
    v_mov_b32 v42, v25
    v_mov_b32 v43, v26
    ds_write_b128 v14, v[28:31] offset:21056
    ds_write_b128 v14, v[36:39] offset:12224
    ds_write_b128 v14, v[40:43] offset:16640
    s_barrier

    v_lshrrev_b32 v21, 1, v0
    v_mul_u32_u24 v20, 18432, v21
    v_and_b32 v49, 1, v0
    v_lshl_add_u32 v20, v49, 4, v20
    s_lshl_b32 s19, s16, 5
    s_add_u32 s19, s19, 0
    s_add_u32 s25, s19, 2359296
    buffer_load_dwordx4 v[44:47], v20, s[44:47], s19 offen sc1
    buffer_load_dwordx4 v[8:11], v20, s[44:47], s25 offen sc1
    v_lshrrev_b32 v48, 3, v21
    v_mul_u32_u24 v48, 160, v48
    v_and_b32 v50, 7, v21
    v_lshl_add_u32 v48, v50, 4, v48
    v_add_u32 v48, 2560, v48
    v_lshlrev_b32 v50, 4, v21
    v_add_u32 v50, 32768, v50
    v_cmp_eq_u32 vcc, 1, v49
    v_mov_b32 v51, 2560
    v_mov_b32 v53, 2048
    v_cndmask_b32 v48, v48, v50, vcc
    v_cndmask_b32 v51, v51, v53, vcc
    v_add_u32 v51, v48, v51
    v_lshlrev_b32 v6, 7, v4
    v_lshl_add_u32 v6, v5, 3, v6
    s_lshl_b32 s23, s17, 5
    s_lshl_b32 s24, s16, 12
    s_add_u32 s24, s24, s23

    v_bfe_u32 v52, v1, 2, 2
    v_mul_u32_u24 v52, 4416, v52
    v_and_b32 v53, 3, v1
    v_lshl_add_u32 v52, v53, 3, v52
    v_lshlrev_b32 v53, 4, v5
    v_sub_u32 v52, v52, v53
    s_lshl_b32 s27, s17, 9
    s_add_u32 s27, s27, 7736
    v_add_u32 v12, s27, v52
    v_mul_u32_u24 v53, 160, v4
    v_lshl_add_u32 v53, v5, 4, v53
    s_mul_i32 s27, s17, 640
    s_sub_u32 s27, 2080, s27
    v_add_u32 v13, s27, v53
    s_waitcnt vmcnt(1)
    ds_write_b128 v48, v[44:47]
    s_waitcnt vmcnt(0)
    ds_write_b128 v51, v[8:11]
    s_waitcnt lgkmcnt(0)
    s_barrier

    v_mov_b32 v14, v62
    v_mov_b32 v15, v63
    ds_read_b128 v[48:51], v13 offset:480
    ds_read_b128 v[52:55], v13 offset:544
    ds_read_b128 v[56:59], v13 offset:3040
    ds_read_b128 v[60:63], v13 offset:3104
    ds_read_b64_tr_b16 v[80:81], v12 offset:8
    ds_read_b64_tr_b16 v[82:83], v12 offset:0
    ds_read_b64_tr_b16 v[104:105], v12 offset:2056
    ds_read_b64_tr_b16 v[106:107], v12 offset:2048
    ds_read_b64_tr_b16 v[84:85], v12 offset:40
    ds_read_b64_tr_b16 v[86:87], v12 offset:32
    ds_read_b64_tr_b16 v[108:109], v12 offset:2088
    ds_read_b64_tr_b16 v[110:111], v12 offset:2080
    s_waitcnt lgkmcnt(4)
    ds_read_b64_tr_b16 v[88:89], v12 offset:72
    ds_read_b64_tr_b16 v[90:91], v12 offset:64
    ds_read_b64_tr_b16 v[112:113], v12 offset:2120
    ds_read_b64_tr_b16 v[114:115], v12 offset:2112
    ds_read_b64_tr_b16 v[92:93], v12 offset:104
    ds_read_b64_tr_b16 v[94:95], v12 offset:96
    ds_read_b64_tr_b16 v[116:117], v12 offset:2152
    ds_read_b64_tr_b16 v[118:119], v12 offset:2144
    s_waitcnt lgkmcnt(4)
    ds_read_b64_tr_b16 v[96:97], v12 offset:136
    ds_read_b64_tr_b16 v[98:99], v12 offset:128
    ds_read_b64_tr_b16 v[120:121], v12 offset:2184
    ds_read_b64_tr_b16 v[122:123], v12 offset:2176
    ds_read_b64_tr_b16 v[100:101], v12 offset:168
    ds_read_b64_tr_b16 v[102:103], v12 offset:160
    ds_read_b64_tr_b16 v[124:125], v12 offset:2216
    ds_read_b64_tr_b16 v[126:127], v12 offset:2208
    s_waitcnt lgkmcnt(0)
    v_mfma_f32_16x16x32_f16 v[16:19], v[80:83], v[52:55], 0
    v_mfma_f32_16x16x32_f16 v[20:23], v[80:83], v[60:63], 0
    v_mfma_f32_16x16x32_f16 v[20:23], v[104:107], v[52:55], v[20:23]
    v_mfma_f32_16x16x32_f16 v[24:27], v[84:87], v[52:55], 0
    v_mfma_f32_16x16x32_f16 v[28:31], v[84:87], v[60:63], 0
    v_mfma_f32_16x16x32_f16 v[28:31], v[108:111], v[52:55], v[28:31]
    v_mfma_f32_16x16x32_f16 v[32:35], v[88:91], v[52:55], 0
    v_mfma_f32_16x16x32_f16 v[36:39], v[88:91], v[60:63], 0
    v_mfma_f32_16x16x32_f16 v[36:39], v[112:115], v[52:55], v[36:39]
    v_mfma_f32_16x16x32_f16 v[40:43], v[92:95], v[52:55], 0
    v_mfma_f32_16x16x32_f16 v[44:47], v[92:95], v[60:63], 0
    v_mfma_f32_16x16x32_f16 v[44:47], v[116:119], v[52:55], v[44:47]
    ds_read_b128 v[64:67], v13 offset:320
    ds_read_b128 v[68:71], v13 offset:384
    ds_read_b128 v[72:75], v13 offset:2880
    ds_read_b128 v[76:79], v13 offset:2944
    ds_read_b64_tr_b16 v[80:81], v12 offset:200
    ds_read_b64_tr_b16 v[82:83], v12 offset:192
    ds_read_b64_tr_b16 v[104:105], v12 offset:2248
    ds_read_b64_tr_b16 v[106:107], v12 offset:2240
    ds_read_b64_tr_b16 v[84:85], v12 offset:232
    ds_read_b64_tr_b16 v[86:87], v12 offset:224
    ds_read_b64_tr_b16 v[108:109], v12 offset:2280
    ds_read_b64_tr_b16 v[110:111], v12 offset:2272
    v_mfma_f32_16x16x32_f16 v[16:19], v[88:91], v[48:51], v[16:19]
    v_mfma_f32_16x16x32_f16 v[20:23], v[88:91], v[56:59], v[20:23]
    v_mfma_f32_16x16x32_f16 v[20:23], v[112:115], v[48:51], v[20:23]
    v_mfma_f32_16x16x32_f16 v[24:27], v[92:95], v[48:51], v[24:27]
    v_mfma_f32_16x16x32_f16 v[28:31], v[92:95], v[56:59], v[28:31]
    v_mfma_f32_16x16x32_f16 v[28:31], v[116:119], v[48:51], v[28:31]
    s_waitcnt lgkmcnt(6)
    ds_read_b64_tr_b16 v[88:89], v12 offset:264
    ds_read_b64_tr_b16 v[90:91], v12 offset:256
    ds_read_b64_tr_b16 v[112:113], v12 offset:2312
    ds_read_b64_tr_b16 v[114:115], v12 offset:2304
    ds_read_b64_tr_b16 v[92:93], v12 offset:296
    ds_read_b64_tr_b16 v[94:95], v12 offset:288
    ds_read_b64_tr_b16 v[116:117], v12 offset:2344
    ds_read_b64_tr_b16 v[118:119], v12 offset:2336
    v_mfma_f32_16x16x32_f16 v[32:35], v[96:99], v[48:51], v[32:35]
    v_mfma_f32_16x16x32_f16 v[36:39], v[96:99], v[56:59], v[36:39]
    v_mfma_f32_16x16x32_f16 v[36:39], v[120:123], v[48:51], v[36:39]
    v_mfma_f32_16x16x32_f16 v[40:43], v[100:103], v[48:51], v[40:43]
    v_mfma_f32_16x16x32_f16 v[44:47], v[100:103], v[56:59], v[44:47]
    v_mfma_f32_16x16x32_f16 v[44:47], v[124:127], v[48:51], v[44:47]
    s_waitcnt lgkmcnt(0)
    v_mfma_f32_16x16x32_f16 v[16:19], v[96:99], v[68:71], v[16:19]
    v_mfma_f32_16x16x32_f16 v[20:23], v[96:99], v[76:79], v[20:23]
    v_mfma_f32_16x16x32_f16 v[20:23], v[120:123], v[68:71], v[20:23]
    v_mfma_f32_16x16x32_f16 v[24:27], v[100:103], v[68:71], v[24:27]
    v_mfma_f32_16x16x32_f16 v[28:31], v[100:103], v[76:79], v[28:31]
    v_mfma_f32_16x16x32_f16 v[28:31], v[124:127], v[68:71], v[28:31]
    v_mfma_f32_16x16x32_f16 v[32:35], v[80:83], v[68:71], v[32:35]
    v_mfma_f32_16x16x32_f16 v[36:39], v[80:83], v[76:79], v[36:39]
    v_mfma_f32_16x16x32_f16 v[36:39], v[104:107], v[68:71], v[36:39]
    v_mfma_f32_16x16x32_f16 v[40:43], v[84:87], v[68:71], v[40:43]
    v_mfma_f32_16x16x32_f16 v[44:47], v[84:87], v[76:79], v[44:47]
    v_mfma_f32_16x16x32_f16 v[44:47], v[108:111], v[68:71], v[44:47]
    ds_read_b128 v[48:51], v13 offset:160
    ds_read_b128 v[52:55], v13 offset:224
    ds_read_b128 v[56:59], v13 offset:2720
    ds_read_b128 v[60:63], v13 offset:2784
    ds_read_b64_tr_b16 v[96:97], v12 offset:328
    ds_read_b64_tr_b16 v[98:99], v12 offset:320
    ds_read_b64_tr_b16 v[120:121], v12 offset:2376
    ds_read_b64_tr_b16 v[122:123], v12 offset:2368
    ds_read_b64_tr_b16 v[100:101], v12 offset:360
    ds_read_b64_tr_b16 v[102:103], v12 offset:352
    ds_read_b64_tr_b16 v[124:125], v12 offset:2408
    ds_read_b64_tr_b16 v[126:127], v12 offset:2400
    v_mfma_f32_16x16x32_f16 v[16:19], v[80:83], v[64:67], v[16:19]
    v_mfma_f32_16x16x32_f16 v[20:23], v[80:83], v[72:75], v[20:23]
    v_mfma_f32_16x16x32_f16 v[20:23], v[104:107], v[64:67], v[20:23]
    v_mfma_f32_16x16x32_f16 v[24:27], v[84:87], v[64:67], v[24:27]
    v_mfma_f32_16x16x32_f16 v[28:31], v[84:87], v[72:75], v[28:31]
    v_mfma_f32_16x16x32_f16 v[28:31], v[108:111], v[64:67], v[28:31]
    s_waitcnt lgkmcnt(6)
    ds_read_b64_tr_b16 v[80:81], v12 offset:392
    ds_read_b64_tr_b16 v[82:83], v12 offset:384
    ds_read_b64_tr_b16 v[104:105], v12 offset:2440
    ds_read_b64_tr_b16 v[106:107], v12 offset:2432
    ds_read_b64_tr_b16 v[84:85], v12 offset:424
    ds_read_b64_tr_b16 v[86:87], v12 offset:416
    ds_read_b64_tr_b16 v[108:109], v12 offset:2472
    ds_read_b64_tr_b16 v[110:111], v12 offset:2464
    v_mfma_f32_16x16x32_f16 v[32:35], v[88:91], v[64:67], v[32:35]
    v_mfma_f32_16x16x32_f16 v[36:39], v[88:91], v[72:75], v[36:39]
    v_mfma_f32_16x16x32_f16 v[36:39], v[112:115], v[64:67], v[36:39]
    v_mfma_f32_16x16x32_f16 v[40:43], v[92:95], v[64:67], v[40:43]
    v_mfma_f32_16x16x32_f16 v[44:47], v[92:95], v[72:75], v[44:47]
    v_mfma_f32_16x16x32_f16 v[44:47], v[116:119], v[64:67], v[44:47]
    s_waitcnt lgkmcnt(0)
    v_mfma_f32_16x16x32_f16 v[16:19], v[88:91], v[52:55], v[16:19]
    v_mfma_f32_16x16x32_f16 v[20:23], v[88:91], v[60:63], v[20:23]
    v_mfma_f32_16x16x32_f16 v[20:23], v[112:115], v[52:55], v[20:23]
    v_mfma_f32_16x16x32_f16 v[24:27], v[92:95], v[52:55], v[24:27]
    v_mfma_f32_16x16x32_f16 v[28:31], v[92:95], v[60:63], v[28:31]
    v_mfma_f32_16x16x32_f16 v[28:31], v[116:119], v[52:55], v[28:31]
    v_mfma_f32_16x16x32_f16 v[32:35], v[96:99], v[52:55], v[32:35]
    v_mfma_f32_16x16x32_f16 v[36:39], v[96:99], v[60:63], v[36:39]
    v_mfma_f32_16x16x32_f16 v[36:39], v[120:123], v[52:55], v[36:39]
    v_mfma_f32_16x16x32_f16 v[40:43], v[100:103], v[52:55], v[40:43]
    v_mfma_f32_16x16x32_f16 v[44:47], v[100:103], v[60:63], v[44:47]
    v_mfma_f32_16x16x32_f16 v[44:47], v[124:127], v[52:55], v[44:47]
    ds_read_b128 v[64:67], v13 offset:0
    ds_read_b128 v[68:71], v13 offset:64
    ds_read_b128 v[72:75], v13 offset:2560
    ds_read_b128 v[76:79], v13 offset:2624
    ds_read_b64_tr_b16 v[88:89], v12 offset:456
    ds_read_b64_tr_b16 v[90:91], v12 offset:448
    ds_read_b64_tr_b16 v[112:113], v12 offset:2504
    ds_read_b64_tr_b16 v[114:115], v12 offset:2496
    ds_read_b64_tr_b16 v[92:93], v12 offset:488
    ds_read_b64_tr_b16 v[94:95], v12 offset:480
    ds_read_b64_tr_b16 v[116:117], v12 offset:2536
    ds_read_b64_tr_b16 v[118:119], v12 offset:2528
    v_mfma_f32_16x16x32_f16 v[16:19], v[96:99], v[48:51], v[16:19]
    v_mfma_f32_16x16x32_f16 v[20:23], v[96:99], v[56:59], v[20:23]
    v_mfma_f32_16x16x32_f16 v[20:23], v[120:123], v[48:51], v[20:23]
    v_mfma_f32_16x16x32_f16 v[24:27], v[100:103], v[48:51], v[24:27]
    v_mfma_f32_16x16x32_f16 v[28:31], v[100:103], v[56:59], v[28:31]
    v_mfma_f32_16x16x32_f16 v[28:31], v[124:127], v[48:51], v[28:31]
    s_waitcnt lgkmcnt(6)
    ds_read_b64_tr_b16 v[96:97], v12 offset:520
    ds_read_b64_tr_b16 v[98:99], v12 offset:512
    ds_read_b64_tr_b16 v[120:121], v12 offset:2568
    ds_read_b64_tr_b16 v[122:123], v12 offset:2560
    ds_read_b64_tr_b16 v[100:101], v12 offset:552
    ds_read_b64_tr_b16 v[102:103], v12 offset:544
    ds_read_b64_tr_b16 v[124:125], v12 offset:2600
    ds_read_b64_tr_b16 v[126:127], v12 offset:2592
    v_mfma_f32_16x16x32_f16 v[32:35], v[80:83], v[48:51], v[32:35]
    v_mfma_f32_16x16x32_f16 v[36:39], v[80:83], v[56:59], v[36:39]
    v_mfma_f32_16x16x32_f16 v[36:39], v[104:107], v[48:51], v[36:39]
    v_mfma_f32_16x16x32_f16 v[40:43], v[84:87], v[48:51], v[40:43]
    v_mfma_f32_16x16x32_f16 v[44:47], v[84:87], v[56:59], v[44:47]
    v_mfma_f32_16x16x32_f16 v[44:47], v[108:111], v[48:51], v[44:47]
    s_waitcnt lgkmcnt(0)
    v_mfma_f32_16x16x32_f16 v[16:19], v[80:83], v[68:71], v[16:19]
    v_mfma_f32_16x16x32_f16 v[20:23], v[80:83], v[76:79], v[20:23]
    v_mfma_f32_16x16x32_f16 v[20:23], v[104:107], v[68:71], v[20:23]
    v_mfma_f32_16x16x32_f16 v[24:27], v[84:87], v[68:71], v[24:27]
    v_mfma_f32_16x16x32_f16 v[28:31], v[84:87], v[76:79], v[28:31]
    v_mfma_f32_16x16x32_f16 v[28:31], v[108:111], v[68:71], v[28:31]
    v_mfma_f32_16x16x32_f16 v[32:35], v[88:91], v[68:71], v[32:35]
    v_mfma_f32_16x16x32_f16 v[36:39], v[88:91], v[76:79], v[36:39]
    v_mfma_f32_16x16x32_f16 v[36:39], v[112:115], v[68:71], v[36:39]
    v_mfma_f32_16x16x32_f16 v[40:43], v[92:95], v[68:71], v[40:43]
    v_mfma_f32_16x16x32_f16 v[44:47], v[92:95], v[76:79], v[44:47]
    v_mfma_f32_16x16x32_f16 v[44:47], v[116:119], v[68:71], v[44:47]
    v_mfma_f32_16x16x32_f16 v[16:19], v[88:91], v[64:67], v[16:19]
    v_mfma_f32_16x16x32_f16 v[20:23], v[88:91], v[72:75], v[20:23]
    v_mfma_f32_16x16x32_f16 v[20:23], v[112:115], v[64:67], v[20:23]
    v_mfma_f32_16x16x32_f16 v[24:27], v[92:95], v[64:67], v[24:27]
    v_mfma_f32_16x16x32_f16 v[28:31], v[92:95], v[72:75], v[28:31]
    v_mfma_f32_16x16x32_f16 v[28:31], v[116:119], v[64:67], v[28:31]
    v_mfma_f32_16x16x32_f16 v[32:35], v[96:99], v[64:67], v[32:35]
    v_mfma_f32_16x16x32_f16 v[36:39], v[96:99], v[72:75], v[36:39]
    v_mfma_f32_16x16x32_f16 v[36:39], v[120:123], v[64:67], v[36:39]
    v_mfma_f32_16x16x32_f16 v[40:43], v[100:103], v[64:67], v[40:43]
    v_mfma_f32_16x16x32_f16 v[44:47], v[100:103], v[72:75], v[44:47]
    v_mfma_f32_16x16x32_f16 v[44:47], v[124:127], v[64:67], v[44:47]
    s_barrier
    v_lshlrev_b32 v12, 4, v1
    s_mul_i32 s27, s17, 6144
    v_add_u32 v12, s27, v12

    s_cmp_eq_u32 s17, 0
    s_cbranch_scc1 Lka_kernel_skw0
    s_sub_u32 s28, 3, s17
    s_and_b32 s28, s28, 3
    s_lshl_b32 s28, s28, 11
    v_add_u32 v13, s28, v12
    ds_write_b128 v13, v[16:19] offset:7680
    ds_write_b128 v13, v[20:23] offset:8704
Lka_kernel_skw0:
    s_cmp_eq_u32 s17, 1
    s_cbranch_scc1 Lka_kernel_skw1
    s_sub_u32 s28, 4, s17
    s_and_b32 s28, s28, 3
    s_lshl_b32 s28, s28, 11
    v_add_u32 v13, s28, v12
    ds_write_b128 v13, v[24:27] offset:7680
    ds_write_b128 v13, v[28:31] offset:8704
Lka_kernel_skw1:
    s_cmp_eq_u32 s17, 2
    s_cbranch_scc1 Lka_kernel_skw2
    s_sub_u32 s28, 5, s17
    s_and_b32 s28, s28, 3
    s_lshl_b32 s28, s28, 11
    v_add_u32 v13, s28, v12
    ds_write_b128 v13, v[32:35] offset:7680
    ds_write_b128 v13, v[36:39] offset:8704
Lka_kernel_skw2:
    s_cmp_eq_u32 s17, 3
    s_cbranch_scc1 Lka_kernel_skw3
    s_sub_u32 s28, 6, s17
    s_and_b32 s28, s28, 3
    s_lshl_b32 s28, s28, 11
    v_add_u32 v13, s28, v12
    ds_write_b128 v13, v[40:43] offset:7680
    ds_write_b128 v13, v[44:47] offset:8704
Lka_kernel_skw3:
    s_cmp_lg_u32 s17, 0
    s_cbranch_scc1 Lka_kernel_mv0
    v_mov_b32 v48, v16
    v_mov_b32 v49, v17
    v_mov_b32 v50, v18
    v_mov_b32 v51, v19
    v_mov_b32 v52, v20
    v_mov_b32 v53, v21
    v_mov_b32 v54, v22
    v_mov_b32 v55, v23
Lka_kernel_mv0:
    s_cmp_lg_u32 s17, 1
    s_cbranch_scc1 Lka_kernel_mv1
    v_mov_b32 v48, v24
    v_mov_b32 v49, v25
    v_mov_b32 v50, v26
    v_mov_b32 v51, v27
    v_mov_b32 v52, v28
    v_mov_b32 v53, v29
    v_mov_b32 v54, v30
    v_mov_b32 v55, v31
Lka_kernel_mv1:
    s_cmp_lg_u32 s17, 2
    s_cbranch_scc1 Lka_kernel_mv2
    v_mov_b32 v48, v32
    v_mov_b32 v49, v33
    v_mov_b32 v50, v34
    v_mov_b32 v51, v35
    v_mov_b32 v52, v36
    v_mov_b32 v53, v37
    v_mov_b32 v54, v38
    v_mov_b32 v55, v39
Lka_kernel_mv2:
    s_cmp_lg_u32 s17, 3
    s_cbranch_scc1 Lka_kernel_mv3
    v_mov_b32 v48, v40
    v_mov_b32 v49, v41
    v_mov_b32 v50, v42
    v_mov_b32 v51, v43
    v_mov_b32 v52, v44
    v_mov_b32 v53, v45
    v_mov_b32 v54, v46
    v_mov_b32 v55, v47
Lka_kernel_mv3:
    s_waitcnt lgkmcnt(0)
    s_barrier
    v_lshlrev_b32 v12, 4, v1
    s_sub_u32 s28, s17, 1
    s_and_b32 s28, s28, 3
    s_mul_i32 s28, s28, 6144
    s_add_u32 s28, s28, 0
    v_add_u32 v13, s28, v12
    ds_read_b128 v[56:59], v13 offset:7680
    ds_read_b128 v[60:63], v13 offset:8704

    s_sub_u32 s28, s17, 2
    s_and_b32 s28, s28, 3
    s_mul_i32 s28, s28, 6144
    s_add_u32 s28, s28, 2048
    v_add_u32 v13, s28, v12
    ds_read_b128 v[64:67], v13 offset:7680
    ds_read_b128 v[68:71], v13 offset:8704

    s_sub_u32 s28, s17, 3
    s_and_b32 s28, s28, 3
    s_mul_i32 s28, s28, 6144
    s_add_u32 s28, s28, 4096
    v_add_u32 v13, s28, v12
    ds_read_b128 v[72:75], v13 offset:7680
    ds_read_b128 v[76:79], v13 offset:8704

    v_mul_u32_u24 v13, 160, v4
    v_lshl_add_u32 v13, v5, 3, v13
    v_add_u32 v13, s23, v13
    ds_read_b64 v[80:81], v13 offset:2560
    ds_read_b64 v[82:83], v13 offset:5120
    v_add_u32 v12, s23, v6
    ds_read_b64 v[8:9], v12 offset:32768
    ds_read_b64 v[10:11], v12 offset:34816
    s_waitcnt vmcnt(0) lgkmcnt(0)

    v_add_f32 v48, v48, v56
    v_add_f32 v49, v49, v57
    v_add_f32 v50, v50, v58
    v_add_f32 v51, v51, v59
    v_add_f32 v52, v52, v60
    v_add_f32 v53, v53, v61
    v_add_f32 v54, v54, v62
    v_add_f32 v55, v55, v63
    v_add_f32 v48, v48, v64
    v_add_f32 v49, v49, v65
    v_add_f32 v50, v50, v66
    v_add_f32 v51, v51, v67
    v_add_f32 v52, v52, v68
    v_add_f32 v53, v53, v69
    v_add_f32 v54, v54, v70
    v_add_f32 v55, v55, v71
    v_add_f32 v48, v48, v72
    v_add_f32 v49, v49, v73
    v_add_f32 v50, v50, v74
    v_add_f32 v51, v51, v75
    v_add_f32 v52, v52, v76
    v_add_f32 v53, v53, v77
    v_add_f32 v54, v54, v78
    v_add_f32 v55, v55, v79
    v_mul_f32 v48, v48, v15
    v_mul_f32 v49, v49, v15
    v_cvt_pk_bf16_f32 v84, v48, v49
    v_cvt_f32_f16 v85, v80
    v_cvt_f32_f16_sdwa v86, v80 dst_sel:DWORD dst_unused:UNUSED_PAD src0_sel:WORD_1
    v_mul_f32 v85, v85, v14
    v_mul_f32 v86, v86, v14
    v_cvt_pk_bf16_f32 v85, v85, v86
    v_lshlrev_b32 v86, 16, v84
    v_and_b32 v84, 0xffff0000, v84
    v_lshlrev_b32 v87, 16, v85
    v_and_b32 v85, 0xffff0000, v85
    v_add_f32 v86, v86, v87
    v_add_f32 v84, v84, v85
    v_cvt_pk_bf16_f32 v84, v86, v84
    v_lshlrev_b32 v86, 16, v84
    v_and_b32 v84, 0xffff0000, v84
    v_lshlrev_b32 v87, 16, v8
    v_and_b32 v85, 0xffff0000, v8
    v_add_f32 v86, v86, v87
    v_add_f32 v84, v84, v85
    v_cvt_pk_bf16_f32 v88, v86, v84

    v_mul_f32 v50, v50, v15
    v_mul_f32 v51, v51, v15
    v_cvt_pk_bf16_f32 v84, v50, v51
    v_cvt_f32_f16 v85, v81
    v_cvt_f32_f16_sdwa v86, v81 dst_sel:DWORD dst_unused:UNUSED_PAD src0_sel:WORD_1
    v_mul_f32 v85, v85, v14
    v_mul_f32 v86, v86, v14
    v_cvt_pk_bf16_f32 v85, v85, v86
    v_lshlrev_b32 v86, 16, v84
    v_and_b32 v84, 0xffff0000, v84
    v_lshlrev_b32 v87, 16, v85
    v_and_b32 v85, 0xffff0000, v85
    v_add_f32 v86, v86, v87
    v_add_f32 v84, v84, v85
    v_cvt_pk_bf16_f32 v84, v86, v84
    v_lshlrev_b32 v86, 16, v84
    v_and_b32 v84, 0xffff0000, v84
    v_lshlrev_b32 v87, 16, v9
    v_and_b32 v85, 0xffff0000, v9
    v_add_f32 v86, v86, v87
    v_add_f32 v84, v84, v85
    v_cvt_pk_bf16_f32 v89, v86, v84

    v_mul_f32 v52, v52, v15
    v_mul_f32 v53, v53, v15
    v_cvt_pk_bf16_f32 v84, v52, v53
    v_cvt_f32_f16 v85, v82
    v_cvt_f32_f16_sdwa v86, v82 dst_sel:DWORD dst_unused:UNUSED_PAD src0_sel:WORD_1
    v_mul_f32 v85, v85, v14
    v_mul_f32 v86, v86, v14
    v_cvt_pk_bf16_f32 v85, v85, v86
    v_lshlrev_b32 v86, 16, v84
    v_and_b32 v84, 0xffff0000, v84
    v_lshlrev_b32 v87, 16, v85
    v_and_b32 v85, 0xffff0000, v85
    v_add_f32 v86, v86, v87
    v_add_f32 v84, v84, v85
    v_cvt_pk_bf16_f32 v84, v86, v84
    v_lshlrev_b32 v86, 16, v84
    v_and_b32 v84, 0xffff0000, v84
    v_lshlrev_b32 v87, 16, v10
    v_and_b32 v85, 0xffff0000, v10
    v_add_f32 v86, v86, v87
    v_add_f32 v84, v84, v85
    v_cvt_pk_bf16_f32 v90, v86, v84

    v_mul_f32 v54, v54, v15
    v_mul_f32 v55, v55, v15
    v_cvt_pk_bf16_f32 v84, v54, v55
    v_cvt_f32_f16 v85, v83
    v_cvt_f32_f16_sdwa v86, v83 dst_sel:DWORD dst_unused:UNUSED_PAD src0_sel:WORD_1
    v_mul_f32 v85, v85, v14
    v_mul_f32 v86, v86, v14
    v_cvt_pk_bf16_f32 v85, v85, v86
    v_lshlrev_b32 v86, 16, v84
    v_and_b32 v84, 0xffff0000, v84
    v_lshlrev_b32 v87, 16, v85
    v_and_b32 v85, 0xffff0000, v85
    v_add_f32 v86, v86, v87
    v_add_f32 v84, v84, v85
    v_cvt_pk_bf16_f32 v84, v86, v84
    v_lshlrev_b32 v86, 16, v84
    v_and_b32 v84, 0xffff0000, v84
    v_lshlrev_b32 v87, 16, v11
    v_and_b32 v85, 0xffff0000, v11
    v_add_f32 v86, v86, v87
    v_add_f32 v84, v84, v85
    v_cvt_pk_bf16_f32 v91, v86, v84

    ds_write_b64 v12, v[88:89] offset:32768
    ds_write_b64 v12, v[90:91] offset:34816
    v_lshlrev_b32 v13, 4, v0
    s_lshl_b32 s25, s16, 12
    s_add_u32 s25, s25, 7671808
    s_waitcnt lgkmcnt(0)
    s_barrier
    ds_read_b128 v[88:91], v13 offset:32768
    s_waitcnt lgkmcnt(0)
    buffer_store_dwordx4 v[88:91], v13, s[44:47], s25 offen

Lka_kernel_end:
    s_endpgm
.globl k3_kernel
.p2align 8
.type k3_kernel,@function
k3_kernel:
    s_cmp_ge_u32 s2, 256
    s_cbranch_scc1 Lk3_kernel_end
    s_load_dwordx4 s[4:7], s[0:1], 64
    s_load_dwordx2 s[40:41], s[0:1], 80
    s_load_dwordx2 s[42:43], s[0:1], 104
    s_load_dwordx2 s[88:89], s[0:1], 88
    v_lshrrev_b32 v35, 6, v0
    v_and_b32 v0, 63, v0
    s_nop 0
    v_readfirstlane_b32 s20, v35

    s_and_b32 s36, s2, 7
    s_lshr_b32 s37, s2, 3
    s_and_b32 s38, s37, 1
    s_lshl_b32 s21, s36, 1
    s_add_u32 s21, s21, s38
    s_lshr_b32 s22, s37, 1
    s_mul_i32 s95, s38, 0

    v_lshrrev_b32 v35, 4, v0
    v_bfe_u32 v36, v0, 1, 3
    v_and_b32 v37, 1, v0
    v_lshlrev_b32 v37, 4, v37
    v_lshlrev_b32 v38, 12, v35
    v_add_u32 v38, v38, v37
    v_xor_b32 v39, v36, v35
    v_xor_b32 v40, 4, v39
    v_lshl_add_u32 v39, v39, 5, v38
    v_lshl_add_u32 v40, v40, 5, v38

    v_add_u32 v112, 0, v39
    v_add_u32 v113, 15360, v40
    v_add_u32 v114, 30720, v39
    v_add_u32 v115, 0, v40
    v_add_u32 v116, 15360, v39
    v_add_u32 v117, 30720, v40
    v_lshrrev_b32 v35, 3, v0
    v_bfe_u32 v36, v0, 1, 2
    v_bfe_u32 v37, v0, 4, 2
    v_xor_b32 v36, v36, v37
    v_and_b32 v37, 1, v0
    v_lshlrev_b32 v37, 4, v37
    v_lshl_add_u32 v36, v36, 5, v37
    v_mul_u32_u24 v37, 9216, v35
    v_add_u32 v1, v37, v36
    v_mul_u32_u24 v37, 1152, v35
    v_add_u32 v7, v37, v36
    v_lshrrev_b32 v35, 2, v0
    v_bfe_u32 v36, v0, 1, 1
    v_bfe_u32 v37, v0, 4, 1
    v_xor_b32 v36, v36, v37
    v_and_b32 v37, 1, v0
    v_lshlrev_b32 v37, 4, v37
    v_lshl_add_u32 v36, v36, 5, v37
    v_mul_u32_u24 v37, 9216, v35
    v_add_u32 v4, v37, v36

    v_add_u32 v2, 72704, v1
    v_add_u32 v8, 8192, v7
    v_add_u32 v5, 146432, v4
    v_add_u32 v3, 145408, v1
    v_add_u32 v9, 16384, v7
    v_add_u32 v6, 292864, v4
    s_mul_i32 s34, s20, 98304
    s_lshl_b32 s36, s22, 8
    s_add_u32 s34, s34, s36
    s_add_u32 s34, s34, 7671808
    s_mul_i32 s35, s20, 6144
    s_and_b32 s38, s21, 1
    s_mul_i32 s36, s21, 288
    s_lshl_b32 s37, s38, 5
    s_add_u32 s37, s36, s37
    s_xor_b32 s39, s38, 1
    s_lshl_b32 s39, s39, 8
    s_add_u32 s39, s36, s39
    s_and_b32 s46, s20, 1
    s_lshr_b32 s47, s20, 1
    s_mul_i32 s23, s46, 442368
    s_lshl_b32 s48, s37, 1
    s_add_u32 s23, s23, s48
    s_mul_i32 s24, s46, 884736
    s_lshl_b32 s48, s39, 1
    s_add_u32 s24, s24, s48
    s_mul_i32 s25, s47, 12288
    s_mul_i32 s48, s46, 6144
    s_add_u32 s25, s25, s48

    s_add_u32 s48, s95, 0
    s_cmp_ge_u32 s48, 6
    s_cselect_b32 s49, 6, 0
    s_sub_u32 s48, s48, s49
    s_mul_i32 s49, s48, 884736
    s_add_u32 s76, s23, s49
    s_mul_i32 s49, s48, 393216
    s_add_u32 s82, s34, s49

    s_add_u32 s48, s95, 1
    s_cmp_ge_u32 s48, 6
    s_cselect_b32 s49, 6, 0
    s_sub_u32 s48, s48, s49
    s_mul_i32 s49, s48, 884736
    s_add_u32 s77, s23, s49
    s_mul_i32 s49, s48, 393216
    s_add_u32 s83, s34, s49

    s_add_u32 s48, s95, 2
    s_cmp_ge_u32 s48, 6
    s_cselect_b32 s49, 6, 0
    s_sub_u32 s48, s48, s49
    s_mul_i32 s49, s48, 884736
    s_add_u32 s78, s23, s49
    s_mul_i32 s49, s48, 393216
    s_add_u32 s84, s34, s49

    s_add_u32 s48, s95, 3
    s_cmp_ge_u32 s48, 6
    s_cselect_b32 s49, 6, 0
    s_sub_u32 s48, s48, s49
    s_mul_i32 s49, s48, 884736
    s_add_u32 s79, s23, s49
    s_mul_i32 s49, s48, 393216
    s_add_u32 s85, s34, s49

    s_add_u32 s48, s95, 4
    s_cmp_ge_u32 s48, 6
    s_cselect_b32 s49, 6, 0
    s_sub_u32 s48, s48, s49
    s_mul_i32 s49, s48, 884736
    s_add_u32 s80, s23, s49
    s_mul_i32 s49, s48, 393216
    s_add_u32 s86, s34, s49

    s_add_u32 s48, s95, 5
    s_cmp_ge_u32 s48, 6
    s_cselect_b32 s49, 6, 0
    s_sub_u32 s48, s48, s49
    s_mul_i32 s49, s48, 884736
    s_add_u32 s81, s23, s49
    s_mul_i32 s49, s48, 393216
    s_add_u32 s87, s34, s49

    s_add_u32 s48, s46, 0
    s_add_u32 s48, s48, s95
    s_cmp_ge_u32 s48, 6
    s_cselect_b32 s49, 6, 0
    s_sub_u32 s48, s48, s49
    s_mul_i32 s48, s48, 884736
    s_lshl_b32 s49, s39, 1
    s_add_u32 s92, s48, s49

    s_add_u32 s48, s46, 2
    s_add_u32 s48, s48, s95
    s_cmp_ge_u32 s48, 6
    s_cselect_b32 s49, 6, 0
    s_sub_u32 s48, s48, s49
    s_mul_i32 s48, s48, 884736
    s_lshl_b32 s49, s39, 1
    s_add_u32 s93, s48, s49

    s_add_u32 s48, s46, 4
    s_add_u32 s48, s48, s95
    s_cmp_ge_u32 s48, 6
    s_cselect_b32 s49, 6, 0
    s_sub_u32 s48, s48, s49
    s_mul_i32 s48, s48, 884736
    s_lshl_b32 s49, s39, 1
    s_add_u32 s94, s48, s49

    s_mul_i32 s48, s20, 24
    s_add_u32 s48, s48, 0
    s_lshl_b32 s49, s38, 5
    s_add_u32 s48, s48, s49
    s_cmp_ge_u32 s48, 288
    s_cselect_b32 s49, 288, 0
    s_sub_u32 s48, s48, s49
    s_add_u32 s48, s48, s36
    s_mul_i32 s50, s48, 1152

    s_mul_i32 s48, s20, 24
    s_add_u32 s48, s48, 96
    s_lshl_b32 s49, s38, 5
    s_add_u32 s48, s48, s49
    s_cmp_ge_u32 s48, 288
    s_cselect_b32 s49, 288, 0
    s_sub_u32 s48, s48, s49
    s_add_u32 s48, s48, s36
    s_mul_i32 s51, s48, 1152

    s_mul_i32 s48, s20, 24
    s_add_u32 s48, s48, 192
    s_lshl_b32 s49, s38, 5
    s_add_u32 s48, s48, s49
    s_cmp_ge_u32 s48, 288
    s_cselect_b32 s49, 288, 0
    s_sub_u32 s48, s48, s49
    s_add_u32 s48, s48, s36
    s_mul_i32 s52, s48, 1152

    s_mul_i32 s48, s20, 24
    s_add_u32 s48, s48, 200
    s_lshl_b32 s49, s38, 5
    s_add_u32 s48, s48, s49
    s_cmp_ge_u32 s48, 288
    s_cselect_b32 s49, 288, 0
    s_sub_u32 s48, s48, s49
    s_add_u32 s48, s48, s36
    s_mul_i32 s53, s48, 1152

    s_sub_u32 s53, s53, 9216
    s_mul_i32 s48, s20, 24
    s_add_u32 s48, s48, 208
    s_lshl_b32 s49, s38, 5
    s_add_u32 s48, s48, s49
    s_cmp_ge_u32 s48, 288
    s_cselect_b32 s49, 288, 0
    s_sub_u32 s48, s48, s49
    s_add_u32 s48, s48, s36
    s_mul_i32 s54, s48, 1152

    s_sub_u32 s54, s54, 18432
    s_mul_i32 s27, s20, 3072
    s_lshl_b32 s48, s21, 4
    s_add_u32 s48, s48, s22
    s_lshl_b32 s48, s48, 2
    s_add_u32 s48, s48, s20
    s_mul_i32 s33, s48, 36864
    s_add_u32 s33, s33, 10096640
    v_lshlrev_b32 v16, 4, v0
    s_lshl_b32 s44, s37, 2
    s_add_u32 s44, s44, 10031104
    s_lshl_b32 s45, s39, 2
    s_add_u32 s45, s45, 10031104

    s_waitcnt lgkmcnt(0)
    s_cmp_ge_u32 s20, 2
    s_cselect_b32 s8, s6, s4
    s_cselect_b32 s9, s7, s5
    s_mov_b32 s10, 5308416
    s_mov_b32 s11, 0x20000
    s_mov_b32 s12, s40
    s_mov_b32 s13, s41
    s_mov_b32 s14, 5308416
    s_mov_b32 s15, 0x20000
    s_mov_b32 s16, s42
    s_mov_b32 s17, s43
    s_mov_b32 s18, 48107520
    s_mov_b32 s19, 0x20000
    s_mov_b32 s90, 2359296
    s_mov_b32 s91, 0x20000

    s_add_u32 s32, s82, 0
    s_add_u32 m0, s35, 0
    s_nop 0
    buffer_load_dwordx4 v112, s[16:19], s32 offen lds
    buffer_load_dwordx4 v113, s[16:19], s32 offen offset:1024 lds
    buffer_load_dwordx4 v114, s[16:19], s32 offen offset:2048 lds
    s_add_u32 s32, s82, 49152
    s_add_u32 m0, s35, 3072
    s_nop 0
    buffer_load_dwordx4 v115, s[16:19], s32 offen lds
    buffer_load_dwordx4 v116, s[16:19], s32 offen offset:1024 lds
    buffer_load_dwordx4 v117, s[16:19], s32 offen offset:2048 lds
    s_add_u32 s32, s76, 0
    s_add_u32 m0, s25, 24576
    s_nop 0
    buffer_load_dwordx4 v1, s[8:11], s32 offen lds
    buffer_load_dwordx4 v2, s[8:11], s32 offen offset:1024 lds
    buffer_load_dwordx4 v3, s[8:11], s32 offen offset:2048 lds
    s_add_u32 s32, s76, 221184
    s_add_u32 m0, s25, 27648
    s_nop 0
    buffer_load_dwordx4 v1, s[8:11], s32 offen lds
    buffer_load_dwordx4 v2, s[8:11], s32 offen offset:1024 lds
    buffer_load_dwordx4 v3, s[8:11], s32 offen offset:2048 lds
    v_bfe_u32 v35, v0, 2, 2
    v_lshrrev_b32 v36, 4, v0
    v_lshl_add_u32 v37, v36, 2, v35
    v_and_b32 v38, 3, v0
    v_lshlrev_b32 v38, 3, v38
    v_bfe_u32 v39, v37, 1, 2
    v_lshlrev_b32 v40, 7, v37
    v_add_u32 v40, v40, v38
    v_lshl_add_u32 v40, v39, 5, v40

    v_mov_b32 v42, v40
    v_xor_b32 v17, 0, v42
    v_xor_b32 v18, 32, v42
    v_xor_b32 v19, 64, v42
    v_xor_b32 v20, 96, v42
    v_xor_b32 v21, 0, v42
    v_add_u32 v21, 49152, v21
    v_xor_b32 v22, 32, v42
    v_add_u32 v22, 49152, v22
    v_xor_b32 v23, 64, v42
    v_add_u32 v23, 49152, v23
    v_xor_b32 v24, 96, v42
    v_add_u32 v24, 49152, v24
    v_xor_b32 v25, 0, v42
    v_add_u32 v25, 98304, v25
    v_xor_b32 v26, 32, v42
    v_add_u32 v26, 98304, v26
    v_xor_b32 v27, 64, v42
    v_add_u32 v27, 98304, v27
    v_xor_b32 v28, 96, v42
    v_add_u32 v28, 98304, v28
    v_lshlrev_b32 v40, 6, v37
    v_add_u32 v40, v40, v38
    v_and_b32 v41, 1, v36
    v_lshl_add_u32 v33, v41, 5, v40
    v_xor_b32 v34, 32, v33
    v_lshlrev_b32 v40, 8, v37
    v_add_u32 v40, v40, v38
    v_and_b32 v41, 7, v37
    s_lshl_b32 s48, s20, 1
    v_xor_b32 v41, s48, v41
    v_lshl_add_u32 v118, v41, 5, v40
    v_xor_b32 v119, 32, v118
    v_mov_b32 v126, 0x3f803f80

    v_accvgpr_write_b32 a230, v126
    v_accvgpr_write_b32 a231, v126
    v_accvgpr_write_b32 a232, v126
    v_accvgpr_write_b32 a233, v126
    s_add_u32 s32, s83, 0
    s_add_u32 m0, s35, 49152
    s_nop 0
    buffer_load_dwordx4 v112, s[16:19], s32 offen lds
    buffer_load_dwordx4 v113, s[16:19], s32 offen offset:1024 lds
    buffer_load_dwordx4 v114, s[16:19], s32 offen offset:2048 lds
    s_add_u32 s32, s83, 49152
    s_add_u32 m0, s35, 52224
    s_nop 0
    buffer_load_dwordx4 v115, s[16:19], s32 offen lds
    buffer_load_dwordx4 v116, s[16:19], s32 offen offset:1024 lds
    buffer_load_dwordx4 v117, s[16:19], s32 offen offset:2048 lds
    s_add_u32 s32, s77, 0
    s_add_u32 m0, s25, 73728
    s_nop 0
    buffer_load_dwordx4 v1, s[8:11], s32 offen lds
    buffer_load_dwordx4 v2, s[8:11], s32 offen offset:1024 lds
    buffer_load_dwordx4 v3, s[8:11], s32 offen offset:2048 lds
    s_add_u32 s32, s77, 221184
    s_add_u32 m0, s25, 76800
    s_nop 0
    buffer_load_dwordx4 v1, s[8:11], s32 offen lds
    buffer_load_dwordx4 v2, s[8:11], s32 offen offset:1024 lds
    buffer_load_dwordx4 v3, s[8:11], s32 offen offset:2048 lds
    s_and_b32 s56, s22, 15
    s_mul_i32 s56, s56, 24
    s_mul_i32 s57, s46, 12
    s_add_u32 s56, s56, s57
    s_mul_hi_u32 s57, s56, 44739243
    s_mul_i32 s58, s57, 96
    s_sub_u32 s56, s56, s58
    s_cmp_eq_u32 s57, 0
    s_cselect_b32 s58, s78, s79
    s_cmp_eq_u32 s57, 2
    s_cselect_b32 s58, s80, s58
    s_cmp_eq_u32 s57, 3
    s_cselect_b32 s58, s81, s58
    s_mul_i32 s57, s46, 442368
    s_sub_u32 s58, s58, s57
    s_mul_i32 s56, s56, 9216
    s_add_u32 s58, s58, s56
    v_mul_u32_u24 v46, 9216, v0
    v_cmp_gt_u32 vcc, 12, v0
    v_mov_b32 v47, 0x7fffffff
    s_nop 0
    v_cndmask_b32 v46, v47, v46, vcc
    buffer_load_dword v47, v46, s[8:11], s58 offen

    s_getpc_b64 s[56:57]
Lk3_kernel_pc0:
    s_sub_u32 s56, s56, Lk3_kernel_pc0-k3_kernel
    s_subb_u32 s57, s57, 0
    s_lshl_b32 s58, s20, 13
    v_lshlrev_b32 v46, 7, v0
    v_add_u32 v46, s58, v46
    global_load_dword v47, v46, s[56:57]
    v_add_u32 v46, 32768, v46
    v_min_u32 v46, 55296, v46
    global_load_dword v47, v46, s[56:57]

    s_waitcnt vmcnt(15)
    s_barrier
    v_add_u32 v120, 0, v118
    v_add_u32 v121, 0, v119
    ds_read_b64_tr_b16 a[0:1], v120 offset:0
    ds_read_b64_tr_b16 a[2:3], v120 offset:4096
    ds_read_b64_tr_b16 a[4:5], v121 offset:0
    ds_read_b64_tr_b16 a[6:7], v121 offset:4096
    ds_read_b64_tr_b16 a[8:9], v120 offset:8192
    ds_read_b64_tr_b16 a[10:11], v120 offset:12288
    ds_read_b64_tr_b16 a[12:13], v121 offset:8192
    ds_read_b64_tr_b16 a[14:15], v121 offset:12288
    ds_read_b64_tr_b16 a[16:17], v120 offset:16384
    ds_read_b64_tr_b16 a[18:19], v120 offset:20480
    ds_read_b64_tr_b16 a[20:21], v121 offset:16384
    ds_read_b64_tr_b16 a[22:23], v121 offset:20480
    s_waitcnt lgkmcnt(0)
    ds_read_b64_tr_b16 a[144:145], v17 offset:24576
    ds_read_b64_tr_b16 a[146:147], v17 offset:26624
    ds_read_b64_tr_b16 a[148:149], v17 offset:36864
    ds_read_b64_tr_b16 a[150:151], v17 offset:38912
    ds_read_b64_tr_b16 a[152:153], v18 offset:24576
    ds_read_b64_tr_b16 a[154:155], v18 offset:26624
    ds_read_b64_tr_b16 a[156:157], v18 offset:36864
    ds_read_b64_tr_b16 a[158:159], v18 offset:38912
    ds_read_b64_tr_b16 a[160:161], v19 offset:24576
    ds_read_b64_tr_b16 a[162:163], v19 offset:26624
    ds_read_b64_tr_b16 a[164:165], v19 offset:36864
    ds_read_b64_tr_b16 a[166:167], v19 offset:38912
    s_mov_b32 s67, 2359296
    s_barrier
    s_waitcnt lgkmcnt(8)
    v_mfma_f32_16x16x32_bf16 v[48:51], a[144:147], a[0:3], 0
    ds_read_b64_tr_b16 a[168:169], v20 offset:24576
    v_mfma_f32_16x16x32_bf16 v[52:55], a[144:147], a[4:7], 0
    ds_read_b64_tr_b16 a[170:171], v20 offset:26624
    s_add_u32 m0, s35, 98304
    s_add_u32 s32, s84, 0
    buffer_load_dwordx4 v112, s[16:19], s32 offen lds
    v_mfma_f32_16x16x32_bf16 v[56:59], a[148:151], a[0:3], 0
    ds_read_b64_tr_b16 a[172:173], v20 offset:36864
    v_mfma_f32_16x16x32_bf16 v[60:63], a[148:151], a[4:7], 0
    ds_read_b64_tr_b16 a[174:175], v20 offset:38912
    v_mfma_f32_16x16x32_bf16 v[132:135], a[230:233], a[0:3], 0
    buffer_load_dwordx4 v113, s[16:19], s32 offen offset:1024 lds
    s_waitcnt lgkmcnt(8)
    v_mfma_f32_16x16x32_bf16 v[64:67], a[152:155], a[0:3], 0
    ds_read_b64_tr_b16 a[144:145], v17 offset:28672
    v_mfma_f32_16x16x32_bf16 v[68:71], a[152:155], a[4:7], 0
    ds_read_b64_tr_b16 a[146:147], v17 offset:30720
    v_mfma_f32_16x16x32_bf16 v[72:75], a[156:159], a[0:3], 0
    ds_read_b64_tr_b16 a[148:149], v17 offset:40960
    buffer_load_dwordx4 v114, s[16:19], s32 offen offset:2048 lds
    v_mfma_f32_16x16x32_bf16 v[76:79], a[156:159], a[4:7], 0
    ds_read_b64_tr_b16 a[150:151], v17 offset:43008
    v_mfma_f32_16x16x32_bf16 v[140:143], a[0:3], a[0:3], 0
    s_waitcnt lgkmcnt(8)
    v_mfma_f32_16x16x32_bf16 v[80:83], a[160:163], a[0:3], 0
    ds_read_b64_tr_b16 a[152:153], v18 offset:28672
    s_add_u32 m0, s35, 101376
    s_add_u32 s32, s84, 49152
    buffer_load_dwordx4 v115, s[16:19], s32 offen lds
    v_mfma_f32_16x16x32_bf16 v[84:87], a[160:163], a[4:7], 0
    ds_read_b64_tr_b16 a[154:155], v18 offset:30720
    v_mfma_f32_16x16x32_bf16 v[88:91], a[164:167], a[0:3], 0
    ds_read_b64_tr_b16 a[156:157], v18 offset:40960
    v_mfma_f32_16x16x32_bf16 v[92:95], a[164:167], a[4:7], 0
    ds_read_b64_tr_b16 a[158:159], v18 offset:43008
    buffer_load_dwordx4 v116, s[16:19], s32 offen offset:1024 lds
    v_mfma_f32_16x16x32_bf16 v[136:139], a[230:233], a[4:7], 0
    s_waitcnt lgkmcnt(8)
    v_mfma_f32_16x16x32_bf16 v[96:99], a[168:171], a[0:3], 0
    ds_read_b64_tr_b16 a[160:161], v19 offset:28672
    v_mfma_f32_16x16x32_bf16 v[100:103], a[168:171], a[4:7], 0
    ds_read_b64_tr_b16 a[162:163], v19 offset:30720
    buffer_load_dwordx4 v117, s[16:19], s32 offen offset:2048 lds
    v_mfma_f32_16x16x32_bf16 v[104:107], a[172:175], a[0:3], 0
    ds_read_b64_tr_b16 a[164:165], v19 offset:40960
    v_mfma_f32_16x16x32_bf16 v[108:111], a[172:175], a[4:7], 0
    ds_read_b64_tr_b16 a[166:167], v19 offset:43008
    v_mfma_f32_16x16x32_bf16 v[144:147], a[4:7], a[4:7], 0
    s_add_u32 m0, s25, 122880
    s_add_u32 s32, s78, 0
    buffer_load_dwordx4 v1, s[8:11], s32 offen lds
    s_waitcnt lgkmcnt(8)
    v_mfma_f32_16x16x32_bf16 v[48:51], a[144:147], a[8:11], v[48:51]
    ds_read_b64_tr_b16 a[168:169], v20 offset:28672
    v_mfma_f32_16x16x32_bf16 v[52:55], a[144:147], a[12:15], v[52:55]
    ds_read_b64_tr_b16 a[170:171], v20 offset:30720
    v_mfma_f32_16x16x32_bf16 v[56:59], a[148:151], a[8:11], v[56:59]
    ds_read_b64_tr_b16 a[172:173], v20 offset:40960
    buffer_load_dwordx4 v2, s[8:11], s32 offen offset:1024 lds
    v_mfma_f32_16x16x32_bf16 v[60:63], a[148:151], a[12:15], v[60:63]
    ds_read_b64_tr_b16 a[174:175], v20 offset:43008
    v_mfma_f32_16x16x32_bf16 v[132:135], a[230:233], a[8:11], v[132:135]
    s_waitcnt lgkmcnt(8)
    v_mfma_f32_16x16x32_bf16 v[64:67], a[152:155], a[8:11], v[64:67]
    ds_read_b64_tr_b16 a[144:145], v17 offset:32768
    buffer_load_dwordx4 v3, s[8:11], s32 offen offset:2048 lds
    v_mfma_f32_16x16x32_bf16 v[68:71], a[152:155], a[12:15], v[68:71]
    ds_read_b64_tr_b16 a[146:147], v17 offset:34816
    v_mfma_f32_16x16x32_bf16 v[72:75], a[156:159], a[8:11], v[72:75]
    ds_read_b64_tr_b16 a[148:149], v17 offset:45056
    v_mfma_f32_16x16x32_bf16 v[76:79], a[156:159], a[12:15], v[76:79]
    ds_read_b64_tr_b16 a[150:151], v17 offset:47104
    s_add_u32 m0, s25, 125952
    s_add_u32 s32, s78, 221184
    buffer_load_dwordx4 v1, s[8:11], s32 offen lds
    v_mfma_f32_16x16x32_bf16 v[140:143], a[8:11], a[8:11], v[140:143]
    s_waitcnt lgkmcnt(8)
    v_mfma_f32_16x16x32_bf16 v[80:83], a[160:163], a[8:11], v[80:83]
    ds_read_b64_tr_b16 a[152:153], v18 offset:32768
    v_mfma_f32_16x16x32_bf16 v[84:87], a[160:163], a[12:15], v[84:87]
    ds_read_b64_tr_b16 a[154:155], v18 offset:34816
    buffer_load_dwordx4 v2, s[8:11], s32 offen offset:1024 lds
    v_mfma_f32_16x16x32_bf16 v[88:91], a[164:167], a[8:11], v[88:91]
    ds_read_b64_tr_b16 a[156:157], v18 offset:45056
    v_mfma_f32_16x16x32_bf16 v[92:95], a[164:167], a[12:15], v[92:95]
    ds_read_b64_tr_b16 a[158:159], v18 offset:47104
    v_mfma_f32_16x16x32_bf16 v[136:139], a[230:233], a[12:15], v[136:139]
    buffer_load_dwordx4 v3, s[8:11], s32 offen offset:2048 lds
    s_waitcnt lgkmcnt(8)
    v_mfma_f32_16x16x32_bf16 v[96:99], a[168:171], a[8:11], v[96:99]
    s_waitcnt vmcnt(15)
    s_barrier
    ds_read_b64_tr_b16 a[160:161], v19 offset:32768
    v_add_u32 v120, 49152, v118
    v_add_u32 v121, 49152, v119
    v_mfma_f32_16x16x32_bf16 v[100:103], a[168:171], a[12:15], v[100:103]
    ds_read_b64_tr_b16 a[162:163], v19 offset:34816
    ds_read_b64_tr_b16 a[24:25], v120 offset:0
    v_mfma_f32_16x16x32_bf16 v[104:107], a[172:175], a[8:11], v[104:107]
    ds_read_b64_tr_b16 a[164:165], v19 offset:45056
    ds_read_b64_tr_b16 a[26:27], v120 offset:4096
    s_add_u32 m0, s35, 0
    s_add_u32 s32, s85, 0
    buffer_load_dwordx4 v112, s[16:19], s32 offen lds
    v_mfma_f32_16x16x32_bf16 v[108:111], a[172:175], a[12:15], v[108:111]
    ds_read_b64_tr_b16 a[166:167], v19 offset:47104
    ds_read_b64_tr_b16 a[28:29], v121 offset:0
    v_mfma_f32_16x16x32_bf16 v[144:147], a[12:15], a[12:15], v[144:147]
    s_waitcnt lgkmcnt(11)
    ds_read_b64_tr_b16 a[30:31], v121 offset:4096
    v_mfma_f32_16x16x32_bf16 v[48:51], a[144:147], a[16:19], v[48:51]
    ds_read_b64_tr_b16 a[168:169], v20 offset:32768
    ds_read_b64_tr_b16 a[32:33], v120 offset:8192
    buffer_load_dwordx4 v113, s[16:19], s32 offen offset:1024 lds
    v_mfma_f32_16x16x32_bf16 v[52:55], a[144:147], a[20:23], v[52:55]
    ds_read_b64_tr_b16 a[170:171], v20 offset:34816
    s_waitcnt lgkmcnt(11)
    ds_read_b64_tr_b16 a[34:35], v120 offset:12288
    v_mfma_f32_16x16x32_bf16 v[56:59], a[148:151], a[16:19], v[56:59]
    ds_read_b64_tr_b16 a[172:173], v20 offset:45056
    ds_read_b64_tr_b16 a[36:37], v121 offset:8192
    v_mfma_f32_16x16x32_bf16 v[60:63], a[148:151], a[20:23], v[60:63]
    ds_read_b64_tr_b16 a[174:175], v20 offset:47104
    s_waitcnt lgkmcnt(11)
    ds_read_b64_tr_b16 a[38:39], v121 offset:12288
    buffer_load_dwordx4 v114, s[16:19], s32 offen offset:2048 lds
    v_mfma_f32_16x16x32_bf16 v[132:135], a[230:233], a[16:19], v[132:135]
    ds_read_b64_tr_b16 a[40:41], v120 offset:16384
    v_mfma_f32_16x16x32_bf16 v[64:67], a[152:155], a[16:19], v[64:67]
    ds_read_b64_tr_b16 a[144:145], v21 offset:24576
    ds_read_b64_tr_b16 a[42:43], v120 offset:20480
    v_mfma_f32_16x16x32_bf16 v[68:71], a[152:155], a[20:23], v[68:71]
    s_waitcnt lgkmcnt(11)
    ds_read_b64_tr_b16 a[146:147], v21 offset:26624
    ds_read_b64_tr_b16 a[44:45], v121 offset:16384
    s_add_u32 m0, s35, 3072
    s_add_u32 s32, s85, 49152
    buffer_load_dwordx4 v115, s[16:19], s32 offen lds
    v_mfma_f32_16x16x32_bf16 v[72:75], a[156:159], a[16:19], v[72:75]
    ds_read_b64_tr_b16 a[148:149], v21 offset:36864
    ds_read_b64_tr_b16 a[46:47], v121 offset:20480
    v_mfma_f32_16x16x32_bf16 v[76:79], a[156:159], a[20:23], v[76:79]
    s_waitcnt lgkmcnt(11)
    ds_read_b64_tr_b16 a[150:151], v21 offset:38912
    v_mfma_f32_16x16x32_bf16 v[140:143], a[16:19], a[16:19], v[140:143]
    buffer_load_dwordx4 v116, s[16:19], s32 offen offset:1024 lds
    v_mfma_f32_16x16x32_bf16 v[80:83], a[160:163], a[16:19], v[80:83]
    ds_read_b64_tr_b16 a[152:153], v22 offset:24576
    v_mfma_f32_16x16x32_bf16 v[84:87], a[160:163], a[20:23], v[84:87]
    ds_read_b64_tr_b16 a[154:155], v22 offset:26624
    v_mfma_f32_16x16x32_bf16 v[88:91], a[164:167], a[16:19], v[88:91]
    ds_read_b64_tr_b16 a[156:157], v22 offset:36864
    buffer_load_dwordx4 v117, s[16:19], s32 offen offset:2048 lds
    v_mfma_f32_16x16x32_bf16 v[92:95], a[164:167], a[20:23], v[92:95]
    s_waitcnt lgkmcnt(11)
    ds_read_b64_tr_b16 a[158:159], v22 offset:38912
    v_mfma_f32_16x16x32_bf16 v[136:139], a[230:233], a[20:23], v[136:139]
    v_mfma_f32_16x16x32_bf16 v[96:99], a[168:171], a[16:19], v[96:99]
    ds_read_b64_tr_b16 a[160:161], v23 offset:24576
    v_mfma_f32_16x16x32_bf16 v[100:103], a[168:171], a[20:23], v[100:103]
    ds_read_b64_tr_b16 a[162:163], v23 offset:26624
    v_mfma_f32_16x16x32_bf16 v[104:107], a[172:175], a[16:19], v[104:107]
    ds_read_b64_tr_b16 a[164:165], v23 offset:36864
    v_mfma_f32_16x16x32_bf16 v[108:111], a[172:175], a[20:23], v[108:111]
    s_waitcnt lgkmcnt(11)
    ds_read_b64_tr_b16 a[166:167], v23 offset:38912
    v_mfma_f32_16x16x32_bf16 v[144:147], a[20:23], a[20:23], v[144:147]
    s_waitcnt lgkmcnt(9)
    s_barrier
    s_waitcnt lgkmcnt(8)
    v_mfma_f32_16x16x32_bf16 v[48:51], a[144:147], a[24:27], v[48:51]
    ds_read_b64_tr_b16 a[168:169], v24 offset:24576
    v_mfma_f32_16x16x32_bf16 v[52:55], a[144:147], a[28:31], v[52:55]
    ds_read_b64_tr_b16 a[170:171], v24 offset:26624
    s_add_u32 m0, s25, 24576
    s_add_u32 s32, s79, 0
    buffer_load_dwordx4 v1, s[8:11], s32 offen lds
    v_mfma_f32_16x16x32_bf16 v[56:59], a[148:151], a[24:27], v[56:59]
    ds_read_b64_tr_b16 a[172:173], v24 offset:36864
    v_mfma_f32_16x16x32_bf16 v[60:63], a[148:151], a[28:31], v[60:63]
    ds_read_b64_tr_b16 a[174:175], v24 offset:38912
    v_and_b32 v45, 15, v0
    v_mfma_f32_16x16x32_bf16 v[132:135], a[230:233], a[24:27], v[132:135]
    buffer_load_dwordx4 v2, s[8:11], s32 offen offset:1024 lds
    s_waitcnt lgkmcnt(8)
    v_mfma_f32_16x16x32_bf16 v[64:67], a[152:155], a[24:27], v[64:67]
    ds_read_b64_tr_b16 a[144:145], v21 offset:28672
    v_mfma_f32_16x16x32_bf16 v[68:71], a[152:155], a[28:31], v[68:71]
    ds_read_b64_tr_b16 a[146:147], v21 offset:30720
    v_mfma_f32_16x16x32_bf16 v[72:75], a[156:159], a[24:27], v[72:75]
    ds_read_b64_tr_b16 a[148:149], v21 offset:40960
    buffer_load_dwordx4 v3, s[8:11], s32 offen offset:2048 lds
    v_mul_u32_u24 v45, 144, v45
    v_mfma_f32_16x16x32_bf16 v[76:79], a[156:159], a[28:31], v[76:79]
    ds_read_b64_tr_b16 a[150:151], v21 offset:43008
    v_mfma_f32_16x16x32_bf16 v[140:143], a[24:27], a[24:27], v[140:143]
    s_waitcnt lgkmcnt(8)
    v_mfma_f32_16x16x32_bf16 v[80:83], a[160:163], a[24:27], v[80:83]
    ds_read_b64_tr_b16 a[152:153], v22 offset:28672
    s_add_u32 m0, s25, 27648
    s_add_u32 s32, s79, 221184
    buffer_load_dwordx4 v1, s[8:11], s32 offen lds
    v_mfma_f32_16x16x32_bf16 v[84:87], a[160:163], a[28:31], v[84:87]
    ds_read_b64_tr_b16 a[154:155], v22 offset:30720
    s_mul_i32 s44, s21, 2304
    v_mfma_f32_16x16x32_bf16 v[88:91], a[164:167], a[24:27], v[88:91]
    ds_read_b64_tr_b16 a[156:157], v22 offset:40960
    v_mfma_f32_16x16x32_bf16 v[92:95], a[164:167], a[28:31], v[92:95]
    ds_read_b64_tr_b16 a[158:159], v22 offset:43008
    buffer_load_dwordx4 v2, s[8:11], s32 offen offset:1024 lds
    v_mfma_f32_16x16x32_bf16 v[136:139], a[230:233], a[28:31], v[136:139]
    s_waitcnt lgkmcnt(8)
    v_mfma_f32_16x16x32_bf16 v[96:99], a[168:171], a[24:27], v[96:99]
    ds_read_b64_tr_b16 a[160:161], v23 offset:28672
    s_add_u32 s44, s44, 10031104
    v_mfma_f32_16x16x32_bf16 v[100:103], a[168:171], a[28:31], v[100:103]
    ds_read_b64_tr_b16 a[162:163], v23 offset:30720
    buffer_load_dwordx4 v3, s[8:11], s32 offen offset:2048 lds
    v_mfma_f32_16x16x32_bf16 v[104:107], a[172:175], a[24:27], v[104:107]
    ds_read_b64_tr_b16 a[164:165], v23 offset:40960
    v_mfma_f32_16x16x32_bf16 v[108:111], a[172:175], a[28:31], v[108:111]
    ds_read_b64_tr_b16 a[166:167], v23 offset:43008
    v_mfma_f32_16x16x32_bf16 v[144:147], a[28:31], a[28:31], v[144:147]
    s_add_u32 m0, s35, 49152
    s_add_u32 s32, s86, 0
    buffer_load_dwordx4 v112, s[16:19], s32 offen lds
    buffer_load_dwordx4 a[176:179], v45, s[16:19], s44 offen
    s_waitcnt lgkmcnt(8)
    v_mfma_f32_16x16x32_bf16 v[48:51], a[144:147], a[32:35], v[48:51]
    ds_read_b64_tr_b16 a[168:169], v24 offset:28672
    v_mfma_f32_16x16x32_bf16 v[52:55], a[144:147], a[36:39], v[52:55]
    ds_read_b64_tr_b16 a[170:171], v24 offset:30720
    v_mfma_f32_16x16x32_bf16 v[56:59], a[148:151], a[32:35], v[56:59]
    ds_read_b64_tr_b16 a[172:173], v24 offset:40960
    buffer_load_dwordx4 v113, s[16:19], s32 offen offset:1024 lds
    v_mfma_f32_16x16x32_bf16 v[60:63], a[148:151], a[36:39], v[60:63]
    ds_read_b64_tr_b16 a[174:175], v24 offset:43008
    buffer_load_dwordx4 a[180:183], v45, s[16:19], s44 offen offset:16
    v_mfma_f32_16x16x32_bf16 v[132:135], a[230:233], a[32:35], v[132:135]
    s_waitcnt lgkmcnt(8)
    v_mfma_f32_16x16x32_bf16 v[64:67], a[152:155], a[32:35], v[64:67]
    ds_read_b64_tr_b16 a[144:145], v21 offset:32768
    buffer_load_dwordx4 v114, s[16:19], s32 offen offset:2048 lds
    v_mfma_f32_16x16x32_bf16 v[68:71], a[152:155], a[36:39], v[68:71]
    ds_read_b64_tr_b16 a[146:147], v21 offset:34816
    v_mfma_f32_16x16x32_bf16 v[72:75], a[156:159], a[32:35], v[72:75]
    ds_read_b64_tr_b16 a[148:149], v21 offset:45056
    buffer_load_dwordx4 a[184:187], v45, s[16:19], s44 offen offset:32
    v_mfma_f32_16x16x32_bf16 v[76:79], a[156:159], a[36:39], v[76:79]
    ds_read_b64_tr_b16 a[150:151], v21 offset:47104
    s_add_u32 m0, s35, 52224
    s_add_u32 s32, s86, 49152
    buffer_load_dwordx4 v115, s[16:19], s32 offen lds
    v_mfma_f32_16x16x32_bf16 v[140:143], a[32:35], a[32:35], v[140:143]
    s_waitcnt lgkmcnt(8)
    v_mfma_f32_16x16x32_bf16 v[80:83], a[160:163], a[32:35], v[80:83]
    ds_read_b64_tr_b16 a[152:153], v22 offset:32768
    v_mfma_f32_16x16x32_bf16 v[84:87], a[160:163], a[36:39], v[84:87]
    ds_read_b64_tr_b16 a[154:155], v22 offset:34816
    buffer_load_dwordx4 v116, s[16:19], s32 offen offset:1024 lds
    buffer_load_dwordx4 a[188:191], v45, s[16:19], s44 offen offset:48
    v_mfma_f32_16x16x32_bf16 v[88:91], a[164:167], a[32:35], v[88:91]
    ds_read_b64_tr_b16 a[156:157], v22 offset:45056
    v_mfma_f32_16x16x32_bf16 v[92:95], a[164:167], a[36:39], v[92:95]
    ds_read_b64_tr_b16 a[158:159], v22 offset:47104
    v_mfma_f32_16x16x32_bf16 v[136:139], a[230:233], a[36:39], v[136:139]
    buffer_load_dwordx4 v117, s[16:19], s32 offen offset:2048 lds
    s_waitcnt lgkmcnt(8)
    v_mfma_f32_16x16x32_bf16 v[96:99], a[168:171], a[32:35], v[96:99]
    s_waitcnt vmcnt(22)
    s_barrier
    ds_read_b64_tr_b16 a[160:161], v23 offset:32768
    v_add_u32 v120, 98304, v118
    v_add_u32 v121, 98304, v119
    buffer_load_dwordx4 a[192:195], v45, s[16:19], s44 offen offset:64
    v_mfma_f32_16x16x32_bf16 v[100:103], a[168:171], a[36:39], v[100:103]
    ds_read_b64_tr_b16 a[162:163], v23 offset:34816
    ds_read_b64_tr_b16 a[48:49], v120 offset:0
    v_mfma_f32_16x16x32_bf16 v[104:107], a[172:175], a[32:35], v[104:107]
    ds_read_b64_tr_b16 a[164:165], v23 offset:45056
    ds_read_b64_tr_b16 a[50:51], v120 offset:4096
    v_mfma_f32_16x16x32_bf16 v[108:111], a[172:175], a[36:39], v[108:111]
    ds_read_b64_tr_b16 a[166:167], v23 offset:47104
    ds_read_b64_tr_b16 a[52:53], v121 offset:0
    v_mfma_f32_16x16x32_bf16 v[144:147], a[36:39], a[36:39], v[144:147]
    s_waitcnt lgkmcnt(11)
    ds_read_b64_tr_b16 a[54:55], v121 offset:4096
    buffer_load_dwordx4 a[196:199], v45, s[16:19], s44 offen offset:80
    v_mfma_f32_16x16x32_bf16 v[48:51], a[144:147], a[40:43], v[48:51]
    ds_read_b64_tr_b16 a[168:169], v24 offset:32768
    ds_read_b64_tr_b16 a[56:57], v120 offset:8192
    v_mfma_f32_16x16x32_bf16 v[52:55], a[144:147], a[44:47], v[52:55]
    ds_read_b64_tr_b16 a[170:171], v24 offset:34816
    s_waitcnt lgkmcnt(11)
    ds_read_b64_tr_b16 a[58:59], v120 offset:12288
    v_mfma_f32_16x16x32_bf16 v[56:59], a[148:151], a[40:43], v[56:59]
    ds_read_b64_tr_b16 a[172:173], v24 offset:45056
    ds_read_b64_tr_b16 a[60:61], v121 offset:8192
    v_mfma_f32_16x16x32_bf16 v[60:63], a[148:151], a[44:47], v[60:63]
    ds_read_b64_tr_b16 a[174:175], v24 offset:47104
    s_waitcnt lgkmcnt(11)
    ds_read_b64_tr_b16 a[62:63], v121 offset:12288
    buffer_load_dwordx4 a[200:203], v45, s[16:19], s44 offen offset:96
    v_mfma_f32_16x16x32_bf16 v[132:135], a[230:233], a[40:43], v[132:135]
    ds_read_b64_tr_b16 a[64:65], v120 offset:16384
    v_mfma_f32_16x16x32_bf16 v[64:67], a[152:155], a[40:43], v[64:67]
    ds_read_b64_tr_b16 a[144:145], v25 offset:24576
    ds_read_b64_tr_b16 a[66:67], v120 offset:20480
    v_mfma_f32_16x16x32_bf16 v[68:71], a[152:155], a[44:47], v[68:71]
    s_waitcnt lgkmcnt(11)
    ds_read_b64_tr_b16 a[146:147], v25 offset:26624
    ds_read_b64_tr_b16 a[68:69], v121 offset:16384
    v_mfma_f32_16x16x32_bf16 v[72:75], a[156:159], a[40:43], v[72:75]
    ds_read_b64_tr_b16 a[148:149], v25 offset:36864
    ds_read_b64_tr_b16 a[70:71], v121 offset:20480
    buffer_load_dwordx4 a[204:207], v45, s[16:19], s44 offen offset:112
    v_mfma_f32_16x16x32_bf16 v[76:79], a[156:159], a[44:47], v[76:79]
    s_waitcnt lgkmcnt(11)
    ds_read_b64_tr_b16 a[150:151], v25 offset:38912
    v_mfma_f32_16x16x32_bf16 v[140:143], a[40:43], a[40:43], v[140:143]
    v_mfma_f32_16x16x32_bf16 v[80:83], a[160:163], a[40:43], v[80:83]
    ds_read_b64_tr_b16 a[152:153], v26 offset:24576
    v_mfma_f32_16x16x32_bf16 v[84:87], a[160:163], a[44:47], v[84:87]
    ds_read_b64_tr_b16 a[154:155], v26 offset:26624
    buffer_load_dwordx4 a[208:211], v45, s[16:19], s44 offen offset:128
    v_mfma_f32_16x16x32_bf16 v[88:91], a[164:167], a[40:43], v[88:91]
    ds_read_b64_tr_b16 a[156:157], v26 offset:36864
    v_mfma_f32_16x16x32_bf16 v[92:95], a[164:167], a[44:47], v[92:95]
    s_waitcnt lgkmcnt(11)
    ds_read_b64_tr_b16 a[158:159], v26 offset:38912
    v_mfma_f32_16x16x32_bf16 v[136:139], a[230:233], a[44:47], v[136:139]
    v_mfma_f32_16x16x32_bf16 v[96:99], a[168:171], a[40:43], v[96:99]
    ds_read_b64_tr_b16 a[160:161], v27 offset:24576
    v_mfma_f32_16x16x32_bf16 v[100:103], a[168:171], a[44:47], v[100:103]
    ds_read_b64_tr_b16 a[162:163], v27 offset:26624
    v_mfma_f32_16x16x32_bf16 v[104:107], a[172:175], a[40:43], v[104:107]
    ds_read_b64_tr_b16 a[164:165], v27 offset:36864
    v_mfma_f32_16x16x32_bf16 v[108:111], a[172:175], a[44:47], v[108:111]
    s_waitcnt lgkmcnt(11)
    ds_read_b64_tr_b16 a[166:167], v27 offset:38912
    v_mfma_f32_16x16x32_bf16 v[144:147], a[44:47], a[44:47], v[144:147]
    s_waitcnt vmcnt(15)
    s_waitcnt lgkmcnt(9)
    s_barrier
    s_waitcnt lgkmcnt(8)
    v_mfma_f32_16x16x32_bf16 v[48:51], a[144:147], a[48:51], v[48:51]
    ds_read_b64_tr_b16 a[168:169], v28 offset:24576
    v_mfma_f32_16x16x32_bf16 v[52:55], a[144:147], a[52:55], v[52:55]
    ds_read_b64_tr_b16 a[170:171], v28 offset:26624
    s_add_u32 m0, s25, 73728
    s_add_u32 s32, s80, 0
    buffer_load_dwordx4 v1, s[8:11], s32 offen lds
    v_mfma_f32_16x16x32_bf16 v[56:59], a[148:151], a[48:51], v[56:59]
    ds_read_b64_tr_b16 a[172:173], v28 offset:36864
    v_add_u32 v120, 0, v118
    v_add_u32 v121, 0, v119
    v_mfma_f32_16x16x32_bf16 v[60:63], a[148:151], a[52:55], v[60:63]
    ds_read_b64_tr_b16 a[174:175], v28 offset:38912
    ds_read_b64_tr_b16 a[72:73], v120 offset:0
    v_mfma_f32_16x16x32_bf16 v[132:135], a[230:233], a[48:51], v[132:135]
    ds_read_b64_tr_b16 a[74:75], v120 offset:4096
    buffer_load_dwordx4 v2, s[8:11], s32 offen offset:1024 lds
    s_waitcnt lgkmcnt(10)
    v_mfma_f32_16x16x32_bf16 v[64:67], a[152:155], a[48:51], v[64:67]
    ds_read_b64_tr_b16 a[144:145], v25 offset:28672
    ds_read_b64_tr_b16 a[76:77], v121 offset:0
    v_mfma_f32_16x16x32_bf16 v[68:71], a[152:155], a[52:55], v[68:71]
    ds_read_b64_tr_b16 a[146:147], v25 offset:30720
    ds_read_b64_tr_b16 a[78:79], v121 offset:4096
    v_mfma_f32_16x16x32_bf16 v[72:75], a[156:159], a[48:51], v[72:75]
    ds_read_b64_tr_b16 a[148:149], v25 offset:40960
    s_waitcnt lgkmcnt(11)
    ds_read_b64_tr_b16 a[80:81], v120 offset:8192
    buffer_load_dwordx4 v3, s[8:11], s32 offen offset:2048 lds
    v_mfma_f32_16x16x32_bf16 v[76:79], a[156:159], a[52:55], v[76:79]
    ds_read_b64_tr_b16 a[150:151], v25 offset:43008
    ds_read_b64_tr_b16 a[82:83], v120 offset:12288
    v_mfma_f32_16x16x32_bf16 v[140:143], a[48:51], a[48:51], v[140:143]
    ds_read_b64_tr_b16 a[84:85], v121 offset:8192
    v_mfma_f32_16x16x32_bf16 v[80:83], a[160:163], a[48:51], v[80:83]
    s_waitcnt lgkmcnt(11)
    ds_read_b64_tr_b16 a[152:153], v26 offset:28672
    ds_read_b64_tr_b16 a[86:87], v121 offset:12288
    s_add_u32 m0, s25, 76800
    s_add_u32 s32, s80, 221184
    buffer_load_dwordx4 v1, s[8:11], s32 offen lds
    v_mfma_f32_16x16x32_bf16 v[84:87], a[160:163], a[52:55], v[84:87]
    ds_read_b64_tr_b16 a[154:155], v26 offset:30720
    ds_read_b64_tr_b16 a[88:89], v120 offset:16384
    v_mfma_f32_16x16x32_bf16 v[88:91], a[164:167], a[48:51], v[88:91]
    s_waitcnt lgkmcnt(11)
    ds_read_b64_tr_b16 a[156:157], v26 offset:40960
    ds_read_b64_tr_b16 a[90:91], v120 offset:20480
    v_mfma_f32_16x16x32_bf16 v[92:95], a[164:167], a[52:55], v[92:95]
    ds_read_b64_tr_b16 a[158:159], v26 offset:43008
    ds_read_b64_tr_b16 a[92:93], v121 offset:16384
    buffer_load_dwordx4 v2, s[8:11], s32 offen offset:1024 lds
    v_mfma_f32_16x16x32_bf16 v[136:139], a[230:233], a[52:55], v[136:139]
    s_waitcnt lgkmcnt(11)
    ds_read_b64_tr_b16 a[94:95], v121 offset:20480
    v_mfma_f32_16x16x32_bf16 v[96:99], a[168:171], a[48:51], v[96:99]
    ds_read_b64_tr_b16 a[160:161], v27 offset:28672
    v_mfma_f32_16x16x32_bf16 v[100:103], a[168:171], a[52:55], v[100:103]
    ds_read_b64_tr_b16 a[162:163], v27 offset:30720
    buffer_load_dwordx4 v3, s[8:11], s32 offen offset:2048 lds
    v_mfma_f32_16x16x32_bf16 v[104:107], a[172:175], a[48:51], v[104:107]
    ds_read_b64_tr_b16 a[164:165], v27 offset:40960
    v_mfma_f32_16x16x32_bf16 v[108:111], a[172:175], a[52:55], v[108:111]
    s_waitcnt lgkmcnt(11)
    ds_read_b64_tr_b16 a[166:167], v27 offset:43008
    v_mfma_f32_16x16x32_bf16 v[144:147], a[52:55], a[52:55], v[144:147]
    s_add_u32 m0, s35, 98304
    s_add_u32 s32, s87, 0
    buffer_load_dwordx4 v112, s[16:19], s32 offen lds
    v_mfma_f32_16x16x32_bf16 v[48:51], a[144:147], a[56:59], v[48:51]
    ds_read_b64_tr_b16 a[168:169], v28 offset:28672
    v_mfma_f32_16x16x32_bf16 v[52:55], a[144:147], a[60:63], v[52:55]
    ds_read_b64_tr_b16 a[170:171], v28 offset:30720
    v_mfma_f32_16x16x32_bf16 v[56:59], a[148:151], a[56:59], v[56:59]
    ds_read_b64_tr_b16 a[172:173], v28 offset:40960
    buffer_load_dwordx4 v113, s[16:19], s32 offen offset:1024 lds
    v_mfma_f32_16x16x32_bf16 v[60:63], a[148:151], a[60:63], v[60:63]
    s_waitcnt lgkmcnt(11)
    ds_read_b64_tr_b16 a[174:175], v28 offset:43008
    v_mfma_f32_16x16x32_bf16 v[132:135], a[230:233], a[56:59], v[132:135]
    s_waitcnt lgkmcnt(10)
    v_mfma_f32_16x16x32_bf16 v[64:67], a[152:155], a[56:59], v[64:67]
    ds_read_b64_tr_b16 a[144:145], v25 offset:32768
    buffer_load_dwordx4 v114, s[16:19], s32 offen offset:2048 lds
    v_mfma_f32_16x16x32_bf16 v[68:71], a[152:155], a[60:63], v[68:71]
    ds_read_b64_tr_b16 a[146:147], v25 offset:34816
    v_mfma_f32_16x16x32_bf16 v[72:75], a[156:159], a[56:59], v[72:75]
    ds_read_b64_tr_b16 a[148:149], v25 offset:45056
    v_mfma_f32_16x16x32_bf16 v[76:79], a[156:159], a[60:63], v[76:79]
    ds_read_b64_tr_b16 a[150:151], v25 offset:47104
    s_add_u32 m0, s35, 101376
    s_add_u32 s32, s87, 49152
    buffer_load_dwordx4 v115, s[16:19], s32 offen lds
    v_mfma_f32_16x16x32_bf16 v[140:143], a[56:59], a[56:59], v[140:143]
    s_waitcnt lgkmcnt(8)
    v_mfma_f32_16x16x32_bf16 v[80:83], a[160:163], a[56:59], v[80:83]
    ds_read_b64_tr_b16 a[152:153], v26 offset:32768
    v_mfma_f32_16x16x32_bf16 v[84:87], a[160:163], a[60:63], v[84:87]
    ds_read_b64_tr_b16 a[154:155], v26 offset:34816
    buffer_load_dwordx4 v116, s[16:19], s32 offen offset:1024 lds
    v_mfma_f32_16x16x32_bf16 v[88:91], a[164:167], a[56:59], v[88:91]
    ds_read_b64_tr_b16 a[156:157], v26 offset:45056
    v_mfma_f32_16x16x32_bf16 v[92:95], a[164:167], a[60:63], v[92:95]
    ds_read_b64_tr_b16 a[158:159], v26 offset:47104
    v_mfma_f32_16x16x32_bf16 v[136:139], a[230:233], a[60:63], v[136:139]
    buffer_load_dwordx4 v117, s[16:19], s32 offen offset:2048 lds
    s_waitcnt lgkmcnt(8)
    v_mfma_f32_16x16x32_bf16 v[96:99], a[168:171], a[56:59], v[96:99]
    ds_read_b64_tr_b16 a[160:161], v27 offset:32768
    v_mfma_f32_16x16x32_bf16 v[100:103], a[168:171], a[60:63], v[100:103]
    ds_read_b64_tr_b16 a[162:163], v27 offset:34816
    v_mfma_f32_16x16x32_bf16 v[104:107], a[172:175], a[56:59], v[104:107]
    ds_read_b64_tr_b16 a[164:165], v27 offset:45056
    v_mfma_f32_16x16x32_bf16 v[108:111], a[172:175], a[60:63], v[108:111]
    ds_read_b64_tr_b16 a[166:167], v27 offset:47104
    v_mfma_f32_16x16x32_bf16 v[144:147], a[60:63], a[60:63], v[144:147]
    s_waitcnt lgkmcnt(8)
    v_mfma_f32_16x16x32_bf16 v[48:51], a[144:147], a[64:67], v[48:51]
    ds_read_b64_tr_b16 a[168:169], v28 offset:32768
    v_mfma_f32_16x16x32_bf16 v[52:55], a[144:147], a[68:71], v[52:55]
    ds_read_b64_tr_b16 a[170:171], v28 offset:34816
    v_mfma_f32_16x16x32_bf16 v[56:59], a[148:151], a[64:67], v[56:59]
    ds_read_b64_tr_b16 a[172:173], v28 offset:45056
    v_mfma_f32_16x16x32_bf16 v[60:63], a[148:151], a[68:71], v[60:63]
    ds_read_b64_tr_b16 a[174:175], v28 offset:47104
    v_mfma_f32_16x16x32_bf16 v[132:135], a[230:233], a[64:67], v[132:135]
    s_waitcnt lgkmcnt(8)
    v_mfma_f32_16x16x32_bf16 v[64:67], a[152:155], a[64:67], v[64:67]
    ds_read_b64_tr_b16 a[144:145], v17 offset:24576
    v_mfma_f32_16x16x32_bf16 v[68:71], a[152:155], a[68:71], v[68:71]
    ds_read_b64_tr_b16 a[146:147], v17 offset:26624
    v_mfma_f32_16x16x32_bf16 v[72:75], a[156:159], a[64:67], v[72:75]
    ds_read_b64_tr_b16 a[148:149], v17 offset:36864
    v_mfma_f32_16x16x32_bf16 v[76:79], a[156:159], a[68:71], v[76:79]
    ds_read_b64_tr_b16 a[150:151], v17 offset:38912
    v_mfma_f32_16x16x32_bf16 v[140:143], a[64:67], a[64:67], v[140:143]
    s_waitcnt lgkmcnt(8)
    v_mfma_f32_16x16x32_bf16 v[80:83], a[160:163], a[64:67], v[80:83]
    ds_read_b64_tr_b16 a[152:153], v18 offset:24576
    v_mfma_f32_16x16x32_bf16 v[84:87], a[160:163], a[68:71], v[84:87]
    ds_read_b64_tr_b16 a[154:155], v18 offset:26624
    v_mfma_f32_16x16x32_bf16 v[88:91], a[164:167], a[64:67], v[88:91]
    ds_read_b64_tr_b16 a[156:157], v18 offset:36864
    v_mfma_f32_16x16x32_bf16 v[92:95], a[164:167], a[68:71], v[92:95]
    ds_read_b64_tr_b16 a[158:159], v18 offset:38912
    v_mfma_f32_16x16x32_bf16 v[136:139], a[230:233], a[68:71], v[136:139]
    s_waitcnt lgkmcnt(8)
    v_mfma_f32_16x16x32_bf16 v[96:99], a[168:171], a[64:67], v[96:99]
    ds_read_b64_tr_b16 a[160:161], v19 offset:24576
    v_mfma_f32_16x16x32_bf16 v[100:103], a[168:171], a[68:71], v[100:103]
    ds_read_b64_tr_b16 a[162:163], v19 offset:26624
    v_mfma_f32_16x16x32_bf16 v[104:107], a[172:175], a[64:67], v[104:107]
    ds_read_b64_tr_b16 a[164:165], v19 offset:36864
    v_mfma_f32_16x16x32_bf16 v[108:111], a[172:175], a[68:71], v[108:111]
    ds_read_b64_tr_b16 a[166:167], v19 offset:38912
    v_mfma_f32_16x16x32_bf16 v[144:147], a[68:71], a[68:71], v[144:147]
    s_waitcnt vmcnt(6)
    s_barrier
    s_waitcnt lgkmcnt(8)
    v_mfma_f32_16x16x32_bf16 v[48:51], a[144:147], a[72:75], v[48:51]
    ds_read_b64_tr_b16 a[168:169], v20 offset:24576
    v_mfma_f32_16x16x32_bf16 v[52:55], a[144:147], a[76:79], v[52:55]
    ds_read_b64_tr_b16 a[170:171], v20 offset:26624
    s_add_u32 m0, s25, 122880
    s_add_u32 s32, s81, 0
    buffer_load_dwordx4 v1, s[8:11], s32 offen lds
    v_mfma_f32_16x16x32_bf16 v[56:59], a[148:151], a[72:75], v[56:59]
    ds_read_b64_tr_b16 a[172:173], v20 offset:36864
    v_add_u32 v120, 49152, v118
    v_add_u32 v121, 49152, v119
    v_mfma_f32_16x16x32_bf16 v[60:63], a[148:151], a[76:79], v[60:63]
    ds_read_b64_tr_b16 a[174:175], v20 offset:38912
    ds_read_b64_tr_b16 a[96:97], v120 offset:0
    v_mfma_f32_16x16x32_bf16 v[132:135], a[230:233], a[72:75], v[132:135]
    ds_read_b64_tr_b16 a[98:99], v120 offset:4096
    buffer_load_dwordx4 v2, s[8:11], s32 offen offset:1024 lds
    s_waitcnt lgkmcnt(10)
    v_mfma_f32_16x16x32_bf16 v[64:67], a[152:155], a[72:75], v[64:67]
    ds_read_b64_tr_b16 a[144:145], v17 offset:28672
    ds_read_b64_tr_b16 a[100:101], v121 offset:0
    v_mfma_f32_16x16x32_bf16 v[68:71], a[152:155], a[76:79], v[68:71]
    ds_read_b64_tr_b16 a[146:147], v17 offset:30720
    ds_read_b64_tr_b16 a[102:103], v121 offset:4096
    v_mfma_f32_16x16x32_bf16 v[72:75], a[156:159], a[72:75], v[72:75]
    ds_read_b64_tr_b16 a[148:149], v17 offset:40960
    s_waitcnt lgkmcnt(11)
    ds_read_b64_tr_b16 a[104:105], v120 offset:8192
    buffer_load_dwordx4 v3, s[8:11], s32 offen offset:2048 lds
    v_mfma_f32_16x16x32_bf16 v[76:79], a[156:159], a[76:79], v[76:79]
    ds_read_b64_tr_b16 a[150:151], v17 offset:43008
    ds_read_b64_tr_b16 a[106:107], v120 offset:12288
    v_mfma_f32_16x16x32_bf16 v[140:143], a[72:75], a[72:75], v[140:143]
    ds_read_b64_tr_b16 a[108:109], v121 offset:8192
    v_mfma_f32_16x16x32_bf16 v[80:83], a[160:163], a[72:75], v[80:83]
    s_waitcnt lgkmcnt(11)
    ds_read_b64_tr_b16 a[152:153], v18 offset:28672
    ds_read_b64_tr_b16 a[110:111], v121 offset:12288
    s_add_u32 m0, s25, 125952
    s_add_u32 s32, s81, 221184
    buffer_load_dwordx4 v1, s[8:11], s32 offen lds
    v_mfma_f32_16x16x32_bf16 v[84:87], a[160:163], a[76:79], v[84:87]
    ds_read_b64_tr_b16 a[154:155], v18 offset:30720
    ds_read_b64_tr_b16 a[112:113], v120 offset:16384
    v_mfma_f32_16x16x32_bf16 v[88:91], a[164:167], a[72:75], v[88:91]
    s_waitcnt lgkmcnt(11)
    ds_read_b64_tr_b16 a[156:157], v18 offset:40960
    ds_read_b64_tr_b16 a[114:115], v120 offset:20480
    v_mfma_f32_16x16x32_bf16 v[92:95], a[164:167], a[76:79], v[92:95]
    ds_read_b64_tr_b16 a[158:159], v18 offset:43008
    ds_read_b64_tr_b16 a[116:117], v121 offset:16384
    buffer_load_dwordx4 v2, s[8:11], s32 offen offset:1024 lds
    v_mfma_f32_16x16x32_bf16 v[136:139], a[230:233], a[76:79], v[136:139]
    s_waitcnt lgkmcnt(11)
    ds_read_b64_tr_b16 a[118:119], v121 offset:20480
    v_mfma_f32_16x16x32_bf16 v[96:99], a[168:171], a[72:75], v[96:99]
    ds_read_b64_tr_b16 a[160:161], v19 offset:28672
    v_mfma_f32_16x16x32_bf16 v[100:103], a[168:171], a[76:79], v[100:103]
    ds_read_b64_tr_b16 a[162:163], v19 offset:30720
    buffer_load_dwordx4 v3, s[8:11], s32 offen offset:2048 lds
    v_mfma_f32_16x16x32_bf16 v[104:107], a[172:175], a[72:75], v[104:107]
    ds_read_b64_tr_b16 a[164:165], v19 offset:40960
    v_mfma_f32_16x16x32_bf16 v[108:111], a[172:175], a[76:79], v[108:111]
    s_waitcnt lgkmcnt(11)
    ds_read_b64_tr_b16 a[166:167], v19 offset:43008
    v_mfma_f32_16x16x32_bf16 v[144:147], a[76:79], a[76:79], v[144:147]
    s_add_u32 m0, s25, 0
    s_add_u32 s32, s76, 128
    buffer_load_dwordx4 v1, s[8:11], s32 offen lds
    v_mfma_f32_16x16x32_bf16 v[48:51], a[144:147], a[80:83], v[48:51]
    ds_read_b64_tr_b16 a[168:169], v20 offset:28672
    v_mfma_f32_16x16x32_bf16 v[52:55], a[144:147], a[84:87], v[52:55]
    ds_read_b64_tr_b16 a[170:171], v20 offset:30720
    v_mfma_f32_16x16x32_bf16 v[56:59], a[148:151], a[80:83], v[56:59]
    ds_read_b64_tr_b16 a[172:173], v20 offset:40960
    buffer_load_dwordx4 v2, s[8:11], s32 offen offset:1024 lds
    v_mfma_f32_16x16x32_bf16 v[60:63], a[148:151], a[84:87], v[60:63]
    s_waitcnt lgkmcnt(11)
    ds_read_b64_tr_b16 a[174:175], v20 offset:43008
    v_mfma_f32_16x16x32_bf16 v[132:135], a[230:233], a[80:83], v[132:135]
    s_waitcnt lgkmcnt(10)
    v_mfma_f32_16x16x32_bf16 v[64:67], a[152:155], a[80:83], v[64:67]
    ds_read_b64_tr_b16 a[144:145], v17 offset:32768
    buffer_load_dwordx4 v3, s[8:11], s32 offen offset:2048 lds
    v_mfma_f32_16x16x32_bf16 v[68:71], a[152:155], a[84:87], v[68:71]
    ds_read_b64_tr_b16 a[146:147], v17 offset:34816
    v_mfma_f32_16x16x32_bf16 v[72:75], a[156:159], a[80:83], v[72:75]
    ds_read_b64_tr_b16 a[148:149], v17 offset:45056
    v_mfma_f32_16x16x32_bf16 v[76:79], a[156:159], a[84:87], v[76:79]
    ds_read_b64_tr_b16 a[150:151], v17 offset:47104
    s_add_u32 m0, s25, 3072
    s_add_u32 s32, s76, 221312
    buffer_load_dwordx4 v1, s[8:11], s32 offen lds
    v_mfma_f32_16x16x32_bf16 v[140:143], a[80:83], a[80:83], v[140:143]
    s_waitcnt lgkmcnt(8)
    v_mfma_f32_16x16x32_bf16 v[80:83], a[160:163], a[80:83], v[80:83]
    ds_read_b64_tr_b16 a[152:153], v18 offset:32768
    v_mfma_f32_16x16x32_bf16 v[84:87], a[160:163], a[84:87], v[84:87]
    ds_read_b64_tr_b16 a[154:155], v18 offset:34816
    buffer_load_dwordx4 v2, s[8:11], s32 offen offset:1024 lds
    v_mfma_f32_16x16x32_bf16 v[88:91], a[164:167], a[80:83], v[88:91]
    ds_read_b64_tr_b16 a[156:157], v18 offset:45056
    v_mfma_f32_16x16x32_bf16 v[92:95], a[164:167], a[84:87], v[92:95]
    ds_read_b64_tr_b16 a[158:159], v18 offset:47104
    v_mfma_f32_16x16x32_bf16 v[136:139], a[230:233], a[84:87], v[136:139]
    buffer_load_dwordx4 v3, s[8:11], s32 offen offset:2048 lds
    s_waitcnt lgkmcnt(8)
    v_mfma_f32_16x16x32_bf16 v[96:99], a[168:171], a[80:83], v[96:99]
    ds_read_b64_tr_b16 a[160:161], v19 offset:32768
    v_mfma_f32_16x16x32_bf16 v[100:103], a[168:171], a[84:87], v[100:103]
    ds_read_b64_tr_b16 a[162:163], v19 offset:34816
    v_mfma_f32_16x16x32_bf16 v[104:107], a[172:175], a[80:83], v[104:107]
    ds_read_b64_tr_b16 a[164:165], v19 offset:45056
    v_mfma_f32_16x16x32_bf16 v[108:111], a[172:175], a[84:87], v[108:111]
    ds_read_b64_tr_b16 a[166:167], v19 offset:47104
    v_mfma_f32_16x16x32_bf16 v[144:147], a[84:87], a[84:87], v[144:147]
    s_waitcnt lgkmcnt(8)
    v_mfma_f32_16x16x32_bf16 v[48:51], a[144:147], a[88:91], v[48:51]
    ds_read_b64_tr_b16 a[168:169], v20 offset:32768
    v_mfma_f32_16x16x32_bf16 v[52:55], a[144:147], a[92:95], v[52:55]
    ds_read_b64_tr_b16 a[170:171], v20 offset:34816
    v_mfma_f32_16x16x32_bf16 v[56:59], a[148:151], a[88:91], v[56:59]
    ds_read_b64_tr_b16 a[172:173], v20 offset:45056
    v_mfma_f32_16x16x32_bf16 v[60:63], a[148:151], a[92:95], v[60:63]
    ds_read_b64_tr_b16 a[174:175], v20 offset:47104
    v_mfma_f32_16x16x32_bf16 v[132:135], a[230:233], a[88:91], v[132:135]
    s_waitcnt lgkmcnt(8)
    v_mfma_f32_16x16x32_bf16 v[64:67], a[152:155], a[88:91], v[64:67]
    ds_read_b64_tr_b16 a[144:145], v21 offset:24576
    v_mfma_f32_16x16x32_bf16 v[68:71], a[152:155], a[92:95], v[68:71]
    ds_read_b64_tr_b16 a[146:147], v21 offset:26624
    v_mfma_f32_16x16x32_bf16 v[72:75], a[156:159], a[88:91], v[72:75]
    ds_read_b64_tr_b16 a[148:149], v21 offset:36864
    v_mfma_f32_16x16x32_bf16 v[76:79], a[156:159], a[92:95], v[76:79]
    ds_read_b64_tr_b16 a[150:151], v21 offset:38912
    v_mfma_f32_16x16x32_bf16 v[140:143], a[88:91], a[88:91], v[140:143]
    s_waitcnt lgkmcnt(8)
    v_mfma_f32_16x16x32_bf16 v[80:83], a[160:163], a[88:91], v[80:83]
    ds_read_b64_tr_b16 a[152:153], v22 offset:24576
    v_mfma_f32_16x16x32_bf16 v[84:87], a[160:163], a[92:95], v[84:87]
    ds_read_b64_tr_b16 a[154:155], v22 offset:26624
    v_mfma_f32_16x16x32_bf16 v[88:91], a[164:167], a[88:91], v[88:91]
    ds_read_b64_tr_b16 a[156:157], v22 offset:36864
    v_mfma_f32_16x16x32_bf16 v[92:95], a[164:167], a[92:95], v[92:95]
    ds_read_b64_tr_b16 a[158:159], v22 offset:38912
    v_mfma_f32_16x16x32_bf16 v[136:139], a[230:233], a[92:95], v[136:139]
    s_waitcnt lgkmcnt(8)
    v_mfma_f32_16x16x32_bf16 v[96:99], a[168:171], a[88:91], v[96:99]
    ds_read_b64_tr_b16 a[160:161], v23 offset:24576
    v_mfma_f32_16x16x32_bf16 v[100:103], a[168:171], a[92:95], v[100:103]
    ds_read_b64_tr_b16 a[162:163], v23 offset:26624
    v_mfma_f32_16x16x32_bf16 v[104:107], a[172:175], a[88:91], v[104:107]
    ds_read_b64_tr_b16 a[164:165], v23 offset:36864
    v_mfma_f32_16x16x32_bf16 v[108:111], a[172:175], a[92:95], v[108:111]
    ds_read_b64_tr_b16 a[166:167], v23 offset:38912
    v_mfma_f32_16x16x32_bf16 v[144:147], a[92:95], a[92:95], v[144:147]
    s_waitcnt vmcnt(6)
    s_barrier
    s_waitcnt lgkmcnt(8)
    v_mfma_f32_16x16x32_bf16 v[48:51], a[144:147], a[96:99], v[48:51]
    ds_read_b64_tr_b16 a[168:169], v24 offset:24576
    v_mfma_f32_16x16x32_bf16 v[52:55], a[144:147], a[100:103], v[52:55]
    ds_read_b64_tr_b16 a[170:171], v24 offset:26624
    s_add_u32 m0, s25, 24576
    s_add_u32 s32, s77, 128
    buffer_load_dwordx4 v1, s[8:11], s32 offen lds
    v_mfma_f32_16x16x32_bf16 v[56:59], a[148:151], a[96:99], v[56:59]
    ds_read_b64_tr_b16 a[172:173], v24 offset:36864
    v_add_u32 v120, 98304, v118
    v_add_u32 v121, 98304, v119
    v_mfma_f32_16x16x32_bf16 v[60:63], a[148:151], a[100:103], v[60:63]
    ds_read_b64_tr_b16 a[174:175], v24 offset:38912
    ds_read_b64_tr_b16 a[120:121], v120 offset:0
    v_mfma_f32_16x16x32_bf16 v[132:135], a[230:233], a[96:99], v[132:135]
    ds_read_b64_tr_b16 a[122:123], v120 offset:4096
    buffer_load_dwordx4 v2, s[8:11], s32 offen offset:1024 lds
    s_waitcnt lgkmcnt(10)
    v_mfma_f32_16x16x32_bf16 v[64:67], a[152:155], a[96:99], v[64:67]
    ds_read_b64_tr_b16 a[144:145], v21 offset:28672
    ds_read_b64_tr_b16 a[124:125], v121 offset:0
    v_mfma_f32_16x16x32_bf16 v[68:71], a[152:155], a[100:103], v[68:71]
    ds_read_b64_tr_b16 a[146:147], v21 offset:30720
    ds_read_b64_tr_b16 a[126:127], v121 offset:4096
    v_mfma_f32_16x16x32_bf16 v[72:75], a[156:159], a[96:99], v[72:75]
    ds_read_b64_tr_b16 a[148:149], v21 offset:40960
    s_waitcnt lgkmcnt(11)
    ds_read_b64_tr_b16 a[128:129], v120 offset:8192
    buffer_load_dwordx4 v3, s[8:11], s32 offen offset:2048 lds
    v_mfma_f32_16x16x32_bf16 v[76:79], a[156:159], a[100:103], v[76:79]
    ds_read_b64_tr_b16 a[150:151], v21 offset:43008
    ds_read_b64_tr_b16 a[130:131], v120 offset:12288
    v_mfma_f32_16x16x32_bf16 v[140:143], a[96:99], a[96:99], v[140:143]
    ds_read_b64_tr_b16 a[132:133], v121 offset:8192
    v_mfma_f32_16x16x32_bf16 v[80:83], a[160:163], a[96:99], v[80:83]
    s_waitcnt lgkmcnt(11)
    ds_read_b64_tr_b16 a[152:153], v22 offset:28672
    ds_read_b64_tr_b16 a[134:135], v121 offset:12288
    s_add_u32 m0, s25, 27648
    s_add_u32 s32, s77, 221312
    buffer_load_dwordx4 v1, s[8:11], s32 offen lds
    v_mfma_f32_16x16x32_bf16 v[84:87], a[160:163], a[100:103], v[84:87]
    ds_read_b64_tr_b16 a[154:155], v22 offset:30720
    ds_read_b64_tr_b16 a[136:137], v120 offset:16384
    v_mfma_f32_16x16x32_bf16 v[88:91], a[164:167], a[96:99], v[88:91]
    s_waitcnt lgkmcnt(11)
    ds_read_b64_tr_b16 a[156:157], v22 offset:40960
    ds_read_b64_tr_b16 a[138:139], v120 offset:20480
    v_mfma_f32_16x16x32_bf16 v[92:95], a[164:167], a[100:103], v[92:95]
    ds_read_b64_tr_b16 a[158:159], v22 offset:43008
    ds_read_b64_tr_b16 a[140:141], v121 offset:16384
    buffer_load_dwordx4 v2, s[8:11], s32 offen offset:1024 lds
    v_mfma_f32_16x16x32_bf16 v[136:139], a[230:233], a[100:103], v[136:139]
    s_waitcnt lgkmcnt(11)
    ds_read_b64_tr_b16 a[142:143], v121 offset:20480
    v_mfma_f32_16x16x32_bf16 v[96:99], a[168:171], a[96:99], v[96:99]
    ds_read_b64_tr_b16 a[160:161], v23 offset:28672
    v_mfma_f32_16x16x32_bf16 v[100:103], a[168:171], a[100:103], v[100:103]
    ds_read_b64_tr_b16 a[162:163], v23 offset:30720
    buffer_load_dwordx4 v3, s[8:11], s32 offen offset:2048 lds
    v_mfma_f32_16x16x32_bf16 v[104:107], a[172:175], a[96:99], v[104:107]
    ds_read_b64_tr_b16 a[164:165], v23 offset:40960
    v_mfma_f32_16x16x32_bf16 v[108:111], a[172:175], a[100:103], v[108:111]
    s_waitcnt lgkmcnt(11)
    ds_read_b64_tr_b16 a[166:167], v23 offset:43008
    v_mfma_f32_16x16x32_bf16 v[144:147], a[100:103], a[100:103], v[144:147]
    s_add_u32 m0, s25, 49152
    s_add_u32 s32, s78, 128
    buffer_load_dwordx4 v1, s[8:11], s32 offen lds
    v_mfma_f32_16x16x32_bf16 v[48:51], a[144:147], a[104:107], v[48:51]
    ds_read_b64_tr_b16 a[168:169], v24 offset:28672
    v_mfma_f32_16x16x32_bf16 v[52:55], a[144:147], a[108:111], v[52:55]
    ds_read_b64_tr_b16 a[170:171], v24 offset:30720
    v_mfma_f32_16x16x32_bf16 v[56:59], a[148:151], a[104:107], v[56:59]
    ds_read_b64_tr_b16 a[172:173], v24 offset:40960
    buffer_load_dwordx4 v2, s[8:11], s32 offen offset:1024 lds
    v_mfma_f32_16x16x32_bf16 v[60:63], a[148:151], a[108:111], v[60:63]
    s_waitcnt lgkmcnt(11)
    ds_read_b64_tr_b16 a[174:175], v24 offset:43008
    v_mfma_f32_16x16x32_bf16 v[132:135], a[230:233], a[104:107], v[132:135]
    s_waitcnt lgkmcnt(10)
    v_mfma_f32_16x16x32_bf16 v[64:67], a[152:155], a[104:107], v[64:67]
    ds_read_b64_tr_b16 a[144:145], v21 offset:32768
    buffer_load_dwordx4 v3, s[8:11], s32 offen offset:2048 lds
    v_mfma_f32_16x16x32_bf16 v[68:71], a[152:155], a[108:111], v[68:71]
    ds_read_b64_tr_b16 a[146:147], v21 offset:34816
    v_mfma_f32_16x16x32_bf16 v[72:75], a[156:159], a[104:107], v[72:75]
    ds_read_b64_tr_b16 a[148:149], v21 offset:45056
    v_mfma_f32_16x16x32_bf16 v[76:79], a[156:159], a[108:111], v[76:79]
    ds_read_b64_tr_b16 a[150:151], v21 offset:47104
    s_add_u32 m0, s25, 52224
    s_add_u32 s32, s78, 221312
    buffer_load_dwordx4 v1, s[8:11], s32 offen lds
    v_mfma_f32_16x16x32_bf16 v[140:143], a[104:107], a[104:107], v[140:143]
    s_waitcnt lgkmcnt(8)
    v_mfma_f32_16x16x32_bf16 v[80:83], a[160:163], a[104:107], v[80:83]
    ds_read_b64_tr_b16 a[152:153], v22 offset:32768
    v_mfma_f32_16x16x32_bf16 v[84:87], a[160:163], a[108:111], v[84:87]
    ds_read_b64_tr_b16 a[154:155], v22 offset:34816
    buffer_load_dwordx4 v2, s[8:11], s32 offen offset:1024 lds
    v_mfma_f32_16x16x32_bf16 v[88:91], a[164:167], a[104:107], v[88:91]
    ds_read_b64_tr_b16 a[156:157], v22 offset:45056
    v_mfma_f32_16x16x32_bf16 v[92:95], a[164:167], a[108:111], v[92:95]
    ds_read_b64_tr_b16 a[158:159], v22 offset:47104
    v_mfma_f32_16x16x32_bf16 v[136:139], a[230:233], a[108:111], v[136:139]
    buffer_load_dwordx4 v3, s[8:11], s32 offen offset:2048 lds
    s_waitcnt lgkmcnt(8)
    v_mfma_f32_16x16x32_bf16 v[96:99], a[168:171], a[104:107], v[96:99]
    ds_read_b64_tr_b16 a[160:161], v23 offset:32768
    v_mfma_f32_16x16x32_bf16 v[100:103], a[168:171], a[108:111], v[100:103]
    ds_read_b64_tr_b16 a[162:163], v23 offset:34816
    v_mfma_f32_16x16x32_bf16 v[104:107], a[172:175], a[104:107], v[104:107]
    ds_read_b64_tr_b16 a[164:165], v23 offset:45056
    v_mfma_f32_16x16x32_bf16 v[108:111], a[172:175], a[108:111], v[108:111]
    ds_read_b64_tr_b16 a[166:167], v23 offset:47104
    v_mfma_f32_16x16x32_bf16 v[144:147], a[108:111], a[108:111], v[144:147]
    s_waitcnt lgkmcnt(8)
    v_mfma_f32_16x16x32_bf16 v[48:51], a[144:147], a[112:115], v[48:51]
    ds_read_b64_tr_b16 a[168:169], v24 offset:32768
    v_mfma_f32_16x16x32_bf16 v[52:55], a[144:147], a[116:119], v[52:55]
    ds_read_b64_tr_b16 a[170:171], v24 offset:34816
    v_mfma_f32_16x16x32_bf16 v[56:59], a[148:151], a[112:115], v[56:59]
    ds_read_b64_tr_b16 a[172:173], v24 offset:45056
    v_mfma_f32_16x16x32_bf16 v[60:63], a[148:151], a[116:119], v[60:63]
    ds_read_b64_tr_b16 a[174:175], v24 offset:47104
    v_mfma_f32_16x16x32_bf16 v[132:135], a[230:233], a[112:115], v[132:135]
    s_waitcnt lgkmcnt(8)
    v_mfma_f32_16x16x32_bf16 v[64:67], a[152:155], a[112:115], v[64:67]
    ds_read_b64_tr_b16 a[144:145], v25 offset:24576
    v_mfma_f32_16x16x32_bf16 v[68:71], a[152:155], a[116:119], v[68:71]
    ds_read_b64_tr_b16 a[146:147], v25 offset:26624
    v_mfma_f32_16x16x32_bf16 v[72:75], a[156:159], a[112:115], v[72:75]
    ds_read_b64_tr_b16 a[148:149], v25 offset:36864
    v_mfma_f32_16x16x32_bf16 v[76:79], a[156:159], a[116:119], v[76:79]
    ds_read_b64_tr_b16 a[150:151], v25 offset:38912
    v_mfma_f32_16x16x32_bf16 v[140:143], a[112:115], a[112:115], v[140:143]
    s_waitcnt lgkmcnt(8)
    v_mfma_f32_16x16x32_bf16 v[80:83], a[160:163], a[112:115], v[80:83]
    ds_read_b64_tr_b16 a[152:153], v26 offset:24576
    v_mfma_f32_16x16x32_bf16 v[84:87], a[160:163], a[116:119], v[84:87]
    ds_read_b64_tr_b16 a[154:155], v26 offset:26624
    v_mfma_f32_16x16x32_bf16 v[88:91], a[164:167], a[112:115], v[88:91]
    ds_read_b64_tr_b16 a[156:157], v26 offset:36864
    v_mfma_f32_16x16x32_bf16 v[92:95], a[164:167], a[116:119], v[92:95]
    ds_read_b64_tr_b16 a[158:159], v26 offset:38912
    v_mfma_f32_16x16x32_bf16 v[136:139], a[230:233], a[116:119], v[136:139]
    s_waitcnt lgkmcnt(8)
    v_mfma_f32_16x16x32_bf16 v[96:99], a[168:171], a[112:115], v[96:99]
    ds_read_b64_tr_b16 a[160:161], v27 offset:24576
    v_mfma_f32_16x16x32_bf16 v[100:103], a[168:171], a[116:119], v[100:103]
    ds_read_b64_tr_b16 a[162:163], v27 offset:26624
    v_mfma_f32_16x16x32_bf16 v[104:107], a[172:175], a[112:115], v[104:107]
    ds_read_b64_tr_b16 a[164:165], v27 offset:36864
    v_mfma_f32_16x16x32_bf16 v[108:111], a[172:175], a[116:119], v[108:111]
    ds_read_b64_tr_b16 a[166:167], v27 offset:38912
    v_mfma_f32_16x16x32_bf16 v[144:147], a[116:119], a[116:119], v[144:147]
    s_waitcnt vmcnt(12)
    s_barrier
    v_mfma_f32_16x16x32_bf16 v[132:135], a[230:233], a[120:123], v[132:135]
    v_mfma_f32_16x16x32_bf16 v[140:143], a[120:123], a[120:123], v[140:143]
    s_add_u32 m0, s25, 73728
    s_add_u32 s32, s79, 128
    buffer_load_dwordx4 v1, s[8:11], s32 offen lds
    v_mfma_f32_16x16x32_bf16 v[136:139], a[230:233], a[124:127], v[136:139]
    v_mfma_f32_16x16x32_bf16 v[144:147], a[124:127], a[124:127], v[144:147]
    v_mfma_f32_16x16x32_bf16 v[132:135], a[230:233], a[128:131], v[132:135]
    buffer_load_dwordx4 v2, s[8:11], s32 offen offset:1024 lds
    v_mfma_f32_16x16x32_bf16 v[140:143], a[128:131], a[128:131], v[140:143]
    v_mfma_f32_16x16x32_bf16 v[136:139], a[230:233], a[132:135], v[136:139]
    v_mfma_f32_16x16x32_bf16 v[144:147], a[132:135], a[132:135], v[144:147]
    buffer_load_dwordx4 v3, s[8:11], s32 offen offset:2048 lds
    v_mfma_f32_16x16x32_bf16 v[132:135], a[230:233], a[136:139], v[132:135]
    v_mfma_f32_16x16x32_bf16 v[140:143], a[136:139], a[136:139], v[140:143]
    v_mfma_f32_16x16x32_bf16 v[136:139], a[230:233], a[140:143], v[136:139]
    s_add_u32 m0, s25, 76800
    s_add_u32 s32, s79, 221312
    buffer_load_dwordx4 v1, s[8:11], s32 offen lds
    v_mfma_f32_16x16x32_bf16 v[144:147], a[140:143], a[140:143], v[144:147]
    s_waitcnt lgkmcnt(8)
    v_mfma_f32_16x16x32_bf16 v[48:51], a[144:147], a[120:123], v[48:51]
    ds_read_b64_tr_b16 a[168:169], v28 offset:24576
    v_mfma_f32_16x16x32_bf16 v[52:55], a[144:147], a[124:127], v[52:55]
    ds_read_b64_tr_b16 a[170:171], v28 offset:26624
    buffer_load_dwordx4 v2, s[8:11], s32 offen offset:1024 lds
    v_mfma_f32_16x16x32_bf16 v[56:59], a[148:151], a[120:123], v[56:59]
    ds_read_b64_tr_b16 a[172:173], v28 offset:36864
    s_nop 7
    v_bfe_u32 v122, v0, 2, 2
    v_mfma_f32_16x16x32_bf16 v[60:63], a[148:151], a[124:127], v[60:63]
    ds_read_b64_tr_b16 a[174:175], v28 offset:38912
    v_lshrrev_b32 v123, 4, v0
    v_cmp_eq_u32 s[56:57], v122, v123
    v_and_b32 v122, 3, v0
    s_waitcnt lgkmcnt(8)
    v_mfma_f32_16x16x32_bf16 v[64:67], a[152:155], a[120:123], v[64:67]
    ds_read_b64_tr_b16 a[144:145], v25 offset:28672
    buffer_load_dwordx4 v3, s[8:11], s32 offen offset:2048 lds
    v_cmp_eq_u32 s[58:59], 1, v122
    v_cmp_eq_u32 s[30:31], 2, v122
    v_cmp_eq_u32 vcc, 3, v122
    v_mfma_f32_16x16x32_bf16 v[68:71], a[152:155], a[124:127], v[68:71]
    ds_read_b64_tr_b16 a[146:147], v25 offset:30720
    s_nop 1
    v_cndmask_b32 v124, v140, v141, s[58:59]
    v_cndmask_b32 v124, v124, v142, s[30:31]
    v_mfma_f32_16x16x32_bf16 v[72:75], a[156:159], a[120:123], v[72:75]
    ds_read_b64_tr_b16 a[148:149], v25 offset:40960
    v_cndmask_b32 v124, v124, v143, vcc
    v_cndmask_b32 v124, 0, v124, s[56:57]
    v_cndmask_b32 v125, v144, v145, s[58:59]
    v_mfma_f32_16x16x32_bf16 v[76:79], a[156:159], a[124:127], v[76:79]
    ds_read_b64_tr_b16 a[150:151], v25 offset:43008
    s_add_u32 m0, s25, 98304
    s_add_u32 s32, s80, 128
    buffer_load_dwordx4 v1, s[8:11], s32 offen lds
    v_cndmask_b32 v125, v125, v146, s[30:31]
    v_cndmask_b32 v125, v125, v147, vcc
    s_waitcnt lgkmcnt(8)
    v_mfma_f32_16x16x32_bf16 v[80:83], a[160:163], a[120:123], v[80:83]
    ds_read_b64_tr_b16 a[152:153], v26 offset:28672
    v_cndmask_b32 v125, 0, v125, s[56:57]
    v_mov_b32 v130, v124
    s_nop 1
    v_mfma_f32_16x16x32_bf16 v[84:87], a[160:163], a[124:127], v[84:87]
    ds_read_b64_tr_b16 a[154:155], v26 offset:30720
    v_permlane16_swap_b32 v124, v130
    s_nop 1
    v_add_f32 v124, v124, v130
    v_mfma_f32_16x16x32_bf16 v[88:91], a[164:167], a[120:123], v[88:91]
    ds_read_b64_tr_b16 a[156:157], v26 offset:40960
    buffer_load_dwordx4 v2, s[8:11], s32 offen offset:1024 lds
    v_mov_b32 v130, v124
    s_nop 1
    v_permlane32_swap_b32 v124, v130
    v_mfma_f32_16x16x32_bf16 v[92:95], a[164:167], a[124:127], v[92:95]
    ds_read_b64_tr_b16 a[158:159], v26 offset:43008
    s_nop 1
    v_add_f32 v124, v124, v130
    v_mul_f32 v127, 0x3ae38e39, v132
    s_waitcnt lgkmcnt(8)
    v_mfma_f32_16x16x32_bf16 v[96:99], a[168:171], a[120:123], v[96:99]
    ds_read_b64_tr_b16 a[160:161], v27 offset:28672
    v_mul_f32 v128, 0x3ae38e39, v124
    v_fma_f32 v128, -v127, v127, v128
    v_mfma_f32_16x16x32_bf16 v[100:103], a[168:171], a[124:127], v[100:103]
    ds_read_b64_tr_b16 a[162:163], v27 offset:30720
    buffer_load_dwordx4 v3, s[8:11], s32 offen offset:2048 lds
    v_max_f32 v128, 0, v128
    v_cvt_pk_bf16_f32 v129, v127, v128
    v_and_b32 v128, 0xffff0000, v129
    v_mfma_f32_16x16x32_bf16 v[104:107], a[172:175], a[120:123], v[104:107]
    ds_read_b64_tr_b16 a[164:165], v27 offset:40960
    v_add_f32 v128, 0x3727c5ac, v128
    v_cvt_pk_bf16_f32 v128, v128, v128
    v_and_b32 v128, 0xffff0000, v128
    v_mfma_f32_16x16x32_bf16 v[108:111], a[172:175], a[124:127], v[108:111]
    ds_read_b64_tr_b16 a[166:167], v27 offset:43008
    v_sqrt_f32 v128, v128
    s_nop 0
    v_cvt_pk_bf16_f32 v128, v128, v128
    s_waitcnt lgkmcnt(8)
    v_mfma_f32_16x16x32_bf16 v[48:51], a[144:147], a[128:131], v[48:51]
    ds_read_b64_tr_b16 a[168:169], v28 offset:28672
    s_add_u32 m0, s25, 101376
    s_add_u32 s32, s80, 221312
    buffer_load_dwordx4 v1, s[8:11], s32 offen lds
    v_and_b32 v128, 0xffff0000, v128
    v_mul_f32 v14, v128, v128
    v_rcp_f32 v128, v128
    v_mfma_f32_16x16x32_bf16 v[52:55], a[144:147], a[132:135], v[52:55]
    ds_read_b64_tr_b16 a[170:171], v28 offset:30720
    s_nop 0
    v_mul_f32 v10, 0xc0135761, v128
    v_mfma_f32_16x16x32_bf16 v[56:59], a[148:151], a[128:131], v[56:59]
    ds_read_b64_tr_b16 a[172:173], v28 offset:40960
    v_mul_f32 v12, v128, v128
    v_mul_f32 v12, v12, v128
    v_mul_f32 v12, 0xbdd2d3e8, v12
    v_mfma_f32_16x16x32_bf16 v[60:63], a[148:151], a[132:135], v[60:63]
    ds_read_b64_tr_b16 a[174:175], v28 offset:43008
    buffer_load_dwordx4 v2, s[8:11], s32 offen offset:1024 lds
    v_and_b32 v129, 0xffff, v129
    v_xor_b32 v129, 0x8000, v129
    v_lshl_or_b32 v129, v129, 16, v129
    s_waitcnt lgkmcnt(8)
    v_mfma_f32_16x16x32_bf16 v[64:67], a[152:155], a[128:131], v[64:67]
    ds_read_b64_tr_b16 a[144:145], v25 offset:32768
    v_cmp_gt_u32 vcc, 16, v0
    s_nop 1
    v_cndmask_b32 v129, 0, v129, vcc
    v_mfma_f32_16x16x32_bf16 v[68:71], a[152:155], a[132:135], v[68:71]
    ds_read_b64_tr_b16 a[146:147], v25 offset:34816
    v_mov_b32 v127, 0
    s_nop 0
    v_accvgpr_write_b32 a214, v129
    v_mfma_f32_16x16x32_bf16 v[72:75], a[156:159], a[128:131], v[72:75]
    ds_read_b64_tr_b16 a[148:149], v25 offset:45056
    buffer_load_dwordx4 v3, s[8:11], s32 offen offset:2048 lds
    v_accvgpr_write_b32 a215, v127
    v_accvgpr_write_b32 a216, v127
    v_mfma_f32_16x16x32_bf16 v[76:79], a[156:159], a[132:135], v[76:79]
    ds_read_b64_tr_b16 a[150:151], v25 offset:47104
    v_accvgpr_write_b32 a217, v127
    v_accvgpr_write_b32 a218, v127
    v_accvgpr_write_b32 a219, v129
    s_waitcnt lgkmcnt(8)
    v_mfma_f32_16x16x32_bf16 v[80:83], a[160:163], a[128:131], v[80:83]
    ds_read_b64_tr_b16 a[152:153], v26 offset:32768
    v_accvgpr_write_b32 a220, v127
    v_accvgpr_write_b32 a221, v127
    v_mov_b32 v130, v125
    v_mfma_f32_16x16x32_bf16 v[84:87], a[160:163], a[132:135], v[84:87]
    ds_read_b64_tr_b16 a[154:155], v26 offset:34816
    s_nop 1
    v_permlane16_swap_b32 v125, v130
    s_nop 1
    v_mfma_f32_16x16x32_bf16 v[88:91], a[164:167], a[128:131], v[88:91]
    ds_read_b64_tr_b16 a[156:157], v26 offset:45056
    v_add_f32 v125, v125, v130
    v_mov_b32 v130, v125
    s_nop 1
    v_mfma_f32_16x16x32_bf16 v[92:95], a[164:167], a[132:135], v[92:95]
    ds_read_b64_tr_b16 a[158:159], v26 offset:47104
    v_permlane32_swap_b32 v125, v130
    s_nop 1
    s_waitcnt lgkmcnt(8)
    v_mfma_f32_16x16x32_bf16 v[96:99], a[168:171], a[128:131], v[96:99]
    ds_read_b64_tr_b16 a[160:161], v27 offset:32768
    v_add_f32 v125, v125, v130
    v_mul_f32 v127, 0x3ae38e39, v136
    v_mul_f32 v128, 0x3ae38e39, v125
    v_mfma_f32_16x16x32_bf16 v[100:103], a[168:171], a[132:135], v[100:103]
    ds_read_b64_tr_b16 a[162:163], v27 offset:34816
    v_fma_f32 v128, -v127, v127, v128
    v_max_f32 v128, 0, v128
    v_cvt_pk_bf16_f32 v129, v127, v128
    v_mfma_f32_16x16x32_bf16 v[104:107], a[172:175], a[128:131], v[104:107]
    ds_read_b64_tr_b16 a[164:165], v27 offset:45056
    v_and_b32 v128, 0xffff0000, v129
    v_add_f32 v128, 0x3727c5ac, v128
    v_cvt_pk_bf16_f32 v128, v128, v128
    v_mfma_f32_16x16x32_bf16 v[108:111], a[172:175], a[132:135], v[108:111]
    ds_read_b64_tr_b16 a[166:167], v27 offset:47104
    v_and_b32 v128, 0xffff0000, v128
    v_sqrt_f32 v128, v128
    s_waitcnt lgkmcnt(8)
    v_mfma_f32_16x16x32_bf16 v[48:51], a[144:147], a[136:139], v[48:51]
    ds_read_b64_tr_b16 a[168:169], v28 offset:32768
    s_nop 0
    v_cvt_pk_bf16_f32 v128, v128, v128
    v_and_b32 v128, 0xffff0000, v128
    v_mfma_f32_16x16x32_bf16 v[52:55], a[144:147], a[140:143], v[52:55]
    ds_read_b64_tr_b16 a[170:171], v28 offset:34816
    v_mul_f32 v15, v128, v128
    v_rcp_f32 v128, v128
    s_nop 0
    v_mfma_f32_16x16x32_bf16 v[56:59], a[148:151], a[136:139], v[56:59]
    ds_read_b64_tr_b16 a[172:173], v28 offset:45056
    v_mul_f32 v11, 0xc0135761, v128
    v_mul_f32 v13, v128, v128
    v_mul_f32 v13, v13, v128
    v_mfma_f32_16x16x32_bf16 v[60:63], a[148:151], a[140:143], v[60:63]
    ds_read_b64_tr_b16 a[174:175], v28 offset:47104
    v_mul_f32 v13, 0xbdd2d3e8, v13
    v_and_b32 v129, 0xffff, v129
    v_xor_b32 v129, 0x8000, v129
    s_waitcnt lgkmcnt(8)
    v_mfma_f32_16x16x32_bf16 v[64:67], a[152:155], a[136:139], v[64:67]
    ds_read_b64_tr_b16 a[144:145], v17 offset:0
    v_lshl_or_b32 v129, v129, 16, v129
    v_cmp_gt_u32 vcc, 16, v0
    v_mfma_f32_16x16x32_bf16 v[68:71], a[152:155], a[140:143], v[68:71]
    ds_read_b64_tr_b16 a[146:147], v17 offset:2048
    s_nop 1
    v_cndmask_b32 v129, 0, v129, vcc
    v_mov_b32 v127, 0
    v_mfma_f32_16x16x32_bf16 v[72:75], a[156:159], a[136:139], v[72:75]
    ds_read_b64_tr_b16 a[148:149], v17 offset:12288
    s_nop 0
    v_accvgpr_write_b32 a222, v129
    v_accvgpr_write_b32 a223, v127
    v_mfma_f32_16x16x32_bf16 v[76:79], a[156:159], a[140:143], v[76:79]
    ds_read_b64_tr_b16 a[150:151], v17 offset:14336
    v_accvgpr_write_b32 a224, v127
    v_accvgpr_write_b32 a225, v127
    v_accvgpr_write_b32 a226, v127
    s_waitcnt lgkmcnt(8)
    v_mfma_f32_16x16x32_bf16 v[80:83], a[160:163], a[136:139], v[80:83]
    ds_read_b64_tr_b16 a[152:153], v18 offset:0
    v_accvgpr_write_b32 a227, v129
    v_accvgpr_write_b32 a228, v127
    v_accvgpr_write_b32 a229, v127
    v_mfma_f32_16x16x32_bf16 v[84:87], a[160:163], a[140:143], v[84:87]
    ds_read_b64_tr_b16 a[154:155], v18 offset:2048
    v_accvgpr_write_b32 a212, v127
    v_accvgpr_write_b32 a213, v127
    v_mfma_f32_16x16x32_bf16 v[88:91], a[164:167], a[136:139], v[88:91]
    ds_read_b64_tr_b16 a[156:157], v18 offset:12288
    s_nop 1
    v_mfma_f32_16x16x32_bf16 v[92:95], a[164:167], a[140:143], v[92:95]
    ds_read_b64_tr_b16 a[158:159], v18 offset:14336
    s_waitcnt lgkmcnt(8)
    v_mfma_f32_16x16x32_bf16 v[96:99], a[168:171], a[136:139], v[96:99]
    ds_read_b64_tr_b16 a[160:161], v19 offset:0
    v_mfma_f32_16x16x32_bf16 v[100:103], a[168:171], a[140:143], v[100:103]
    ds_read_b64_tr_b16 a[162:163], v19 offset:2048
    v_mfma_f32_16x16x32_bf16 v[104:107], a[172:175], a[136:139], v[104:107]
    ds_read_b64_tr_b16 a[164:165], v19 offset:12288
    v_mfma_f32_16x16x32_bf16 v[108:111], a[172:175], a[140:143], v[108:111]
    ds_read_b64_tr_b16 a[166:167], v19 offset:14336
    v_mfma_f32_16x16x32_bf16 v[48:51], a[176:179], a[214:217], v[48:51]
    v_mfma_f32_16x16x32_bf16 v[52:55], a[176:179], a[222:225], v[52:55]
    v_mfma_f32_16x16x32_bf16 v[56:59], a[176:179], a[218:221], v[56:59]
    v_mfma_f32_16x16x32_bf16 v[60:63], a[176:179], a[226:229], v[60:63]
    v_mfma_f32_16x16x32_bf16 v[64:67], a[178:181], a[214:217], v[64:67]
    v_mfma_f32_16x16x32_bf16 v[68:71], a[178:181], a[222:225], v[68:71]
    v_mfma_f32_16x16x32_bf16 v[72:75], a[178:181], a[218:221], v[72:75]
    v_mfma_f32_16x16x32_bf16 v[76:79], a[178:181], a[226:229], v[76:79]
    v_mfma_f32_16x16x32_bf16 v[80:83], a[180:183], a[214:217], v[80:83]
    v_mfma_f32_16x16x32_bf16 v[84:87], a[180:183], a[222:225], v[84:87]
    v_mfma_f32_16x16x32_bf16 v[88:91], a[180:183], a[218:221], v[88:91]
    v_mfma_f32_16x16x32_bf16 v[92:95], a[180:183], a[226:229], v[92:95]
    v_mfma_f32_16x16x32_bf16 v[96:99], a[182:185], a[214:217], v[96:99]
    v_mfma_f32_16x16x32_bf16 v[100:103], a[182:185], a[222:225], v[100:103]
    v_mfma_f32_16x16x32_bf16 v[104:107], a[182:185], a[218:221], v[104:107]
    v_mfma_f32_16x16x32_bf16 v[108:111], a[182:185], a[226:229], v[108:111]
    s_waitcnt vmcnt(18)
    s_barrier
    s_waitcnt lgkmcnt(8)
    v_mfma_f32_16x16x32_bf16 v[112:115], a[144:147], a[0:3], 0
    ds_read_b64_tr_b16 a[168:169], v20 offset:0
    v_mfma_f32_16x16x32_bf16 v[116:119], a[144:147], a[4:7], 0
    ds_read_b64_tr_b16 a[170:171], v20 offset:2048
    s_add_u32 m0, s25, 122880
    s_add_u32 s32, s81, 128
    buffer_load_dwordx4 v1, s[8:11], s32 offen lds
    v_mfma_f32_16x16x32_bf16 v[120:123], a[148:151], a[0:3], 0
    ds_read_b64_tr_b16 a[172:173], v20 offset:12288
    v_mfma_f32_16x16x32_bf16 v[124:127], a[148:151], a[4:7], 0
    ds_read_b64_tr_b16 a[174:175], v20 offset:14336
    s_waitcnt lgkmcnt(8)
    v_mfma_f32_16x16x32_bf16 v[128:131], a[152:155], a[0:3], 0
    ds_read_b64_tr_b16 a[144:145], v17 offset:4096
    buffer_load_dwordx4 v2, s[8:11], s32 offen offset:1024 lds
    v_mfma_f32_16x16x32_bf16 v[132:135], a[152:155], a[4:7], 0
    ds_read_b64_tr_b16 a[146:147], v17 offset:6144
    v_mfma_f32_16x16x32_bf16 v[136:139], a[156:159], a[0:3], 0
    ds_read_b64_tr_b16 a[148:149], v17 offset:16384
    s_and_b32 s44, s22, 15
    v_mfma_f32_16x16x32_bf16 v[140:143], a[156:159], a[4:7], 0
    ds_read_b64_tr_b16 a[150:151], v17 offset:18432
    buffer_load_dwordx4 v3, s[8:11], s32 offen offset:2048 lds
    s_mul_i32 s44, s44, 162
    s_waitcnt lgkmcnt(8)
    v_mfma_f32_16x16x32_bf16 v[144:147], a[160:163], a[0:3], 0
    ds_read_b64_tr_b16 a[152:153], v18 offset:4096
    s_mul_i32 s45, s20, 41
    v_mfma_f32_16x16x32_bf16 v[148:151], a[160:163], a[4:7], 0
    ds_read_b64_tr_b16 a[154:155], v18 offset:6144
    s_add_u32 s44, s44, s45
    v_mfma_f32_16x16x32_bf16 v[152:155], a[164:167], a[0:3], 0
    ds_read_b64_tr_b16 a[156:157], v18 offset:16384
    s_add_u32 m0, s25, 125952
    s_add_u32 s32, s81, 221312
    buffer_load_dwordx4 v1, s[8:11], s32 offen lds
    s_lshl_b32 s44, s44, 7
    v_mfma_f32_16x16x32_bf16 v[156:159], a[164:167], a[4:7], 0
    ds_read_b64_tr_b16 a[158:159], v18 offset:18432
    s_mul_i32 s45, s21, 331776
    s_add_u32 s44, s44, s45
    s_waitcnt lgkmcnt(8)
    v_mfma_f32_16x16x32_bf16 v[160:163], a[168:171], a[0:3], 0
    ds_read_b64_tr_b16 a[160:161], v19 offset:4096
    v_add_u32 v46, 0, v0
    v_mfma_f32_16x16x32_bf16 v[164:167], a[168:171], a[4:7], 0
    ds_read_b64_tr_b16 a[162:163], v19 offset:6144
    buffer_load_dwordx4 v2, s[8:11], s32 offen offset:1024 lds
    v_cmp_gt_u32 vcc, 41, v46
    v_mfma_f32_16x16x32_bf16 v[168:171], a[172:175], a[0:3], 0
    ds_read_b64_tr_b16 a[164:165], v19 offset:16384
    v_lshlrev_b32 v46, 7, v46
    v_mfma_f32_16x16x32_bf16 v[172:175], a[172:175], a[4:7], 0
    ds_read_b64_tr_b16 a[166:167], v19 offset:18432
    v_mov_b32 v47, 0x7fffffff
    s_waitcnt lgkmcnt(8)
    v_mfma_f32_16x16x32_bf16 v[112:115], a[144:147], a[8:11], v[112:115]
    ds_read_b64_tr_b16 a[168:169], v20 offset:4096
    buffer_load_dwordx4 v3, s[8:11], s32 offen offset:2048 lds
    s_nop 0
    v_cndmask_b32 v46, v47, v46, vcc
    v_mfma_f32_16x16x32_bf16 v[116:119], a[144:147], a[12:15], v[116:119]
    ds_read_b64_tr_b16 a[170:171], v20 offset:6144
    buffer_load_dword v45, v46, s[12:15], s44 offen
    v_mfma_f32_16x16x32_bf16 v[120:123], a[148:151], a[8:11], v[120:123]
    ds_read_b64_tr_b16 a[172:173], v20 offset:16384
    v_mul_f32 v248, v48, v48
    v_mfma_f32_16x16x32_bf16 v[124:127], a[148:151], a[12:15], v[124:127]
    ds_read_b64_tr_b16 a[174:175], v20 offset:18432
    v_mul_f32 v249, v49, v49
    s_waitcnt lgkmcnt(8)
    v_mfma_f32_16x16x32_bf16 v[128:131], a[152:155], a[8:11], v[128:131]
    ds_read_b64_tr_b16 a[144:145], v17 offset:8192
    v_fma_f32 v248, v248, v12, v10
    v_mfma_f32_16x16x32_bf16 v[132:135], a[152:155], a[12:15], v[132:135]
    ds_read_b64_tr_b16 a[146:147], v17 offset:10240
    v_fma_f32 v249, v249, v12, v10
    v_mul_f32 v248, v48, v248
    v_mfma_f32_16x16x32_bf16 v[136:139], a[156:159], a[8:11], v[136:139]
    ds_read_b64_tr_b16 a[148:149], v17 offset:20480
    v_mul_f32 v249, v49, v249
    v_mfma_f32_16x16x32_bf16 v[140:143], a[156:159], a[12:15], v[140:143]
    ds_read_b64_tr_b16 a[150:151], v17 offset:22528
    s_waitcnt lgkmcnt(8)
    v_mfma_f32_16x16x32_bf16 v[144:147], a[160:163], a[8:11], v[144:147]
    ds_read_b64_tr_b16 a[152:153], v18 offset:8192
    v_exp_f32 v248, v248
    v_mfma_f32_16x16x32_bf16 v[148:151], a[160:163], a[12:15], v[148:151]
    ds_read_b64_tr_b16 a[154:155], v18 offset:10240
    v_mfma_f32_16x16x32_bf16 v[152:155], a[164:167], a[8:11], v[152:155]
    ds_read_b64_tr_b16 a[156:157], v18 offset:20480
    v_exp_f32 v249, v249
    v_mul_f32 v250, v48, v56
    v_mfma_f32_16x16x32_bf16 v[156:159], a[164:167], a[12:15], v[156:159]
    ds_read_b64_tr_b16 a[158:159], v18 offset:22528
    v_mul_f32 v251, v49, v57
    s_waitcnt lgkmcnt(8)
    v_mfma_f32_16x16x32_bf16 v[160:163], a[168:171], a[8:11], v[160:163]
    ds_read_b64_tr_b16 a[160:161], v19 offset:8192
    v_fma_f32 v248, v248, v14, v14
    v_mfma_f32_16x16x32_bf16 v[164:167], a[168:171], a[12:15], v[164:167]
    ds_read_b64_tr_b16 a[162:163], v19 offset:10240
    v_fma_f32 v249, v249, v14, v14
    v_mfma_f32_16x16x32_bf16 v[168:171], a[172:175], a[8:11], v[168:171]
    ds_read_b64_tr_b16 a[164:165], v19 offset:20480
    v_mfma_f32_16x16x32_bf16 v[172:175], a[172:175], a[12:15], v[172:175]
    ds_read_b64_tr_b16 a[166:167], v19 offset:22528
    v_rcp_f32 v248, v248
    s_waitcnt lgkmcnt(8)
    v_mfma_f32_16x16x32_bf16 v[112:115], a[144:147], a[16:19], v[112:115]
    ds_read_b64_tr_b16 a[168:169], v20 offset:8192
    v_rcp_f32 v249, v249
    v_mfma_f32_16x16x32_bf16 v[116:119], a[144:147], a[20:23], v[116:119]
    ds_read_b64_tr_b16 a[170:171], v20 offset:10240
    v_mul_f32 v250, v250, v248
    v_mfma_f32_16x16x32_bf16 v[120:123], a[148:151], a[16:19], v[120:123]
    ds_read_b64_tr_b16 a[172:173], v20 offset:20480
    v_mul_f32 v251, v251, v249
    v_mfma_f32_16x16x32_bf16 v[124:127], a[148:151], a[20:23], v[124:127]
    ds_read_b64_tr_b16 a[174:175], v20 offset:22528
    v_cvt_pk_bf16_f32 v176, v250, v251
    s_waitcnt lgkmcnt(8)
    v_mfma_f32_16x16x32_bf16 v[128:131], a[152:155], a[16:19], v[128:131]
    ds_read_b64_tr_b16 a[144:145], v17 offset:24576
    v_mul_f32 v252, v50, v50
    v_mul_f32 v253, v51, v51
    v_mfma_f32_16x16x32_bf16 v[132:135], a[152:155], a[20:23], v[132:135]
    ds_read_b64_tr_b16 a[146:147], v17 offset:26624
    v_fma_f32 v252, v252, v12, v10
    v_mfma_f32_16x16x32_bf16 v[136:139], a[156:159], a[16:19], v[136:139]
    ds_read_b64_tr_b16 a[148:149], v17 offset:36864
    v_fma_f32 v253, v253, v12, v10
    v_mfma_f32_16x16x32_bf16 v[140:143], a[156:159], a[20:23], v[140:143]
    ds_read_b64_tr_b16 a[150:151], v17 offset:38912
    v_mul_f32 v252, v50, v252
    s_waitcnt lgkmcnt(8)
    v_mfma_f32_16x16x32_bf16 v[144:147], a[160:163], a[16:19], v[144:147]
    ds_read_b64_tr_b16 a[152:153], v18 offset:24576
    v_mul_f32 v253, v51, v253
    v_mfma_f32_16x16x32_bf16 v[148:151], a[160:163], a[20:23], v[148:151]
    ds_read_b64_tr_b16 a[154:155], v18 offset:26624
    v_exp_f32 v252, v252
    v_mfma_f32_16x16x32_bf16 v[152:155], a[164:167], a[16:19], v[152:155]
    ds_read_b64_tr_b16 a[156:157], v18 offset:36864
    v_mfma_f32_16x16x32_bf16 v[156:159], a[164:167], a[20:23], v[156:159]
    ds_read_b64_tr_b16 a[158:159], v18 offset:38912
    v_exp_f32 v253, v253
    s_waitcnt lgkmcnt(8)
    v_mfma_f32_16x16x32_bf16 v[160:163], a[168:171], a[16:19], v[160:163]
    ds_read_b64_tr_b16 a[160:161], v19 offset:24576
    v_mul_f32 v254, v50, v58
    v_mfma_f32_16x16x32_bf16 v[164:167], a[168:171], a[20:23], v[164:167]
    ds_read_b64_tr_b16 a[162:163], v19 offset:26624
    v_mul_f32 v255, v51, v59
    v_mfma_f32_16x16x32_bf16 v[168:171], a[172:175], a[16:19], v[168:171]
    ds_read_b64_tr_b16 a[164:165], v19 offset:36864
    v_fma_f32 v252, v252, v14, v14
    v_fma_f32 v253, v253, v14, v14
    v_mfma_f32_16x16x32_bf16 v[172:175], a[172:175], a[20:23], v[172:175]
    ds_read_b64_tr_b16 a[166:167], v19 offset:38912
    s_waitcnt vmcnt(19)
    s_barrier
    s_waitcnt lgkmcnt(8)
    v_mfma_f32_16x16x32_bf16 v[112:115], a[144:147], a[24:27], v[112:115]
    ds_read_b64_tr_b16 a[168:169], v20 offset:24576
    v_rcp_f32 v252, v252
    v_mfma_f32_16x16x32_bf16 v[116:119], a[144:147], a[28:31], v[116:119]
    ds_read_b64_tr_b16 a[170:171], v20 offset:26624
    s_add_u32 m0, s25, 0
    s_add_u32 s32, s76, 256
    buffer_load_dwordx4 v1, s[8:11], s32 offen lds
    v_mfma_f32_16x16x32_bf16 v[120:123], a[148:151], a[24:27], v[120:123]
    ds_read_b64_tr_b16 a[172:173], v20 offset:36864
    v_rcp_f32 v253, v253
    v_mfma_f32_16x16x32_bf16 v[124:127], a[148:151], a[28:31], v[124:127]
    ds_read_b64_tr_b16 a[174:175], v20 offset:38912
    v_mul_f32 v254, v254, v252
    v_mul_f32 v255, v255, v253
    s_waitcnt lgkmcnt(8)
    v_mfma_f32_16x16x32_bf16 v[128:131], a[152:155], a[24:27], v[128:131]
    ds_read_b64_tr_b16 a[144:145], v17 offset:28672
    buffer_load_dwordx4 v2, s[8:11], s32 offen offset:1024 lds
    v_cvt_pk_bf16_f32 v177, v254, v255
    v_mfma_f32_16x16x32_bf16 v[132:135], a[152:155], a[28:31], v[132:135]
    ds_read_b64_tr_b16 a[146:147], v17 offset:30720
    v_mul_f32 v248, v52, v52
    v_mfma_f32_16x16x32_bf16 v[136:139], a[156:159], a[24:27], v[136:139]
    ds_read_b64_tr_b16 a[148:149], v17 offset:40960
    v_mul_f32 v249, v53, v53
    v_mfma_f32_16x16x32_bf16 v[140:143], a[156:159], a[28:31], v[140:143]
    ds_read_b64_tr_b16 a[150:151], v17 offset:43008
    buffer_load_dwordx4 v3, s[8:11], s32 offen offset:2048 lds
    v_fma_f32 v248, v248, v13, v11
    s_waitcnt lgkmcnt(8)
    v_mfma_f32_16x16x32_bf16 v[144:147], a[160:163], a[24:27], v[144:147]
    ds_read_b64_tr_b16 a[152:153], v18 offset:28672
    v_fma_f32 v249, v249, v13, v11
    v_mul_f32 v248, v52, v248
    v_mfma_f32_16x16x32_bf16 v[148:151], a[160:163], a[28:31], v[148:151]
    ds_read_b64_tr_b16 a[154:155], v18 offset:30720
    v_mul_f32 v249, v53, v249
    v_mfma_f32_16x16x32_bf16 v[152:155], a[164:167], a[24:27], v[152:155]
    ds_read_b64_tr_b16 a[156:157], v18 offset:40960
    s_add_u32 m0, s25, 3072
    s_add_u32 s32, s76, 221440
    buffer_load_dwordx4 v1, s[8:11], s32 offen lds
    v_mfma_f32_16x16x32_bf16 v[156:159], a[164:167], a[28:31], v[156:159]
    ds_read_b64_tr_b16 a[158:159], v18 offset:43008
    v_exp_f32 v248, v248
    s_waitcnt lgkmcnt(8)
    v_mfma_f32_16x16x32_bf16 v[160:163], a[168:171], a[24:27], v[160:163]
    ds_read_b64_tr_b16 a[160:161], v19 offset:28672
    v_mfma_f32_16x16x32_bf16 v[164:167], a[168:171], a[28:31], v[164:167]
    ds_read_b64_tr_b16 a[162:163], v19 offset:30720
    buffer_load_dwordx4 v2, s[8:11], s32 offen offset:1024 lds
    v_exp_f32 v249, v249
    v_mul_f32 v250, v52, v60
    v_mfma_f32_16x16x32_bf16 v[168:171], a[172:175], a[24:27], v[168:171]
    ds_read_b64_tr_b16 a[164:165], v19 offset:40960
    v_mul_f32 v251, v53, v61
    v_mfma_f32_16x16x32_bf16 v[172:175], a[172:175], a[28:31], v[172:175]
    ds_read_b64_tr_b16 a[166:167], v19 offset:43008
    v_fma_f32 v248, v248, v15, v15
    s_waitcnt lgkmcnt(8)
    v_mfma_f32_16x16x32_bf16 v[112:115], a[144:147], a[32:35], v[112:115]
    ds_read_b64_tr_b16 a[168:169], v20 offset:28672
    buffer_load_dwordx4 v3, s[8:11], s32 offen offset:2048 lds
    v_fma_f32 v249, v249, v15, v15
    v_mfma_f32_16x16x32_bf16 v[116:119], a[144:147], a[36:39], v[116:119]
    ds_read_b64_tr_b16 a[170:171], v20 offset:30720
    v_mfma_f32_16x16x32_bf16 v[120:123], a[148:151], a[32:35], v[120:123]
    ds_read_b64_tr_b16 a[172:173], v20 offset:40960
    v_rcp_f32 v248, v248
    v_mfma_f32_16x16x32_bf16 v[124:127], a[148:151], a[36:39], v[124:127]
    ds_read_b64_tr_b16 a[174:175], v20 offset:43008
    v_rcp_f32 v249, v249
    s_waitcnt lgkmcnt(8)
    v_mfma_f32_16x16x32_bf16 v[128:131], a[152:155], a[32:35], v[128:131]
    ds_read_b64_tr_b16 a[144:145], v17 offset:32768
    v_mul_f32 v250, v250, v248
    v_mfma_f32_16x16x32_bf16 v[132:135], a[152:155], a[36:39], v[132:135]
    ds_read_b64_tr_b16 a[146:147], v17 offset:34816
    v_mul_f32 v251, v251, v249
    v_mfma_f32_16x16x32_bf16 v[136:139], a[156:159], a[32:35], v[136:139]
    ds_read_b64_tr_b16 a[148:149], v17 offset:45056
    v_cvt_pk_bf16_f32 v180, v250, v251
    v_mfma_f32_16x16x32_bf16 v[140:143], a[156:159], a[36:39], v[140:143]
    ds_read_b64_tr_b16 a[150:151], v17 offset:47104
    v_mul_f32 v252, v54, v54
    v_mul_f32 v253, v55, v55
    s_waitcnt lgkmcnt(8)
    v_mfma_f32_16x16x32_bf16 v[144:147], a[160:163], a[32:35], v[144:147]
    ds_read_b64_tr_b16 a[152:153], v18 offset:32768
    v_fma_f32 v252, v252, v13, v11
    v_mfma_f32_16x16x32_bf16 v[148:151], a[160:163], a[36:39], v[148:151]
    ds_read_b64_tr_b16 a[154:155], v18 offset:34816
    v_fma_f32 v253, v253, v13, v11
    v_mfma_f32_16x16x32_bf16 v[152:155], a[164:167], a[32:35], v[152:155]
    ds_read_b64_tr_b16 a[156:157], v18 offset:45056
    v_mul_f32 v252, v54, v252
    v_mfma_f32_16x16x32_bf16 v[156:159], a[164:167], a[36:39], v[156:159]
    ds_read_b64_tr_b16 a[158:159], v18 offset:47104
    v_mul_f32 v253, v55, v253
    s_waitcnt lgkmcnt(8)
    v_mfma_f32_16x16x32_bf16 v[160:163], a[168:171], a[32:35], v[160:163]
    ds_read_b64_tr_b16 a[160:161], v19 offset:32768
    v_exp_f32 v252, v252
    v_mfma_f32_16x16x32_bf16 v[164:167], a[168:171], a[36:39], v[164:167]
    ds_read_b64_tr_b16 a[162:163], v19 offset:34816
    v_mfma_f32_16x16x32_bf16 v[168:171], a[172:175], a[32:35], v[168:171]
    ds_read_b64_tr_b16 a[164:165], v19 offset:45056
    v_exp_f32 v253, v253
    v_mfma_f32_16x16x32_bf16 v[172:175], a[172:175], a[36:39], v[172:175]
    ds_read_b64_tr_b16 a[166:167], v19 offset:47104
    v_mul_f32 v254, v54, v62
    s_waitcnt lgkmcnt(8)
    v_mfma_f32_16x16x32_bf16 v[112:115], a[144:147], a[40:43], v[112:115]
    ds_read_b64_tr_b16 a[168:169], v20 offset:32768
    v_mul_f32 v255, v55, v63
    v_mfma_f32_16x16x32_bf16 v[116:119], a[144:147], a[44:47], v[116:119]
    ds_read_b64_tr_b16 a[170:171], v20 offset:34816
    v_fma_f32 v252, v252, v15, v15
    v_fma_f32 v253, v253, v15, v15
    v_mfma_f32_16x16x32_bf16 v[120:123], a[148:151], a[40:43], v[120:123]
    ds_read_b64_tr_b16 a[172:173], v20 offset:45056
    v_mfma_f32_16x16x32_bf16 v[124:127], a[148:151], a[44:47], v[124:127]
    ds_read_b64_tr_b16 a[174:175], v20 offset:47104
    v_rcp_f32 v252, v252
    s_waitcnt lgkmcnt(8)
    v_mfma_f32_16x16x32_bf16 v[128:131], a[152:155], a[40:43], v[128:131]
    ds_read_b64_tr_b16 a[144:145], v21 offset:0
    v_mfma_f32_16x16x32_bf16 v[132:135], a[152:155], a[44:47], v[132:135]
    ds_read_b64_tr_b16 a[146:147], v21 offset:2048
    v_rcp_f32 v253, v253
    v_mfma_f32_16x16x32_bf16 v[136:139], a[156:159], a[40:43], v[136:139]
    ds_read_b64_tr_b16 a[148:149], v21 offset:12288
    v_mul_f32 v254, v254, v252
    v_mul_f32 v255, v255, v253
    v_mfma_f32_16x16x32_bf16 v[140:143], a[156:159], a[44:47], v[140:143]
    ds_read_b64_tr_b16 a[150:151], v21 offset:14336
    v_cvt_pk_bf16_f32 v181, v254, v255
    s_waitcnt lgkmcnt(8)
    v_mfma_f32_16x16x32_bf16 v[144:147], a[160:163], a[40:43], v[144:147]
    ds_read_b64_tr_b16 a[152:153], v22 offset:0
    v_mul_f32 v248, v64, v64
    v_mfma_f32_16x16x32_bf16 v[148:151], a[160:163], a[44:47], v[148:151]
    ds_read_b64_tr_b16 a[154:155], v22 offset:2048
    v_mul_f32 v249, v65, v65
    v_mfma_f32_16x16x32_bf16 v[152:155], a[164:167], a[40:43], v[152:155]
    ds_read_b64_tr_b16 a[156:157], v22 offset:12288
    v_fma_f32 v248, v248, v12, v10
    v_mfma_f32_16x16x32_bf16 v[156:159], a[164:167], a[44:47], v[156:159]
    ds_read_b64_tr_b16 a[158:159], v22 offset:14336
    v_fma_f32 v249, v249, v12, v10
    v_mul_f32 v248, v64, v248
    s_waitcnt lgkmcnt(8)
    v_mfma_f32_16x16x32_bf16 v[160:163], a[168:171], a[40:43], v[160:163]
    ds_read_b64_tr_b16 a[160:161], v23 offset:0
    v_mul_f32 v249, v65, v249
    v_mfma_f32_16x16x32_bf16 v[164:167], a[168:171], a[44:47], v[164:167]
    ds_read_b64_tr_b16 a[162:163], v23 offset:2048
    v_mfma_f32_16x16x32_bf16 v[168:171], a[172:175], a[40:43], v[168:171]
    ds_read_b64_tr_b16 a[164:165], v23 offset:12288
    v_exp_f32 v248, v248
    v_mfma_f32_16x16x32_bf16 v[172:175], a[172:175], a[44:47], v[172:175]
    ds_read_b64_tr_b16 a[166:167], v23 offset:14336
    s_waitcnt vmcnt(19)
    s_barrier
    s_waitcnt lgkmcnt(8)
    v_mfma_f32_16x16x32_bf16 v[112:115], a[144:147], a[48:51], v[112:115]
    ds_read_b64_tr_b16 a[168:169], v24 offset:0
    v_exp_f32 v249, v249
    v_mul_f32 v250, v64, v72
    v_mfma_f32_16x16x32_bf16 v[116:119], a[144:147], a[52:55], v[116:119]
    ds_read_b64_tr_b16 a[170:171], v24 offset:2048
    s_add_u32 m0, s25, 24576
    s_add_u32 s32, s77, 256
    buffer_load_dwordx4 v1, s[8:11], s32 offen lds
    v_mul_f32 v251, v65, v73
    v_mfma_f32_16x16x32_bf16 v[120:123], a[148:151], a[48:51], v[120:123]
    ds_read_b64_tr_b16 a[172:173], v24 offset:12288
    v_fma_f32 v248, v248, v14, v14
    v_mfma_f32_16x16x32_bf16 v[124:127], a[148:151], a[52:55], v[124:127]
    ds_read_b64_tr_b16 a[174:175], v24 offset:14336
    v_fma_f32 v249, v249, v14, v14
    s_waitcnt lgkmcnt(8)
    v_mfma_f32_16x16x32_bf16 v[128:131], a[152:155], a[48:51], v[128:131]
    ds_read_b64_tr_b16 a[144:145], v21 offset:4096
    buffer_load_dwordx4 v2, s[8:11], s32 offen offset:1024 lds
    v_mfma_f32_16x16x32_bf16 v[132:135], a[152:155], a[52:55], v[132:135]
    ds_read_b64_tr_b16 a[146:147], v21 offset:6144
    v_rcp_f32 v248, v248
    v_mfma_f32_16x16x32_bf16 v[136:139], a[156:159], a[48:51], v[136:139]
    ds_read_b64_tr_b16 a[148:149], v21 offset:16384
    v_rcp_f32 v249, v249
    v_mfma_f32_16x16x32_bf16 v[140:143], a[156:159], a[52:55], v[140:143]
    ds_read_b64_tr_b16 a[150:151], v21 offset:18432
    buffer_load_dwordx4 v3, s[8:11], s32 offen offset:2048 lds
    v_mul_f32 v250, v250, v248
    s_waitcnt lgkmcnt(8)
    v_mfma_f32_16x16x32_bf16 v[144:147], a[160:163], a[48:51], v[144:147]
    ds_read_b64_tr_b16 a[152:153], v22 offset:4096
    v_mul_f32 v251, v251, v249
    v_mfma_f32_16x16x32_bf16 v[148:151], a[160:163], a[52:55], v[148:151]
    ds_read_b64_tr_b16 a[154:155], v22 offset:6144
    v_cvt_pk_bf16_f32 v178, v250, v251
    v_mfma_f32_16x16x32_bf16 v[152:155], a[164:167], a[48:51], v[152:155]
    ds_read_b64_tr_b16 a[156:157], v22 offset:16384
    s_add_u32 m0, s25, 27648
    s_add_u32 s32, s77, 221440
    buffer_load_dwordx4 v1, s[8:11], s32 offen lds
    v_mul_f32 v252, v66, v66
    v_mul_f32 v253, v67, v67
    v_mfma_f32_16x16x32_bf16 v[156:159], a[164:167], a[52:55], v[156:159]
    ds_read_b64_tr_b16 a[158:159], v22 offset:18432
    v_fma_f32 v252, v252, v12, v10
    s_waitcnt lgkmcnt(8)
    v_mfma_f32_16x16x32_bf16 v[160:163], a[168:171], a[48:51], v[160:163]
    ds_read_b64_tr_b16 a[160:161], v23 offset:4096
    v_fma_f32 v253, v253, v12, v10
    v_mfma_f32_16x16x32_bf16 v[164:167], a[168:171], a[52:55], v[164:167]
    ds_read_b64_tr_b16 a[162:163], v23 offset:6144
    buffer_load_dwordx4 v2, s[8:11], s32 offen offset:1024 lds
    v_mul_f32 v252, v66, v252
    v_mfma_f32_16x16x32_bf16 v[168:171], a[172:175], a[48:51], v[168:171]
    ds_read_b64_tr_b16 a[164:165], v23 offset:16384
    v_mul_f32 v253, v67, v253
    v_mfma_f32_16x16x32_bf16 v[172:175], a[172:175], a[52:55], v[172:175]
    ds_read_b64_tr_b16 a[166:167], v23 offset:18432
    v_exp_f32 v252, v252
    s_waitcnt lgkmcnt(8)
    v_mfma_f32_16x16x32_bf16 v[112:115], a[144:147], a[56:59], v[112:115]
    ds_read_b64_tr_b16 a[168:169], v24 offset:4096
    buffer_load_dwordx4 v3, s[8:11], s32 offen offset:2048 lds
    v_mfma_f32_16x16x32_bf16 v[116:119], a[144:147], a[60:63], v[116:119]
    ds_read_b64_tr_b16 a[170:171], v24 offset:6144
    v_exp_f32 v253, v253
    v_mfma_f32_16x16x32_bf16 v[120:123], a[148:151], a[56:59], v[120:123]
    ds_read_b64_tr_b16 a[172:173], v24 offset:16384
    v_mul_f32 v254, v66, v74
    v_mfma_f32_16x16x32_bf16 v[124:127], a[148:151], a[60:63], v[124:127]
    ds_read_b64_tr_b16 a[174:175], v24 offset:18432
    v_mul_f32 v255, v67, v75
    s_waitcnt lgkmcnt(8)
    v_mfma_f32_16x16x32_bf16 v[128:131], a[152:155], a[56:59], v[128:131]
    ds_read_b64_tr_b16 a[144:145], v21 offset:8192
    v_fma_f32 v252, v252, v14, v14
    v_fma_f32 v253, v253, v14, v14
    v_mfma_f32_16x16x32_bf16 v[132:135], a[152:155], a[60:63], v[132:135]
    ds_read_b64_tr_b16 a[146:147], v21 offset:10240
    v_mfma_f32_16x16x32_bf16 v[136:139], a[156:159], a[56:59], v[136:139]
    ds_read_b64_tr_b16 a[148:149], v21 offset:20480
    v_rcp_f32 v252, v252
    v_mfma_f32_16x16x32_bf16 v[140:143], a[156:159], a[60:63], v[140:143]
    ds_read_b64_tr_b16 a[150:151], v21 offset:22528
    s_waitcnt lgkmcnt(8)
    v_mfma_f32_16x16x32_bf16 v[144:147], a[160:163], a[56:59], v[144:147]
    ds_read_b64_tr_b16 a[152:153], v22 offset:8192
    v_rcp_f32 v253, v253
    v_mfma_f32_16x16x32_bf16 v[148:151], a[160:163], a[60:63], v[148:151]
    ds_read_b64_tr_b16 a[154:155], v22 offset:10240
    v_mul_f32 v254, v254, v252
    v_mul_f32 v255, v255, v253
    v_mfma_f32_16x16x32_bf16 v[152:155], a[164:167], a[56:59], v[152:155]
    ds_read_b64_tr_b16 a[156:157], v22 offset:20480
    v_cvt_pk_bf16_f32 v179, v254, v255
    v_mfma_f32_16x16x32_bf16 v[156:159], a[164:167], a[60:63], v[156:159]
    ds_read_b64_tr_b16 a[158:159], v22 offset:22528
    v_mul_f32 v248, v68, v68
    s_waitcnt lgkmcnt(8)
    v_mfma_f32_16x16x32_bf16 v[160:163], a[168:171], a[56:59], v[160:163]
    ds_read_b64_tr_b16 a[160:161], v23 offset:8192
    v_mul_f32 v249, v69, v69
    v_mfma_f32_16x16x32_bf16 v[164:167], a[168:171], a[60:63], v[164:167]
    ds_read_b64_tr_b16 a[162:163], v23 offset:10240
    v_fma_f32 v248, v248, v13, v11
    v_mfma_f32_16x16x32_bf16 v[168:171], a[172:175], a[56:59], v[168:171]
    ds_read_b64_tr_b16 a[164:165], v23 offset:20480
    v_fma_f32 v249, v249, v13, v11
    v_mul_f32 v248, v68, v248
    v_mfma_f32_16x16x32_bf16 v[172:175], a[172:175], a[60:63], v[172:175]
    ds_read_b64_tr_b16 a[166:167], v23 offset:22528
    v_mul_f32 v249, v69, v249
    s_waitcnt lgkmcnt(8)
    v_mfma_f32_16x16x32_bf16 v[112:115], a[144:147], a[64:67], v[112:115]
    ds_read_b64_tr_b16 a[168:169], v24 offset:8192
    v_mfma_f32_16x16x32_bf16 v[116:119], a[144:147], a[68:71], v[116:119]
    ds_read_b64_tr_b16 a[170:171], v24 offset:10240
    v_exp_f32 v248, v248
    v_mfma_f32_16x16x32_bf16 v[120:123], a[148:151], a[64:67], v[120:123]
    ds_read_b64_tr_b16 a[172:173], v24 offset:20480
    v_mfma_f32_16x16x32_bf16 v[124:127], a[148:151], a[68:71], v[124:127]
    ds_read_b64_tr_b16 a[174:175], v24 offset:22528
    v_exp_f32 v249, v249
    v_mul_f32 v250, v68, v76
    s_waitcnt lgkmcnt(8)
    v_mfma_f32_16x16x32_bf16 v[128:131], a[152:155], a[64:67], v[128:131]
    ds_read_b64_tr_b16 a[144:145], v21 offset:24576
    v_mul_f32 v251, v69, v77
    v_mfma_f32_16x16x32_bf16 v[132:135], a[152:155], a[68:71], v[132:135]
    ds_read_b64_tr_b16 a[146:147], v21 offset:26624
    v_fma_f32 v248, v248, v15, v15
    v_mfma_f32_16x16x32_bf16 v[136:139], a[156:159], a[64:67], v[136:139]
    ds_read_b64_tr_b16 a[148:149], v21 offset:36864
    v_fma_f32 v249, v249, v15, v15
    v_mfma_f32_16x16x32_bf16 v[140:143], a[156:159], a[68:71], v[140:143]
    ds_read_b64_tr_b16 a[150:151], v21 offset:38912
    s_waitcnt lgkmcnt(8)
    v_mfma_f32_16x16x32_bf16 v[144:147], a[160:163], a[64:67], v[144:147]
    ds_read_b64_tr_b16 a[152:153], v22 offset:24576
    v_rcp_f32 v248, v248
    v_mfma_f32_16x16x32_bf16 v[148:151], a[160:163], a[68:71], v[148:151]
    ds_read_b64_tr_b16 a[154:155], v22 offset:26624
    v_rcp_f32 v249, v249
    v_mfma_f32_16x16x32_bf16 v[152:155], a[164:167], a[64:67], v[152:155]
    ds_read_b64_tr_b16 a[156:157], v22 offset:36864
    v_mul_f32 v250, v250, v248
    v_mfma_f32_16x16x32_bf16 v[156:159], a[164:167], a[68:71], v[156:159]
    ds_read_b64_tr_b16 a[158:159], v22 offset:38912
    v_mul_f32 v251, v251, v249
    s_waitcnt lgkmcnt(8)
    v_mfma_f32_16x16x32_bf16 v[160:163], a[168:171], a[64:67], v[160:163]
    ds_read_b64_tr_b16 a[160:161], v23 offset:24576
    v_cvt_pk_bf16_f32 v182, v250, v251
    v_mfma_f32_16x16x32_bf16 v[164:167], a[168:171], a[68:71], v[164:167]
    ds_read_b64_tr_b16 a[162:163], v23 offset:26624
    v_mul_f32 v252, v70, v70
    v_mul_f32 v253, v71, v71
    v_mfma_f32_16x16x32_bf16 v[168:171], a[172:175], a[64:67], v[168:171]
    ds_read_b64_tr_b16 a[164:165], v23 offset:36864
    v_fma_f32 v252, v252, v13, v11
    v_mfma_f32_16x16x32_bf16 v[172:175], a[172:175], a[68:71], v[172:175]
    ds_read_b64_tr_b16 a[166:167], v23 offset:38912
    v_fma_f32 v253, v253, v13, v11
    s_waitcnt vmcnt(19)
    s_barrier
    s_waitcnt lgkmcnt(8)
    v_mfma_f32_16x16x32_bf16 v[112:115], a[144:147], a[72:75], v[112:115]
    ds_read_b64_tr_b16 a[168:169], v24 offset:24576
    v_mul_f32 v252, v70, v252
    v_mfma_f32_16x16x32_bf16 v[116:119], a[144:147], a[76:79], v[116:119]
    ds_read_b64_tr_b16 a[170:171], v24 offset:26624
    s_add_u32 m0, s25, 49152
    s_add_u32 s32, s78, 256
    buffer_load_dwordx4 v1, s[8:11], s32 offen lds
    v_mul_f32 v253, v71, v253
    v_mfma_f32_16x16x32_bf16 v[120:123], a[148:151], a[72:75], v[120:123]
    ds_read_b64_tr_b16 a[172:173], v24 offset:36864
    v_exp_f32 v252, v252
    v_mfma_f32_16x16x32_bf16 v[124:127], a[148:151], a[76:79], v[124:127]
    ds_read_b64_tr_b16 a[174:175], v24 offset:38912
    s_waitcnt lgkmcnt(8)
    v_mfma_f32_16x16x32_bf16 v[128:131], a[152:155], a[72:75], v[128:131]
    ds_read_b64_tr_b16 a[144:145], v21 offset:28672
    buffer_load_dwordx4 v2, s[8:11], s32 offen offset:1024 lds
    v_exp_f32 v253, v253
    v_mfma_f32_16x16x32_bf16 v[132:135], a[152:155], a[76:79], v[132:135]
    ds_read_b64_tr_b16 a[146:147], v21 offset:30720
    v_mul_f32 v254, v70, v78
    v_mfma_f32_16x16x32_bf16 v[136:139], a[156:159], a[72:75], v[136:139]
    ds_read_b64_tr_b16 a[148:149], v21 offset:40960
    v_mul_f32 v255, v71, v79
    v_mfma_f32_16x16x32_bf16 v[140:143], a[156:159], a[76:79], v[140:143]
    ds_read_b64_tr_b16 a[150:151], v21 offset:43008
    buffer_load_dwordx4 v3, s[8:11], s32 offen offset:2048 lds
    v_fma_f32 v252, v252, v15, v15
    s_waitcnt lgkmcnt(8)
    v_mfma_f32_16x16x32_bf16 v[144:147], a[160:163], a[72:75], v[144:147]
    ds_read_b64_tr_b16 a[152:153], v22 offset:28672
    v_fma_f32 v253, v253, v15, v15
    v_mfma_f32_16x16x32_bf16 v[148:151], a[160:163], a[76:79], v[148:151]
    ds_read_b64_tr_b16 a[154:155], v22 offset:30720
    v_rcp_f32 v252, v252
    v_mfma_f32_16x16x32_bf16 v[152:155], a[164:167], a[72:75], v[152:155]
    ds_read_b64_tr_b16 a[156:157], v22 offset:40960
    s_add_u32 m0, s25, 52224
    s_add_u32 s32, s78, 221440
    buffer_load_dwordx4 v1, s[8:11], s32 offen lds
    v_mfma_f32_16x16x32_bf16 v[156:159], a[164:167], a[76:79], v[156:159]
    ds_read_b64_tr_b16 a[158:159], v22 offset:43008
    v_rcp_f32 v253, v253
    s_waitcnt lgkmcnt(8)
    v_mfma_f32_16x16x32_bf16 v[160:163], a[168:171], a[72:75], v[160:163]
    ds_read_b64_tr_b16 a[160:161], v23 offset:28672
    v_mul_f32 v254, v254, v252
    v_mfma_f32_16x16x32_bf16 v[164:167], a[168:171], a[76:79], v[164:167]
    ds_read_b64_tr_b16 a[162:163], v23 offset:30720
    buffer_load_dwordx4 v2, s[8:11], s32 offen offset:1024 lds
    v_mul_f32 v255, v255, v253
    v_cvt_pk_bf16_f32 v183, v254, v255
    v_mfma_f32_16x16x32_bf16 v[168:171], a[172:175], a[72:75], v[168:171]
    ds_read_b64_tr_b16 a[164:165], v23 offset:40960
    v_mul_f32 v248, v80, v80
    v_mfma_f32_16x16x32_bf16 v[172:175], a[172:175], a[76:79], v[172:175]
    ds_read_b64_tr_b16 a[166:167], v23 offset:43008
    v_mul_f32 v249, v81, v81
    s_waitcnt lgkmcnt(8)
    v_mfma_f32_16x16x32_bf16 v[112:115], a[144:147], a[80:83], v[112:115]
    ds_read_b64_tr_b16 a[168:169], v24 offset:28672
    buffer_load_dwordx4 v3, s[8:11], s32 offen offset:2048 lds
    v_fma_f32 v248, v248, v12, v10
    v_mfma_f32_16x16x32_bf16 v[116:119], a[144:147], a[84:87], v[116:119]
    ds_read_b64_tr_b16 a[170:171], v24 offset:30720
    v_fma_f32 v249, v249, v12, v10
    v_mfma_f32_16x16x32_bf16 v[120:123], a[148:151], a[80:83], v[120:123]
    ds_read_b64_tr_b16 a[172:173], v24 offset:40960
    v_mul_f32 v248, v80, v248
    v_mul_f32 v249, v81, v249
    v_mfma_f32_16x16x32_bf16 v[124:127], a[148:151], a[84:87], v[124:127]
    ds_read_b64_tr_b16 a[174:175], v24 offset:43008
    s_waitcnt lgkmcnt(8)
    v_mfma_f32_16x16x32_bf16 v[128:131], a[152:155], a[80:83], v[128:131]
    ds_read_b64_tr_b16 a[144:145], v21 offset:32768
    v_exp_f32 v248, v248
    v_mfma_f32_16x16x32_bf16 v[132:135], a[152:155], a[84:87], v[132:135]
    ds_read_b64_tr_b16 a[146:147], v21 offset:34816
    v_mfma_f32_16x16x32_bf16 v[136:139], a[156:159], a[80:83], v[136:139]
    ds_read_b64_tr_b16 a[148:149], v21 offset:45056
    v_exp_f32 v249, v249
    v_mfma_f32_16x16x32_bf16 v[140:143], a[156:159], a[84:87], v[140:143]
    ds_read_b64_tr_b16 a[150:151], v21 offset:47104
    v_mul_f32 v250, v80, v88
    v_mul_f32 v251, v81, v89
    s_waitcnt lgkmcnt(8)
    v_mfma_f32_16x16x32_bf16 v[144:147], a[160:163], a[80:83], v[144:147]
    ds_read_b64_tr_b16 a[152:153], v22 offset:32768
    v_fma_f32 v248, v248, v14, v14
    v_mfma_f32_16x16x32_bf16 v[148:151], a[160:163], a[84:87], v[148:151]
    ds_read_b64_tr_b16 a[154:155], v22 offset:34816
    v_fma_f32 v249, v249, v14, v14
    v_mfma_f32_16x16x32_bf16 v[152:155], a[164:167], a[80:83], v[152:155]
    ds_read_b64_tr_b16 a[156:157], v22 offset:45056
    v_mfma_f32_16x16x32_bf16 v[156:159], a[164:167], a[84:87], v[156:159]
    ds_read_b64_tr_b16 a[158:159], v22 offset:47104
    v_rcp_f32 v248, v248
    s_waitcnt lgkmcnt(8)
    v_mfma_f32_16x16x32_bf16 v[160:163], a[168:171], a[80:83], v[160:163]
    ds_read_b64_tr_b16 a[160:161], v23 offset:32768
    v_rcp_f32 v249, v249
    v_mfma_f32_16x16x32_bf16 v[164:167], a[168:171], a[84:87], v[164:167]
    ds_read_b64_tr_b16 a[162:163], v23 offset:34816
    v_mul_f32 v250, v250, v248
    v_mfma_f32_16x16x32_bf16 v[168:171], a[172:175], a[80:83], v[168:171]
    ds_read_b64_tr_b16 a[164:165], v23 offset:45056
    v_mul_f32 v251, v251, v249
    v_mfma_f32_16x16x32_bf16 v[172:175], a[172:175], a[84:87], v[172:175]
    ds_read_b64_tr_b16 a[166:167], v23 offset:47104
    v_cvt_pk_bf16_f32 v184, v250, v251
    s_waitcnt lgkmcnt(8)
    v_mfma_f32_16x16x32_bf16 v[112:115], a[144:147], a[88:91], v[112:115]
    ds_read_b64_tr_b16 a[168:169], v24 offset:32768
    v_mul_f32 v252, v82, v82
    v_mfma_f32_16x16x32_bf16 v[116:119], a[144:147], a[92:95], v[116:119]
    ds_read_b64_tr_b16 a[170:171], v24 offset:34816
    v_mul_f32 v253, v83, v83
    v_fma_f32 v252, v252, v12, v10
    v_mfma_f32_16x16x32_bf16 v[120:123], a[148:151], a[88:91], v[120:123]
    ds_read_b64_tr_b16 a[172:173], v24 offset:45056
    v_fma_f32 v253, v253, v12, v10
    v_mfma_f32_16x16x32_bf16 v[124:127], a[148:151], a[92:95], v[124:127]
    ds_read_b64_tr_b16 a[174:175], v24 offset:47104
    v_mul_f32 v252, v82, v252
    s_waitcnt lgkmcnt(8)
    v_mfma_f32_16x16x32_bf16 v[128:131], a[152:155], a[88:91], v[128:131]
    ds_read_b64_tr_b16 a[144:145], v25 offset:0
    v_mul_f32 v253, v83, v253
    v_mfma_f32_16x16x32_bf16 v[132:135], a[152:155], a[92:95], v[132:135]
    ds_read_b64_tr_b16 a[146:147], v25 offset:2048
    v_mfma_f32_16x16x32_bf16 v[136:139], a[156:159], a[88:91], v[136:139]
    ds_read_b64_tr_b16 a[148:149], v25 offset:12288
    v_exp_f32 v252, v252
    v_mfma_f32_16x16x32_bf16 v[140:143], a[156:159], a[92:95], v[140:143]
    ds_read_b64_tr_b16 a[150:151], v25 offset:14336
    v_exp_f32 v253, v253
    s_waitcnt lgkmcnt(8)
    v_mfma_f32_16x16x32_bf16 v[144:147], a[160:163], a[88:91], v[144:147]
    ds_read_b64_tr_b16 a[152:153], v26 offset:0
    v_mul_f32 v254, v82, v90
    v_mfma_f32_16x16x32_bf16 v[148:151], a[160:163], a[92:95], v[148:151]
    ds_read_b64_tr_b16 a[154:155], v26 offset:2048
    v_mul_f32 v255, v83, v91
    v_mfma_f32_16x16x32_bf16 v[152:155], a[164:167], a[88:91], v[152:155]
    ds_read_b64_tr_b16 a[156:157], v26 offset:12288
    v_fma_f32 v252, v252, v14, v14
    v_mfma_f32_16x16x32_bf16 v[156:159], a[164:167], a[92:95], v[156:159]
    ds_read_b64_tr_b16 a[158:159], v26 offset:14336
    v_fma_f32 v253, v253, v14, v14
    s_waitcnt lgkmcnt(8)
    v_mfma_f32_16x16x32_bf16 v[160:163], a[168:171], a[88:91], v[160:163]
    ds_read_b64_tr_b16 a[160:161], v27 offset:0
    v_rcp_f32 v252, v252
    v_mfma_f32_16x16x32_bf16 v[164:167], a[168:171], a[92:95], v[164:167]
    ds_read_b64_tr_b16 a[162:163], v27 offset:2048
    v_mfma_f32_16x16x32_bf16 v[168:171], a[172:175], a[88:91], v[168:171]
    ds_read_b64_tr_b16 a[164:165], v27 offset:12288
    v_rcp_f32 v253, v253
    v_mfma_f32_16x16x32_bf16 v[172:175], a[172:175], a[92:95], v[172:175]
    ds_read_b64_tr_b16 a[166:167], v27 offset:14336
    v_mul_f32 v254, v254, v252
    s_waitcnt vmcnt(19)
    s_barrier
    s_waitcnt lgkmcnt(8)
    v_mfma_f32_16x16x32_bf16 v[112:115], a[144:147], a[96:99], v[112:115]
    ds_read_b64_tr_b16 a[168:169], v28 offset:0
    v_mul_f32 v255, v255, v253
    v_cvt_pk_bf16_f32 v185, v254, v255
    v_mfma_f32_16x16x32_bf16 v[116:119], a[144:147], a[100:103], v[116:119]
    ds_read_b64_tr_b16 a[170:171], v28 offset:2048
    s_add_u32 m0, s25, 73728
    s_add_u32 s32, s79, 256
    buffer_load_dwordx4 v1, s[8:11], s32 offen lds
    v_mul_f32 v248, v84, v84
    v_mfma_f32_16x16x32_bf16 v[120:123], a[148:151], a[96:99], v[120:123]
    ds_read_b64_tr_b16 a[172:173], v28 offset:12288
    v_mul_f32 v249, v85, v85
    v_mfma_f32_16x16x32_bf16 v[124:127], a[148:151], a[100:103], v[124:127]
    ds_read_b64_tr_b16 a[174:175], v28 offset:14336
    v_fma_f32 v248, v248, v13, v11
    s_waitcnt lgkmcnt(8)
    v_mfma_f32_16x16x32_bf16 v[128:131], a[152:155], a[96:99], v[128:131]
    ds_read_b64_tr_b16 a[144:145], v25 offset:4096
    buffer_load_dwordx4 v2, s[8:11], s32 offen offset:1024 lds
    v_fma_f32 v249, v249, v13, v11
    v_mfma_f32_16x16x32_bf16 v[132:135], a[152:155], a[100:103], v[132:135]
    ds_read_b64_tr_b16 a[146:147], v25 offset:6144
    v_mul_f32 v248, v84, v248
    v_mul_f32 v249, v85, v249
    v_mfma_f32_16x16x32_bf16 v[136:139], a[156:159], a[96:99], v[136:139]
    ds_read_b64_tr_b16 a[148:149], v25 offset:16384
    v_mfma_f32_16x16x32_bf16 v[140:143], a[156:159], a[100:103], v[140:143]
    ds_read_b64_tr_b16 a[150:151], v25 offset:18432
    buffer_load_dwordx4 v3, s[8:11], s32 offen offset:2048 lds
    v_exp_f32 v248, v248
    s_waitcnt lgkmcnt(8)
    v_mfma_f32_16x16x32_bf16 v[144:147], a[160:163], a[96:99], v[144:147]
    ds_read_b64_tr_b16 a[152:153], v26 offset:4096
    v_mfma_f32_16x16x32_bf16 v[148:151], a[160:163], a[100:103], v[148:151]
    ds_read_b64_tr_b16 a[154:155], v26 offset:6144
    v_exp_f32 v249, v249
    v_mfma_f32_16x16x32_bf16 v[152:155], a[164:167], a[96:99], v[152:155]
    ds_read_b64_tr_b16 a[156:157], v26 offset:16384
    s_add_u32 m0, s25, 76800
    s_add_u32 s32, s79, 221440
    buffer_load_dwordx4 v1, s[8:11], s32 offen lds
    v_mul_f32 v250, v84, v92
    v_mul_f32 v251, v85, v93
    v_mfma_f32_16x16x32_bf16 v[156:159], a[164:167], a[100:103], v[156:159]
    ds_read_b64_tr_b16 a[158:159], v26 offset:18432
    v_fma_f32 v248, v248, v15, v15
    s_waitcnt lgkmcnt(8)
    v_mfma_f32_16x16x32_bf16 v[160:163], a[168:171], a[96:99], v[160:163]
    ds_read_b64_tr_b16 a[160:161], v27 offset:4096
    v_fma_f32 v249, v249, v15, v15
    v_mfma_f32_16x16x32_bf16 v[164:167], a[168:171], a[100:103], v[164:167]
    ds_read_b64_tr_b16 a[162:163], v27 offset:6144
    buffer_load_dwordx4 v2, s[8:11], s32 offen offset:1024 lds
    v_mfma_f32_16x16x32_bf16 v[168:171], a[172:175], a[96:99], v[168:171]
    ds_read_b64_tr_b16 a[164:165], v27 offset:16384
    v_rcp_f32 v248, v248
    v_mfma_f32_16x16x32_bf16 v[172:175], a[172:175], a[100:103], v[172:175]
    ds_read_b64_tr_b16 a[166:167], v27 offset:18432
    v_rcp_f32 v249, v249
    s_waitcnt lgkmcnt(8)
    v_mfma_f32_16x16x32_bf16 v[112:115], a[144:147], a[104:107], v[112:115]
    ds_read_b64_tr_b16 a[168:169], v28 offset:4096
    buffer_load_dwordx4 v3, s[8:11], s32 offen offset:2048 lds
    v_mul_f32 v250, v250, v248
    v_mfma_f32_16x16x32_bf16 v[116:119], a[144:147], a[108:111], v[116:119]
    ds_read_b64_tr_b16 a[170:171], v28 offset:6144
    v_mul_f32 v251, v251, v249
    v_mfma_f32_16x16x32_bf16 v[120:123], a[148:151], a[104:107], v[120:123]
    ds_read_b64_tr_b16 a[172:173], v28 offset:16384
    v_cvt_pk_bf16_f32 v188, v250, v251
    v_mfma_f32_16x16x32_bf16 v[124:127], a[148:151], a[108:111], v[124:127]
    ds_read_b64_tr_b16 a[174:175], v28 offset:18432
    v_mul_f32 v252, v86, v86
    s_waitcnt lgkmcnt(8)
    v_mfma_f32_16x16x32_bf16 v[128:131], a[152:155], a[104:107], v[128:131]
    ds_read_b64_tr_b16 a[144:145], v25 offset:8192
    v_mul_f32 v253, v87, v87
    v_fma_f32 v252, v252, v13, v11
    v_mfma_f32_16x16x32_bf16 v[132:135], a[152:155], a[108:111], v[132:135]
    ds_read_b64_tr_b16 a[146:147], v25 offset:10240
    v_fma_f32 v253, v253, v13, v11
    v_mfma_f32_16x16x32_bf16 v[136:139], a[156:159], a[104:107], v[136:139]
    ds_read_b64_tr_b16 a[148:149], v25 offset:20480
    v_mul_f32 v252, v86, v252
    v_mfma_f32_16x16x32_bf16 v[140:143], a[156:159], a[108:111], v[140:143]
    ds_read_b64_tr_b16 a[150:151], v25 offset:22528
    v_mul_f32 v253, v87, v253
    s_waitcnt lgkmcnt(8)
    v_mfma_f32_16x16x32_bf16 v[144:147], a[160:163], a[104:107], v[144:147]
    ds_read_b64_tr_b16 a[152:153], v26 offset:8192
    v_mfma_f32_16x16x32_bf16 v[148:151], a[160:163], a[108:111], v[148:151]
    ds_read_b64_tr_b16 a[154:155], v26 offset:10240
    v_exp_f32 v252, v252
    v_mfma_f32_16x16x32_bf16 v[152:155], a[164:167], a[104:107], v[152:155]
    ds_read_b64_tr_b16 a[156:157], v26 offset:20480
    v_exp_f32 v253, v253
    v_mfma_f32_16x16x32_bf16 v[156:159], a[164:167], a[108:111], v[156:159]
    ds_read_b64_tr_b16 a[158:159], v26 offset:22528
    v_mul_f32 v254, v86, v94
    s_waitcnt lgkmcnt(8)
    v_mfma_f32_16x16x32_bf16 v[160:163], a[168:171], a[104:107], v[160:163]
    ds_read_b64_tr_b16 a[160:161], v27 offset:8192
    v_mul_f32 v255, v87, v95
    v_mfma_f32_16x16x32_bf16 v[164:167], a[168:171], a[108:111], v[164:167]
    ds_read_b64_tr_b16 a[162:163], v27 offset:10240
    v_fma_f32 v252, v252, v15, v15
    v_mfma_f32_16x16x32_bf16 v[168:171], a[172:175], a[104:107], v[168:171]
    ds_read_b64_tr_b16 a[164:165], v27 offset:20480
    v_fma_f32 v253, v253, v15, v15
    v_mfma_f32_16x16x32_bf16 v[172:175], a[172:175], a[108:111], v[172:175]
    ds_read_b64_tr_b16 a[166:167], v27 offset:22528
    v_rcp_f32 v252, v252
    s_waitcnt lgkmcnt(8)
    v_mfma_f32_16x16x32_bf16 v[112:115], a[144:147], a[112:115], v[112:115]
    ds_read_b64_tr_b16 a[168:169], v28 offset:8192
    v_mfma_f32_16x16x32_bf16 v[116:119], a[144:147], a[116:119], v[116:119]
    ds_read_b64_tr_b16 a[170:171], v28 offset:10240
    v_rcp_f32 v253, v253
    v_mfma_f32_16x16x32_bf16 v[120:123], a[148:151], a[112:115], v[120:123]
    ds_read_b64_tr_b16 a[172:173], v28 offset:20480
    v_mul_f32 v254, v254, v252
    v_mfma_f32_16x16x32_bf16 v[124:127], a[148:151], a[116:119], v[124:127]
    ds_read_b64_tr_b16 a[174:175], v28 offset:22528
    v_mul_f32 v255, v255, v253
    v_cvt_pk_bf16_f32 v189, v254, v255
    s_waitcnt lgkmcnt(8)
    v_mfma_f32_16x16x32_bf16 v[128:131], a[152:155], a[112:115], v[128:131]
    ds_read_b64_tr_b16 a[144:145], v25 offset:24576
    v_mul_f32 v248, v96, v96
    v_mfma_f32_16x16x32_bf16 v[132:135], a[152:155], a[116:119], v[132:135]
    ds_read_b64_tr_b16 a[146:147], v25 offset:26624
    v_mul_f32 v249, v97, v97
    v_mfma_f32_16x16x32_bf16 v[136:139], a[156:159], a[112:115], v[136:139]
    ds_read_b64_tr_b16 a[148:149], v25 offset:36864
    v_fma_f32 v248, v248, v12, v10
    v_mfma_f32_16x16x32_bf16 v[140:143], a[156:159], a[116:119], v[140:143]
    ds_read_b64_tr_b16 a[150:151], v25 offset:38912
    v_fma_f32 v249, v249, v12, v10
    s_waitcnt lgkmcnt(8)
    v_mfma_f32_16x16x32_bf16 v[144:147], a[160:163], a[112:115], v[144:147]
    ds_read_b64_tr_b16 a[152:153], v26 offset:24576
    v_mul_f32 v248, v96, v248
    v_mul_f32 v249, v97, v249
    v_mfma_f32_16x16x32_bf16 v[148:151], a[160:163], a[116:119], v[148:151]
    ds_read_b64_tr_b16 a[154:155], v26 offset:26624
    v_mfma_f32_16x16x32_bf16 v[152:155], a[164:167], a[112:115], v[152:155]
    ds_read_b64_tr_b16 a[156:157], v26 offset:36864
    v_exp_f32 v248, v248
    v_mfma_f32_16x16x32_bf16 v[156:159], a[164:167], a[116:119], v[156:159]
    ds_read_b64_tr_b16 a[158:159], v26 offset:38912
    s_waitcnt lgkmcnt(8)
    v_mfma_f32_16x16x32_bf16 v[160:163], a[168:171], a[112:115], v[160:163]
    ds_read_b64_tr_b16 a[160:161], v27 offset:24576
    v_exp_f32 v249, v249
    v_mfma_f32_16x16x32_bf16 v[164:167], a[168:171], a[116:119], v[164:167]
    ds_read_b64_tr_b16 a[162:163], v27 offset:26624
    v_mul_f32 v250, v96, v104
    v_mul_f32 v251, v97, v105
    v_mfma_f32_16x16x32_bf16 v[168:171], a[172:175], a[112:115], v[168:171]
    ds_read_b64_tr_b16 a[164:165], v27 offset:36864
    v_fma_f32 v248, v248, v14, v14
    v_mfma_f32_16x16x32_bf16 v[172:175], a[172:175], a[116:119], v[172:175]
    ds_read_b64_tr_b16 a[166:167], v27 offset:38912
    v_fma_f32 v249, v249, v14, v14
    s_waitcnt vmcnt(18)
    s_barrier
    s_waitcnt lgkmcnt(8)
    v_mfma_f32_16x16x32_bf16 v[112:115], a[144:147], a[120:123], v[112:115]
    ds_read_b64_tr_b16 a[168:169], v28 offset:24576
    v_mfma_f32_16x16x32_bf16 v[116:119], a[144:147], a[124:127], v[116:119]
    ds_read_b64_tr_b16 a[170:171], v28 offset:26624
    s_add_u32 m0, s25, 98304
    s_add_u32 s32, s80, 256
    buffer_load_dwordx4 v1, s[8:11], s32 offen lds
    v_rcp_f32 v248, v248
    v_mfma_f32_16x16x32_bf16 v[120:123], a[148:151], a[120:123], v[120:123]
    ds_read_b64_tr_b16 a[172:173], v28 offset:36864
    v_rcp_f32 v249, v249
    v_mfma_f32_16x16x32_bf16 v[124:127], a[148:151], a[124:127], v[124:127]
    ds_read_b64_tr_b16 a[174:175], v28 offset:38912
    v_mul_f32 v250, v250, v248
    s_waitcnt lgkmcnt(8)
    v_mfma_f32_16x16x32_bf16 v[128:131], a[152:155], a[120:123], v[128:131]
    ds_read_b64_tr_b16 a[144:145], v25 offset:28672
    buffer_load_dwordx4 v2, s[8:11], s32 offen offset:1024 lds
    v_mul_f32 v251, v251, v249
    v_mfma_f32_16x16x32_bf16 v[132:135], a[152:155], a[124:127], v[132:135]
    ds_read_b64_tr_b16 a[146:147], v25 offset:30720
    v_cvt_pk_bf16_f32 v186, v250, v251
    v_mfma_f32_16x16x32_bf16 v[136:139], a[156:159], a[120:123], v[136:139]
    ds_read_b64_tr_b16 a[148:149], v25 offset:40960
    v_mul_f32 v252, v98, v98
    v_mfma_f32_16x16x32_bf16 v[140:143], a[156:159], a[124:127], v[140:143]
    ds_read_b64_tr_b16 a[150:151], v25 offset:43008
    buffer_load_dwordx4 v3, s[8:11], s32 offen offset:2048 lds
    v_mul_f32 v253, v99, v99
    v_fma_f32 v252, v252, v12, v10
    s_waitcnt lgkmcnt(8)
    v_mfma_f32_16x16x32_bf16 v[144:147], a[160:163], a[120:123], v[144:147]
    ds_read_b64_tr_b16 a[152:153], v26 offset:28672
    v_fma_f32 v253, v253, v12, v10
    v_mfma_f32_16x16x32_bf16 v[148:151], a[160:163], a[124:127], v[148:151]
    ds_read_b64_tr_b16 a[154:155], v26 offset:30720
    v_mul_f32 v252, v98, v252
    v_mfma_f32_16x16x32_bf16 v[152:155], a[164:167], a[120:123], v[152:155]
    ds_read_b64_tr_b16 a[156:157], v26 offset:40960
    s_add_u32 m0, s25, 101376
    s_add_u32 s32, s80, 221440
    buffer_load_dwordx4 v1, s[8:11], s32 offen lds
    v_mul_f32 v253, v99, v253
    v_mfma_f32_16x16x32_bf16 v[156:159], a[164:167], a[124:127], v[156:159]
    ds_read_b64_tr_b16 a[158:159], v26 offset:43008
    s_waitcnt lgkmcnt(8)
    v_mfma_f32_16x16x32_bf16 v[160:163], a[168:171], a[120:123], v[160:163]
    ds_read_b64_tr_b16 a[160:161], v27 offset:28672
    v_exp_f32 v252, v252
    v_mfma_f32_16x16x32_bf16 v[164:167], a[168:171], a[124:127], v[164:167]
    ds_read_b64_tr_b16 a[162:163], v27 offset:30720
    buffer_load_dwordx4 v2, s[8:11], s32 offen offset:1024 lds
    v_exp_f32 v253, v253
    v_mfma_f32_16x16x32_bf16 v[168:171], a[172:175], a[120:123], v[168:171]
    ds_read_b64_tr_b16 a[164:165], v27 offset:40960
    v_mul_f32 v254, v98, v106
    v_mfma_f32_16x16x32_bf16 v[172:175], a[172:175], a[124:127], v[172:175]
    ds_read_b64_tr_b16 a[166:167], v27 offset:43008
    v_mul_f32 v255, v99, v107
    s_waitcnt lgkmcnt(8)
    v_mfma_f32_16x16x32_bf16 v[112:115], a[144:147], a[128:131], v[112:115]
    ds_read_b64_tr_b16 a[168:169], v28 offset:28672
    buffer_load_dwordx4 v3, s[8:11], s32 offen offset:2048 lds
    v_fma_f32 v252, v252, v14, v14
    v_mfma_f32_16x16x32_bf16 v[116:119], a[144:147], a[132:135], v[116:119]
    ds_read_b64_tr_b16 a[170:171], v28 offset:30720
    v_fma_f32 v253, v253, v14, v14
    v_mfma_f32_16x16x32_bf16 v[120:123], a[148:151], a[128:131], v[120:123]
    ds_read_b64_tr_b16 a[172:173], v28 offset:40960
    v_rcp_f32 v252, v252
    v_mfma_f32_16x16x32_bf16 v[124:127], a[148:151], a[132:135], v[124:127]
    ds_read_b64_tr_b16 a[174:175], v28 offset:43008
    s_waitcnt lgkmcnt(8)
    v_mfma_f32_16x16x32_bf16 v[128:131], a[152:155], a[128:131], v[128:131]
    ds_read_b64_tr_b16 a[144:145], v25 offset:32768
    v_rcp_f32 v253, v253
    v_mfma_f32_16x16x32_bf16 v[132:135], a[152:155], a[132:135], v[132:135]
    ds_read_b64_tr_b16 a[146:147], v25 offset:34816
    v_mul_f32 v254, v254, v252
    v_mfma_f32_16x16x32_bf16 v[136:139], a[156:159], a[128:131], v[136:139]
    ds_read_b64_tr_b16 a[148:149], v25 offset:45056
    v_mul_f32 v255, v255, v253
    v_cvt_pk_bf16_f32 v187, v254, v255
    v_mfma_f32_16x16x32_bf16 v[140:143], a[156:159], a[132:135], v[140:143]
    ds_read_b64_tr_b16 a[150:151], v25 offset:47104
    v_mul_f32 v248, v100, v100
    s_waitcnt lgkmcnt(8)
    v_mfma_f32_16x16x32_bf16 v[144:147], a[160:163], a[128:131], v[144:147]
    ds_read_b64_tr_b16 a[152:153], v26 offset:32768
    v_mul_f32 v249, v101, v101
    v_mfma_f32_16x16x32_bf16 v[148:151], a[160:163], a[132:135], v[148:151]
    ds_read_b64_tr_b16 a[154:155], v26 offset:34816
    v_fma_f32 v248, v248, v13, v11
    v_mfma_f32_16x16x32_bf16 v[152:155], a[164:167], a[128:131], v[152:155]
    ds_read_b64_tr_b16 a[156:157], v26 offset:45056
    v_fma_f32 v249, v249, v13, v11
    v_mfma_f32_16x16x32_bf16 v[156:159], a[164:167], a[132:135], v[156:159]
    ds_read_b64_tr_b16 a[158:159], v26 offset:47104
    v_mul_f32 v248, v100, v248
    v_mul_f32 v249, v101, v249
    s_waitcnt lgkmcnt(8)
    v_mfma_f32_16x16x32_bf16 v[160:163], a[168:171], a[128:131], v[160:163]
    ds_read_b64_tr_b16 a[160:161], v27 offset:32768
    v_mfma_f32_16x16x32_bf16 v[164:167], a[168:171], a[132:135], v[164:167]
    ds_read_b64_tr_b16 a[162:163], v27 offset:34816
    v_exp_f32 v248, v248
    v_mfma_f32_16x16x32_bf16 v[168:171], a[172:175], a[128:131], v[168:171]
    ds_read_b64_tr_b16 a[164:165], v27 offset:45056
    v_mfma_f32_16x16x32_bf16 v[172:175], a[172:175], a[132:135], v[172:175]
    ds_read_b64_tr_b16 a[166:167], v27 offset:47104
    v_exp_f32 v249, v249
    s_waitcnt lgkmcnt(8)
    v_mfma_f32_16x16x32_bf16 v[112:115], a[144:147], a[136:139], v[112:115]
    ds_read_b64_tr_b16 a[168:169], v28 offset:32768
    v_mul_f32 v250, v100, v108
    v_mul_f32 v251, v101, v109
    v_mfma_f32_16x16x32_bf16 v[116:119], a[144:147], a[140:143], v[116:119]
    ds_read_b64_tr_b16 a[170:171], v28 offset:34816
    v_fma_f32 v248, v248, v15, v15
    v_mfma_f32_16x16x32_bf16 v[120:123], a[148:151], a[136:139], v[120:123]
    ds_read_b64_tr_b16 a[172:173], v28 offset:45056
    v_fma_f32 v249, v249, v15, v15
    v_mfma_f32_16x16x32_bf16 v[124:127], a[148:151], a[140:143], v[124:127]
    ds_read_b64_tr_b16 a[174:175], v28 offset:47104
    s_waitcnt lgkmcnt(8)
    v_mfma_f32_16x16x32_bf16 v[128:131], a[152:155], a[136:139], v[128:131]
    ds_read_b64_tr_b16 a[144:145], v17 offset:0
    v_rcp_f32 v248, v248
    v_mfma_f32_16x16x32_bf16 v[132:135], a[152:155], a[140:143], v[132:135]
    ds_read_b64_tr_b16 a[146:147], v17 offset:2048
    v_rcp_f32 v249, v249
    v_mfma_f32_16x16x32_bf16 v[136:139], a[156:159], a[136:139], v[136:139]
    ds_read_b64_tr_b16 a[148:149], v17 offset:12288
    v_mul_f32 v250, v250, v248
    v_mfma_f32_16x16x32_bf16 v[140:143], a[156:159], a[140:143], v[140:143]
    ds_read_b64_tr_b16 a[150:151], v17 offset:14336
    v_mul_f32 v251, v251, v249
    s_waitcnt lgkmcnt(8)
    v_mfma_f32_16x16x32_bf16 v[144:147], a[160:163], a[136:139], v[144:147]
    ds_read_b64_tr_b16 a[152:153], v18 offset:0
    v_cvt_pk_bf16_f32 v190, v250, v251
    v_mfma_f32_16x16x32_bf16 v[148:151], a[160:163], a[140:143], v[148:151]
    ds_read_b64_tr_b16 a[154:155], v18 offset:2048
    v_mul_f32 v252, v102, v102
    v_mfma_f32_16x16x32_bf16 v[152:155], a[164:167], a[136:139], v[152:155]
    ds_read_b64_tr_b16 a[156:157], v18 offset:12288
    v_mul_f32 v253, v103, v103
    v_fma_f32 v252, v252, v13, v11
    v_mfma_f32_16x16x32_bf16 v[156:159], a[164:167], a[140:143], v[156:159]
    ds_read_b64_tr_b16 a[158:159], v18 offset:14336
    v_fma_f32 v253, v253, v13, v11
    s_waitcnt lgkmcnt(8)
    v_mfma_f32_16x16x32_bf16 v[160:163], a[168:171], a[136:139], v[160:163]
    ds_read_b64_tr_b16 a[160:161], v19 offset:0
    v_mul_f32 v252, v102, v252
    v_mfma_f32_16x16x32_bf16 v[164:167], a[168:171], a[140:143], v[164:167]
    ds_read_b64_tr_b16 a[162:163], v19 offset:2048
    v_mul_f32 v253, v103, v253
    v_mfma_f32_16x16x32_bf16 v[168:171], a[172:175], a[136:139], v[168:171]
    ds_read_b64_tr_b16 a[164:165], v19 offset:12288
    v_mfma_f32_16x16x32_bf16 v[172:175], a[172:175], a[140:143], v[172:175]
    ds_read_b64_tr_b16 a[166:167], v19 offset:14336
    v_exp_f32 v252, v252
    v_mfma_f32_16x16x32_bf16 v[112:115], a[184:187], a[214:217], v[112:115]
    v_exp_f32 v253, v253
    v_mfma_f32_16x16x32_bf16 v[116:119], a[184:187], a[222:225], v[116:119]
    v_mul_f32 v254, v102, v110
    v_mfma_f32_16x16x32_bf16 v[120:123], a[184:187], a[218:221], v[120:123]
    v_mul_f32 v255, v103, v111
    v_mfma_f32_16x16x32_bf16 v[124:127], a[184:187], a[226:229], v[124:127]
    v_fma_f32 v252, v252, v15, v15
    v_mfma_f32_16x16x32_bf16 v[128:131], a[186:189], a[214:217], v[128:131]
    v_fma_f32 v253, v253, v15, v15
    v_mfma_f32_16x16x32_bf16 v[132:135], a[186:189], a[222:225], v[132:135]
    v_rcp_f32 v252, v252
    v_mfma_f32_16x16x32_bf16 v[136:139], a[186:189], a[218:221], v[136:139]
    v_mfma_f32_16x16x32_bf16 v[140:143], a[186:189], a[226:229], v[140:143]
    v_rcp_f32 v253, v253
    v_mfma_f32_16x16x32_bf16 v[144:147], a[188:191], a[214:217], v[144:147]
    v_mul_f32 v254, v254, v252
    v_mfma_f32_16x16x32_bf16 v[148:151], a[188:191], a[222:225], v[148:151]
    v_mul_f32 v255, v255, v253
    v_mfma_f32_16x16x32_bf16 v[152:155], a[188:191], a[218:221], v[152:155]
    v_cvt_pk_bf16_f32 v191, v254, v255
    v_mfma_f32_16x16x32_bf16 v[156:159], a[188:191], a[226:229], v[156:159]
    v_mfma_f32_16x16x32_bf16 v[160:163], a[190:193], a[214:217], v[160:163]
    v_mfma_f32_16x16x32_bf16 v[164:167], a[190:193], a[222:225], v[164:167]
    v_mfma_f32_16x16x32_bf16 v[168:171], a[190:193], a[218:221], v[168:171]
    v_mfma_f32_16x16x32_bf16 v[172:175], a[190:193], a[226:229], v[172:175]
    s_waitcnt vmcnt(18)
    s_barrier
    s_waitcnt lgkmcnt(8)
    v_mfma_f32_16x16x32_bf16 v[48:51], a[144:147], a[0:3], 0
    ds_read_b64_tr_b16 a[168:169], v20 offset:0
    v_mfma_f32_16x16x32_bf16 v[52:55], a[144:147], a[4:7], 0
    ds_read_b64_tr_b16 a[170:171], v20 offset:2048
    s_add_u32 m0, s25, 122880
    s_add_u32 s32, s81, 256
    buffer_load_dwordx4 v1, s[8:11], s32 offen lds
    v_mfma_f32_16x16x32_bf16 v[56:59], a[148:151], a[0:3], 0
    ds_read_b64_tr_b16 a[172:173], v20 offset:12288
    v_mfma_f32_16x16x32_bf16 v[60:63], a[148:151], a[4:7], 0
    ds_read_b64_tr_b16 a[174:175], v20 offset:14336
    s_waitcnt lgkmcnt(8)
    v_mfma_f32_16x16x32_bf16 v[64:67], a[152:155], a[0:3], 0
    ds_read_b64_tr_b16 a[144:145], v17 offset:4096
    buffer_load_dwordx4 v2, s[8:11], s32 offen offset:1024 lds
    v_mfma_f32_16x16x32_bf16 v[68:71], a[152:155], a[4:7], 0
    ds_read_b64_tr_b16 a[146:147], v17 offset:6144
    v_mfma_f32_16x16x32_bf16 v[72:75], a[156:159], a[0:3], 0
    ds_read_b64_tr_b16 a[148:149], v17 offset:16384
    v_mul_f32 v248, v112, v112
    v_mfma_f32_16x16x32_bf16 v[76:79], a[156:159], a[4:7], 0
    ds_read_b64_tr_b16 a[150:151], v17 offset:18432
    buffer_load_dwordx4 v3, s[8:11], s32 offen offset:2048 lds
    v_mul_f32 v249, v113, v113
    s_waitcnt lgkmcnt(8)
    v_mfma_f32_16x16x32_bf16 v[80:83], a[160:163], a[0:3], 0
    ds_read_b64_tr_b16 a[152:153], v18 offset:4096
    v_fma_f32 v248, v248, v12, v10
    v_mfma_f32_16x16x32_bf16 v[84:87], a[160:163], a[4:7], 0
    ds_read_b64_tr_b16 a[154:155], v18 offset:6144
    v_fma_f32 v249, v249, v12, v10
    v_mfma_f32_16x16x32_bf16 v[88:91], a[164:167], a[0:3], 0
    ds_read_b64_tr_b16 a[156:157], v18 offset:16384
    s_add_u32 m0, s25, 125952
    s_add_u32 s32, s81, 221440
    buffer_load_dwordx4 v1, s[8:11], s32 offen lds
    v_mul_f32 v248, v112, v248
    v_mfma_f32_16x16x32_bf16 v[92:95], a[164:167], a[4:7], 0
    ds_read_b64_tr_b16 a[158:159], v18 offset:18432
    v_mul_f32 v249, v113, v249
    s_waitcnt lgkmcnt(8)
    v_mfma_f32_16x16x32_bf16 v[96:99], a[168:171], a[0:3], 0
    ds_read_b64_tr_b16 a[160:161], v19 offset:4096
    v_exp_f32 v248, v248
    v_mfma_f32_16x16x32_bf16 v[100:103], a[168:171], a[4:7], 0
    ds_read_b64_tr_b16 a[162:163], v19 offset:6144
    buffer_load_dwordx4 v2, s[8:11], s32 offen offset:1024 lds
    v_mfma_f32_16x16x32_bf16 v[104:107], a[172:175], a[0:3], 0
    ds_read_b64_tr_b16 a[164:165], v19 offset:16384
    v_exp_f32 v249, v249
    v_mfma_f32_16x16x32_bf16 v[108:111], a[172:175], a[4:7], 0
    ds_read_b64_tr_b16 a[166:167], v19 offset:18432
    v_mul_f32 v250, v112, v120
    s_waitcnt lgkmcnt(8)
    v_mfma_f32_16x16x32_bf16 v[48:51], a[144:147], a[8:11], v[48:51]
    ds_read_b64_tr_b16 a[168:169], v20 offset:4096
    buffer_load_dwordx4 v3, s[8:11], s32 offen offset:2048 lds
    v_mul_f32 v251, v113, v121
    v_mfma_f32_16x16x32_bf16 v[52:55], a[144:147], a[12:15], v[52:55]
    ds_read_b64_tr_b16 a[170:171], v20 offset:6144
    v_fma_f32 v248, v248, v14, v14
    v_mfma_f32_16x16x32_bf16 v[56:59], a[148:151], a[8:11], v[56:59]
    ds_read_b64_tr_b16 a[172:173], v20 offset:16384
    v_fma_f32 v249, v249, v14, v14
    v_mfma_f32_16x16x32_bf16 v[60:63], a[148:151], a[12:15], v[60:63]
    ds_read_b64_tr_b16 a[174:175], v20 offset:18432
    v_rcp_f32 v248, v248
    s_waitcnt lgkmcnt(8)
    v_mfma_f32_16x16x32_bf16 v[64:67], a[152:155], a[8:11], v[64:67]
    ds_read_b64_tr_b16 a[144:145], v17 offset:8192
    v_mfma_f32_16x16x32_bf16 v[68:71], a[152:155], a[12:15], v[68:71]
    ds_read_b64_tr_b16 a[146:147], v17 offset:10240
    v_rcp_f32 v249, v249
    v_mfma_f32_16x16x32_bf16 v[72:75], a[156:159], a[8:11], v[72:75]
    ds_read_b64_tr_b16 a[148:149], v17 offset:20480
    v_mul_f32 v250, v250, v248
    v_mfma_f32_16x16x32_bf16 v[76:79], a[156:159], a[12:15], v[76:79]
    ds_read_b64_tr_b16 a[150:151], v17 offset:22528
    v_mul_f32 v251, v251, v249
    s_waitcnt lgkmcnt(8)
    v_mfma_f32_16x16x32_bf16 v[80:83], a[160:163], a[8:11], v[80:83]
    ds_read_b64_tr_b16 a[152:153], v18 offset:8192
    v_cvt_pk_bf16_f32 v192, v250, v251
    v_mfma_f32_16x16x32_bf16 v[84:87], a[160:163], a[12:15], v[84:87]
    ds_read_b64_tr_b16 a[154:155], v18 offset:10240
    v_mul_f32 v252, v114, v114
    v_mul_f32 v253, v115, v115
    v_mfma_f32_16x16x32_bf16 v[88:91], a[164:167], a[8:11], v[88:91]
    ds_read_b64_tr_b16 a[156:157], v18 offset:20480
    v_fma_f32 v252, v252, v12, v10
    v_mfma_f32_16x16x32_bf16 v[92:95], a[164:167], a[12:15], v[92:95]
    ds_read_b64_tr_b16 a[158:159], v18 offset:22528
    v_fma_f32 v253, v253, v12, v10
    s_waitcnt lgkmcnt(8)
    v_mfma_f32_16x16x32_bf16 v[96:99], a[168:171], a[8:11], v[96:99]
    ds_read_b64_tr_b16 a[160:161], v19 offset:8192
    v_mul_f32 v252, v114, v252
    v_mfma_f32_16x16x32_bf16 v[100:103], a[168:171], a[12:15], v[100:103]
    ds_read_b64_tr_b16 a[162:163], v19 offset:10240
    v_mul_f32 v253, v115, v253
    v_mfma_f32_16x16x32_bf16 v[104:107], a[172:175], a[8:11], v[104:107]
    ds_read_b64_tr_b16 a[164:165], v19 offset:20480
    v_mfma_f32_16x16x32_bf16 v[108:111], a[172:175], a[12:15], v[108:111]
    ds_read_b64_tr_b16 a[166:167], v19 offset:22528
    v_exp_f32 v252, v252
    s_waitcnt lgkmcnt(8)
    v_mfma_f32_16x16x32_bf16 v[48:51], a[144:147], a[16:19], v[48:51]
    ds_read_b64_tr_b16 a[168:169], v20 offset:8192
    v_exp_f32 v253, v253
    v_mfma_f32_16x16x32_bf16 v[52:55], a[144:147], a[20:23], v[52:55]
    ds_read_b64_tr_b16 a[170:171], v20 offset:10240
    v_mul_f32 v254, v114, v122
    v_mfma_f32_16x16x32_bf16 v[56:59], a[148:151], a[16:19], v[56:59]
    ds_read_b64_tr_b16 a[172:173], v20 offset:20480
    v_mul_f32 v255, v115, v123
    v_mfma_f32_16x16x32_bf16 v[60:63], a[148:151], a[20:23], v[60:63]
    ds_read_b64_tr_b16 a[174:175], v20 offset:22528
    v_fma_f32 v252, v252, v14, v14
    s_waitcnt lgkmcnt(8)
    v_mfma_f32_16x16x32_bf16 v[64:67], a[152:155], a[16:19], v[64:67]
    ds_read_b64_tr_b16 a[144:145], v17 offset:24576
    v_fma_f32 v253, v253, v14, v14
    v_mfma_f32_16x16x32_bf16 v[68:71], a[152:155], a[20:23], v[68:71]
    ds_read_b64_tr_b16 a[146:147], v17 offset:26624
    v_mfma_f32_16x16x32_bf16 v[72:75], a[156:159], a[16:19], v[72:75]
    ds_read_b64_tr_b16 a[148:149], v17 offset:36864
    v_rcp_f32 v252, v252
    v_mfma_f32_16x16x32_bf16 v[76:79], a[156:159], a[20:23], v[76:79]
    ds_read_b64_tr_b16 a[150:151], v17 offset:38912
    v_rcp_f32 v253, v253
    s_waitcnt lgkmcnt(8)
    v_mfma_f32_16x16x32_bf16 v[80:83], a[160:163], a[16:19], v[80:83]
    ds_read_b64_tr_b16 a[152:153], v18 offset:24576
    v_mul_f32 v254, v254, v252
    v_mfma_f32_16x16x32_bf16 v[84:87], a[160:163], a[20:23], v[84:87]
    ds_read_b64_tr_b16 a[154:155], v18 offset:26624
    v_mul_f32 v255, v255, v253
    v_mfma_f32_16x16x32_bf16 v[88:91], a[164:167], a[16:19], v[88:91]
    ds_read_b64_tr_b16 a[156:157], v18 offset:36864
    v_cvt_pk_bf16_f32 v193, v254, v255
    v_mfma_f32_16x16x32_bf16 v[92:95], a[164:167], a[20:23], v[92:95]
    ds_read_b64_tr_b16 a[158:159], v18 offset:38912
    v_mul_f32 v248, v116, v116
    s_waitcnt lgkmcnt(8)
    v_mfma_f32_16x16x32_bf16 v[96:99], a[168:171], a[16:19], v[96:99]
    ds_read_b64_tr_b16 a[160:161], v19 offset:24576
    v_mul_f32 v249, v117, v117
    v_mfma_f32_16x16x32_bf16 v[100:103], a[168:171], a[20:23], v[100:103]
    ds_read_b64_tr_b16 a[162:163], v19 offset:26624
    v_fma_f32 v248, v248, v13, v11
    v_fma_f32 v249, v249, v13, v11
    v_mfma_f32_16x16x32_bf16 v[104:107], a[172:175], a[16:19], v[104:107]
    ds_read_b64_tr_b16 a[164:165], v19 offset:36864
    v_mul_f32 v248, v116, v248
    v_mfma_f32_16x16x32_bf16 v[108:111], a[172:175], a[20:23], v[108:111]
    ds_read_b64_tr_b16 a[166:167], v19 offset:38912
    v_mul_f32 v249, v117, v249
    s_waitcnt vmcnt(18)
    s_barrier
    s_waitcnt lgkmcnt(8)
    v_mfma_f32_16x16x32_bf16 v[48:51], a[144:147], a[24:27], v[48:51]
    ds_read_b64_tr_b16 a[168:169], v20 offset:24576
    v_mfma_f32_16x16x32_bf16 v[52:55], a[144:147], a[28:31], v[52:55]
    ds_read_b64_tr_b16 a[170:171], v20 offset:26624
    s_add_u32 m0, s25, 0
    s_add_u32 s32, s76, 384
    buffer_load_dwordx4 v1, s[8:11], s32 offen lds
    v_exp_f32 v248, v248
    v_mfma_f32_16x16x32_bf16 v[56:59], a[148:151], a[24:27], v[56:59]
    ds_read_b64_tr_b16 a[172:173], v20 offset:36864
    v_mfma_f32_16x16x32_bf16 v[60:63], a[148:151], a[28:31], v[60:63]
    ds_read_b64_tr_b16 a[174:175], v20 offset:38912
    v_exp_f32 v249, v249
    s_waitcnt lgkmcnt(8)
    v_mfma_f32_16x16x32_bf16 v[64:67], a[152:155], a[24:27], v[64:67]
    ds_read_b64_tr_b16 a[144:145], v17 offset:28672
    buffer_load_dwordx4 v2, s[8:11], s32 offen offset:1024 lds
    v_mul_f32 v250, v116, v124
    v_mul_f32 v251, v117, v125
    v_mfma_f32_16x16x32_bf16 v[68:71], a[152:155], a[28:31], v[68:71]
    ds_read_b64_tr_b16 a[146:147], v17 offset:30720
    v_fma_f32 v248, v248, v15, v15
    v_mfma_f32_16x16x32_bf16 v[72:75], a[156:159], a[24:27], v[72:75]
    ds_read_b64_tr_b16 a[148:149], v17 offset:40960
    v_fma_f32 v249, v249, v15, v15
    v_mfma_f32_16x16x32_bf16 v[76:79], a[156:159], a[28:31], v[76:79]
    ds_read_b64_tr_b16 a[150:151], v17 offset:43008
    buffer_load_dwordx4 v3, s[8:11], s32 offen offset:2048 lds
    s_waitcnt lgkmcnt(8)
    v_mfma_f32_16x16x32_bf16 v[80:83], a[160:163], a[24:27], v[80:83]
    ds_read_b64_tr_b16 a[152:153], v18 offset:28672
    v_rcp_f32 v248, v248
    v_mfma_f32_16x16x32_bf16 v[84:87], a[160:163], a[28:31], v[84:87]
    ds_read_b64_tr_b16 a[154:155], v18 offset:30720
    v_mfma_f32_16x16x32_bf16 v[88:91], a[164:167], a[24:27], v[88:91]
    ds_read_b64_tr_b16 a[156:157], v18 offset:40960
    s_add_u32 m0, s25, 3072
    s_add_u32 s32, s76, 221568
    buffer_load_dwordx4 v1, s[8:11], s32 offen lds
    v_rcp_f32 v249, v249
    v_mfma_f32_16x16x32_bf16 v[92:95], a[164:167], a[28:31], v[92:95]
    ds_read_b64_tr_b16 a[158:159], v18 offset:43008
    v_mul_f32 v250, v250, v248
    v_mul_f32 v251, v251, v249
    s_waitcnt lgkmcnt(8)
    v_mfma_f32_16x16x32_bf16 v[96:99], a[168:171], a[24:27], v[96:99]
    ds_read_b64_tr_b16 a[160:161], v19 offset:28672
    v_cvt_pk_bf16_f32 v196, v250, v251
    v_mfma_f32_16x16x32_bf16 v[100:103], a[168:171], a[28:31], v[100:103]
    ds_read_b64_tr_b16 a[162:163], v19 offset:30720
    buffer_load_dwordx4 v2, s[8:11], s32 offen offset:1024 lds
    v_mul_f32 v252, v118, v118
    v_mfma_f32_16x16x32_bf16 v[104:107], a[172:175], a[24:27], v[104:107]
    ds_read_b64_tr_b16 a[164:165], v19 offset:40960
    v_mul_f32 v253, v119, v119
    v_mfma_f32_16x16x32_bf16 v[108:111], a[172:175], a[28:31], v[108:111]
    ds_read_b64_tr_b16 a[166:167], v19 offset:43008
    v_fma_f32 v252, v252, v13, v11
    s_waitcnt lgkmcnt(8)
    v_mfma_f32_16x16x32_bf16 v[48:51], a[144:147], a[32:35], v[48:51]
    ds_read_b64_tr_b16 a[168:169], v20 offset:28672
    buffer_load_dwordx4 v3, s[8:11], s32 offen offset:2048 lds
    v_fma_f32 v253, v253, v13, v11
    v_mfma_f32_16x16x32_bf16 v[52:55], a[144:147], a[36:39], v[52:55]
    ds_read_b64_tr_b16 a[170:171], v20 offset:30720
    v_mul_f32 v252, v118, v252
    v_mul_f32 v253, v119, v253
    v_mfma_f32_16x16x32_bf16 v[56:59], a[148:151], a[32:35], v[56:59]
    ds_read_b64_tr_b16 a[172:173], v20 offset:40960
    v_mfma_f32_16x16x32_bf16 v[60:63], a[148:151], a[36:39], v[60:63]
    ds_read_b64_tr_b16 a[174:175], v20 offset:43008
    v_exp_f32 v252, v252
    s_waitcnt lgkmcnt(8)
    v_mfma_f32_16x16x32_bf16 v[64:67], a[152:155], a[32:35], v[64:67]
    ds_read_b64_tr_b16 a[144:145], v17 offset:32768
    v_mfma_f32_16x16x32_bf16 v[68:71], a[152:155], a[36:39], v[68:71]
    ds_read_b64_tr_b16 a[146:147], v17 offset:34816
    v_exp_f32 v253, v253
    v_mfma_f32_16x16x32_bf16 v[72:75], a[156:159], a[32:35], v[72:75]
    ds_read_b64_tr_b16 a[148:149], v17 offset:45056
    v_mul_f32 v254, v118, v126
    v_mfma_f32_16x16x32_bf16 v[76:79], a[156:159], a[36:39], v[76:79]
    ds_read_b64_tr_b16 a[150:151], v17 offset:47104
    v_mul_f32 v255, v119, v127
    s_waitcnt lgkmcnt(8)
    v_mfma_f32_16x16x32_bf16 v[80:83], a[160:163], a[32:35], v[80:83]
    ds_read_b64_tr_b16 a[152:153], v18 offset:32768
    v_fma_f32 v252, v252, v15, v15
    v_fma_f32 v253, v253, v15, v15
    v_mfma_f32_16x16x32_bf16 v[84:87], a[160:163], a[36:39], v[84:87]
    ds_read_b64_tr_b16 a[154:155], v18 offset:34816
    v_mfma_f32_16x16x32_bf16 v[88:91], a[164:167], a[32:35], v[88:91]
    ds_read_b64_tr_b16 a[156:157], v18 offset:45056
    v_rcp_f32 v252, v252
    v_mfma_f32_16x16x32_bf16 v[92:95], a[164:167], a[36:39], v[92:95]
    ds_read_b64_tr_b16 a[158:159], v18 offset:47104
    s_waitcnt lgkmcnt(8)
    v_mfma_f32_16x16x32_bf16 v[96:99], a[168:171], a[32:35], v[96:99]
    ds_read_b64_tr_b16 a[160:161], v19 offset:32768
    v_rcp_f32 v253, v253
    v_mfma_f32_16x16x32_bf16 v[100:103], a[168:171], a[36:39], v[100:103]
    ds_read_b64_tr_b16 a[162:163], v19 offset:34816
    v_mul_f32 v254, v254, v252
    v_mfma_f32_16x16x32_bf16 v[104:107], a[172:175], a[32:35], v[104:107]
    ds_read_b64_tr_b16 a[164:165], v19 offset:45056
    v_mul_f32 v255, v255, v253
    v_mfma_f32_16x16x32_bf16 v[108:111], a[172:175], a[36:39], v[108:111]
    ds_read_b64_tr_b16 a[166:167], v19 offset:47104
    v_cvt_pk_bf16_f32 v197, v254, v255
    v_mul_f32 v248, v128, v128
    s_waitcnt lgkmcnt(8)
    v_mfma_f32_16x16x32_bf16 v[48:51], a[144:147], a[40:43], v[48:51]
    ds_read_b64_tr_b16 a[168:169], v20 offset:32768
    v_mul_f32 v249, v129, v129
    v_mfma_f32_16x16x32_bf16 v[52:55], a[144:147], a[44:47], v[52:55]
    ds_read_b64_tr_b16 a[170:171], v20 offset:34816
    v_fma_f32 v248, v248, v12, v10
    v_mfma_f32_16x16x32_bf16 v[56:59], a[148:151], a[40:43], v[56:59]
    ds_read_b64_tr_b16 a[172:173], v20 offset:45056
    v_fma_f32 v249, v249, v12, v10
    v_mfma_f32_16x16x32_bf16 v[60:63], a[148:151], a[44:47], v[60:63]
    ds_read_b64_tr_b16 a[174:175], v20 offset:47104
    v_mul_f32 v248, v128, v248
    s_waitcnt lgkmcnt(8)
    v_mfma_f32_16x16x32_bf16 v[64:67], a[152:155], a[40:43], v[64:67]
    ds_read_b64_tr_b16 a[144:145], v21 offset:0
    v_mul_f32 v249, v129, v249
    v_mfma_f32_16x16x32_bf16 v[68:71], a[152:155], a[44:47], v[68:71]
    ds_read_b64_tr_b16 a[146:147], v21 offset:2048
    v_exp_f32 v248, v248
    v_mfma_f32_16x16x32_bf16 v[72:75], a[156:159], a[40:43], v[72:75]
    ds_read_b64_tr_b16 a[148:149], v21 offset:12288
    v_mfma_f32_16x16x32_bf16 v[76:79], a[156:159], a[44:47], v[76:79]
    ds_read_b64_tr_b16 a[150:151], v21 offset:14336
    v_exp_f32 v249, v249
    s_waitcnt lgkmcnt(8)
    v_mfma_f32_16x16x32_bf16 v[80:83], a[160:163], a[40:43], v[80:83]
    ds_read_b64_tr_b16 a[152:153], v22 offset:0
    v_mul_f32 v250, v128, v136
    v_mfma_f32_16x16x32_bf16 v[84:87], a[160:163], a[44:47], v[84:87]
    ds_read_b64_tr_b16 a[154:155], v22 offset:2048
    v_mul_f32 v251, v129, v137
    v_mfma_f32_16x16x32_bf16 v[88:91], a[164:167], a[40:43], v[88:91]
    ds_read_b64_tr_b16 a[156:157], v22 offset:12288
    v_fma_f32 v248, v248, v14, v14
    v_mfma_f32_16x16x32_bf16 v[92:95], a[164:167], a[44:47], v[92:95]
    ds_read_b64_tr_b16 a[158:159], v22 offset:14336
    v_fma_f32 v249, v249, v14, v14
    s_waitcnt lgkmcnt(8)
    v_mfma_f32_16x16x32_bf16 v[96:99], a[168:171], a[40:43], v[96:99]
    ds_read_b64_tr_b16 a[160:161], v23 offset:0
    v_rcp_f32 v248, v248
    v_mfma_f32_16x16x32_bf16 v[100:103], a[168:171], a[44:47], v[100:103]
    ds_read_b64_tr_b16 a[162:163], v23 offset:2048
    v_mfma_f32_16x16x32_bf16 v[104:107], a[172:175], a[40:43], v[104:107]
    ds_read_b64_tr_b16 a[164:165], v23 offset:12288
    v_rcp_f32 v249, v249
    v_mfma_f32_16x16x32_bf16 v[108:111], a[172:175], a[44:47], v[108:111]
    ds_read_b64_tr_b16 a[166:167], v23 offset:14336
    v_mul_f32 v250, v250, v248
    s_waitcnt vmcnt(18)
    s_barrier
    s_waitcnt lgkmcnt(8)
    v_mfma_f32_16x16x32_bf16 v[48:51], a[144:147], a[48:51], v[48:51]
    ds_read_b64_tr_b16 a[168:169], v24 offset:0
    v_mul_f32 v251, v251, v249
    v_mfma_f32_16x16x32_bf16 v[52:55], a[144:147], a[52:55], v[52:55]
    ds_read_b64_tr_b16 a[170:171], v24 offset:2048
    s_add_u32 m0, s25, 24576
    s_add_u32 s32, s77, 384
    buffer_load_dwordx4 v1, s[8:11], s32 offen lds
    v_cvt_pk_bf16_f32 v194, v250, v251
    v_mfma_f32_16x16x32_bf16 v[56:59], a[148:151], a[48:51], v[56:59]
    ds_read_b64_tr_b16 a[172:173], v24 offset:12288
    v_mul_f32 v252, v130, v130
    v_mul_f32 v253, v131, v131
    v_mfma_f32_16x16x32_bf16 v[60:63], a[148:151], a[52:55], v[60:63]
    ds_read_b64_tr_b16 a[174:175], v24 offset:14336
    v_fma_f32 v252, v252, v12, v10
    s_waitcnt lgkmcnt(8)
    v_mfma_f32_16x16x32_bf16 v[64:67], a[152:155], a[48:51], v[64:67]
    ds_read_b64_tr_b16 a[144:145], v21 offset:4096
    buffer_load_dwordx4 v2, s[8:11], s32 offen offset:1024 lds
    v_fma_f32 v253, v253, v12, v10
    v_mfma_f32_16x16x32_bf16 v[68:71], a[152:155], a[52:55], v[68:71]
    ds_read_b64_tr_b16 a[146:147], v21 offset:6144
    v_mul_f32 v252, v130, v252
    v_mfma_f32_16x16x32_bf16 v[72:75], a[156:159], a[48:51], v[72:75]
    ds_read_b64_tr_b16 a[148:149], v21 offset:16384
    v_mul_f32 v253, v131, v253
    v_mfma_f32_16x16x32_bf16 v[76:79], a[156:159], a[52:55], v[76:79]
    ds_read_b64_tr_b16 a[150:151], v21 offset:18432
    buffer_load_dwordx4 v3, s[8:11], s32 offen offset:2048 lds
    s_waitcnt lgkmcnt(8)
    v_mfma_f32_16x16x32_bf16 v[80:83], a[160:163], a[48:51], v[80:83]
    ds_read_b64_tr_b16 a[152:153], v22 offset:4096
    v_exp_f32 v252, v252
    v_mfma_f32_16x16x32_bf16 v[84:87], a[160:163], a[52:55], v[84:87]
    ds_read_b64_tr_b16 a[154:155], v22 offset:6144
    v_exp_f32 v253, v253
    v_mfma_f32_16x16x32_bf16 v[88:91], a[164:167], a[48:51], v[88:91]
    ds_read_b64_tr_b16 a[156:157], v22 offset:16384
    s_add_u32 m0, s25, 27648
    s_add_u32 s32, s77, 221568
    buffer_load_dwordx4 v1, s[8:11], s32 offen lds
    v_mul_f32 v254, v130, v138
    v_mfma_f32_16x16x32_bf16 v[92:95], a[164:167], a[52:55], v[92:95]
    ds_read_b64_tr_b16 a[158:159], v22 offset:18432
    v_mul_f32 v255, v131, v139
    s_waitcnt lgkmcnt(8)
    v_mfma_f32_16x16x32_bf16 v[96:99], a[168:171], a[48:51], v[96:99]
    ds_read_b64_tr_b16 a[160:161], v23 offset:4096
    v_fma_f32 v252, v252, v14, v14
    v_mfma_f32_16x16x32_bf16 v[100:103], a[168:171], a[52:55], v[100:103]
    ds_read_b64_tr_b16 a[162:163], v23 offset:6144
    buffer_load_dwordx4 v2, s[8:11], s32 offen offset:1024 lds
    v_fma_f32 v253, v253, v14, v14
    v_mfma_f32_16x16x32_bf16 v[104:107], a[172:175], a[48:51], v[104:107]
    ds_read_b64_tr_b16 a[164:165], v23 offset:16384
    v_mfma_f32_16x16x32_bf16 v[108:111], a[172:175], a[52:55], v[108:111]
    ds_read_b64_tr_b16 a[166:167], v23 offset:18432
    v_rcp_f32 v252, v252
    s_waitcnt lgkmcnt(8)
    v_mfma_f32_16x16x32_bf16 v[48:51], a[144:147], a[56:59], v[48:51]
    ds_read_b64_tr_b16 a[168:169], v24 offset:4096
    buffer_load_dwordx4 v3, s[8:11], s32 offen offset:2048 lds
    v_rcp_f32 v253, v253
    v_mfma_f32_16x16x32_bf16 v[52:55], a[144:147], a[60:63], v[52:55]
    ds_read_b64_tr_b16 a[170:171], v24 offset:6144
    v_mul_f32 v254, v254, v252
    v_mfma_f32_16x16x32_bf16 v[56:59], a[148:151], a[56:59], v[56:59]
    ds_read_b64_tr_b16 a[172:173], v24 offset:16384
    v_mul_f32 v255, v255, v253
    v_mfma_f32_16x16x32_bf16 v[60:63], a[148:151], a[60:63], v[60:63]
    ds_read_b64_tr_b16 a[174:175], v24 offset:18432
    v_cvt_pk_bf16_f32 v195, v254, v255
    s_waitcnt lgkmcnt(8)
    v_mfma_f32_16x16x32_bf16 v[64:67], a[152:155], a[56:59], v[64:67]
    ds_read_b64_tr_b16 a[144:145], v21 offset:8192
    v_mul_f32 v248, v132, v132
    v_mfma_f32_16x16x32_bf16 v[68:71], a[152:155], a[60:63], v[68:71]
    ds_read_b64_tr_b16 a[146:147], v21 offset:10240
    v_mul_f32 v249, v133, v133
    v_mfma_f32_16x16x32_bf16 v[72:75], a[156:159], a[56:59], v[72:75]
    ds_read_b64_tr_b16 a[148:149], v21 offset:20480
    v_fma_f32 v248, v248, v13, v11
    v_fma_f32 v249, v249, v13, v11
    v_mfma_f32_16x16x32_bf16 v[76:79], a[156:159], a[60:63], v[76:79]
    ds_read_b64_tr_b16 a[150:151], v21 offset:22528
    v_mul_f32 v248, v132, v248
    s_waitcnt lgkmcnt(8)
    v_mfma_f32_16x16x32_bf16 v[80:83], a[160:163], a[56:59], v[80:83]
    ds_read_b64_tr_b16 a[152:153], v22 offset:8192
    v_mul_f32 v249, v133, v249
    v_mfma_f32_16x16x32_bf16 v[84:87], a[160:163], a[60:63], v[84:87]
    ds_read_b64_tr_b16 a[154:155], v22 offset:10240
    v_mfma_f32_16x16x32_bf16 v[88:91], a[164:167], a[56:59], v[88:91]
    ds_read_b64_tr_b16 a[156:157], v22 offset:20480
    v_exp_f32 v248, v248
    v_mfma_f32_16x16x32_bf16 v[92:95], a[164:167], a[60:63], v[92:95]
    ds_read_b64_tr_b16 a[158:159], v22 offset:22528
    s_waitcnt lgkmcnt(8)
    v_mfma_f32_16x16x32_bf16 v[96:99], a[168:171], a[56:59], v[96:99]
    ds_read_b64_tr_b16 a[160:161], v23 offset:8192
    v_exp_f32 v249, v249
    v_mfma_f32_16x16x32_bf16 v[100:103], a[168:171], a[60:63], v[100:103]
    ds_read_b64_tr_b16 a[162:163], v23 offset:10240
    v_mul_f32 v250, v132, v140
    v_mul_f32 v251, v133, v141
    v_mfma_f32_16x16x32_bf16 v[104:107], a[172:175], a[56:59], v[104:107]
    ds_read_b64_tr_b16 a[164:165], v23 offset:20480
    v_fma_f32 v248, v248, v15, v15
    v_mfma_f32_16x16x32_bf16 v[108:111], a[172:175], a[60:63], v[108:111]
    ds_read_b64_tr_b16 a[166:167], v23 offset:22528
    v_fma_f32 v249, v249, v15, v15
    s_waitcnt lgkmcnt(8)
    v_mfma_f32_16x16x32_bf16 v[48:51], a[144:147], a[64:67], v[48:51]
    ds_read_b64_tr_b16 a[168:169], v24 offset:8192
    v_mfma_f32_16x16x32_bf16 v[52:55], a[144:147], a[68:71], v[52:55]
    ds_read_b64_tr_b16 a[170:171], v24 offset:10240
    v_rcp_f32 v248, v248
    v_mfma_f32_16x16x32_bf16 v[56:59], a[148:151], a[64:67], v[56:59]
    ds_read_b64_tr_b16 a[172:173], v24 offset:20480
    v_mfma_f32_16x16x32_bf16 v[60:63], a[148:151], a[68:71], v[60:63]
    ds_read_b64_tr_b16 a[174:175], v24 offset:22528
    v_rcp_f32 v249, v249
    s_waitcnt lgkmcnt(8)
    v_mfma_f32_16x16x32_bf16 v[64:67], a[152:155], a[64:67], v[64:67]
    ds_read_b64_tr_b16 a[144:145], v21 offset:24576
    v_mul_f32 v250, v250, v248
    v_mul_f32 v251, v251, v249
    v_mfma_f32_16x16x32_bf16 v[68:71], a[152:155], a[68:71], v[68:71]
    ds_read_b64_tr_b16 a[146:147], v21 offset:26624
    v_cvt_pk_bf16_f32 v198, v250, v251
    v_mfma_f32_16x16x32_bf16 v[72:75], a[156:159], a[64:67], v[72:75]
    ds_read_b64_tr_b16 a[148:149], v21 offset:36864
    v_mul_f32 v252, v134, v134
    v_mfma_f32_16x16x32_bf16 v[76:79], a[156:159], a[68:71], v[76:79]
    ds_read_b64_tr_b16 a[150:151], v21 offset:38912
    v_mul_f32 v253, v135, v135
    s_waitcnt lgkmcnt(8)
    v_mfma_f32_16x16x32_bf16 v[80:83], a[160:163], a[64:67], v[80:83]
    ds_read_b64_tr_b16 a[152:153], v22 offset:24576
    v_fma_f32 v252, v252, v13, v11
    v_mfma_f32_16x16x32_bf16 v[84:87], a[160:163], a[68:71], v[84:87]
    ds_read_b64_tr_b16 a[154:155], v22 offset:26624
    v_fma_f32 v253, v253, v13, v11
    v_mfma_f32_16x16x32_bf16 v[88:91], a[164:167], a[64:67], v[88:91]
    ds_read_b64_tr_b16 a[156:157], v22 offset:36864
    v_mul_f32 v252, v134, v252
    v_mul_f32 v253, v135, v253
    v_mfma_f32_16x16x32_bf16 v[92:95], a[164:167], a[68:71], v[92:95]
    ds_read_b64_tr_b16 a[158:159], v22 offset:38912
    s_waitcnt lgkmcnt(8)
    v_mfma_f32_16x16x32_bf16 v[96:99], a[168:171], a[64:67], v[96:99]
    ds_read_b64_tr_b16 a[160:161], v23 offset:24576
    v_exp_f32 v252, v252
    v_mfma_f32_16x16x32_bf16 v[100:103], a[168:171], a[68:71], v[100:103]
    ds_read_b64_tr_b16 a[162:163], v23 offset:26624
    v_mfma_f32_16x16x32_bf16 v[104:107], a[172:175], a[64:67], v[104:107]
    ds_read_b64_tr_b16 a[164:165], v23 offset:36864
    v_exp_f32 v253, v253
    v_mfma_f32_16x16x32_bf16 v[108:111], a[172:175], a[68:71], v[108:111]
    ds_read_b64_tr_b16 a[166:167], v23 offset:38912
    v_mul_f32 v254, v134, v142
    s_waitcnt vmcnt(18)
    s_barrier
    s_waitcnt lgkmcnt(8)
    v_mfma_f32_16x16x32_bf16 v[48:51], a[144:147], a[72:75], v[48:51]
    ds_read_b64_tr_b16 a[168:169], v24 offset:24576
    v_mul_f32 v255, v135, v143
    v_mfma_f32_16x16x32_bf16 v[52:55], a[144:147], a[76:79], v[52:55]
    ds_read_b64_tr_b16 a[170:171], v24 offset:26624
    s_add_u32 m0, s25, 49152
    s_add_u32 s32, s78, 384
    buffer_load_dwordx4 v1, s[8:11], s32 offen lds
    v_fma_f32 v252, v252, v15, v15
    v_fma_f32 v253, v253, v15, v15
    v_mfma_f32_16x16x32_bf16 v[56:59], a[148:151], a[72:75], v[56:59]
    ds_read_b64_tr_b16 a[172:173], v24 offset:36864
    v_mfma_f32_16x16x32_bf16 v[60:63], a[148:151], a[76:79], v[60:63]
    ds_read_b64_tr_b16 a[174:175], v24 offset:38912
    v_rcp_f32 v252, v252
    s_waitcnt lgkmcnt(8)
    v_mfma_f32_16x16x32_bf16 v[64:67], a[152:155], a[72:75], v[64:67]
    ds_read_b64_tr_b16 a[144:145], v21 offset:28672
    buffer_load_dwordx4 v2, s[8:11], s32 offen offset:1024 lds
    v_mfma_f32_16x16x32_bf16 v[68:71], a[152:155], a[76:79], v[68:71]
    ds_read_b64_tr_b16 a[146:147], v21 offset:30720
    v_rcp_f32 v253, v253
    v_mfma_f32_16x16x32_bf16 v[72:75], a[156:159], a[72:75], v[72:75]
    ds_read_b64_tr_b16 a[148:149], v21 offset:40960
    v_mul_f32 v254, v254, v252
    v_mfma_f32_16x16x32_bf16 v[76:79], a[156:159], a[76:79], v[76:79]
    ds_read_b64_tr_b16 a[150:151], v21 offset:43008
    buffer_load_dwordx4 v3, s[8:11], s32 offen offset:2048 lds
    v_mul_f32 v255, v255, v253
    s_waitcnt lgkmcnt(8)
    v_mfma_f32_16x16x32_bf16 v[80:83], a[160:163], a[72:75], v[80:83]
    ds_read_b64_tr_b16 a[152:153], v22 offset:28672
    v_cvt_pk_bf16_f32 v199, v254, v255
    v_mul_f32 v248, v144, v144
    v_mfma_f32_16x16x32_bf16 v[84:87], a[160:163], a[76:79], v[84:87]
    ds_read_b64_tr_b16 a[154:155], v22 offset:30720
    v_mul_f32 v249, v145, v145
    v_mfma_f32_16x16x32_bf16 v[88:91], a[164:167], a[72:75], v[88:91]
    ds_read_b64_tr_b16 a[156:157], v22 offset:40960
    s_add_u32 m0, s25, 52224
    s_add_u32 s32, s78, 221568
    buffer_load_dwordx4 v1, s[8:11], s32 offen lds
    v_fma_f32 v248, v248, v12, v10
    v_mfma_f32_16x16x32_bf16 v[92:95], a[164:167], a[76:79], v[92:95]
    ds_read_b64_tr_b16 a[158:159], v22 offset:43008
    v_fma_f32 v249, v249, v12, v10
    s_waitcnt lgkmcnt(8)
    v_mfma_f32_16x16x32_bf16 v[96:99], a[168:171], a[72:75], v[96:99]
    ds_read_b64_tr_b16 a[160:161], v23 offset:28672
    v_mul_f32 v248, v144, v248
    v_mfma_f32_16x16x32_bf16 v[100:103], a[168:171], a[76:79], v[100:103]
    ds_read_b64_tr_b16 a[162:163], v23 offset:30720
    buffer_load_dwordx4 v2, s[8:11], s32 offen offset:1024 lds
    v_mul_f32 v249, v145, v249
    v_mfma_f32_16x16x32_bf16 v[104:107], a[172:175], a[72:75], v[104:107]
    ds_read_b64_tr_b16 a[164:165], v23 offset:40960
    v_exp_f32 v248, v248
    v_mfma_f32_16x16x32_bf16 v[108:111], a[172:175], a[76:79], v[108:111]
    ds_read_b64_tr_b16 a[166:167], v23 offset:43008
    s_waitcnt lgkmcnt(8)
    v_mfma_f32_16x16x32_bf16 v[48:51], a[144:147], a[80:83], v[48:51]
    ds_read_b64_tr_b16 a[168:169], v24 offset:28672
    buffer_load_dwordx4 v3, s[8:11], s32 offen offset:2048 lds
    v_exp_f32 v249, v249
    v_mfma_f32_16x16x32_bf16 v[52:55], a[144:147], a[84:87], v[52:55]
    ds_read_b64_tr_b16 a[170:171], v24 offset:30720
    v_mul_f32 v250, v144, v152
    v_mfma_f32_16x16x32_bf16 v[56:59], a[148:151], a[80:83], v[56:59]
    ds_read_b64_tr_b16 a[172:173], v24 offset:40960
    v_mul_f32 v251, v145, v153
    v_mfma_f32_16x16x32_bf16 v[60:63], a[148:151], a[84:87], v[60:63]
    ds_read_b64_tr_b16 a[174:175], v24 offset:43008
    v_fma_f32 v248, v248, v14, v14
    s_waitcnt lgkmcnt(8)
    v_mfma_f32_16x16x32_bf16 v[64:67], a[152:155], a[80:83], v[64:67]
    ds_read_b64_tr_b16 a[144:145], v21 offset:32768
    v_fma_f32 v249, v249, v14, v14
    v_mfma_f32_16x16x32_bf16 v[68:71], a[152:155], a[84:87], v[68:71]
    ds_read_b64_tr_b16 a[146:147], v21 offset:34816
    v_rcp_f32 v248, v248
    v_mfma_f32_16x16x32_bf16 v[72:75], a[156:159], a[80:83], v[72:75]
    ds_read_b64_tr_b16 a[148:149], v21 offset:45056
    v_mfma_f32_16x16x32_bf16 v[76:79], a[156:159], a[84:87], v[76:79]
    ds_read_b64_tr_b16 a[150:151], v21 offset:47104
    v_rcp_f32 v249, v249
    s_waitcnt lgkmcnt(8)
    v_mfma_f32_16x16x32_bf16 v[80:83], a[160:163], a[80:83], v[80:83]
    ds_read_b64_tr_b16 a[152:153], v22 offset:32768
    v_mul_f32 v250, v250, v248
    v_mfma_f32_16x16x32_bf16 v[84:87], a[160:163], a[84:87], v[84:87]
    ds_read_b64_tr_b16 a[154:155], v22 offset:34816
    v_mul_f32 v251, v251, v249
    v_mfma_f32_16x16x32_bf16 v[88:91], a[164:167], a[80:83], v[88:91]
    ds_read_b64_tr_b16 a[156:157], v22 offset:45056
    v_cvt_pk_bf16_f32 v200, v250, v251
    v_mfma_f32_16x16x32_bf16 v[92:95], a[164:167], a[84:87], v[92:95]
    ds_read_b64_tr_b16 a[158:159], v22 offset:47104
    v_mul_f32 v252, v146, v146
    v_mul_f32 v253, v147, v147
    s_waitcnt lgkmcnt(8)
    v_mfma_f32_16x16x32_bf16 v[96:99], a[168:171], a[80:83], v[96:99]
    ds_read_b64_tr_b16 a[160:161], v23 offset:32768
    v_fma_f32 v252, v252, v12, v10
    v_mfma_f32_16x16x32_bf16 v[100:103], a[168:171], a[84:87], v[100:103]
    ds_read_b64_tr_b16 a[162:163], v23 offset:34816
    v_fma_f32 v253, v253, v12, v10
    v_mfma_f32_16x16x32_bf16 v[104:107], a[172:175], a[80:83], v[104:107]
    ds_read_b64_tr_b16 a[164:165], v23 offset:45056
    v_mul_f32 v252, v146, v252
    v_mfma_f32_16x16x32_bf16 v[108:111], a[172:175], a[84:87], v[108:111]
    ds_read_b64_tr_b16 a[166:167], v23 offset:47104
    v_mul_f32 v253, v147, v253
    s_waitcnt lgkmcnt(8)
    v_mfma_f32_16x16x32_bf16 v[48:51], a[144:147], a[88:91], v[48:51]
    ds_read_b64_tr_b16 a[168:169], v24 offset:32768
    v_mfma_f32_16x16x32_bf16 v[52:55], a[144:147], a[92:95], v[52:55]
    ds_read_b64_tr_b16 a[170:171], v24 offset:34816
    v_exp_f32 v252, v252
    v_mfma_f32_16x16x32_bf16 v[56:59], a[148:151], a[88:91], v[56:59]
    ds_read_b64_tr_b16 a[172:173], v24 offset:45056
    v_exp_f32 v253, v253
    v_mfma_f32_16x16x32_bf16 v[60:63], a[148:151], a[92:95], v[60:63]
    ds_read_b64_tr_b16 a[174:175], v24 offset:47104
    v_mul_f32 v254, v146, v154
    s_waitcnt lgkmcnt(8)
    v_mfma_f32_16x16x32_bf16 v[64:67], a[152:155], a[88:91], v[64:67]
    ds_read_b64_tr_b16 a[144:145], v25 offset:0
    v_mul_f32 v255, v147, v155
    v_mfma_f32_16x16x32_bf16 v[68:71], a[152:155], a[92:95], v[68:71]
    ds_read_b64_tr_b16 a[146:147], v25 offset:2048
    v_fma_f32 v252, v252, v14, v14
    v_mfma_f32_16x16x32_bf16 v[72:75], a[156:159], a[88:91], v[72:75]
    ds_read_b64_tr_b16 a[148:149], v25 offset:12288
    v_fma_f32 v253, v253, v14, v14
    v_mfma_f32_16x16x32_bf16 v[76:79], a[156:159], a[92:95], v[76:79]
    ds_read_b64_tr_b16 a[150:151], v25 offset:14336
    s_waitcnt lgkmcnt(8)
    v_mfma_f32_16x16x32_bf16 v[80:83], a[160:163], a[88:91], v[80:83]
    ds_read_b64_tr_b16 a[152:153], v26 offset:0
    v_rcp_f32 v252, v252
    v_mfma_f32_16x16x32_bf16 v[84:87], a[160:163], a[92:95], v[84:87]
    ds_read_b64_tr_b16 a[154:155], v26 offset:2048
    v_rcp_f32 v253, v253
    v_mfma_f32_16x16x32_bf16 v[88:91], a[164:167], a[88:91], v[88:91]
    ds_read_b64_tr_b16 a[156:157], v26 offset:12288
    v_mul_f32 v254, v254, v252
    v_mfma_f32_16x16x32_bf16 v[92:95], a[164:167], a[92:95], v[92:95]
    ds_read_b64_tr_b16 a[158:159], v26 offset:14336
    v_mul_f32 v255, v255, v253
    s_waitcnt lgkmcnt(8)
    v_mfma_f32_16x16x32_bf16 v[96:99], a[168:171], a[88:91], v[96:99]
    ds_read_b64_tr_b16 a[160:161], v27 offset:0
    v_cvt_pk_bf16_f32 v201, v254, v255
    v_mfma_f32_16x16x32_bf16 v[100:103], a[168:171], a[92:95], v[100:103]
    ds_read_b64_tr_b16 a[162:163], v27 offset:2048
    v_mul_f32 v248, v148, v148
    v_mfma_f32_16x16x32_bf16 v[104:107], a[172:175], a[88:91], v[104:107]
    ds_read_b64_tr_b16 a[164:165], v27 offset:12288
    v_mul_f32 v249, v149, v149
    v_mfma_f32_16x16x32_bf16 v[108:111], a[172:175], a[92:95], v[108:111]
    ds_read_b64_tr_b16 a[166:167], v27 offset:14336
    v_fma_f32 v248, v248, v13, v11
    v_fma_f32 v249, v249, v13, v11
    s_waitcnt vmcnt(18)
    s_barrier
    s_waitcnt lgkmcnt(8)
    v_mfma_f32_16x16x32_bf16 v[48:51], a[144:147], a[96:99], v[48:51]
    ds_read_b64_tr_b16 a[168:169], v28 offset:0
    v_mul_f32 v248, v148, v248
    v_mfma_f32_16x16x32_bf16 v[52:55], a[144:147], a[100:103], v[52:55]
    ds_read_b64_tr_b16 a[170:171], v28 offset:2048
    s_add_u32 m0, s25, 73728
    s_add_u32 s32, s79, 384
    buffer_load_dwordx4 v1, s[8:11], s32 offen lds
    v_mul_f32 v249, v149, v249
    v_mfma_f32_16x16x32_bf16 v[56:59], a[148:151], a[96:99], v[56:59]
    ds_read_b64_tr_b16 a[172:173], v28 offset:12288
    v_mfma_f32_16x16x32_bf16 v[60:63], a[148:151], a[100:103], v[60:63]
    ds_read_b64_tr_b16 a[174:175], v28 offset:14336
    v_exp_f32 v248, v248
    s_waitcnt lgkmcnt(8)
    v_mfma_f32_16x16x32_bf16 v[64:67], a[152:155], a[96:99], v[64:67]
    ds_read_b64_tr_b16 a[144:145], v25 offset:4096
    buffer_load_dwordx4 v2, s[8:11], s32 offen offset:1024 lds
    v_mfma_f32_16x16x32_bf16 v[68:71], a[152:155], a[100:103], v[68:71]
    ds_read_b64_tr_b16 a[146:147], v25 offset:6144
    v_exp_f32 v249, v249
    v_mfma_f32_16x16x32_bf16 v[72:75], a[156:159], a[96:99], v[72:75]
    ds_read_b64_tr_b16 a[148:149], v25 offset:16384
    v_mul_f32 v250, v148, v156
    v_mul_f32 v251, v149, v157
    v_mfma_f32_16x16x32_bf16 v[76:79], a[156:159], a[100:103], v[76:79]
    ds_read_b64_tr_b16 a[150:151], v25 offset:18432
    buffer_load_dwordx4 v3, s[8:11], s32 offen offset:2048 lds
    v_fma_f32 v248, v248, v15, v15
    s_waitcnt lgkmcnt(8)
    v_mfma_f32_16x16x32_bf16 v[80:83], a[160:163], a[96:99], v[80:83]
    ds_read_b64_tr_b16 a[152:153], v26 offset:4096
    v_fma_f32 v249, v249, v15, v15
    v_mfma_f32_16x16x32_bf16 v[84:87], a[160:163], a[100:103], v[84:87]
    ds_read_b64_tr_b16 a[154:155], v26 offset:6144
    v_mfma_f32_16x16x32_bf16 v[88:91], a[164:167], a[96:99], v[88:91]
    ds_read_b64_tr_b16 a[156:157], v26 offset:16384
    s_add_u32 m0, s25, 76800
    s_add_u32 s32, s79, 221568
    buffer_load_dwordx4 v1, s[8:11], s32 offen lds
    v_rcp_f32 v248, v248
    v_mfma_f32_16x16x32_bf16 v[92:95], a[164:167], a[100:103], v[92:95]
    ds_read_b64_tr_b16 a[158:159], v26 offset:18432
    s_waitcnt lgkmcnt(8)
    v_mfma_f32_16x16x32_bf16 v[96:99], a[168:171], a[96:99], v[96:99]
    ds_read_b64_tr_b16 a[160:161], v27 offset:4096
    v_rcp_f32 v249, v249
    v_mfma_f32_16x16x32_bf16 v[100:103], a[168:171], a[100:103], v[100:103]
    ds_read_b64_tr_b16 a[162:163], v27 offset:6144
    buffer_load_dwordx4 v2, s[8:11], s32 offen offset:1024 lds
    v_mul_f32 v250, v250, v248
    v_mul_f32 v251, v251, v249
    v_mfma_f32_16x16x32_bf16 v[104:107], a[172:175], a[96:99], v[104:107]
    ds_read_b64_tr_b16 a[164:165], v27 offset:16384
    v_cvt_pk_bf16_f32 v204, v250, v251
    v_mfma_f32_16x16x32_bf16 v[108:111], a[172:175], a[100:103], v[108:111]
    ds_read_b64_tr_b16 a[166:167], v27 offset:18432
    v_mul_f32 v252, v150, v150
    s_waitcnt lgkmcnt(8)
    v_mfma_f32_16x16x32_bf16 v[48:51], a[144:147], a[104:107], v[48:51]
    ds_read_b64_tr_b16 a[168:169], v28 offset:4096
    buffer_load_dwordx4 v3, s[8:11], s32 offen offset:2048 lds
    v_mul_f32 v253, v151, v151
    v_mfma_f32_16x16x32_bf16 v[52:55], a[144:147], a[108:111], v[52:55]
    ds_read_b64_tr_b16 a[170:171], v28 offset:6144
    v_fma_f32 v252, v252, v13, v11
    v_mfma_f32_16x16x32_bf16 v[56:59], a[148:151], a[104:107], v[56:59]
    ds_read_b64_tr_b16 a[172:173], v28 offset:16384
    v_fma_f32 v253, v253, v13, v11
    v_mfma_f32_16x16x32_bf16 v[60:63], a[148:151], a[108:111], v[60:63]
    ds_read_b64_tr_b16 a[174:175], v28 offset:18432
    v_mul_f32 v252, v150, v252
    v_mul_f32 v253, v151, v253
    s_waitcnt lgkmcnt(8)
    v_mfma_f32_16x16x32_bf16 v[64:67], a[152:155], a[104:107], v[64:67]
    ds_read_b64_tr_b16 a[144:145], v25 offset:8192
    v_mfma_f32_16x16x32_bf16 v[68:71], a[152:155], a[108:111], v[68:71]
    ds_read_b64_tr_b16 a[146:147], v25 offset:10240
    v_exp_f32 v252, v252
    v_mfma_f32_16x16x32_bf16 v[72:75], a[156:159], a[104:107], v[72:75]
    ds_read_b64_tr_b16 a[148:149], v25 offset:20480
    v_mfma_f32_16x16x32_bf16 v[76:79], a[156:159], a[108:111], v[76:79]
    ds_read_b64_tr_b16 a[150:151], v25 offset:22528
    v_exp_f32 v253, v253
    s_waitcnt lgkmcnt(8)
    v_mfma_f32_16x16x32_bf16 v[80:83], a[160:163], a[104:107], v[80:83]
    ds_read_b64_tr_b16 a[152:153], v26 offset:8192
    v_mul_f32 v254, v150, v158
    v_mfma_f32_16x16x32_bf16 v[84:87], a[160:163], a[108:111], v[84:87]
    ds_read_b64_tr_b16 a[154:155], v26 offset:10240
    v_mul_f32 v255, v151, v159
    v_mfma_f32_16x16x32_bf16 v[88:91], a[164:167], a[104:107], v[88:91]
    ds_read_b64_tr_b16 a[156:157], v26 offset:20480
    v_fma_f32 v252, v252, v15, v15
    v_fma_f32 v253, v253, v15, v15
    v_mfma_f32_16x16x32_bf16 v[92:95], a[164:167], a[108:111], v[92:95]
    ds_read_b64_tr_b16 a[158:159], v26 offset:22528
    s_waitcnt lgkmcnt(8)
    v_mfma_f32_16x16x32_bf16 v[96:99], a[168:171], a[104:107], v[96:99]
    ds_read_b64_tr_b16 a[160:161], v27 offset:8192
    v_rcp_f32 v252, v252
    v_mfma_f32_16x16x32_bf16 v[100:103], a[168:171], a[108:111], v[100:103]
    ds_read_b64_tr_b16 a[162:163], v27 offset:10240
    v_mfma_f32_16x16x32_bf16 v[104:107], a[172:175], a[104:107], v[104:107]
    ds_read_b64_tr_b16 a[164:165], v27 offset:20480
    v_rcp_f32 v253, v253
    v_mfma_f32_16x16x32_bf16 v[108:111], a[172:175], a[108:111], v[108:111]
    ds_read_b64_tr_b16 a[166:167], v27 offset:22528
    v_mul_f32 v254, v254, v252
    s_waitcnt lgkmcnt(8)
    v_mfma_f32_16x16x32_bf16 v[48:51], a[144:147], a[112:115], v[48:51]
    ds_read_b64_tr_b16 a[168:169], v28 offset:8192
    v_mul_f32 v255, v255, v253
    v_mfma_f32_16x16x32_bf16 v[52:55], a[144:147], a[116:119], v[52:55]
    ds_read_b64_tr_b16 a[170:171], v28 offset:10240
    v_cvt_pk_bf16_f32 v205, v254, v255
    v_mul_f32 v248, v160, v160
    v_mfma_f32_16x16x32_bf16 v[56:59], a[148:151], a[112:115], v[56:59]
    ds_read_b64_tr_b16 a[172:173], v28 offset:20480
    v_mul_f32 v249, v161, v161
    v_mfma_f32_16x16x32_bf16 v[60:63], a[148:151], a[116:119], v[60:63]
    ds_read_b64_tr_b16 a[174:175], v28 offset:22528
    v_fma_f32 v248, v248, v12, v10
    s_waitcnt lgkmcnt(8)
    v_mfma_f32_16x16x32_bf16 v[64:67], a[152:155], a[112:115], v[64:67]
    ds_read_b64_tr_b16 a[144:145], v25 offset:24576
    v_fma_f32 v249, v249, v12, v10
    v_mfma_f32_16x16x32_bf16 v[68:71], a[152:155], a[116:119], v[68:71]
    ds_read_b64_tr_b16 a[146:147], v25 offset:26624
    v_mul_f32 v248, v160, v248
    v_mfma_f32_16x16x32_bf16 v[72:75], a[156:159], a[112:115], v[72:75]
    ds_read_b64_tr_b16 a[148:149], v25 offset:36864
    v_mul_f32 v249, v161, v249
    v_mfma_f32_16x16x32_bf16 v[76:79], a[156:159], a[116:119], v[76:79]
    ds_read_b64_tr_b16 a[150:151], v25 offset:38912
    v_exp_f32 v248, v248
    s_waitcnt lgkmcnt(8)
    v_mfma_f32_16x16x32_bf16 v[80:83], a[160:163], a[112:115], v[80:83]
    ds_read_b64_tr_b16 a[152:153], v26 offset:24576
    v_mfma_f32_16x16x32_bf16 v[84:87], a[160:163], a[116:119], v[84:87]
    ds_read_b64_tr_b16 a[154:155], v26 offset:26624
    v_exp_f32 v249, v249
    v_mfma_f32_16x16x32_bf16 v[88:91], a[164:167], a[112:115], v[88:91]
    ds_read_b64_tr_b16 a[156:157], v26 offset:36864
    v_mul_f32 v250, v160, v168
    v_mfma_f32_16x16x32_bf16 v[92:95], a[164:167], a[116:119], v[92:95]
    ds_read_b64_tr_b16 a[158:159], v26 offset:38912
    v_mul_f32 v251, v161, v169
    s_waitcnt lgkmcnt(8)
    v_mfma_f32_16x16x32_bf16 v[96:99], a[168:171], a[112:115], v[96:99]
    ds_read_b64_tr_b16 a[160:161], v27 offset:24576
    v_fma_f32 v248, v248, v14, v14
    v_mfma_f32_16x16x32_bf16 v[100:103], a[168:171], a[116:119], v[100:103]
    ds_read_b64_tr_b16 a[162:163], v27 offset:26624
    v_fma_f32 v249, v249, v14, v14
    v_mfma_f32_16x16x32_bf16 v[104:107], a[172:175], a[112:115], v[104:107]
    ds_read_b64_tr_b16 a[164:165], v27 offset:36864
    v_rcp_f32 v248, v248
    v_mfma_f32_16x16x32_bf16 v[108:111], a[172:175], a[116:119], v[108:111]
    ds_read_b64_tr_b16 a[166:167], v27 offset:38912
    s_waitcnt vmcnt(18)
    s_barrier
    s_waitcnt lgkmcnt(8)
    v_mfma_f32_16x16x32_bf16 v[48:51], a[144:147], a[120:123], v[48:51]
    ds_read_b64_tr_b16 a[168:169], v28 offset:24576
    v_rcp_f32 v249, v249
    v_mfma_f32_16x16x32_bf16 v[52:55], a[144:147], a[124:127], v[52:55]
    ds_read_b64_tr_b16 a[170:171], v28 offset:26624
    s_add_u32 m0, s25, 98304
    s_add_u32 s32, s80, 384
    buffer_load_dwordx4 v1, s[8:11], s32 offen lds
    v_mul_f32 v250, v250, v248
    v_mfma_f32_16x16x32_bf16 v[56:59], a[148:151], a[120:123], v[56:59]
    ds_read_b64_tr_b16 a[172:173], v28 offset:36864
    v_mul_f32 v251, v251, v249
    v_mfma_f32_16x16x32_bf16 v[60:63], a[148:151], a[124:127], v[60:63]
    ds_read_b64_tr_b16 a[174:175], v28 offset:38912
    v_cvt_pk_bf16_f32 v202, v250, v251
    s_waitcnt lgkmcnt(8)
    v_mfma_f32_16x16x32_bf16 v[64:67], a[152:155], a[120:123], v[64:67]
    ds_read_b64_tr_b16 a[144:145], v25 offset:28672
    buffer_load_dwordx4 v2, s[8:11], s32 offen offset:1024 lds
    v_mul_f32 v252, v162, v162
    v_mul_f32 v253, v163, v163
    v_mfma_f32_16x16x32_bf16 v[68:71], a[152:155], a[124:127], v[68:71]
    ds_read_b64_tr_b16 a[146:147], v25 offset:30720
    v_fma_f32 v252, v252, v12, v10
    v_mfma_f32_16x16x32_bf16 v[72:75], a[156:159], a[120:123], v[72:75]
    ds_read_b64_tr_b16 a[148:149], v25 offset:40960
    v_fma_f32 v253, v253, v12, v10
    v_mfma_f32_16x16x32_bf16 v[76:79], a[156:159], a[124:127], v[76:79]
    ds_read_b64_tr_b16 a[150:151], v25 offset:43008
    buffer_load_dwordx4 v3, s[8:11], s32 offen offset:2048 lds
    v_mul_f32 v252, v162, v252
    s_waitcnt lgkmcnt(8)
    v_mfma_f32_16x16x32_bf16 v[80:83], a[160:163], a[120:123], v[80:83]
    ds_read_b64_tr_b16 a[152:153], v26 offset:28672
    v_mul_f32 v253, v163, v253
    v_mfma_f32_16x16x32_bf16 v[84:87], a[160:163], a[124:127], v[84:87]
    ds_read_b64_tr_b16 a[154:155], v26 offset:30720
    v_mfma_f32_16x16x32_bf16 v[88:91], a[164:167], a[120:123], v[88:91]
    ds_read_b64_tr_b16 a[156:157], v26 offset:40960
    s_add_u32 m0, s25, 101376
    s_add_u32 s32, s80, 221568
    buffer_load_dwordx4 v1, s[8:11], s32 offen lds
    v_exp_f32 v252, v252
    v_mfma_f32_16x16x32_bf16 v[92:95], a[164:167], a[124:127], v[92:95]
    ds_read_b64_tr_b16 a[158:159], v26 offset:43008
    v_exp_f32 v253, v253
    s_waitcnt lgkmcnt(8)
    v_mfma_f32_16x16x32_bf16 v[96:99], a[168:171], a[120:123], v[96:99]
    ds_read_b64_tr_b16 a[160:161], v27 offset:28672
    v_mul_f32 v254, v162, v170
    v_mfma_f32_16x16x32_bf16 v[100:103], a[168:171], a[124:127], v[100:103]
    ds_read_b64_tr_b16 a[162:163], v27 offset:30720
    buffer_load_dwordx4 v2, s[8:11], s32 offen offset:1024 lds
    v_mul_f32 v255, v163, v171
    v_mfma_f32_16x16x32_bf16 v[104:107], a[172:175], a[120:123], v[104:107]
    ds_read_b64_tr_b16 a[164:165], v27 offset:40960
    v_fma_f32 v252, v252, v14, v14
    v_mfma_f32_16x16x32_bf16 v[108:111], a[172:175], a[124:127], v[108:111]
    ds_read_b64_tr_b16 a[166:167], v27 offset:43008
    v_fma_f32 v253, v253, v14, v14
    s_waitcnt lgkmcnt(8)
    v_mfma_f32_16x16x32_bf16 v[48:51], a[144:147], a[128:131], v[48:51]
    ds_read_b64_tr_b16 a[168:169], v28 offset:28672
    buffer_load_dwordx4 v3, s[8:11], s32 offen offset:2048 lds
    v_mfma_f32_16x16x32_bf16 v[52:55], a[144:147], a[132:135], v[52:55]
    ds_read_b64_tr_b16 a[170:171], v28 offset:30720
    v_rcp_f32 v252, v252
    v_mfma_f32_16x16x32_bf16 v[56:59], a[148:151], a[128:131], v[56:59]
    ds_read_b64_tr_b16 a[172:173], v28 offset:40960
    v_rcp_f32 v253, v253
    v_mfma_f32_16x16x32_bf16 v[60:63], a[148:151], a[132:135], v[60:63]
    ds_read_b64_tr_b16 a[174:175], v28 offset:43008
    v_mul_f32 v254, v254, v252
    s_waitcnt lgkmcnt(8)
    v_mfma_f32_16x16x32_bf16 v[64:67], a[152:155], a[128:131], v[64:67]
    ds_read_b64_tr_b16 a[144:145], v25 offset:32768
    v_mul_f32 v255, v255, v253
    v_mfma_f32_16x16x32_bf16 v[68:71], a[152:155], a[132:135], v[68:71]
    ds_read_b64_tr_b16 a[146:147], v25 offset:34816
    v_cvt_pk_bf16_f32 v203, v254, v255
    v_mfma_f32_16x16x32_bf16 v[72:75], a[156:159], a[128:131], v[72:75]
    ds_read_b64_tr_b16 a[148:149], v25 offset:45056
    v_mul_f32 v248, v164, v164
    v_mfma_f32_16x16x32_bf16 v[76:79], a[156:159], a[132:135], v[76:79]
    ds_read_b64_tr_b16 a[150:151], v25 offset:47104
    v_mul_f32 v249, v165, v165
    s_waitcnt lgkmcnt(8)
    v_mfma_f32_16x16x32_bf16 v[80:83], a[160:163], a[128:131], v[80:83]
    ds_read_b64_tr_b16 a[152:153], v26 offset:32768
    v_fma_f32 v248, v248, v13, v11
    v_fma_f32 v249, v249, v13, v11
    v_mfma_f32_16x16x32_bf16 v[84:87], a[160:163], a[132:135], v[84:87]
    ds_read_b64_tr_b16 a[154:155], v26 offset:34816
    v_mul_f32 v248, v164, v248
    v_mfma_f32_16x16x32_bf16 v[88:91], a[164:167], a[128:131], v[88:91]
    ds_read_b64_tr_b16 a[156:157], v26 offset:45056
    v_mul_f32 v249, v165, v249
    v_mfma_f32_16x16x32_bf16 v[92:95], a[164:167], a[132:135], v[92:95]
    ds_read_b64_tr_b16 a[158:159], v26 offset:47104
    s_waitcnt lgkmcnt(8)
    v_mfma_f32_16x16x32_bf16 v[96:99], a[168:171], a[128:131], v[96:99]
    ds_read_b64_tr_b16 a[160:161], v27 offset:32768
    v_exp_f32 v248, v248
    v_mfma_f32_16x16x32_bf16 v[100:103], a[168:171], a[132:135], v[100:103]
    ds_read_b64_tr_b16 a[162:163], v27 offset:34816
    v_mfma_f32_16x16x32_bf16 v[104:107], a[172:175], a[128:131], v[104:107]
    ds_read_b64_tr_b16 a[164:165], v27 offset:45056
    v_exp_f32 v249, v249
    v_mfma_f32_16x16x32_bf16 v[108:111], a[172:175], a[132:135], v[108:111]
    ds_read_b64_tr_b16 a[166:167], v27 offset:47104
    v_mul_f32 v250, v164, v172
    v_mul_f32 v251, v165, v173
    s_waitcnt lgkmcnt(8)
    v_mfma_f32_16x16x32_bf16 v[48:51], a[144:147], a[136:139], v[48:51]
    ds_read_b64_tr_b16 a[168:169], v28 offset:32768
    v_fma_f32 v248, v248, v15, v15
    v_mfma_f32_16x16x32_bf16 v[52:55], a[144:147], a[140:143], v[52:55]
    ds_read_b64_tr_b16 a[170:171], v28 offset:34816
    v_fma_f32 v249, v249, v15, v15
    v_mfma_f32_16x16x32_bf16 v[56:59], a[148:151], a[136:139], v[56:59]
    ds_read_b64_tr_b16 a[172:173], v28 offset:45056
    v_mfma_f32_16x16x32_bf16 v[60:63], a[148:151], a[140:143], v[60:63]
    ds_read_b64_tr_b16 a[174:175], v28 offset:47104
    v_rcp_f32 v248, v248
    s_waitcnt lgkmcnt(8)
    v_mfma_f32_16x16x32_bf16 v[64:67], a[152:155], a[136:139], v[64:67]
    ds_read_b64_tr_b16 a[144:145], v17 offset:0
    v_mfma_f32_16x16x32_bf16 v[68:71], a[152:155], a[140:143], v[68:71]
    ds_read_b64_tr_b16 a[146:147], v17 offset:2048
    v_rcp_f32 v249, v249
    v_mfma_f32_16x16x32_bf16 v[72:75], a[156:159], a[136:139], v[72:75]
    ds_read_b64_tr_b16 a[148:149], v17 offset:12288
    v_mul_f32 v250, v250, v248
    v_mul_f32 v251, v251, v249
    v_mfma_f32_16x16x32_bf16 v[76:79], a[156:159], a[140:143], v[76:79]
    ds_read_b64_tr_b16 a[150:151], v17 offset:14336
    v_cvt_pk_bf16_f32 v206, v250, v251
    s_waitcnt lgkmcnt(8)
    v_mfma_f32_16x16x32_bf16 v[80:83], a[160:163], a[136:139], v[80:83]
    ds_read_b64_tr_b16 a[152:153], v18 offset:0
    v_mul_f32 v252, v166, v166
    v_mfma_f32_16x16x32_bf16 v[84:87], a[160:163], a[140:143], v[84:87]
    ds_read_b64_tr_b16 a[154:155], v18 offset:2048
    v_mul_f32 v253, v167, v167
    v_mfma_f32_16x16x32_bf16 v[88:91], a[164:167], a[136:139], v[88:91]
    ds_read_b64_tr_b16 a[156:157], v18 offset:12288
    v_fma_f32 v252, v252, v13, v11
    v_mfma_f32_16x16x32_bf16 v[92:95], a[164:167], a[140:143], v[92:95]
    ds_read_b64_tr_b16 a[158:159], v18 offset:14336
    v_fma_f32 v253, v253, v13, v11
    s_waitcnt lgkmcnt(8)
    v_mfma_f32_16x16x32_bf16 v[96:99], a[168:171], a[136:139], v[96:99]
    ds_read_b64_tr_b16 a[160:161], v19 offset:0
    v_mul_f32 v252, v166, v252
    v_mul_f32 v253, v167, v253
    v_mfma_f32_16x16x32_bf16 v[100:103], a[168:171], a[140:143], v[100:103]
    ds_read_b64_tr_b16 a[162:163], v19 offset:2048
    v_mfma_f32_16x16x32_bf16 v[104:107], a[172:175], a[136:139], v[104:107]
    ds_read_b64_tr_b16 a[164:165], v19 offset:12288
    v_exp_f32 v252, v252
    v_mfma_f32_16x16x32_bf16 v[108:111], a[172:175], a[140:143], v[108:111]
    ds_read_b64_tr_b16 a[166:167], v19 offset:14336
    v_mfma_f32_16x16x32_bf16 v[48:51], a[192:195], a[214:217], v[48:51]
    v_exp_f32 v253, v253
    v_mfma_f32_16x16x32_bf16 v[52:55], a[192:195], a[222:225], v[52:55]
    v_mul_f32 v254, v166, v174
    v_mfma_f32_16x16x32_bf16 v[56:59], a[192:195], a[218:221], v[56:59]
    v_mul_f32 v255, v167, v175
    v_mfma_f32_16x16x32_bf16 v[60:63], a[192:195], a[226:229], v[60:63]
    v_fma_f32 v252, v252, v15, v15
    v_fma_f32 v253, v253, v15, v15
    v_mfma_f32_16x16x32_bf16 v[64:67], a[194:197], a[214:217], v[64:67]
    v_mfma_f32_16x16x32_bf16 v[68:71], a[194:197], a[222:225], v[68:71]
    v_rcp_f32 v252, v252
    v_mfma_f32_16x16x32_bf16 v[72:75], a[194:197], a[218:221], v[72:75]
    v_mfma_f32_16x16x32_bf16 v[76:79], a[194:197], a[226:229], v[76:79]
    v_rcp_f32 v253, v253
    v_mfma_f32_16x16x32_bf16 v[80:83], a[196:199], a[214:217], v[80:83]
    v_mul_f32 v254, v254, v252
    v_mfma_f32_16x16x32_bf16 v[84:87], a[196:199], a[222:225], v[84:87]
    v_mul_f32 v255, v255, v253
    v_mfma_f32_16x16x32_bf16 v[88:91], a[196:199], a[218:221], v[88:91]
    v_cvt_pk_bf16_f32 v207, v254, v255
    v_mfma_f32_16x16x32_bf16 v[92:95], a[196:199], a[226:229], v[92:95]
    v_mfma_f32_16x16x32_bf16 v[96:99], a[198:201], a[214:217], v[96:99]
    v_mfma_f32_16x16x32_bf16 v[100:103], a[198:201], a[222:225], v[100:103]
    v_mfma_f32_16x16x32_bf16 v[104:107], a[198:201], a[218:221], v[104:107]
    v_mfma_f32_16x16x32_bf16 v[108:111], a[198:201], a[226:229], v[108:111]
    s_waitcnt vmcnt(18)
    s_barrier
    s_waitcnt lgkmcnt(8)
    v_mfma_f32_16x16x32_bf16 v[112:115], a[144:147], a[0:3], 0
    ds_read_b64_tr_b16 a[168:169], v20 offset:0
    v_mfma_f32_16x16x32_bf16 v[116:119], a[144:147], a[4:7], 0
    ds_read_b64_tr_b16 a[170:171], v20 offset:2048
    s_add_u32 m0, s25, 122880
    s_add_u32 s32, s81, 384
    buffer_load_dwordx4 v1, s[8:11], s32 offen lds
    v_mfma_f32_16x16x32_bf16 v[120:123], a[148:151], a[0:3], 0
    ds_read_b64_tr_b16 a[172:173], v20 offset:12288
    v_mfma_f32_16x16x32_bf16 v[124:127], a[148:151], a[4:7], 0
    ds_read_b64_tr_b16 a[174:175], v20 offset:14336
    s_waitcnt lgkmcnt(8)
    v_mfma_f32_16x16x32_bf16 v[128:131], a[152:155], a[0:3], 0
    ds_read_b64_tr_b16 a[144:145], v17 offset:4096
    buffer_load_dwordx4 v2, s[8:11], s32 offen offset:1024 lds
    v_mfma_f32_16x16x32_bf16 v[132:135], a[152:155], a[4:7], 0
    ds_read_b64_tr_b16 a[146:147], v17 offset:6144
    v_mfma_f32_16x16x32_bf16 v[136:139], a[156:159], a[0:3], 0
    ds_read_b64_tr_b16 a[148:149], v17 offset:16384
    v_mul_f32 v248, v48, v48
    v_mfma_f32_16x16x32_bf16 v[140:143], a[156:159], a[4:7], 0
    ds_read_b64_tr_b16 a[150:151], v17 offset:18432
    buffer_load_dwordx4 v3, s[8:11], s32 offen offset:2048 lds
    v_mul_f32 v249, v49, v49
    s_waitcnt lgkmcnt(8)
    v_mfma_f32_16x16x32_bf16 v[144:147], a[160:163], a[0:3], 0
    ds_read_b64_tr_b16 a[152:153], v18 offset:4096
    v_fma_f32 v248, v248, v12, v10
    v_mfma_f32_16x16x32_bf16 v[148:151], a[160:163], a[4:7], 0
    ds_read_b64_tr_b16 a[154:155], v18 offset:6144
    v_fma_f32 v249, v249, v12, v10
    v_mfma_f32_16x16x32_bf16 v[152:155], a[164:167], a[0:3], 0
    ds_read_b64_tr_b16 a[156:157], v18 offset:16384
    s_add_u32 m0, s25, 125952
    s_add_u32 s32, s81, 221568
    buffer_load_dwordx4 v1, s[8:11], s32 offen lds
    v_mul_f32 v248, v48, v248
    v_mfma_f32_16x16x32_bf16 v[156:159], a[164:167], a[4:7], 0
    ds_read_b64_tr_b16 a[158:159], v18 offset:18432
    v_mul_f32 v249, v49, v249
    s_waitcnt lgkmcnt(8)
    v_mfma_f32_16x16x32_bf16 v[160:163], a[168:171], a[0:3], 0
    ds_read_b64_tr_b16 a[160:161], v19 offset:4096
    v_exp_f32 v248, v248
    v_mfma_f32_16x16x32_bf16 v[164:167], a[168:171], a[4:7], 0
    ds_read_b64_tr_b16 a[162:163], v19 offset:6144
    buffer_load_dwordx4 v2, s[8:11], s32 offen offset:1024 lds
    v_mfma_f32_16x16x32_bf16 v[168:171], a[172:175], a[0:3], 0
    ds_read_b64_tr_b16 a[164:165], v19 offset:16384
    v_exp_f32 v249, v249
    v_mfma_f32_16x16x32_bf16 v[172:175], a[172:175], a[4:7], 0
    ds_read_b64_tr_b16 a[166:167], v19 offset:18432
    v_mul_f32 v250, v48, v56
    s_waitcnt lgkmcnt(8)
    v_mfma_f32_16x16x32_bf16 v[112:115], a[144:147], a[8:11], v[112:115]
    ds_read_b64_tr_b16 a[168:169], v20 offset:4096
    buffer_load_dwordx4 v3, s[8:11], s32 offen offset:2048 lds
    v_mul_f32 v251, v49, v57
    v_mfma_f32_16x16x32_bf16 v[116:119], a[144:147], a[12:15], v[116:119]
    ds_read_b64_tr_b16 a[170:171], v20 offset:6144
    v_fma_f32 v248, v248, v14, v14
    v_mfma_f32_16x16x32_bf16 v[120:123], a[148:151], a[8:11], v[120:123]
    ds_read_b64_tr_b16 a[172:173], v20 offset:16384
    v_fma_f32 v249, v249, v14, v14
    v_mfma_f32_16x16x32_bf16 v[124:127], a[148:151], a[12:15], v[124:127]
    ds_read_b64_tr_b16 a[174:175], v20 offset:18432
    v_rcp_f32 v248, v248
    s_waitcnt lgkmcnt(8)
    v_mfma_f32_16x16x32_bf16 v[128:131], a[152:155], a[8:11], v[128:131]
    ds_read_b64_tr_b16 a[144:145], v17 offset:8192
    v_mfma_f32_16x16x32_bf16 v[132:135], a[152:155], a[12:15], v[132:135]
    ds_read_b64_tr_b16 a[146:147], v17 offset:10240
    v_rcp_f32 v249, v249
    v_mfma_f32_16x16x32_bf16 v[136:139], a[156:159], a[8:11], v[136:139]
    ds_read_b64_tr_b16 a[148:149], v17 offset:20480
    v_mul_f32 v250, v250, v248
    v_mfma_f32_16x16x32_bf16 v[140:143], a[156:159], a[12:15], v[140:143]
    ds_read_b64_tr_b16 a[150:151], v17 offset:22528
    v_mul_f32 v251, v251, v249
    s_waitcnt lgkmcnt(8)
    v_mfma_f32_16x16x32_bf16 v[144:147], a[160:163], a[8:11], v[144:147]
    ds_read_b64_tr_b16 a[152:153], v18 offset:8192
    v_cvt_pk_bf16_f32 v208, v250, v251
    v_mfma_f32_16x16x32_bf16 v[148:151], a[160:163], a[12:15], v[148:151]
    ds_read_b64_tr_b16 a[154:155], v18 offset:10240
    v_mul_f32 v252, v50, v50
    v_mul_f32 v253, v51, v51
    v_mfma_f32_16x16x32_bf16 v[152:155], a[164:167], a[8:11], v[152:155]
    ds_read_b64_tr_b16 a[156:157], v18 offset:20480
    v_fma_f32 v252, v252, v12, v10
    v_mfma_f32_16x16x32_bf16 v[156:159], a[164:167], a[12:15], v[156:159]
    ds_read_b64_tr_b16 a[158:159], v18 offset:22528
    v_fma_f32 v253, v253, v12, v10
    s_waitcnt lgkmcnt(8)
    v_mfma_f32_16x16x32_bf16 v[160:163], a[168:171], a[8:11], v[160:163]
    ds_read_b64_tr_b16 a[160:161], v19 offset:8192
    v_mul_f32 v252, v50, v252
    v_mfma_f32_16x16x32_bf16 v[164:167], a[168:171], a[12:15], v[164:167]
    ds_read_b64_tr_b16 a[162:163], v19 offset:10240
    v_mul_f32 v253, v51, v253
    v_mfma_f32_16x16x32_bf16 v[168:171], a[172:175], a[8:11], v[168:171]
    ds_read_b64_tr_b16 a[164:165], v19 offset:20480
    v_mfma_f32_16x16x32_bf16 v[172:175], a[172:175], a[12:15], v[172:175]
    ds_read_b64_tr_b16 a[166:167], v19 offset:22528
    v_exp_f32 v252, v252
    s_waitcnt lgkmcnt(8)
    v_mfma_f32_16x16x32_bf16 v[112:115], a[144:147], a[16:19], v[112:115]
    ds_read_b64_tr_b16 a[168:169], v20 offset:8192
    v_exp_f32 v253, v253
    v_mfma_f32_16x16x32_bf16 v[116:119], a[144:147], a[20:23], v[116:119]
    ds_read_b64_tr_b16 a[170:171], v20 offset:10240
    v_mul_f32 v254, v50, v58
    v_mfma_f32_16x16x32_bf16 v[120:123], a[148:151], a[16:19], v[120:123]
    ds_read_b64_tr_b16 a[172:173], v20 offset:20480
    v_mul_f32 v255, v51, v59
    v_mfma_f32_16x16x32_bf16 v[124:127], a[148:151], a[20:23], v[124:127]
    ds_read_b64_tr_b16 a[174:175], v20 offset:22528
    v_fma_f32 v252, v252, v14, v14
    s_waitcnt lgkmcnt(8)
    v_mfma_f32_16x16x32_bf16 v[128:131], a[152:155], a[16:19], v[128:131]
    ds_read_b64_tr_b16 a[144:145], v17 offset:24576
    v_fma_f32 v253, v253, v14, v14
    v_mfma_f32_16x16x32_bf16 v[132:135], a[152:155], a[20:23], v[132:135]
    ds_read_b64_tr_b16 a[146:147], v17 offset:26624
    v_mfma_f32_16x16x32_bf16 v[136:139], a[156:159], a[16:19], v[136:139]
    ds_read_b64_tr_b16 a[148:149], v17 offset:36864
    v_rcp_f32 v252, v252
    v_mfma_f32_16x16x32_bf16 v[140:143], a[156:159], a[20:23], v[140:143]
    ds_read_b64_tr_b16 a[150:151], v17 offset:38912
    v_rcp_f32 v253, v253
    s_waitcnt lgkmcnt(8)
    v_mfma_f32_16x16x32_bf16 v[144:147], a[160:163], a[16:19], v[144:147]
    ds_read_b64_tr_b16 a[152:153], v18 offset:24576
    v_mul_f32 v254, v254, v252
    v_mfma_f32_16x16x32_bf16 v[148:151], a[160:163], a[20:23], v[148:151]
    ds_read_b64_tr_b16 a[154:155], v18 offset:26624
    v_mul_f32 v255, v255, v253
    v_mfma_f32_16x16x32_bf16 v[152:155], a[164:167], a[16:19], v[152:155]
    ds_read_b64_tr_b16 a[156:157], v18 offset:36864
    v_cvt_pk_bf16_f32 v209, v254, v255
    v_mfma_f32_16x16x32_bf16 v[156:159], a[164:167], a[20:23], v[156:159]
    ds_read_b64_tr_b16 a[158:159], v18 offset:38912
    v_mul_f32 v248, v52, v52
    s_waitcnt lgkmcnt(8)
    v_mfma_f32_16x16x32_bf16 v[160:163], a[168:171], a[16:19], v[160:163]
    ds_read_b64_tr_b16 a[160:161], v19 offset:24576
    v_mul_f32 v249, v53, v53
    v_mfma_f32_16x16x32_bf16 v[164:167], a[168:171], a[20:23], v[164:167]
    ds_read_b64_tr_b16 a[162:163], v19 offset:26624
    v_fma_f32 v248, v248, v13, v11
    v_fma_f32 v249, v249, v13, v11
    v_mfma_f32_16x16x32_bf16 v[168:171], a[172:175], a[16:19], v[168:171]
    ds_read_b64_tr_b16 a[164:165], v19 offset:36864
    v_mul_f32 v248, v52, v248
    v_mfma_f32_16x16x32_bf16 v[172:175], a[172:175], a[20:23], v[172:175]
    ds_read_b64_tr_b16 a[166:167], v19 offset:38912
    v_mul_f32 v249, v53, v249
    s_waitcnt vmcnt(18)
    s_barrier
    s_waitcnt lgkmcnt(8)
    v_mfma_f32_16x16x32_bf16 v[112:115], a[144:147], a[24:27], v[112:115]
    ds_read_b64_tr_b16 a[168:169], v20 offset:24576
    v_mfma_f32_16x16x32_bf16 v[116:119], a[144:147], a[28:31], v[116:119]
    ds_read_b64_tr_b16 a[170:171], v20 offset:26624
    s_add_u32 m0, s25, 0
    s_add_u32 s32, s92, 0
    buffer_load_dwordx4 v4, s[8:11], s32 offen lds
    v_exp_f32 v248, v248
    v_mfma_f32_16x16x32_bf16 v[120:123], a[148:151], a[24:27], v[120:123]
    ds_read_b64_tr_b16 a[172:173], v20 offset:36864
    v_mfma_f32_16x16x32_bf16 v[124:127], a[148:151], a[28:31], v[124:127]
    ds_read_b64_tr_b16 a[174:175], v20 offset:38912
    v_exp_f32 v249, v249
    s_waitcnt lgkmcnt(8)
    v_mfma_f32_16x16x32_bf16 v[128:131], a[152:155], a[24:27], v[128:131]
    ds_read_b64_tr_b16 a[144:145], v17 offset:28672
    buffer_load_dwordx4 v5, s[8:11], s32 offen offset:1024 lds
    v_mul_f32 v250, v52, v60
    v_mul_f32 v251, v53, v61
    v_mfma_f32_16x16x32_bf16 v[132:135], a[152:155], a[28:31], v[132:135]
    ds_read_b64_tr_b16 a[146:147], v17 offset:30720
    v_fma_f32 v248, v248, v15, v15
    v_mfma_f32_16x16x32_bf16 v[136:139], a[156:159], a[24:27], v[136:139]
    ds_read_b64_tr_b16 a[148:149], v17 offset:40960
    v_fma_f32 v249, v249, v15, v15
    v_mfma_f32_16x16x32_bf16 v[140:143], a[156:159], a[28:31], v[140:143]
    ds_read_b64_tr_b16 a[150:151], v17 offset:43008
    buffer_load_dwordx4 v6, s[8:11], s32 offen offset:2048 lds
    s_waitcnt lgkmcnt(8)
    v_mfma_f32_16x16x32_bf16 v[144:147], a[160:163], a[24:27], v[144:147]
    ds_read_b64_tr_b16 a[152:153], v18 offset:28672
    v_rcp_f32 v248, v248
    v_mfma_f32_16x16x32_bf16 v[148:151], a[160:163], a[28:31], v[148:151]
    ds_read_b64_tr_b16 a[154:155], v18 offset:30720
    v_mfma_f32_16x16x32_bf16 v[152:155], a[164:167], a[24:27], v[152:155]
    ds_read_b64_tr_b16 a[156:157], v18 offset:40960
    s_add_u32 m0, s25, 3072
    s_add_u32 s32, s92, 442368
    buffer_load_dwordx4 v4, s[8:11], s32 offen lds
    v_rcp_f32 v249, v249
    v_mfma_f32_16x16x32_bf16 v[156:159], a[164:167], a[28:31], v[156:159]
    ds_read_b64_tr_b16 a[158:159], v18 offset:43008
    v_mul_f32 v250, v250, v248
    v_mul_f32 v251, v251, v249
    s_waitcnt lgkmcnt(8)
    v_mfma_f32_16x16x32_bf16 v[160:163], a[168:171], a[24:27], v[160:163]
    ds_read_b64_tr_b16 a[160:161], v19 offset:28672
    v_cvt_pk_bf16_f32 v212, v250, v251
    v_mfma_f32_16x16x32_bf16 v[164:167], a[168:171], a[28:31], v[164:167]
    ds_read_b64_tr_b16 a[162:163], v19 offset:30720
    buffer_load_dwordx4 v5, s[8:11], s32 offen offset:1024 lds
    v_mul_f32 v252, v54, v54
    v_mfma_f32_16x16x32_bf16 v[168:171], a[172:175], a[24:27], v[168:171]
    ds_read_b64_tr_b16 a[164:165], v19 offset:40960
    v_mul_f32 v253, v55, v55
    v_mfma_f32_16x16x32_bf16 v[172:175], a[172:175], a[28:31], v[172:175]
    ds_read_b64_tr_b16 a[166:167], v19 offset:43008
    v_fma_f32 v252, v252, v13, v11
    s_waitcnt lgkmcnt(8)
    v_mfma_f32_16x16x32_bf16 v[112:115], a[144:147], a[32:35], v[112:115]
    ds_read_b64_tr_b16 a[168:169], v20 offset:28672
    buffer_load_dwordx4 v6, s[8:11], s32 offen offset:2048 lds
    v_fma_f32 v253, v253, v13, v11
    v_mfma_f32_16x16x32_bf16 v[116:119], a[144:147], a[36:39], v[116:119]
    ds_read_b64_tr_b16 a[170:171], v20 offset:30720
    v_mul_f32 v252, v54, v252
    v_mul_f32 v253, v55, v253
    v_mfma_f32_16x16x32_bf16 v[120:123], a[148:151], a[32:35], v[120:123]
    ds_read_b64_tr_b16 a[172:173], v20 offset:40960
    v_mfma_f32_16x16x32_bf16 v[124:127], a[148:151], a[36:39], v[124:127]
    ds_read_b64_tr_b16 a[174:175], v20 offset:43008
    v_exp_f32 v252, v252
    s_waitcnt lgkmcnt(8)
    v_mfma_f32_16x16x32_bf16 v[128:131], a[152:155], a[32:35], v[128:131]
    ds_read_b64_tr_b16 a[144:145], v17 offset:32768
    v_mfma_f32_16x16x32_bf16 v[132:135], a[152:155], a[36:39], v[132:135]
    ds_read_b64_tr_b16 a[146:147], v17 offset:34816
    v_exp_f32 v253, v253
    v_mfma_f32_16x16x32_bf16 v[136:139], a[156:159], a[32:35], v[136:139]
    ds_read_b64_tr_b16 a[148:149], v17 offset:45056
    v_mul_f32 v254, v54, v62
    v_mfma_f32_16x16x32_bf16 v[140:143], a[156:159], a[36:39], v[140:143]
    ds_read_b64_tr_b16 a[150:151], v17 offset:47104
    v_mul_f32 v255, v55, v63
    s_waitcnt lgkmcnt(8)
    v_mfma_f32_16x16x32_bf16 v[144:147], a[160:163], a[32:35], v[144:147]
    ds_read_b64_tr_b16 a[152:153], v18 offset:32768
    v_fma_f32 v252, v252, v15, v15
    v_fma_f32 v253, v253, v15, v15
    v_mfma_f32_16x16x32_bf16 v[148:151], a[160:163], a[36:39], v[148:151]
    ds_read_b64_tr_b16 a[154:155], v18 offset:34816
    v_mfma_f32_16x16x32_bf16 v[152:155], a[164:167], a[32:35], v[152:155]
    ds_read_b64_tr_b16 a[156:157], v18 offset:45056
    v_rcp_f32 v252, v252
    v_mfma_f32_16x16x32_bf16 v[156:159], a[164:167], a[36:39], v[156:159]
    ds_read_b64_tr_b16 a[158:159], v18 offset:47104
    s_waitcnt lgkmcnt(8)
    v_mfma_f32_16x16x32_bf16 v[160:163], a[168:171], a[32:35], v[160:163]
    ds_read_b64_tr_b16 a[160:161], v19 offset:32768
    v_rcp_f32 v253, v253
    v_mfma_f32_16x16x32_bf16 v[164:167], a[168:171], a[36:39], v[164:167]
    ds_read_b64_tr_b16 a[162:163], v19 offset:34816
    v_mul_f32 v254, v254, v252
    v_mfma_f32_16x16x32_bf16 v[168:171], a[172:175], a[32:35], v[168:171]
    ds_read_b64_tr_b16 a[164:165], v19 offset:45056
    v_mul_f32 v255, v255, v253
    v_mfma_f32_16x16x32_bf16 v[172:175], a[172:175], a[36:39], v[172:175]
    ds_read_b64_tr_b16 a[166:167], v19 offset:47104
    v_cvt_pk_bf16_f32 v213, v254, v255
    v_mul_f32 v248, v64, v64
    s_waitcnt lgkmcnt(8)
    v_mfma_f32_16x16x32_bf16 v[112:115], a[144:147], a[40:43], v[112:115]
    ds_read_b64_tr_b16 a[168:169], v20 offset:32768
    v_mul_f32 v249, v65, v65
    v_mfma_f32_16x16x32_bf16 v[116:119], a[144:147], a[44:47], v[116:119]
    ds_read_b64_tr_b16 a[170:171], v20 offset:34816
    v_fma_f32 v248, v248, v12, v10
    v_mfma_f32_16x16x32_bf16 v[120:123], a[148:151], a[40:43], v[120:123]
    ds_read_b64_tr_b16 a[172:173], v20 offset:45056
    v_fma_f32 v249, v249, v12, v10
    v_mfma_f32_16x16x32_bf16 v[124:127], a[148:151], a[44:47], v[124:127]
    ds_read_b64_tr_b16 a[174:175], v20 offset:47104
    v_mul_f32 v248, v64, v248
    s_waitcnt lgkmcnt(8)
    v_mfma_f32_16x16x32_bf16 v[128:131], a[152:155], a[40:43], v[128:131]
    ds_read_b64_tr_b16 a[144:145], v21 offset:0
    v_mul_f32 v249, v65, v249
    v_mfma_f32_16x16x32_bf16 v[132:135], a[152:155], a[44:47], v[132:135]
    ds_read_b64_tr_b16 a[146:147], v21 offset:2048
    v_exp_f32 v248, v248
    v_mfma_f32_16x16x32_bf16 v[136:139], a[156:159], a[40:43], v[136:139]
    ds_read_b64_tr_b16 a[148:149], v21 offset:12288
    v_mfma_f32_16x16x32_bf16 v[140:143], a[156:159], a[44:47], v[140:143]
    ds_read_b64_tr_b16 a[150:151], v21 offset:14336
    v_exp_f32 v249, v249
    s_waitcnt lgkmcnt(8)
    v_mfma_f32_16x16x32_bf16 v[144:147], a[160:163], a[40:43], v[144:147]
    ds_read_b64_tr_b16 a[152:153], v22 offset:0
    v_mul_f32 v250, v64, v72
    v_mfma_f32_16x16x32_bf16 v[148:151], a[160:163], a[44:47], v[148:151]
    ds_read_b64_tr_b16 a[154:155], v22 offset:2048
    v_mul_f32 v251, v65, v73
    v_mfma_f32_16x16x32_bf16 v[152:155], a[164:167], a[40:43], v[152:155]
    ds_read_b64_tr_b16 a[156:157], v22 offset:12288
    v_fma_f32 v248, v248, v14, v14
    v_mfma_f32_16x16x32_bf16 v[156:159], a[164:167], a[44:47], v[156:159]
    ds_read_b64_tr_b16 a[158:159], v22 offset:14336
    v_fma_f32 v249, v249, v14, v14
    s_waitcnt lgkmcnt(8)
    v_mfma_f32_16x16x32_bf16 v[160:163], a[168:171], a[40:43], v[160:163]
    ds_read_b64_tr_b16 a[160:161], v23 offset:0
    v_rcp_f32 v248, v248
    v_mfma_f32_16x16x32_bf16 v[164:167], a[168:171], a[44:47], v[164:167]
    ds_read_b64_tr_b16 a[162:163], v23 offset:2048
    v_mfma_f32_16x16x32_bf16 v[168:171], a[172:175], a[40:43], v[168:171]
    ds_read_b64_tr_b16 a[164:165], v23 offset:12288
    v_rcp_f32 v249, v249
    v_mfma_f32_16x16x32_bf16 v[172:175], a[172:175], a[44:47], v[172:175]
    ds_read_b64_tr_b16 a[166:167], v23 offset:14336
    v_mul_f32 v250, v250, v248
    s_waitcnt vmcnt(18)
    s_barrier
    s_waitcnt lgkmcnt(8)
    v_mfma_f32_16x16x32_bf16 v[112:115], a[144:147], a[48:51], v[112:115]
    ds_read_b64_tr_b16 a[168:169], v24 offset:0
    v_mul_f32 v251, v251, v249
    v_mfma_f32_16x16x32_bf16 v[116:119], a[144:147], a[52:55], v[116:119]
    ds_read_b64_tr_b16 a[170:171], v24 offset:2048
    s_add_u32 m0, s25, 24576
    s_add_u32 s32, s93, 0
    buffer_load_dwordx4 v4, s[8:11], s32 offen lds
    v_cvt_pk_bf16_f32 v210, v250, v251
    v_mfma_f32_16x16x32_bf16 v[120:123], a[148:151], a[48:51], v[120:123]
    ds_read_b64_tr_b16 a[172:173], v24 offset:12288
    v_mul_f32 v252, v66, v66
    v_mul_f32 v253, v67, v67
    v_mfma_f32_16x16x32_bf16 v[124:127], a[148:151], a[52:55], v[124:127]
    ds_read_b64_tr_b16 a[174:175], v24 offset:14336
    v_fma_f32 v252, v252, v12, v10
    s_waitcnt lgkmcnt(8)
    v_mfma_f32_16x16x32_bf16 v[128:131], a[152:155], a[48:51], v[128:131]
    ds_read_b64_tr_b16 a[144:145], v21 offset:4096
    buffer_load_dwordx4 v5, s[8:11], s32 offen offset:1024 lds
    v_fma_f32 v253, v253, v12, v10
    v_mfma_f32_16x16x32_bf16 v[132:135], a[152:155], a[52:55], v[132:135]
    ds_read_b64_tr_b16 a[146:147], v21 offset:6144
    v_mul_f32 v252, v66, v252
    v_mfma_f32_16x16x32_bf16 v[136:139], a[156:159], a[48:51], v[136:139]
    ds_read_b64_tr_b16 a[148:149], v21 offset:16384
    v_mul_f32 v253, v67, v253
    v_mfma_f32_16x16x32_bf16 v[140:143], a[156:159], a[52:55], v[140:143]
    ds_read_b64_tr_b16 a[150:151], v21 offset:18432
    buffer_load_dwordx4 v6, s[8:11], s32 offen offset:2048 lds
    s_waitcnt lgkmcnt(8)
    v_mfma_f32_16x16x32_bf16 v[144:147], a[160:163], a[48:51], v[144:147]
    ds_read_b64_tr_b16 a[152:153], v22 offset:4096
    v_exp_f32 v252, v252
    v_mfma_f32_16x16x32_bf16 v[148:151], a[160:163], a[52:55], v[148:151]
    ds_read_b64_tr_b16 a[154:155], v22 offset:6144
    v_exp_f32 v253, v253
    v_mfma_f32_16x16x32_bf16 v[152:155], a[164:167], a[48:51], v[152:155]
    ds_read_b64_tr_b16 a[156:157], v22 offset:16384
    s_add_u32 m0, s25, 27648
    s_add_u32 s32, s93, 442368
    buffer_load_dwordx4 v4, s[8:11], s32 offen lds
    v_mul_f32 v254, v66, v74
    v_mfma_f32_16x16x32_bf16 v[156:159], a[164:167], a[52:55], v[156:159]
    ds_read_b64_tr_b16 a[158:159], v22 offset:18432
    v_mul_f32 v255, v67, v75
    s_waitcnt lgkmcnt(8)
    v_mfma_f32_16x16x32_bf16 v[160:163], a[168:171], a[48:51], v[160:163]
    ds_read_b64_tr_b16 a[160:161], v23 offset:4096
    v_fma_f32 v252, v252, v14, v14
    v_mfma_f32_16x16x32_bf16 v[164:167], a[168:171], a[52:55], v[164:167]
    ds_read_b64_tr_b16 a[162:163], v23 offset:6144
    buffer_load_dwordx4 v5, s[8:11], s32 offen offset:1024 lds
    v_fma_f32 v253, v253, v14, v14
    v_mfma_f32_16x16x32_bf16 v[168:171], a[172:175], a[48:51], v[168:171]
    ds_read_b64_tr_b16 a[164:165], v23 offset:16384
    v_mfma_f32_16x16x32_bf16 v[172:175], a[172:175], a[52:55], v[172:175]
    ds_read_b64_tr_b16 a[166:167], v23 offset:18432
    v_rcp_f32 v252, v252
    s_waitcnt lgkmcnt(8)
    v_mfma_f32_16x16x32_bf16 v[112:115], a[144:147], a[56:59], v[112:115]
    ds_read_b64_tr_b16 a[168:169], v24 offset:4096
    buffer_load_dwordx4 v6, s[8:11], s32 offen offset:2048 lds
    v_rcp_f32 v253, v253
    v_mfma_f32_16x16x32_bf16 v[116:119], a[144:147], a[60:63], v[116:119]
    ds_read_b64_tr_b16 a[170:171], v24 offset:6144
    v_mul_f32 v254, v254, v252
    v_mfma_f32_16x16x32_bf16 v[120:123], a[148:151], a[56:59], v[120:123]
    ds_read_b64_tr_b16 a[172:173], v24 offset:16384
    v_mul_f32 v255, v255, v253
    v_mfma_f32_16x16x32_bf16 v[124:127], a[148:151], a[60:63], v[124:127]
    ds_read_b64_tr_b16 a[174:175], v24 offset:18432
    v_cvt_pk_bf16_f32 v211, v254, v255
    s_waitcnt lgkmcnt(8)
    v_mfma_f32_16x16x32_bf16 v[128:131], a[152:155], a[56:59], v[128:131]
    ds_read_b64_tr_b16 a[144:145], v21 offset:8192
    v_mul_f32 v248, v68, v68
    v_mfma_f32_16x16x32_bf16 v[132:135], a[152:155], a[60:63], v[132:135]
    ds_read_b64_tr_b16 a[146:147], v21 offset:10240
    v_mul_f32 v249, v69, v69
    v_mfma_f32_16x16x32_bf16 v[136:139], a[156:159], a[56:59], v[136:139]
    ds_read_b64_tr_b16 a[148:149], v21 offset:20480
    v_fma_f32 v248, v248, v13, v11
    v_fma_f32 v249, v249, v13, v11
    v_mfma_f32_16x16x32_bf16 v[140:143], a[156:159], a[60:63], v[140:143]
    ds_read_b64_tr_b16 a[150:151], v21 offset:22528
    v_mul_f32 v248, v68, v248
    s_waitcnt lgkmcnt(8)
    v_mfma_f32_16x16x32_bf16 v[144:147], a[160:163], a[56:59], v[144:147]
    ds_read_b64_tr_b16 a[152:153], v22 offset:8192
    v_mul_f32 v249, v69, v249
    v_mfma_f32_16x16x32_bf16 v[148:151], a[160:163], a[60:63], v[148:151]
    ds_read_b64_tr_b16 a[154:155], v22 offset:10240
    v_mfma_f32_16x16x32_bf16 v[152:155], a[164:167], a[56:59], v[152:155]
    ds_read_b64_tr_b16 a[156:157], v22 offset:20480
    v_exp_f32 v248, v248
    v_mfma_f32_16x16x32_bf16 v[156:159], a[164:167], a[60:63], v[156:159]
    ds_read_b64_tr_b16 a[158:159], v22 offset:22528
    s_waitcnt lgkmcnt(8)
    v_mfma_f32_16x16x32_bf16 v[160:163], a[168:171], a[56:59], v[160:163]
    ds_read_b64_tr_b16 a[160:161], v23 offset:8192
    v_exp_f32 v249, v249
    v_mfma_f32_16x16x32_bf16 v[164:167], a[168:171], a[60:63], v[164:167]
    ds_read_b64_tr_b16 a[162:163], v23 offset:10240
    v_mul_f32 v250, v68, v76
    v_mul_f32 v251, v69, v77
    v_mfma_f32_16x16x32_bf16 v[168:171], a[172:175], a[56:59], v[168:171]
    ds_read_b64_tr_b16 a[164:165], v23 offset:20480
    v_fma_f32 v248, v248, v15, v15
    v_mfma_f32_16x16x32_bf16 v[172:175], a[172:175], a[60:63], v[172:175]
    ds_read_b64_tr_b16 a[166:167], v23 offset:22528
    v_fma_f32 v249, v249, v15, v15
    s_waitcnt lgkmcnt(8)
    v_mfma_f32_16x16x32_bf16 v[112:115], a[144:147], a[64:67], v[112:115]
    ds_read_b64_tr_b16 a[168:169], v24 offset:8192
    v_mfma_f32_16x16x32_bf16 v[116:119], a[144:147], a[68:71], v[116:119]
    ds_read_b64_tr_b16 a[170:171], v24 offset:10240
    v_rcp_f32 v248, v248
    v_mfma_f32_16x16x32_bf16 v[120:123], a[148:151], a[64:67], v[120:123]
    ds_read_b64_tr_b16 a[172:173], v24 offset:20480
    v_mfma_f32_16x16x32_bf16 v[124:127], a[148:151], a[68:71], v[124:127]
    ds_read_b64_tr_b16 a[174:175], v24 offset:22528
    v_rcp_f32 v249, v249
    s_waitcnt lgkmcnt(8)
    v_mfma_f32_16x16x32_bf16 v[128:131], a[152:155], a[64:67], v[128:131]
    ds_read_b64_tr_b16 a[144:145], v21 offset:24576
    v_mul_f32 v250, v250, v248
    v_mul_f32 v251, v251, v249
    v_mfma_f32_16x16x32_bf16 v[132:135], a[152:155], a[68:71], v[132:135]
    ds_read_b64_tr_b16 a[146:147], v21 offset:26624
    v_cvt_pk_bf16_f32 v214, v250, v251
    v_mfma_f32_16x16x32_bf16 v[136:139], a[156:159], a[64:67], v[136:139]
    ds_read_b64_tr_b16 a[148:149], v21 offset:36864
    v_mul_f32 v252, v70, v70
    v_mfma_f32_16x16x32_bf16 v[140:143], a[156:159], a[68:71], v[140:143]
    ds_read_b64_tr_b16 a[150:151], v21 offset:38912
    v_mul_f32 v253, v71, v71
    s_waitcnt lgkmcnt(8)
    v_mfma_f32_16x16x32_bf16 v[144:147], a[160:163], a[64:67], v[144:147]
    ds_read_b64_tr_b16 a[152:153], v22 offset:24576
    v_fma_f32 v252, v252, v13, v11
    v_mfma_f32_16x16x32_bf16 v[148:151], a[160:163], a[68:71], v[148:151]
    ds_read_b64_tr_b16 a[154:155], v22 offset:26624
    v_fma_f32 v253, v253, v13, v11
    v_mfma_f32_16x16x32_bf16 v[152:155], a[164:167], a[64:67], v[152:155]
    ds_read_b64_tr_b16 a[156:157], v22 offset:36864
    v_mul_f32 v252, v70, v252
    v_mul_f32 v253, v71, v253
    v_mfma_f32_16x16x32_bf16 v[156:159], a[164:167], a[68:71], v[156:159]
    ds_read_b64_tr_b16 a[158:159], v22 offset:38912
    s_waitcnt lgkmcnt(8)
    v_mfma_f32_16x16x32_bf16 v[160:163], a[168:171], a[64:67], v[160:163]
    ds_read_b64_tr_b16 a[160:161], v23 offset:24576
    v_exp_f32 v252, v252
    v_mfma_f32_16x16x32_bf16 v[164:167], a[168:171], a[68:71], v[164:167]
    ds_read_b64_tr_b16 a[162:163], v23 offset:26624
    v_mfma_f32_16x16x32_bf16 v[168:171], a[172:175], a[64:67], v[168:171]
    ds_read_b64_tr_b16 a[164:165], v23 offset:36864
    v_exp_f32 v253, v253
    v_mfma_f32_16x16x32_bf16 v[172:175], a[172:175], a[68:71], v[172:175]
    ds_read_b64_tr_b16 a[166:167], v23 offset:38912
    v_mul_f32 v254, v70, v78
    s_waitcnt vmcnt(18)
    s_barrier
    s_waitcnt lgkmcnt(8)
    v_mfma_f32_16x16x32_bf16 v[112:115], a[144:147], a[72:75], v[112:115]
    ds_read_b64_tr_b16 a[168:169], v24 offset:24576
    v_mul_f32 v255, v71, v79
    v_mfma_f32_16x16x32_bf16 v[116:119], a[144:147], a[76:79], v[116:119]
    ds_read_b64_tr_b16 a[170:171], v24 offset:26624
    s_add_u32 m0, s25, 49152
    s_add_u32 s32, s94, 0
    buffer_load_dwordx4 v4, s[8:11], s32 offen lds
    v_fma_f32 v252, v252, v15, v15
    v_fma_f32 v253, v253, v15, v15
    v_mfma_f32_16x16x32_bf16 v[120:123], a[148:151], a[72:75], v[120:123]
    ds_read_b64_tr_b16 a[172:173], v24 offset:36864
    v_mfma_f32_16x16x32_bf16 v[124:127], a[148:151], a[76:79], v[124:127]
    ds_read_b64_tr_b16 a[174:175], v24 offset:38912
    v_rcp_f32 v252, v252
    s_waitcnt lgkmcnt(8)
    v_mfma_f32_16x16x32_bf16 v[128:131], a[152:155], a[72:75], v[128:131]
    ds_read_b64_tr_b16 a[144:145], v21 offset:28672
    buffer_load_dwordx4 v5, s[8:11], s32 offen offset:1024 lds
    v_mfma_f32_16x16x32_bf16 v[132:135], a[152:155], a[76:79], v[132:135]
    ds_read_b64_tr_b16 a[146:147], v21 offset:30720
    v_rcp_f32 v253, v253
    v_mfma_f32_16x16x32_bf16 v[136:139], a[156:159], a[72:75], v[136:139]
    ds_read_b64_tr_b16 a[148:149], v21 offset:40960
    v_mul_f32 v254, v254, v252
    v_mfma_f32_16x16x32_bf16 v[140:143], a[156:159], a[76:79], v[140:143]
    ds_read_b64_tr_b16 a[150:151], v21 offset:43008
    buffer_load_dwordx4 v6, s[8:11], s32 offen offset:2048 lds
    v_mul_f32 v255, v255, v253
    s_waitcnt lgkmcnt(8)
    v_mfma_f32_16x16x32_bf16 v[144:147], a[160:163], a[72:75], v[144:147]
    ds_read_b64_tr_b16 a[152:153], v22 offset:28672
    v_cvt_pk_bf16_f32 v215, v254, v255
    v_mul_f32 v248, v80, v80
    v_mfma_f32_16x16x32_bf16 v[148:151], a[160:163], a[76:79], v[148:151]
    ds_read_b64_tr_b16 a[154:155], v22 offset:30720
    v_mul_f32 v249, v81, v81
    v_mfma_f32_16x16x32_bf16 v[152:155], a[164:167], a[72:75], v[152:155]
    ds_read_b64_tr_b16 a[156:157], v22 offset:40960
    s_add_u32 m0, s25, 52224
    s_add_u32 s32, s94, 442368
    buffer_load_dwordx4 v4, s[8:11], s32 offen lds
    v_fma_f32 v248, v248, v12, v10
    v_mfma_f32_16x16x32_bf16 v[156:159], a[164:167], a[76:79], v[156:159]
    ds_read_b64_tr_b16 a[158:159], v22 offset:43008
    v_fma_f32 v249, v249, v12, v10
    s_waitcnt lgkmcnt(8)
    v_mfma_f32_16x16x32_bf16 v[160:163], a[168:171], a[72:75], v[160:163]
    ds_read_b64_tr_b16 a[160:161], v23 offset:28672
    v_mul_f32 v248, v80, v248
    v_mfma_f32_16x16x32_bf16 v[164:167], a[168:171], a[76:79], v[164:167]
    ds_read_b64_tr_b16 a[162:163], v23 offset:30720
    buffer_load_dwordx4 v5, s[8:11], s32 offen offset:1024 lds
    v_mul_f32 v249, v81, v249
    v_mfma_f32_16x16x32_bf16 v[168:171], a[172:175], a[72:75], v[168:171]
    ds_read_b64_tr_b16 a[164:165], v23 offset:40960
    v_exp_f32 v248, v248
    v_mfma_f32_16x16x32_bf16 v[172:175], a[172:175], a[76:79], v[172:175]
    ds_read_b64_tr_b16 a[166:167], v23 offset:43008
    s_waitcnt lgkmcnt(8)
    v_mfma_f32_16x16x32_bf16 v[112:115], a[144:147], a[80:83], v[112:115]
    ds_read_b64_tr_b16 a[168:169], v24 offset:28672
    buffer_load_dwordx4 v6, s[8:11], s32 offen offset:2048 lds
    v_exp_f32 v249, v249
    v_mfma_f32_16x16x32_bf16 v[116:119], a[144:147], a[84:87], v[116:119]
    ds_read_b64_tr_b16 a[170:171], v24 offset:30720
    v_mul_f32 v250, v80, v88
    v_mfma_f32_16x16x32_bf16 v[120:123], a[148:151], a[80:83], v[120:123]
    ds_read_b64_tr_b16 a[172:173], v24 offset:40960
    v_mul_f32 v251, v81, v89
    v_mfma_f32_16x16x32_bf16 v[124:127], a[148:151], a[84:87], v[124:127]
    ds_read_b64_tr_b16 a[174:175], v24 offset:43008
    v_fma_f32 v248, v248, v14, v14
    s_waitcnt lgkmcnt(8)
    v_mfma_f32_16x16x32_bf16 v[128:131], a[152:155], a[80:83], v[128:131]
    ds_read_b64_tr_b16 a[144:145], v21 offset:32768
    v_fma_f32 v249, v249, v14, v14
    v_mfma_f32_16x16x32_bf16 v[132:135], a[152:155], a[84:87], v[132:135]
    ds_read_b64_tr_b16 a[146:147], v21 offset:34816
    v_rcp_f32 v248, v248
    v_mfma_f32_16x16x32_bf16 v[136:139], a[156:159], a[80:83], v[136:139]
    ds_read_b64_tr_b16 a[148:149], v21 offset:45056
    v_mfma_f32_16x16x32_bf16 v[140:143], a[156:159], a[84:87], v[140:143]
    ds_read_b64_tr_b16 a[150:151], v21 offset:47104
    v_rcp_f32 v249, v249
    s_waitcnt lgkmcnt(8)
    v_mfma_f32_16x16x32_bf16 v[144:147], a[160:163], a[80:83], v[144:147]
    ds_read_b64_tr_b16 a[152:153], v22 offset:32768
    v_mul_f32 v250, v250, v248
    v_mfma_f32_16x16x32_bf16 v[148:151], a[160:163], a[84:87], v[148:151]
    ds_read_b64_tr_b16 a[154:155], v22 offset:34816
    v_mul_f32 v251, v251, v249
    v_mfma_f32_16x16x32_bf16 v[152:155], a[164:167], a[80:83], v[152:155]
    ds_read_b64_tr_b16 a[156:157], v22 offset:45056
    v_cvt_pk_bf16_f32 v216, v250, v251
    v_mfma_f32_16x16x32_bf16 v[156:159], a[164:167], a[84:87], v[156:159]
    ds_read_b64_tr_b16 a[158:159], v22 offset:47104
    v_mul_f32 v252, v82, v82
    v_mul_f32 v253, v83, v83
    s_waitcnt lgkmcnt(8)
    v_mfma_f32_16x16x32_bf16 v[160:163], a[168:171], a[80:83], v[160:163]
    ds_read_b64_tr_b16 a[160:161], v23 offset:32768
    v_fma_f32 v252, v252, v12, v10
    v_mfma_f32_16x16x32_bf16 v[164:167], a[168:171], a[84:87], v[164:167]
    ds_read_b64_tr_b16 a[162:163], v23 offset:34816
    v_fma_f32 v253, v253, v12, v10
    v_mfma_f32_16x16x32_bf16 v[168:171], a[172:175], a[80:83], v[168:171]
    ds_read_b64_tr_b16 a[164:165], v23 offset:45056
    v_mul_f32 v252, v82, v252
    v_mfma_f32_16x16x32_bf16 v[172:175], a[172:175], a[84:87], v[172:175]
    ds_read_b64_tr_b16 a[166:167], v23 offset:47104
    v_mul_f32 v253, v83, v253
    s_waitcnt lgkmcnt(8)
    v_mfma_f32_16x16x32_bf16 v[112:115], a[144:147], a[88:91], v[112:115]
    ds_read_b64_tr_b16 a[168:169], v24 offset:32768
    v_mfma_f32_16x16x32_bf16 v[116:119], a[144:147], a[92:95], v[116:119]
    ds_read_b64_tr_b16 a[170:171], v24 offset:34816
    v_exp_f32 v252, v252
    v_mfma_f32_16x16x32_bf16 v[120:123], a[148:151], a[88:91], v[120:123]
    ds_read_b64_tr_b16 a[172:173], v24 offset:45056
    v_exp_f32 v253, v253
    v_mfma_f32_16x16x32_bf16 v[124:127], a[148:151], a[92:95], v[124:127]
    ds_read_b64_tr_b16 a[174:175], v24 offset:47104
    v_mul_f32 v254, v82, v90
    s_waitcnt lgkmcnt(8)
    v_mfma_f32_16x16x32_bf16 v[128:131], a[152:155], a[88:91], v[128:131]
    ds_read_b64_tr_b16 a[144:145], v25 offset:0
    v_mul_f32 v255, v83, v91
    v_mfma_f32_16x16x32_bf16 v[132:135], a[152:155], a[92:95], v[132:135]
    ds_read_b64_tr_b16 a[146:147], v25 offset:2048
    v_fma_f32 v252, v252, v14, v14
    v_mfma_f32_16x16x32_bf16 v[136:139], a[156:159], a[88:91], v[136:139]
    ds_read_b64_tr_b16 a[148:149], v25 offset:12288
    v_fma_f32 v253, v253, v14, v14
    v_mfma_f32_16x16x32_bf16 v[140:143], a[156:159], a[92:95], v[140:143]
    ds_read_b64_tr_b16 a[150:151], v25 offset:14336
    s_waitcnt lgkmcnt(8)
    v_mfma_f32_16x16x32_bf16 v[144:147], a[160:163], a[88:91], v[144:147]
    ds_read_b64_tr_b16 a[152:153], v26 offset:0
    v_rcp_f32 v252, v252
    v_mfma_f32_16x16x32_bf16 v[148:151], a[160:163], a[92:95], v[148:151]
    ds_read_b64_tr_b16 a[154:155], v26 offset:2048
    v_rcp_f32 v253, v253
    v_mfma_f32_16x16x32_bf16 v[152:155], a[164:167], a[88:91], v[152:155]
    ds_read_b64_tr_b16 a[156:157], v26 offset:12288
    v_mul_f32 v254, v254, v252
    v_mfma_f32_16x16x32_bf16 v[156:159], a[164:167], a[92:95], v[156:159]
    ds_read_b64_tr_b16 a[158:159], v26 offset:14336
    v_mul_f32 v255, v255, v253
    s_waitcnt lgkmcnt(8)
    v_mfma_f32_16x16x32_bf16 v[160:163], a[168:171], a[88:91], v[160:163]
    ds_read_b64_tr_b16 a[160:161], v27 offset:0
    v_cvt_pk_bf16_f32 v217, v254, v255
    v_mfma_f32_16x16x32_bf16 v[164:167], a[168:171], a[92:95], v[164:167]
    ds_read_b64_tr_b16 a[162:163], v27 offset:2048
    v_mul_f32 v248, v84, v84
    v_mfma_f32_16x16x32_bf16 v[168:171], a[172:175], a[88:91], v[168:171]
    ds_read_b64_tr_b16 a[164:165], v27 offset:12288
    v_mul_f32 v249, v85, v85
    v_mfma_f32_16x16x32_bf16 v[172:175], a[172:175], a[92:95], v[172:175]
    ds_read_b64_tr_b16 a[166:167], v27 offset:14336
    v_fma_f32 v248, v248, v13, v11
    v_fma_f32 v249, v249, v13, v11
    s_waitcnt vmcnt(18)
    s_barrier
    s_waitcnt lgkmcnt(8)
    v_mfma_f32_16x16x32_bf16 v[112:115], a[144:147], a[96:99], v[112:115]
    ds_read_b64_tr_b16 a[168:169], v28 offset:0
    v_mul_f32 v248, v84, v248
    v_mfma_f32_16x16x32_bf16 v[116:119], a[144:147], a[100:103], v[116:119]
    ds_read_b64_tr_b16 a[170:171], v28 offset:2048
    v_mul_f32 v249, v85, v249
    v_mfma_f32_16x16x32_bf16 v[120:123], a[148:151], a[96:99], v[120:123]
    ds_read_b64_tr_b16 a[172:173], v28 offset:12288
    v_mfma_f32_16x16x32_bf16 v[124:127], a[148:151], a[100:103], v[124:127]
    ds_read_b64_tr_b16 a[174:175], v28 offset:14336
    v_exp_f32 v248, v248
    s_waitcnt lgkmcnt(8)
    v_mfma_f32_16x16x32_bf16 v[128:131], a[152:155], a[96:99], v[128:131]
    ds_read_b64_tr_b16 a[144:145], v25 offset:4096
    v_mfma_f32_16x16x32_bf16 v[132:135], a[152:155], a[100:103], v[132:135]
    ds_read_b64_tr_b16 a[146:147], v25 offset:6144
    v_exp_f32 v249, v249
    v_mfma_f32_16x16x32_bf16 v[136:139], a[156:159], a[96:99], v[136:139]
    ds_read_b64_tr_b16 a[148:149], v25 offset:16384
    v_mul_f32 v250, v84, v92
    v_mul_f32 v251, v85, v93
    v_mfma_f32_16x16x32_bf16 v[140:143], a[156:159], a[100:103], v[140:143]
    ds_read_b64_tr_b16 a[150:151], v25 offset:18432
    v_fma_f32 v248, v248, v15, v15
    s_waitcnt lgkmcnt(8)
    v_mfma_f32_16x16x32_bf16 v[144:147], a[160:163], a[96:99], v[144:147]
    ds_read_b64_tr_b16 a[152:153], v26 offset:4096
    v_fma_f32 v249, v249, v15, v15
    v_mfma_f32_16x16x32_bf16 v[148:151], a[160:163], a[100:103], v[148:151]
    ds_read_b64_tr_b16 a[154:155], v26 offset:6144
    v_mfma_f32_16x16x32_bf16 v[152:155], a[164:167], a[96:99], v[152:155]
    ds_read_b64_tr_b16 a[156:157], v26 offset:16384
    v_rcp_f32 v248, v248
    v_mfma_f32_16x16x32_bf16 v[156:159], a[164:167], a[100:103], v[156:159]
    ds_read_b64_tr_b16 a[158:159], v26 offset:18432
    s_waitcnt lgkmcnt(8)
    v_mfma_f32_16x16x32_bf16 v[160:163], a[168:171], a[96:99], v[160:163]
    ds_read_b64_tr_b16 a[160:161], v27 offset:4096
    v_rcp_f32 v249, v249
    v_mfma_f32_16x16x32_bf16 v[164:167], a[168:171], a[100:103], v[164:167]
    ds_read_b64_tr_b16 a[162:163], v27 offset:6144
    v_mul_f32 v250, v250, v248
    v_mul_f32 v251, v251, v249
    v_mfma_f32_16x16x32_bf16 v[168:171], a[172:175], a[96:99], v[168:171]
    ds_read_b64_tr_b16 a[164:165], v27 offset:16384
    v_cvt_pk_bf16_f32 v220, v250, v251
    v_mfma_f32_16x16x32_bf16 v[172:175], a[172:175], a[100:103], v[172:175]
    ds_read_b64_tr_b16 a[166:167], v27 offset:18432
    v_mul_f32 v252, v86, v86
    s_waitcnt lgkmcnt(8)
    v_mfma_f32_16x16x32_bf16 v[112:115], a[144:147], a[104:107], v[112:115]
    ds_read_b64_tr_b16 a[168:169], v28 offset:4096
    v_mul_f32 v253, v87, v87
    v_mfma_f32_16x16x32_bf16 v[116:119], a[144:147], a[108:111], v[116:119]
    ds_read_b64_tr_b16 a[170:171], v28 offset:6144
    v_fma_f32 v252, v252, v13, v11
    v_mfma_f32_16x16x32_bf16 v[120:123], a[148:151], a[104:107], v[120:123]
    ds_read_b64_tr_b16 a[172:173], v28 offset:16384
    v_fma_f32 v253, v253, v13, v11
    v_mfma_f32_16x16x32_bf16 v[124:127], a[148:151], a[108:111], v[124:127]
    ds_read_b64_tr_b16 a[174:175], v28 offset:18432
    v_mul_f32 v252, v86, v252
    v_mul_f32 v253, v87, v253
    s_waitcnt lgkmcnt(8)
    v_mfma_f32_16x16x32_bf16 v[128:131], a[152:155], a[104:107], v[128:131]
    ds_read_b64_tr_b16 a[144:145], v25 offset:8192
    v_mfma_f32_16x16x32_bf16 v[132:135], a[152:155], a[108:111], v[132:135]
    ds_read_b64_tr_b16 a[146:147], v25 offset:10240
    v_exp_f32 v252, v252
    v_mfma_f32_16x16x32_bf16 v[136:139], a[156:159], a[104:107], v[136:139]
    ds_read_b64_tr_b16 a[148:149], v25 offset:20480
    v_mfma_f32_16x16x32_bf16 v[140:143], a[156:159], a[108:111], v[140:143]
    ds_read_b64_tr_b16 a[150:151], v25 offset:22528
    v_exp_f32 v253, v253
    s_waitcnt lgkmcnt(8)
    v_mfma_f32_16x16x32_bf16 v[144:147], a[160:163], a[104:107], v[144:147]
    ds_read_b64_tr_b16 a[152:153], v26 offset:8192
    v_mul_f32 v254, v86, v94
    v_mfma_f32_16x16x32_bf16 v[148:151], a[160:163], a[108:111], v[148:151]
    ds_read_b64_tr_b16 a[154:155], v26 offset:10240
    v_mul_f32 v255, v87, v95
    v_mfma_f32_16x16x32_bf16 v[152:155], a[164:167], a[104:107], v[152:155]
    ds_read_b64_tr_b16 a[156:157], v26 offset:20480
    v_fma_f32 v252, v252, v15, v15
    v_fma_f32 v253, v253, v15, v15
    v_mfma_f32_16x16x32_bf16 v[156:159], a[164:167], a[108:111], v[156:159]
    ds_read_b64_tr_b16 a[158:159], v26 offset:22528
    s_waitcnt lgkmcnt(8)
    v_mfma_f32_16x16x32_bf16 v[160:163], a[168:171], a[104:107], v[160:163]
    ds_read_b64_tr_b16 a[160:161], v27 offset:8192
    v_rcp_f32 v252, v252
    v_mfma_f32_16x16x32_bf16 v[164:167], a[168:171], a[108:111], v[164:167]
    ds_read_b64_tr_b16 a[162:163], v27 offset:10240
    v_mfma_f32_16x16x32_bf16 v[168:171], a[172:175], a[104:107], v[168:171]
    ds_read_b64_tr_b16 a[164:165], v27 offset:20480
    v_rcp_f32 v253, v253
    v_mfma_f32_16x16x32_bf16 v[172:175], a[172:175], a[108:111], v[172:175]
    ds_read_b64_tr_b16 a[166:167], v27 offset:22528
    v_mul_f32 v254, v254, v252
    s_waitcnt lgkmcnt(8)
    v_mfma_f32_16x16x32_bf16 v[112:115], a[144:147], a[112:115], v[112:115]
    ds_read_b64_tr_b16 a[168:169], v28 offset:8192
    v_mul_f32 v255, v255, v253
    v_mfma_f32_16x16x32_bf16 v[116:119], a[144:147], a[116:119], v[116:119]
    ds_read_b64_tr_b16 a[170:171], v28 offset:10240
    v_cvt_pk_bf16_f32 v221, v254, v255
    v_mul_f32 v248, v96, v96
    v_mfma_f32_16x16x32_bf16 v[120:123], a[148:151], a[112:115], v[120:123]
    ds_read_b64_tr_b16 a[172:173], v28 offset:20480
    v_mul_f32 v249, v97, v97
    v_mfma_f32_16x16x32_bf16 v[124:127], a[148:151], a[116:119], v[124:127]
    ds_read_b64_tr_b16 a[174:175], v28 offset:22528
    v_fma_f32 v248, v248, v12, v10
    s_waitcnt lgkmcnt(8)
    v_mfma_f32_16x16x32_bf16 v[128:131], a[152:155], a[112:115], v[128:131]
    ds_read_b64_tr_b16 a[144:145], v25 offset:24576
    v_fma_f32 v249, v249, v12, v10
    v_mfma_f32_16x16x32_bf16 v[132:135], a[152:155], a[116:119], v[132:135]
    ds_read_b64_tr_b16 a[146:147], v25 offset:26624
    v_mul_f32 v248, v96, v248
    v_mfma_f32_16x16x32_bf16 v[136:139], a[156:159], a[112:115], v[136:139]
    ds_read_b64_tr_b16 a[148:149], v25 offset:36864
    v_mul_f32 v249, v97, v249
    v_mfma_f32_16x16x32_bf16 v[140:143], a[156:159], a[116:119], v[140:143]
    ds_read_b64_tr_b16 a[150:151], v25 offset:38912
    v_exp_f32 v248, v248
    s_waitcnt lgkmcnt(8)
    v_mfma_f32_16x16x32_bf16 v[144:147], a[160:163], a[112:115], v[144:147]
    ds_read_b64_tr_b16 a[152:153], v26 offset:24576
    v_mfma_f32_16x16x32_bf16 v[148:151], a[160:163], a[116:119], v[148:151]
    ds_read_b64_tr_b16 a[154:155], v26 offset:26624
    v_exp_f32 v249, v249
    v_mfma_f32_16x16x32_bf16 v[152:155], a[164:167], a[112:115], v[152:155]
    ds_read_b64_tr_b16 a[156:157], v26 offset:36864
    v_mul_f32 v250, v96, v104
    v_mfma_f32_16x16x32_bf16 v[156:159], a[164:167], a[116:119], v[156:159]
    ds_read_b64_tr_b16 a[158:159], v26 offset:38912
    v_mul_f32 v251, v97, v105
    s_waitcnt lgkmcnt(8)
    v_mfma_f32_16x16x32_bf16 v[160:163], a[168:171], a[112:115], v[160:163]
    ds_read_b64_tr_b16 a[160:161], v27 offset:24576
    v_fma_f32 v248, v248, v14, v14
    v_mfma_f32_16x16x32_bf16 v[164:167], a[168:171], a[116:119], v[164:167]
    ds_read_b64_tr_b16 a[162:163], v27 offset:26624
    v_fma_f32 v249, v249, v14, v14
    v_mfma_f32_16x16x32_bf16 v[168:171], a[172:175], a[112:115], v[168:171]
    ds_read_b64_tr_b16 a[164:165], v27 offset:36864
    v_rcp_f32 v248, v248
    v_mfma_f32_16x16x32_bf16 v[172:175], a[172:175], a[116:119], v[172:175]
    ds_read_b64_tr_b16 a[166:167], v27 offset:38912
    s_waitcnt vmcnt(12)
    s_barrier
    s_waitcnt lgkmcnt(8)
    v_mfma_f32_16x16x32_bf16 v[112:115], a[144:147], a[120:123], v[112:115]
    ds_read_b64_tr_b16 a[168:169], v28 offset:24576
    v_rcp_f32 v249, v249
    v_mfma_f32_16x16x32_bf16 v[116:119], a[144:147], a[124:127], v[116:119]
    ds_read_b64_tr_b16 a[170:171], v28 offset:26624
    s_add_u32 m0, s27, 73728
    s_add_u32 s32, s50, 0
    buffer_load_dwordx4 v7, s[12:15], s32 offen lds
    v_mul_f32 v250, v250, v248
    v_mfma_f32_16x16x32_bf16 v[120:123], a[148:151], a[120:123], v[120:123]
    ds_read_b64_tr_b16 a[172:173], v28 offset:36864
    v_mul_f32 v251, v251, v249
    v_mfma_f32_16x16x32_bf16 v[124:127], a[148:151], a[124:127], v[124:127]
    ds_read_b64_tr_b16 a[174:175], v28 offset:38912
    v_cvt_pk_bf16_f32 v218, v250, v251
    s_waitcnt lgkmcnt(8)
    v_mfma_f32_16x16x32_bf16 v[128:131], a[152:155], a[120:123], v[128:131]
    ds_read_b64_tr_b16 a[144:145], v25 offset:28672
    buffer_load_dwordx4 v8, s[12:15], s32 offen offset:1024 lds
    v_mul_f32 v252, v98, v98
    v_mul_f32 v253, v99, v99
    v_mfma_f32_16x16x32_bf16 v[132:135], a[152:155], a[124:127], v[132:135]
    ds_read_b64_tr_b16 a[146:147], v25 offset:30720
    v_fma_f32 v252, v252, v12, v10
    v_mfma_f32_16x16x32_bf16 v[136:139], a[156:159], a[120:123], v[136:139]
    ds_read_b64_tr_b16 a[148:149], v25 offset:40960
    v_fma_f32 v253, v253, v12, v10
    v_mfma_f32_16x16x32_bf16 v[140:143], a[156:159], a[124:127], v[140:143]
    ds_read_b64_tr_b16 a[150:151], v25 offset:43008
    buffer_load_dwordx4 v9, s[12:15], s32 offen offset:2048 lds
    v_mul_f32 v252, v98, v252
    s_waitcnt lgkmcnt(8)
    v_mfma_f32_16x16x32_bf16 v[144:147], a[160:163], a[120:123], v[144:147]
    ds_read_b64_tr_b16 a[152:153], v26 offset:28672
    v_mul_f32 v253, v99, v253
    v_mfma_f32_16x16x32_bf16 v[148:151], a[160:163], a[124:127], v[148:151]
    ds_read_b64_tr_b16 a[154:155], v26 offset:30720
    v_mfma_f32_16x16x32_bf16 v[152:155], a[164:167], a[120:123], v[152:155]
    ds_read_b64_tr_b16 a[156:157], v26 offset:40960
    s_add_u32 m0, s27, 86016
    s_add_u32 s32, s51, 0
    buffer_load_dwordx4 v7, s[12:15], s32 offen lds
    v_exp_f32 v252, v252
    v_mfma_f32_16x16x32_bf16 v[156:159], a[164:167], a[124:127], v[156:159]
    ds_read_b64_tr_b16 a[158:159], v26 offset:43008
    v_exp_f32 v253, v253
    s_waitcnt lgkmcnt(8)
    v_mfma_f32_16x16x32_bf16 v[160:163], a[168:171], a[120:123], v[160:163]
    ds_read_b64_tr_b16 a[160:161], v27 offset:28672
    v_mul_f32 v254, v98, v106
    v_mfma_f32_16x16x32_bf16 v[164:167], a[168:171], a[124:127], v[164:167]
    ds_read_b64_tr_b16 a[162:163], v27 offset:30720
    buffer_load_dwordx4 v8, s[12:15], s32 offen offset:1024 lds
    v_mul_f32 v255, v99, v107
    v_mfma_f32_16x16x32_bf16 v[168:171], a[172:175], a[120:123], v[168:171]
    ds_read_b64_tr_b16 a[164:165], v27 offset:40960
    v_fma_f32 v252, v252, v14, v14
    v_mfma_f32_16x16x32_bf16 v[172:175], a[172:175], a[124:127], v[172:175]
    ds_read_b64_tr_b16 a[166:167], v27 offset:43008
    v_fma_f32 v253, v253, v14, v14
    s_waitcnt lgkmcnt(8)
    v_mfma_f32_16x16x32_bf16 v[112:115], a[144:147], a[128:131], v[112:115]
    ds_read_b64_tr_b16 a[168:169], v28 offset:28672
    buffer_load_dwordx4 v9, s[12:15], s32 offen offset:2048 lds
    v_mfma_f32_16x16x32_bf16 v[116:119], a[144:147], a[132:135], v[116:119]
    ds_read_b64_tr_b16 a[170:171], v28 offset:30720
    v_rcp_f32 v252, v252
    v_mfma_f32_16x16x32_bf16 v[120:123], a[148:151], a[128:131], v[120:123]
    ds_read_b64_tr_b16 a[172:173], v28 offset:40960
    v_rcp_f32 v253, v253
    v_mfma_f32_16x16x32_bf16 v[124:127], a[148:151], a[132:135], v[124:127]
    ds_read_b64_tr_b16 a[174:175], v28 offset:43008
    s_add_u32 m0, s27, 98304
    s_add_u32 s32, s52, 0
    buffer_load_dwordx4 v7, s[12:15], s32 offen lds
    v_mul_f32 v254, v254, v252
    s_waitcnt lgkmcnt(8)
    v_mfma_f32_16x16x32_bf16 v[128:131], a[152:155], a[128:131], v[128:131]
    ds_read_b64_tr_b16 a[144:145], v25 offset:32768
    v_mul_f32 v255, v255, v253
    v_mfma_f32_16x16x32_bf16 v[132:135], a[152:155], a[132:135], v[132:135]
    ds_read_b64_tr_b16 a[146:147], v25 offset:34816
    v_cvt_pk_bf16_f32 v219, v254, v255
    v_mfma_f32_16x16x32_bf16 v[136:139], a[156:159], a[128:131], v[136:139]
    ds_read_b64_tr_b16 a[148:149], v25 offset:45056
    s_add_u32 s32, s53, 0
    s_nop 0
    buffer_load_dwordx4 v8, s[12:15], s32 offen offset:1024 lds
    v_mul_f32 v248, v100, v100
    v_mfma_f32_16x16x32_bf16 v[140:143], a[156:159], a[132:135], v[140:143]
    ds_read_b64_tr_b16 a[150:151], v25 offset:47104
    v_mul_f32 v249, v101, v101
    s_waitcnt lgkmcnt(8)
    v_mfma_f32_16x16x32_bf16 v[144:147], a[160:163], a[128:131], v[144:147]
    ds_read_b64_tr_b16 a[152:153], v26 offset:32768
    v_fma_f32 v248, v248, v13, v11
    v_fma_f32 v249, v249, v13, v11
    v_mfma_f32_16x16x32_bf16 v[148:151], a[160:163], a[132:135], v[148:151]
    ds_read_b64_tr_b16 a[154:155], v26 offset:34816
    s_add_u32 s32, s54, 0
    s_nop 0
    buffer_load_dwordx4 v9, s[12:15], s32 offen offset:2048 lds
    v_mul_f32 v248, v100, v248
    v_mfma_f32_16x16x32_bf16 v[152:155], a[164:167], a[128:131], v[152:155]
    ds_read_b64_tr_b16 a[156:157], v26 offset:45056
    v_mul_f32 v249, v101, v249
    v_mfma_f32_16x16x32_bf16 v[156:159], a[164:167], a[132:135], v[156:159]
    ds_read_b64_tr_b16 a[158:159], v26 offset:47104
    s_waitcnt lgkmcnt(8)
    v_mfma_f32_16x16x32_bf16 v[160:163], a[168:171], a[128:131], v[160:163]
    ds_read_b64_tr_b16 a[160:161], v27 offset:32768
    v_exp_f32 v248, v248
    v_mfma_f32_16x16x32_bf16 v[164:167], a[168:171], a[132:135], v[164:167]
    ds_read_b64_tr_b16 a[162:163], v27 offset:34816
    v_mfma_f32_16x16x32_bf16 v[168:171], a[172:175], a[128:131], v[168:171]
    ds_read_b64_tr_b16 a[164:165], v27 offset:45056
    v_exp_f32 v249, v249
    v_mfma_f32_16x16x32_bf16 v[172:175], a[172:175], a[132:135], v[172:175]
    ds_read_b64_tr_b16 a[166:167], v27 offset:47104
    v_mul_f32 v250, v100, v108
    v_mul_f32 v251, v101, v109
    s_waitcnt lgkmcnt(8)
    v_mfma_f32_16x16x32_bf16 v[112:115], a[144:147], a[136:139], v[112:115]
    ds_read_b64_tr_b16 a[168:169], v28 offset:32768
    v_fma_f32 v248, v248, v15, v15
    v_mfma_f32_16x16x32_bf16 v[116:119], a[144:147], a[140:143], v[116:119]
    ds_read_b64_tr_b16 a[170:171], v28 offset:34816
    v_fma_f32 v249, v249, v15, v15
    v_mfma_f32_16x16x32_bf16 v[120:123], a[148:151], a[136:139], v[120:123]
    ds_read_b64_tr_b16 a[172:173], v28 offset:45056
    v_mfma_f32_16x16x32_bf16 v[124:127], a[148:151], a[140:143], v[124:127]
    ds_read_b64_tr_b16 a[174:175], v28 offset:47104
    v_rcp_f32 v248, v248
    s_waitcnt lgkmcnt(8)
    v_mfma_f32_16x16x32_bf16 v[128:131], a[152:155], a[136:139], v[128:131]
    v_add_u32 v43, 0, v33
    v_add_u32 v44, 0, v34
    ds_read_b64_tr_b16 a[144:145], v43 offset:0
    v_mfma_f32_16x16x32_bf16 v[132:135], a[152:155], a[140:143], v[132:135]
    ds_read_b64_tr_b16 a[146:147], v43 offset:1024
    v_rcp_f32 v249, v249
    v_mfma_f32_16x16x32_bf16 v[136:139], a[156:159], a[136:139], v[136:139]
    ds_read_b64_tr_b16 a[148:149], v43 offset:12288
    v_mul_f32 v250, v250, v248
    v_mul_f32 v251, v251, v249
    v_mfma_f32_16x16x32_bf16 v[140:143], a[156:159], a[140:143], v[140:143]
    ds_read_b64_tr_b16 a[150:151], v43 offset:13312
    v_cvt_pk_bf16_f32 v222, v250, v251
    s_waitcnt lgkmcnt(8)
    v_mfma_f32_16x16x32_bf16 v[144:147], a[160:163], a[136:139], v[144:147]
    ds_read_b64_tr_b16 a[152:153], v44 offset:0
    v_mul_f32 v252, v102, v102
    v_mfma_f32_16x16x32_bf16 v[148:151], a[160:163], a[140:143], v[148:151]
    ds_read_b64_tr_b16 a[154:155], v44 offset:1024
    v_mul_f32 v253, v103, v103
    v_mfma_f32_16x16x32_bf16 v[152:155], a[164:167], a[136:139], v[152:155]
    ds_read_b64_tr_b16 a[156:157], v44 offset:12288
    v_fma_f32 v252, v252, v13, v11
    v_mfma_f32_16x16x32_bf16 v[156:159], a[164:167], a[140:143], v[156:159]
    ds_read_b64_tr_b16 a[158:159], v44 offset:13312
    v_fma_f32 v253, v253, v13, v11
    s_waitcnt lgkmcnt(8)
    v_mfma_f32_16x16x32_bf16 v[160:163], a[168:171], a[136:139], v[160:163]
    ds_read_b64_tr_b16 a[160:161], v43 offset:2048
    v_mul_f32 v252, v102, v252
    v_mul_f32 v253, v103, v253
    v_mfma_f32_16x16x32_bf16 v[164:167], a[168:171], a[140:143], v[164:167]
    ds_read_b64_tr_b16 a[162:163], v43 offset:3072
    v_mfma_f32_16x16x32_bf16 v[168:171], a[172:175], a[136:139], v[168:171]
    ds_read_b64_tr_b16 a[164:165], v43 offset:14336
    v_exp_f32 v252, v252
    v_mfma_f32_16x16x32_bf16 v[172:175], a[172:175], a[140:143], v[172:175]
    ds_read_b64_tr_b16 a[166:167], v43 offset:15360
    v_mfma_f32_16x16x32_bf16 v[112:115], a[200:203], a[214:217], v[112:115]
    v_exp_f32 v253, v253
    v_mfma_f32_16x16x32_bf16 v[116:119], a[200:203], a[222:225], v[116:119]
    v_mul_f32 v254, v102, v110
    v_mfma_f32_16x16x32_bf16 v[120:123], a[200:203], a[218:221], v[120:123]
    v_mul_f32 v255, v103, v111
    v_mfma_f32_16x16x32_bf16 v[124:127], a[200:203], a[226:229], v[124:127]
    v_fma_f32 v252, v252, v15, v15
    v_fma_f32 v253, v253, v15, v15
    v_mfma_f32_16x16x32_bf16 v[128:131], a[202:205], a[214:217], v[128:131]
    v_mfma_f32_16x16x32_bf16 v[132:135], a[202:205], a[222:225], v[132:135]
    v_rcp_f32 v252, v252
    v_mfma_f32_16x16x32_bf16 v[136:139], a[202:205], a[218:221], v[136:139]
    v_mfma_f32_16x16x32_bf16 v[140:143], a[202:205], a[226:229], v[140:143]
    v_rcp_f32 v253, v253
    v_mfma_f32_16x16x32_bf16 v[144:147], a[204:207], a[214:217], v[144:147]
    v_mul_f32 v254, v254, v252
    v_mfma_f32_16x16x32_bf16 v[148:151], a[204:207], a[222:225], v[148:151]
    v_mul_f32 v255, v255, v253
    v_mfma_f32_16x16x32_bf16 v[152:155], a[204:207], a[218:221], v[152:155]
    v_cvt_pk_bf16_f32 v223, v254, v255
    v_mfma_f32_16x16x32_bf16 v[156:159], a[204:207], a[226:229], v[156:159]
    v_mfma_f32_16x16x32_bf16 v[160:163], a[206:209], a[214:217], v[160:163]
    v_mfma_f32_16x16x32_bf16 v[164:167], a[206:209], a[222:225], v[164:167]
    v_mfma_f32_16x16x32_bf16 v[168:171], a[206:209], a[218:221], v[168:171]
    v_mfma_f32_16x16x32_bf16 v[172:175], a[206:209], a[226:229], v[172:175]
    s_waitcnt vmcnt(15)
    s_barrier
    s_waitcnt lgkmcnt(8)
    v_mfma_f32_16x16x32_bf16 v[48:51], a[144:147], a[0:3], 0
    ds_read_b64_tr_b16 a[168:169], v44 offset:2048
    v_mfma_f32_16x16x32_bf16 v[52:55], a[144:147], a[4:7], 0
    ds_read_b64_tr_b16 a[170:171], v44 offset:3072
    s_add_u32 m0, s27, 110592
    s_add_u32 s32, s50, 128
    buffer_load_dwordx4 v7, s[12:15], s32 offen lds
    v_mfma_f32_16x16x32_bf16 v[56:59], a[148:151], a[0:3], 0
    ds_read_b64_tr_b16 a[172:173], v44 offset:14336
    v_mfma_f32_16x16x32_bf16 v[60:63], a[148:151], a[4:7], 0
    ds_read_b64_tr_b16 a[174:175], v44 offset:15360
    s_waitcnt lgkmcnt(8)
    v_mfma_f32_16x16x32_bf16 v[64:67], a[152:155], a[0:3], 0
    ds_read_b64_tr_b16 a[144:145], v43 offset:4096
    buffer_load_dwordx4 v8, s[12:15], s32 offen offset:1024 lds
    v_mfma_f32_16x16x32_bf16 v[68:71], a[152:155], a[4:7], 0
    ds_read_b64_tr_b16 a[146:147], v43 offset:5120
    v_mfma_f32_16x16x32_bf16 v[72:75], a[156:159], a[0:3], 0
    ds_read_b64_tr_b16 a[148:149], v43 offset:16384
    v_mul_f32 v248, v112, v112
    v_mul_f32 v249, v113, v113
    v_mfma_f32_16x16x32_bf16 v[76:79], a[156:159], a[4:7], 0
    ds_read_b64_tr_b16 a[150:151], v43 offset:17408
    buffer_load_dwordx4 v9, s[12:15], s32 offen offset:2048 lds
    v_fma_f32 v248, v248, v12, v10
    v_fma_f32 v249, v249, v12, v10
    s_waitcnt lgkmcnt(8)
    v_mfma_f32_16x16x32_bf16 v[48:51], a[160:163], a[8:11], v[48:51]
    ds_read_b64_tr_b16 a[152:153], v44 offset:4096
    v_mul_f32 v248, v112, v248
    v_mul_f32 v249, v113, v249
    v_mfma_f32_16x16x32_bf16 v[52:55], a[160:163], a[12:15], v[52:55]
    ds_read_b64_tr_b16 a[154:155], v44 offset:5120
    v_exp_f32 v248, v248
    v_mfma_f32_16x16x32_bf16 v[56:59], a[164:167], a[8:11], v[56:59]
    ds_read_b64_tr_b16 a[156:157], v44 offset:16384
    s_add_u32 m0, s27, 122880
    s_add_u32 s32, s51, 128
    buffer_load_dwordx4 v7, s[12:15], s32 offen lds
    v_exp_f32 v249, v249
    v_mul_f32 v250, v112, v120
    v_mul_f32 v251, v113, v121
    v_mfma_f32_16x16x32_bf16 v[60:63], a[164:167], a[12:15], v[60:63]
    ds_read_b64_tr_b16 a[158:159], v44 offset:17408
    v_fma_f32 v248, v248, v14, v14
    v_fma_f32 v249, v249, v14, v14
    s_waitcnt lgkmcnt(8)
    v_mfma_f32_16x16x32_bf16 v[64:67], a[168:171], a[8:11], v[64:67]
    ds_read_b64_tr_b16 a[160:161], v43 offset:6144
    v_rcp_f32 v248, v248
    v_mfma_f32_16x16x32_bf16 v[68:71], a[168:171], a[12:15], v[68:71]
    ds_read_b64_tr_b16 a[162:163], v43 offset:7168
    buffer_load_dwordx4 v8, s[12:15], s32 offen offset:1024 lds
    v_rcp_f32 v249, v249
    v_mul_f32 v250, v250, v248
    v_mfma_f32_16x16x32_bf16 v[72:75], a[172:175], a[8:11], v[72:75]
    ds_read_b64_tr_b16 a[164:165], v43 offset:18432
    v_mul_f32 v251, v251, v249
    v_cvt_pk_bf16_f32 v224, v250, v251
    v_mfma_f32_16x16x32_bf16 v[76:79], a[172:175], a[12:15], v[76:79]
    ds_read_b64_tr_b16 a[166:167], v43 offset:19456
    v_mul_f32 v252, v114, v114
    v_mul_f32 v253, v115, v115
    v_fma_f32 v252, v252, v12, v10
    s_waitcnt lgkmcnt(8)
    v_mfma_f32_16x16x32_bf16 v[48:51], a[144:147], a[16:19], v[48:51]
    ds_read_b64_tr_b16 a[168:169], v44 offset:6144
    buffer_load_dwordx4 v9, s[12:15], s32 offen offset:2048 lds
    v_fma_f32 v253, v253, v12, v10
    v_mul_f32 v252, v114, v252
    v_mfma_f32_16x16x32_bf16 v[52:55], a[144:147], a[20:23], v[52:55]
    ds_read_b64_tr_b16 a[170:171], v44 offset:7168
    v_mul_f32 v253, v115, v253
    v_mfma_f32_16x16x32_bf16 v[56:59], a[148:151], a[16:19], v[56:59]
    ds_read_b64_tr_b16 a[172:173], v44 offset:18432
    v_exp_f32 v252, v252
    v_exp_f32 v253, v253
    v_mfma_f32_16x16x32_bf16 v[60:63], a[148:151], a[20:23], v[60:63]
    ds_read_b64_tr_b16 a[174:175], v44 offset:19456
    s_add_u32 m0, s27, 135168
    s_add_u32 s32, s52, 128
    buffer_load_dwordx4 v7, s[12:15], s32 offen lds
    v_mul_f32 v254, v114, v122
    v_mul_f32 v255, v115, v123
    s_waitcnt lgkmcnt(8)
    v_mfma_f32_16x16x32_bf16 v[64:67], a[152:155], a[16:19], v[64:67]
    ds_read_b64_tr_b16 a[144:145], v43 offset:8192
    v_fma_f32 v252, v252, v14, v14
    v_fma_f32 v253, v253, v14, v14
    v_mfma_f32_16x16x32_bf16 v[68:71], a[152:155], a[20:23], v[68:71]
    ds_read_b64_tr_b16 a[146:147], v43 offset:9216
    v_rcp_f32 v252, v252
    v_mfma_f32_16x16x32_bf16 v[72:75], a[156:159], a[16:19], v[72:75]
    ds_read_b64_tr_b16 a[148:149], v43 offset:20480
    s_add_u32 s32, s53, 128
    s_nop 0
    buffer_load_dwordx4 v8, s[12:15], s32 offen offset:1024 lds
    v_rcp_f32 v253, v253
    v_mul_f32 v254, v254, v252
    v_mfma_f32_16x16x32_bf16 v[76:79], a[156:159], a[20:23], v[76:79]
    ds_read_b64_tr_b16 a[150:151], v43 offset:21504
    v_mul_f32 v255, v255, v253
    v_cvt_pk_bf16_f32 v225, v254, v255
    v_mul_f32 v248, v116, v116
    s_waitcnt lgkmcnt(8)
    v_mfma_f32_16x16x32_bf16 v[48:51], a[160:163], a[24:27], v[48:51]
    ds_read_b64_tr_b16 a[152:153], v44 offset:8192
    v_mul_f32 v249, v117, v117
    v_fma_f32 v248, v248, v13, v11
    v_mfma_f32_16x16x32_bf16 v[52:55], a[160:163], a[28:31], v[52:55]
    ds_read_b64_tr_b16 a[154:155], v44 offset:9216
    s_add_u32 s32, s54, 128
    s_nop 0
    buffer_load_dwordx4 v9, s[12:15], s32 offen offset:2048 lds
    v_fma_f32 v249, v249, v13, v11
    v_mul_f32 v248, v116, v248
    v_mul_f32 v249, v117, v249
    v_mfma_f32_16x16x32_bf16 v[56:59], a[164:167], a[24:27], v[56:59]
    ds_read_b64_tr_b16 a[156:157], v44 offset:20480
    v_exp_f32 v248, v248
    v_mfma_f32_16x16x32_bf16 v[60:63], a[164:167], a[28:31], v[60:63]
    ds_read_b64_tr_b16 a[158:159], v44 offset:21504
    v_exp_f32 v249, v249
    s_waitcnt lgkmcnt(8)
    v_mfma_f32_16x16x32_bf16 v[64:67], a[168:171], a[24:27], v[64:67]
    ds_read_b64_tr_b16 a[160:161], v43 offset:10240
    v_mul_f32 v250, v116, v124
    v_mul_f32 v251, v117, v125
    v_fma_f32 v248, v248, v15, v15
    v_mfma_f32_16x16x32_bf16 v[68:71], a[168:171], a[28:31], v[68:71]
    ds_read_b64_tr_b16 a[162:163], v43 offset:11264
    v_fma_f32 v249, v249, v15, v15
    v_mfma_f32_16x16x32_bf16 v[72:75], a[172:175], a[24:27], v[72:75]
    ds_read_b64_tr_b16 a[164:165], v43 offset:22528
    v_rcp_f32 v248, v248
    v_rcp_f32 v249, v249
    v_mfma_f32_16x16x32_bf16 v[76:79], a[172:175], a[28:31], v[76:79]
    ds_read_b64_tr_b16 a[166:167], v43 offset:23552
    v_mul_f32 v250, v250, v248
    v_mul_f32 v251, v251, v249
    s_waitcnt lgkmcnt(8)
    v_mfma_f32_16x16x32_bf16 v[48:51], a[144:147], a[32:35], v[48:51]
    ds_read_b64_tr_b16 a[168:169], v44 offset:10240
    v_cvt_pk_bf16_f32 v228, v250, v251
    v_mul_f32 v252, v118, v118
    v_mfma_f32_16x16x32_bf16 v[52:55], a[144:147], a[36:39], v[52:55]
    ds_read_b64_tr_b16 a[170:171], v44 offset:11264
    v_mul_f32 v253, v119, v119
    v_fma_f32 v252, v252, v13, v11
    v_fma_f32 v253, v253, v13, v11
    v_mfma_f32_16x16x32_bf16 v[56:59], a[148:151], a[32:35], v[56:59]
    ds_read_b64_tr_b16 a[172:173], v44 offset:22528
    v_mul_f32 v252, v118, v252
    v_mul_f32 v253, v119, v253
    v_mfma_f32_16x16x32_bf16 v[60:63], a[148:151], a[36:39], v[60:63]
    ds_read_b64_tr_b16 a[174:175], v44 offset:23552
    v_exp_f32 v252, v252
    s_waitcnt lgkmcnt(8)
    v_mfma_f32_16x16x32_bf16 v[64:67], a[152:155], a[32:35], v[64:67]
    v_add_u32 v43, 24576, v33
    v_add_u32 v44, 24576, v34
    ds_read_b64_tr_b16 a[144:145], v43 offset:0
    v_exp_f32 v253, v253
    v_mul_f32 v254, v118, v126
    v_mfma_f32_16x16x32_bf16 v[68:71], a[152:155], a[36:39], v[68:71]
    ds_read_b64_tr_b16 a[146:147], v43 offset:1024
    v_mul_f32 v255, v119, v127
    v_fma_f32 v252, v252, v15, v15
    v_mfma_f32_16x16x32_bf16 v[72:75], a[156:159], a[32:35], v[72:75]
    ds_read_b64_tr_b16 a[148:149], v43 offset:12288
    v_fma_f32 v253, v253, v15, v15
    v_rcp_f32 v252, v252
    v_mfma_f32_16x16x32_bf16 v[76:79], a[156:159], a[36:39], v[76:79]
    ds_read_b64_tr_b16 a[150:151], v43 offset:13312
    v_rcp_f32 v253, v253
    s_waitcnt lgkmcnt(8)
    v_mfma_f32_16x16x32_bf16 v[48:51], a[160:163], a[40:43], v[48:51]
    ds_read_b64_tr_b16 a[152:153], v44 offset:0
    v_mul_f32 v254, v254, v252
    v_mul_f32 v255, v255, v253
    v_mfma_f32_16x16x32_bf16 v[52:55], a[160:163], a[44:47], v[52:55]
    ds_read_b64_tr_b16 a[154:155], v44 offset:1024
    v_cvt_pk_bf16_f32 v229, v254, v255
    v_mul_f32 v248, v128, v128
    v_mul_f32 v249, v129, v129
    v_mfma_f32_16x16x32_bf16 v[56:59], a[164:167], a[40:43], v[56:59]
    ds_read_b64_tr_b16 a[156:157], v44 offset:12288
    v_fma_f32 v248, v248, v12, v10
    v_fma_f32 v249, v249, v12, v10
    v_mfma_f32_16x16x32_bf16 v[60:63], a[164:167], a[44:47], v[60:63]
    ds_read_b64_tr_b16 a[158:159], v44 offset:13312
    v_mul_f32 v248, v128, v248
    v_mul_f32 v249, v129, v249
    s_waitcnt lgkmcnt(8)
    v_mfma_f32_16x16x32_bf16 v[64:67], a[168:171], a[40:43], v[64:67]
    ds_read_b64_tr_b16 a[160:161], v43 offset:2048
    v_exp_f32 v248, v248
    v_mfma_f32_16x16x32_bf16 v[68:71], a[168:171], a[44:47], v[68:71]
    ds_read_b64_tr_b16 a[162:163], v43 offset:3072
    v_exp_f32 v249, v249
    v_mul_f32 v250, v128, v136
    v_mfma_f32_16x16x32_bf16 v[72:75], a[172:175], a[40:43], v[72:75]
    ds_read_b64_tr_b16 a[164:165], v43 offset:14336
    v_mul_f32 v251, v129, v137
    v_fma_f32 v248, v248, v14, v14
    v_fma_f32 v249, v249, v14, v14
    v_mfma_f32_16x16x32_bf16 v[76:79], a[172:175], a[44:47], v[76:79]
    ds_read_b64_tr_b16 a[166:167], v43 offset:15360
    v_rcp_f32 v248, v248
    s_waitcnt vmcnt(18)
    s_barrier
    s_waitcnt lgkmcnt(8)
    v_mfma_f32_16x16x32_bf16 v[48:51], a[144:147], a[48:51], v[48:51]
    ds_read_b64_tr_b16 a[168:169], v44 offset:2048
    v_rcp_f32 v249, v249
    v_mul_f32 v250, v250, v248
    v_mfma_f32_16x16x32_bf16 v[52:55], a[144:147], a[52:55], v[52:55]
    ds_read_b64_tr_b16 a[170:171], v44 offset:3072
    v_mul_f32 v251, v251, v249
    v_cvt_pk_bf16_f32 v226, v250, v251
    v_mfma_f32_16x16x32_bf16 v[56:59], a[148:151], a[48:51], v[56:59]
    ds_read_b64_tr_b16 a[172:173], v44 offset:14336
    v_mul_f32 v252, v130, v130
    v_mul_f32 v253, v131, v131
    v_mfma_f32_16x16x32_bf16 v[60:63], a[148:151], a[52:55], v[60:63]
    ds_read_b64_tr_b16 a[174:175], v44 offset:15360
    v_fma_f32 v252, v252, v12, v10
    v_fma_f32 v253, v253, v12, v10
    v_mul_f32 v252, v130, v252
    s_waitcnt lgkmcnt(8)
    v_mfma_f32_16x16x32_bf16 v[64:67], a[152:155], a[48:51], v[64:67]
    ds_read_b64_tr_b16 a[144:145], v43 offset:4096
    v_mul_f32 v253, v131, v253
    v_mfma_f32_16x16x32_bf16 v[68:71], a[152:155], a[52:55], v[68:71]
    ds_read_b64_tr_b16 a[146:147], v43 offset:5120
    v_exp_f32 v252, v252
    v_exp_f32 v253, v253
    v_mfma_f32_16x16x32_bf16 v[72:75], a[156:159], a[48:51], v[72:75]
    ds_read_b64_tr_b16 a[148:149], v43 offset:16384
    v_mul_f32 v254, v130, v138
    v_mul_f32 v255, v131, v139
    v_mfma_f32_16x16x32_bf16 v[76:79], a[156:159], a[52:55], v[76:79]
    ds_read_b64_tr_b16 a[150:151], v43 offset:17408
    v_fma_f32 v252, v252, v14, v14
    v_fma_f32 v253, v253, v14, v14
    s_waitcnt lgkmcnt(8)
    v_mfma_f32_16x16x32_bf16 v[48:51], a[160:163], a[56:59], v[48:51]
    ds_read_b64_tr_b16 a[152:153], v44 offset:4096
    v_rcp_f32 v252, v252
    v_mfma_f32_16x16x32_bf16 v[52:55], a[160:163], a[60:63], v[52:55]
    ds_read_b64_tr_b16 a[154:155], v44 offset:5120
    v_rcp_f32 v253, v253
    v_mul_f32 v254, v254, v252
    v_mfma_f32_16x16x32_bf16 v[56:59], a[164:167], a[56:59], v[56:59]
    ds_read_b64_tr_b16 a[156:157], v44 offset:16384
    v_mul_f32 v255, v255, v253
    v_cvt_pk_bf16_f32 v227, v254, v255
    v_mul_f32 v248, v132, v132
    v_mfma_f32_16x16x32_bf16 v[60:63], a[164:167], a[60:63], v[60:63]
    ds_read_b64_tr_b16 a[158:159], v44 offset:17408
    v_mul_f32 v249, v133, v133
    v_fma_f32 v248, v248, v13, v11
    s_waitcnt lgkmcnt(8)
    v_mfma_f32_16x16x32_bf16 v[64:67], a[168:171], a[56:59], v[64:67]
    ds_read_b64_tr_b16 a[160:161], v43 offset:6144
    v_fma_f32 v249, v249, v13, v11
    v_mul_f32 v248, v132, v248
    v_mfma_f32_16x16x32_bf16 v[68:71], a[168:171], a[60:63], v[68:71]
    ds_read_b64_tr_b16 a[162:163], v43 offset:7168
    v_mul_f32 v249, v133, v249
    v_exp_f32 v248, v248
    v_mfma_f32_16x16x32_bf16 v[72:75], a[172:175], a[56:59], v[72:75]
    ds_read_b64_tr_b16 a[164:165], v43 offset:18432
    v_exp_f32 v249, v249
    v_mfma_f32_16x16x32_bf16 v[76:79], a[172:175], a[60:63], v[76:79]
    ds_read_b64_tr_b16 a[166:167], v43 offset:19456
    v_mul_f32 v250, v132, v140
    v_mul_f32 v251, v133, v141
    v_fma_f32 v248, v248, v15, v15
    s_waitcnt lgkmcnt(8)
    v_mfma_f32_16x16x32_bf16 v[48:51], a[144:147], a[64:67], v[48:51]
    ds_read_b64_tr_b16 a[168:169], v44 offset:6144
    v_fma_f32 v249, v249, v15, v15
    v_mfma_f32_16x16x32_bf16 v[52:55], a[144:147], a[68:71], v[52:55]
    ds_read_b64_tr_b16 a[170:171], v44 offset:7168
    v_rcp_f32 v248, v248
    v_mfma_f32_16x16x32_bf16 v[56:59], a[148:151], a[64:67], v[56:59]
    ds_read_b64_tr_b16 a[172:173], v44 offset:18432
    v_rcp_f32 v249, v249
    v_mul_f32 v250, v250, v248
    v_mul_f32 v251, v251, v249
    v_mfma_f32_16x16x32_bf16 v[60:63], a[148:151], a[68:71], v[60:63]
    ds_read_b64_tr_b16 a[174:175], v44 offset:19456
    v_cvt_pk_bf16_f32 v230, v250, v251
    v_mul_f32 v252, v134, v134
    s_waitcnt lgkmcnt(8)
    v_mfma_f32_16x16x32_bf16 v[64:67], a[152:155], a[64:67], v[64:67]
    ds_read_b64_tr_b16 a[144:145], v43 offset:8192
    v_mul_f32 v253, v135, v135
    v_fma_f32 v252, v252, v13, v11
    v_fma_f32 v253, v253, v13, v11
    v_mfma_f32_16x16x32_bf16 v[68:71], a[152:155], a[68:71], v[68:71]
    ds_read_b64_tr_b16 a[146:147], v43 offset:9216
    v_mul_f32 v252, v134, v252
    v_mul_f32 v253, v135, v253
    v_mfma_f32_16x16x32_bf16 v[72:75], a[156:159], a[64:67], v[72:75]
    ds_read_b64_tr_b16 a[148:149], v43 offset:20480
    v_exp_f32 v252, v252
    v_mfma_f32_16x16x32_bf16 v[76:79], a[156:159], a[68:71], v[76:79]
    ds_read_b64_tr_b16 a[150:151], v43 offset:21504
    v_exp_f32 v253, v253
    v_mul_f32 v254, v134, v142
    s_waitcnt lgkmcnt(8)
    v_mfma_f32_16x16x32_bf16 v[48:51], a[160:163], a[72:75], v[48:51]
    ds_read_b64_tr_b16 a[152:153], v44 offset:8192
    v_mul_f32 v255, v135, v143
    v_fma_f32 v252, v252, v15, v15
    v_mfma_f32_16x16x32_bf16 v[52:55], a[160:163], a[76:79], v[52:55]
    ds_read_b64_tr_b16 a[154:155], v44 offset:9216
    v_fma_f32 v253, v253, v15, v15
    v_rcp_f32 v252, v252
    v_mfma_f32_16x16x32_bf16 v[56:59], a[164:167], a[72:75], v[56:59]
    ds_read_b64_tr_b16 a[156:157], v44 offset:20480
    v_rcp_f32 v253, v253
    v_mfma_f32_16x16x32_bf16 v[60:63], a[164:167], a[76:79], v[60:63]
    ds_read_b64_tr_b16 a[158:159], v44 offset:21504
    v_mul_f32 v254, v254, v252
    v_mul_f32 v255, v255, v253
    s_waitcnt lgkmcnt(8)
    v_mfma_f32_16x16x32_bf16 v[64:67], a[168:171], a[72:75], v[64:67]
    ds_read_b64_tr_b16 a[160:161], v43 offset:10240
    v_cvt_pk_bf16_f32 v231, v254, v255
    v_mul_f32 v248, v144, v144
    v_mul_f32 v249, v145, v145
    v_mfma_f32_16x16x32_bf16 v[68:71], a[168:171], a[76:79], v[68:71]
    ds_read_b64_tr_b16 a[162:163], v43 offset:11264
    v_fma_f32 v248, v248, v12, v10
    v_fma_f32 v249, v249, v12, v10
    v_mfma_f32_16x16x32_bf16 v[72:75], a[172:175], a[72:75], v[72:75]
    ds_read_b64_tr_b16 a[164:165], v43 offset:22528
    v_mul_f32 v248, v144, v248
    v_mul_f32 v249, v145, v249
    v_mfma_f32_16x16x32_bf16 v[76:79], a[172:175], a[76:79], v[76:79]
    ds_read_b64_tr_b16 a[166:167], v43 offset:23552
    v_exp_f32 v248, v248
    s_waitcnt lgkmcnt(8)
    v_mfma_f32_16x16x32_bf16 v[48:51], a[144:147], a[80:83], v[48:51]
    ds_read_b64_tr_b16 a[168:169], v44 offset:10240
    v_exp_f32 v249, v249
    v_mul_f32 v250, v144, v152
    v_mfma_f32_16x16x32_bf16 v[52:55], a[144:147], a[84:87], v[52:55]
    ds_read_b64_tr_b16 a[170:171], v44 offset:11264
    v_mul_f32 v251, v145, v153
    v_fma_f32 v248, v248, v14, v14
    v_fma_f32 v249, v249, v14, v14
    v_mfma_f32_16x16x32_bf16 v[56:59], a[148:151], a[80:83], v[56:59]
    ds_read_b64_tr_b16 a[172:173], v44 offset:22528
    v_rcp_f32 v248, v248
    v_mfma_f32_16x16x32_bf16 v[60:63], a[148:151], a[84:87], v[60:63]
    ds_read_b64_tr_b16 a[174:175], v44 offset:23552
    v_rcp_f32 v249, v249
    v_mul_f32 v250, v250, v248
    s_waitcnt lgkmcnt(8)
    v_mfma_f32_16x16x32_bf16 v[64:67], a[152:155], a[80:83], v[64:67]
    v_add_u32 v43, 49152, v33
    v_add_u32 v44, 49152, v34
    ds_read_b64_tr_b16 a[144:145], v43 offset:0
    v_mul_f32 v251, v251, v249
    v_cvt_pk_bf16_f32 v232, v250, v251
    v_mfma_f32_16x16x32_bf16 v[68:71], a[152:155], a[84:87], v[68:71]
    ds_read_b64_tr_b16 a[146:147], v43 offset:1024
    v_mul_f32 v252, v146, v146
    v_mul_f32 v253, v147, v147
    v_mfma_f32_16x16x32_bf16 v[72:75], a[156:159], a[80:83], v[72:75]
    ds_read_b64_tr_b16 a[148:149], v43 offset:12288
    v_fma_f32 v252, v252, v12, v10
    v_fma_f32 v253, v253, v12, v10
    v_mul_f32 v252, v146, v252
    v_mfma_f32_16x16x32_bf16 v[76:79], a[156:159], a[84:87], v[76:79]
    ds_read_b64_tr_b16 a[150:151], v43 offset:13312
    v_mul_f32 v253, v147, v253
    s_waitcnt lgkmcnt(8)
    v_mfma_f32_16x16x32_bf16 v[48:51], a[160:163], a[88:91], v[48:51]
    ds_read_b64_tr_b16 a[152:153], v44 offset:0
    v_exp_f32 v252, v252
    v_exp_f32 v253, v253
    v_mfma_f32_16x16x32_bf16 v[52:55], a[160:163], a[92:95], v[52:55]
    ds_read_b64_tr_b16 a[154:155], v44 offset:1024
    v_mul_f32 v254, v146, v154
    v_mul_f32 v255, v147, v155
    v_mfma_f32_16x16x32_bf16 v[56:59], a[164:167], a[88:91], v[56:59]
    ds_read_b64_tr_b16 a[156:157], v44 offset:12288
    v_fma_f32 v252, v252, v14, v14
    v_fma_f32 v253, v253, v14, v14
    v_mfma_f32_16x16x32_bf16 v[60:63], a[164:167], a[92:95], v[60:63]
    ds_read_b64_tr_b16 a[158:159], v44 offset:13312
    v_rcp_f32 v252, v252
    s_waitcnt lgkmcnt(8)
    v_mfma_f32_16x16x32_bf16 v[64:67], a[168:171], a[88:91], v[64:67]
    ds_read_b64_tr_b16 a[160:161], v43 offset:2048
    v_rcp_f32 v253, v253
    v_mul_f32 v254, v254, v252
    v_mfma_f32_16x16x32_bf16 v[68:71], a[168:171], a[92:95], v[68:71]
    ds_read_b64_tr_b16 a[162:163], v43 offset:3072
    v_mul_f32 v255, v255, v253
    v_cvt_pk_bf16_f32 v233, v254, v255
    v_mul_f32 v248, v148, v148
    v_mfma_f32_16x16x32_bf16 v[72:75], a[172:175], a[88:91], v[72:75]
    ds_read_b64_tr_b16 a[164:165], v43 offset:14336
    v_mul_f32 v249, v149, v149
    v_fma_f32 v248, v248, v13, v11
    v_mfma_f32_16x16x32_bf16 v[76:79], a[172:175], a[92:95], v[76:79]
    ds_read_b64_tr_b16 a[166:167], v43 offset:15360
    v_fma_f32 v249, v249, v13, v11
    v_mul_f32 v248, v148, v248
    s_waitcnt vmcnt(9)
    s_barrier
    s_waitcnt lgkmcnt(8)
    v_mfma_f32_16x16x32_bf16 v[48:51], a[144:147], a[96:99], v[48:51]
    ds_read_b64_tr_b16 a[168:169], v44 offset:2048
    v_mul_f32 v249, v149, v249
    v_exp_f32 v248, v248
    v_mfma_f32_16x16x32_bf16 v[52:55], a[144:147], a[100:103], v[52:55]
    ds_read_b64_tr_b16 a[170:171], v44 offset:3072
    s_add_u32 m0, s27, 0
    s_add_u32 s32, s50, 256
    buffer_load_dwordx4 v7, s[12:15], s32 offen lds
    v_exp_f32 v249, v249
    v_mfma_f32_16x16x32_bf16 v[56:59], a[148:151], a[96:99], v[56:59]
    ds_read_b64_tr_b16 a[172:173], v44 offset:14336
    v_mul_f32 v250, v148, v156
    v_mul_f32 v251, v149, v157
    v_fma_f32 v248, v248, v15, v15
    v_mfma_f32_16x16x32_bf16 v[60:63], a[148:151], a[100:103], v[60:63]
    ds_read_b64_tr_b16 a[174:175], v44 offset:15360
    v_fma_f32 v249, v249, v15, v15
    s_waitcnt lgkmcnt(8)
    v_mfma_f32_16x16x32_bf16 v[64:67], a[152:155], a[96:99], v[64:67]
    ds_read_b64_tr_b16 a[144:145], v43 offset:4096
    buffer_load_dwordx4 v8, s[12:15], s32 offen offset:1024 lds
    v_rcp_f32 v248, v248
    v_mfma_f32_16x16x32_bf16 v[68:71], a[152:155], a[100:103], v[68:71]
    ds_read_b64_tr_b16 a[146:147], v43 offset:5120
    v_rcp_f32 v249, v249
    v_mul_f32 v250, v250, v248
    v_mul_f32 v251, v251, v249
    v_mfma_f32_16x16x32_bf16 v[72:75], a[156:159], a[96:99], v[72:75]
    ds_read_b64_tr_b16 a[148:149], v43 offset:16384
    v_cvt_pk_bf16_f32 v236, v250, v251
    v_mul_f32 v252, v150, v150
    v_mfma_f32_16x16x32_bf16 v[76:79], a[156:159], a[100:103], v[76:79]
    ds_read_b64_tr_b16 a[150:151], v43 offset:17408
    buffer_load_dwordx4 v9, s[12:15], s32 offen offset:2048 lds
    v_mul_f32 v253, v151, v151
    v_fma_f32 v252, v252, v13, v11
    v_fma_f32 v253, v253, v13, v11
    s_waitcnt lgkmcnt(8)
    v_mfma_f32_16x16x32_bf16 v[48:51], a[160:163], a[104:107], v[48:51]
    ds_read_b64_tr_b16 a[152:153], v44 offset:4096
    v_mul_f32 v252, v150, v252
    v_mul_f32 v253, v151, v253
    v_mfma_f32_16x16x32_bf16 v[52:55], a[160:163], a[108:111], v[52:55]
    ds_read_b64_tr_b16 a[154:155], v44 offset:5120
    v_exp_f32 v252, v252
    v_mfma_f32_16x16x32_bf16 v[56:59], a[164:167], a[104:107], v[56:59]
    ds_read_b64_tr_b16 a[156:157], v44 offset:16384
    s_add_u32 m0, s27, 12288
    s_add_u32 s32, s51, 256
    buffer_load_dwordx4 v7, s[12:15], s32 offen lds
    v_exp_f32 v253, v253
    v_mul_f32 v254, v150, v158
    v_mfma_f32_16x16x32_bf16 v[60:63], a[164:167], a[108:111], v[60:63]
    ds_read_b64_tr_b16 a[158:159], v44 offset:17408
    v_mul_f32 v255, v151, v159
    v_fma_f32 v252, v252, v15, v15
    s_waitcnt lgkmcnt(8)
    v_mfma_f32_16x16x32_bf16 v[64:67], a[168:171], a[104:107], v[64:67]
    ds_read_b64_tr_b16 a[160:161], v43 offset:6144
    v_fma_f32 v253, v253, v15, v15
    v_rcp_f32 v252, v252
    v_mfma_f32_16x16x32_bf16 v[68:71], a[168:171], a[108:111], v[68:71]
    ds_read_b64_tr_b16 a[162:163], v43 offset:7168
    buffer_load_dwordx4 v8, s[12:15], s32 offen offset:1024 lds
    v_rcp_f32 v253, v253
    v_mfma_f32_16x16x32_bf16 v[72:75], a[172:175], a[104:107], v[72:75]
    ds_read_b64_tr_b16 a[164:165], v43 offset:18432
    v_mul_f32 v254, v254, v252
    v_mul_f32 v255, v255, v253
    v_mfma_f32_16x16x32_bf16 v[76:79], a[172:175], a[108:111], v[76:79]
    ds_read_b64_tr_b16 a[166:167], v43 offset:19456
    v_cvt_pk_bf16_f32 v237, v254, v255
    v_mul_f32 v248, v160, v160
    v_mul_f32 v249, v161, v161
    s_waitcnt lgkmcnt(8)
    v_mfma_f32_16x16x32_bf16 v[48:51], a[144:147], a[112:115], v[48:51]
    ds_read_b64_tr_b16 a[168:169], v44 offset:6144
    buffer_load_dwordx4 v9, s[12:15], s32 offen offset:2048 lds
    v_fma_f32 v248, v248, v12, v10
    v_fma_f32 v249, v249, v12, v10
    v_mfma_f32_16x16x32_bf16 v[52:55], a[144:147], a[116:119], v[52:55]
    ds_read_b64_tr_b16 a[170:171], v44 offset:7168
    v_mul_f32 v248, v160, v248
    v_mul_f32 v249, v161, v249
    v_mfma_f32_16x16x32_bf16 v[56:59], a[148:151], a[112:115], v[56:59]
    ds_read_b64_tr_b16 a[172:173], v44 offset:18432
    v_exp_f32 v248, v248
    v_mfma_f32_16x16x32_bf16 v[60:63], a[148:151], a[116:119], v[60:63]
    ds_read_b64_tr_b16 a[174:175], v44 offset:19456
    s_add_u32 m0, s27, 24576
    s_add_u32 s32, s52, 256
    buffer_load_dwordx4 v7, s[12:15], s32 offen lds
    v_exp_f32 v249, v249
    v_mul_f32 v250, v160, v168
    s_waitcnt lgkmcnt(8)
    v_mfma_f32_16x16x32_bf16 v[64:67], a[152:155], a[112:115], v[64:67]
    ds_read_b64_tr_b16 a[144:145], v43 offset:8192
    v_mul_f32 v251, v161, v169
    v_fma_f32 v248, v248, v14, v14
    v_fma_f32 v249, v249, v14, v14
    v_mfma_f32_16x16x32_bf16 v[68:71], a[152:155], a[116:119], v[68:71]
    ds_read_b64_tr_b16 a[146:147], v43 offset:9216
    v_rcp_f32 v248, v248
    v_mfma_f32_16x16x32_bf16 v[72:75], a[156:159], a[112:115], v[72:75]
    ds_read_b64_tr_b16 a[148:149], v43 offset:20480
    s_add_u32 s32, s53, 256
    s_nop 0
    buffer_load_dwordx4 v8, s[12:15], s32 offen offset:1024 lds
    v_rcp_f32 v249, v249
    v_mul_f32 v250, v250, v248
    v_mfma_f32_16x16x32_bf16 v[76:79], a[156:159], a[116:119], v[76:79]
    ds_read_b64_tr_b16 a[150:151], v43 offset:21504
    v_mul_f32 v251, v251, v249
    v_cvt_pk_bf16_f32 v234, v250, v251
    s_waitcnt lgkmcnt(8)
    v_mfma_f32_16x16x32_bf16 v[48:51], a[160:163], a[120:123], v[48:51]
    ds_read_b64_tr_b16 a[152:153], v44 offset:8192
    v_mul_f32 v252, v162, v162
    v_mul_f32 v253, v163, v163
    v_mfma_f32_16x16x32_bf16 v[52:55], a[160:163], a[124:127], v[52:55]
    ds_read_b64_tr_b16 a[154:155], v44 offset:9216
    s_add_u32 s32, s54, 256
    s_nop 0
    buffer_load_dwordx4 v9, s[12:15], s32 offen offset:2048 lds
    v_fma_f32 v252, v252, v12, v10
    v_fma_f32 v253, v253, v12, v10
    v_mul_f32 v252, v162, v252
    v_mfma_f32_16x16x32_bf16 v[56:59], a[164:167], a[120:123], v[56:59]
    ds_read_b64_tr_b16 a[156:157], v44 offset:20480
    v_mul_f32 v253, v163, v253
    v_mfma_f32_16x16x32_bf16 v[60:63], a[164:167], a[124:127], v[60:63]
    ds_read_b64_tr_b16 a[158:159], v44 offset:21504
    v_exp_f32 v252, v252
    v_exp_f32 v253, v253
    s_waitcnt lgkmcnt(8)
    v_mfma_f32_16x16x32_bf16 v[64:67], a[168:171], a[120:123], v[64:67]
    ds_read_b64_tr_b16 a[160:161], v43 offset:10240
    v_mul_f32 v254, v162, v170
    v_mul_f32 v255, v163, v171
    v_mfma_f32_16x16x32_bf16 v[68:71], a[168:171], a[124:127], v[68:71]
    ds_read_b64_tr_b16 a[162:163], v43 offset:11264
    v_fma_f32 v252, v252, v14, v14
    v_fma_f32 v253, v253, v14, v14
    v_mfma_f32_16x16x32_bf16 v[72:75], a[172:175], a[120:123], v[72:75]
    ds_read_b64_tr_b16 a[164:165], v43 offset:22528
    v_rcp_f32 v252, v252
    v_mfma_f32_16x16x32_bf16 v[76:79], a[172:175], a[124:127], v[76:79]
    ds_read_b64_tr_b16 a[166:167], v43 offset:23552
    v_rcp_f32 v253, v253
    v_mul_f32 v254, v254, v252
    s_waitcnt lgkmcnt(8)
    v_mfma_f32_16x16x32_bf16 v[48:51], a[144:147], a[128:131], v[48:51]
    ds_read_b64_tr_b16 a[168:169], v44 offset:10240
    v_mul_f32 v255, v255, v253
    v_cvt_pk_bf16_f32 v235, v254, v255
    v_mul_f32 v248, v164, v164
    v_mfma_f32_16x16x32_bf16 v[52:55], a[144:147], a[132:135], v[52:55]
    ds_read_b64_tr_b16 a[170:171], v44 offset:11264
    v_mul_f32 v249, v165, v165
    v_fma_f32 v248, v248, v13, v11
    v_mfma_f32_16x16x32_bf16 v[56:59], a[148:151], a[128:131], v[56:59]
    ds_read_b64_tr_b16 a[172:173], v44 offset:22528
    v_fma_f32 v249, v249, v13, v11
    v_mul_f32 v248, v164, v248
    v_mfma_f32_16x16x32_bf16 v[60:63], a[148:151], a[132:135], v[60:63]
    ds_read_b64_tr_b16 a[174:175], v44 offset:23552
    v_mul_f32 v249, v165, v249
    v_exp_f32 v248, v248
    s_waitcnt lgkmcnt(8)
    v_mfma_f32_16x16x32_bf16 v[64:67], a[152:155], a[128:131], v[64:67]
    v_xor_b32 v17, 0, v42
    v_xor_b32 v18, 32, v42
    v_xor_b32 v19, 64, v42
    v_xor_b32 v20, 96, v42
    v_xor_b32 v21, 0, v42
    v_add_u32 v21, 36864, v21
    v_xor_b32 v22, 32, v42
    v_add_u32 v22, 36864, v22
    v_xor_b32 v23, 64, v42
    v_add_u32 v23, 36864, v23
    v_xor_b32 v24, 96, v42
    v_add_u32 v24, 36864, v24
    v_xor_b32 v25, 0, v42
    v_add_u32 v25, 73728, v25
    v_xor_b32 v26, 32, v42
    v_add_u32 v26, 73728, v26
    v_xor_b32 v27, 64, v42
    v_add_u32 v27, 73728, v27
    v_xor_b32 v28, 96, v42
    v_add_u32 v28, 73728, v28
    v_xor_b32 v29, 0, v42
    v_add_u32 v29, 110592, v29
    v_xor_b32 v30, 32, v42
    v_add_u32 v30, 110592, v30
    v_xor_b32 v31, 64, v42
    v_add_u32 v31, 110592, v31
    v_xor_b32 v32, 96, v42
    v_add_u32 v32, 110592, v32
    ds_read_b64_tr_b16 a[144:145], v25 offset:0
    v_exp_f32 v249, v249
    v_mfma_f32_16x16x32_bf16 v[68:71], a[152:155], a[132:135], v[68:71]
    ds_read_b64_tr_b16 a[146:147], v25 offset:2048
    v_mul_f32 v250, v164, v172
    v_mul_f32 v251, v165, v173
    v_fma_f32 v248, v248, v15, v15
    v_mfma_f32_16x16x32_bf16 v[72:75], a[156:159], a[128:131], v[72:75]
    ds_read_b64_tr_b16 a[148:149], v26 offset:0
    v_fma_f32 v249, v249, v15, v15
    v_mfma_f32_16x16x32_bf16 v[76:79], a[156:159], a[132:135], v[76:79]
    ds_read_b64_tr_b16 a[150:151], v26 offset:2048
    v_rcp_f32 v248, v248
    s_waitcnt lgkmcnt(8)
    v_mfma_f32_16x16x32_bf16 v[48:51], a[160:163], a[136:139], v[48:51]
    ds_read_b64_tr_b16 a[152:153], v27 offset:0
    v_rcp_f32 v249, v249
    v_mul_f32 v250, v250, v248
    v_mul_f32 v251, v251, v249
    v_mfma_f32_16x16x32_bf16 v[52:55], a[160:163], a[140:143], v[52:55]
    ds_read_b64_tr_b16 a[154:155], v27 offset:2048
    v_cvt_pk_bf16_f32 v238, v250, v251
    v_mul_f32 v252, v166, v166
    v_mfma_f32_16x16x32_bf16 v[56:59], a[164:167], a[136:139], v[56:59]
    ds_read_b64_tr_b16 a[156:157], v28 offset:0
    v_mul_f32 v253, v167, v167
    v_fma_f32 v252, v252, v13, v11
    v_fma_f32 v253, v253, v13, v11
    v_mfma_f32_16x16x32_bf16 v[60:63], a[164:167], a[140:143], v[60:63]
    ds_read_b64_tr_b16 a[158:159], v28 offset:2048
    v_mul_f32 v252, v166, v252
    v_mul_f32 v253, v167, v253
    s_waitcnt lgkmcnt(8)
    v_mfma_f32_16x16x32_bf16 v[64:67], a[168:171], a[136:139], v[64:67]
    ds_read_b64_tr_b16 a[160:161], v25 offset:4096
    v_exp_f32 v252, v252
    v_mfma_f32_16x16x32_bf16 v[68:71], a[168:171], a[140:143], v[68:71]
    ds_read_b64_tr_b16 a[162:163], v25 offset:6144
    v_exp_f32 v253, v253
    v_mul_f32 v254, v166, v174
    v_mfma_f32_16x16x32_bf16 v[72:75], a[172:175], a[136:139], v[72:75]
    ds_read_b64_tr_b16 a[164:165], v26 offset:4096
    v_mul_f32 v255, v167, v175
    v_fma_f32 v252, v252, v15, v15
    v_mfma_f32_16x16x32_bf16 v[76:79], a[172:175], a[140:143], v[76:79]
    ds_read_b64_tr_b16 a[166:167], v26 offset:6144
    v_fma_f32 v253, v253, v15, v15
    v_rcp_f32 v252, v252
    v_mfma_f32_16x16x32_bf16 v[48:51], a[208:211], a[214:217], v[48:51]
    v_rcp_f32 v253, v253
    v_mfma_f32_16x16x32_bf16 v[52:55], a[208:211], a[222:225], v[52:55]
    v_mul_f32 v254, v254, v252
    v_mul_f32 v255, v255, v253
    v_mfma_f32_16x16x32_bf16 v[56:59], a[208:211], a[218:221], v[56:59]
    v_cvt_pk_bf16_f32 v239, v254, v255
    v_mfma_f32_16x16x32_bf16 v[60:63], a[208:211], a[226:229], v[60:63]
    v_mfma_f32_16x16x32_bf16 v[64:67], a[210:213], a[214:217], v[64:67]
    v_mfma_f32_16x16x32_bf16 v[68:71], a[210:213], a[222:225], v[68:71]
    v_mfma_f32_16x16x32_bf16 v[72:75], a[210:213], a[218:221], v[72:75]
    v_mfma_f32_16x16x32_bf16 v[76:79], a[210:213], a[226:229], v[76:79]
    s_waitcnt vmcnt(9)
    s_barrier
    s_waitcnt lgkmcnt(8)
    v_mfma_f32_16x16x32_bf16 v[112:115], a[144:147], v[176:179], 0
    ds_read_b64_tr_b16 a[168:169], v27 offset:4096
    v_mfma_f32_16x16x32_bf16 v[116:119], a[144:147], v[180:183], 0
    ds_read_b64_tr_b16 a[170:171], v27 offset:6144
    s_add_u32 m0, s27, 36864
    s_add_u32 s32, s50, 384
    buffer_load_dwordx4 v7, s[12:15], s32 offen lds
    v_mfma_f32_16x16x32_bf16 v[120:123], a[148:151], v[176:179], 0
    ds_read_b64_tr_b16 a[172:173], v28 offset:4096
    v_mfma_f32_16x16x32_bf16 v[124:127], a[148:151], v[180:183], 0
    ds_read_b64_tr_b16 a[174:175], v28 offset:6144
    s_waitcnt lgkmcnt(8)
    v_mfma_f32_16x16x32_bf16 v[128:131], a[152:155], v[176:179], 0
    ds_read_b64_tr_b16 a[144:145], v25 offset:8192
    buffer_load_dwordx4 v8, s[12:15], s32 offen offset:1024 lds
    v_mfma_f32_16x16x32_bf16 v[132:135], a[152:155], v[180:183], 0
    ds_read_b64_tr_b16 a[146:147], v25 offset:10240
    v_mfma_f32_16x16x32_bf16 v[136:139], a[156:159], v[176:179], 0
    ds_read_b64_tr_b16 a[148:149], v26 offset:8192
    v_mul_f32 v248, v48, v48
    v_mul_f32 v249, v49, v49
    v_fma_f32 v248, v248, v12, v10
    v_mfma_f32_16x16x32_bf16 v[140:143], a[156:159], v[180:183], 0
    ds_read_b64_tr_b16 a[150:151], v26 offset:10240
    buffer_load_dwordx4 v9, s[12:15], s32 offen offset:2048 lds
    v_fma_f32 v249, v249, v12, v10
    v_mul_f32 v248, v48, v248
    v_mul_f32 v249, v49, v249
    s_waitcnt lgkmcnt(8)
    v_mfma_f32_16x16x32_bf16 v[112:115], a[160:163], v[184:187], v[112:115]
    ds_read_b64_tr_b16 a[152:153], v27 offset:8192
    v_exp_f32 v248, v248
    v_mfma_f32_16x16x32_bf16 v[116:119], a[160:163], v[188:191], v[116:119]
    ds_read_b64_tr_b16 a[154:155], v27 offset:10240
    v_exp_f32 v249, v249
    v_mul_f32 v250, v48, v56
    v_mul_f32 v251, v49, v57
    v_mfma_f32_16x16x32_bf16 v[120:123], a[164:167], v[184:187], v[120:123]
    ds_read_b64_tr_b16 a[156:157], v28 offset:8192
    s_add_u32 m0, s27, 49152
    s_add_u32 s32, s51, 384
    buffer_load_dwordx4 v7, s[12:15], s32 offen lds
    v_fma_f32 v248, v248, v14, v14
    v_fma_f32 v249, v249, v14, v14
    v_mfma_f32_16x16x32_bf16 v[124:127], a[164:167], v[188:191], v[124:127]
    ds_read_b64_tr_b16 a[158:159], v28 offset:10240
    v_rcp_f32 v248, v248
    v_rcp_f32 v249, v249
    s_waitcnt lgkmcnt(8)
    v_mfma_f32_16x16x32_bf16 v[128:131], a[168:171], v[184:187], v[128:131]
    ds_read_b64_tr_b16 a[160:161], v25 offset:12288
    v_mul_f32 v250, v250, v248
    v_mul_f32 v251, v251, v249
    v_cvt_pk_bf16_f32 v240, v250, v251
    v_mfma_f32_16x16x32_bf16 v[132:135], a[168:171], v[188:191], v[132:135]
    ds_read_b64_tr_b16 a[162:163], v25 offset:14336
    buffer_load_dwordx4 v8, s[12:15], s32 offen offset:1024 lds
    v_mul_f32 v252, v50, v50
    v_mul_f32 v253, v51, v51
    v_fma_f32 v252, v252, v12, v10
    v_mfma_f32_16x16x32_bf16 v[136:139], a[172:175], v[184:187], v[136:139]
    ds_read_b64_tr_b16 a[164:165], v26 offset:12288
    v_fma_f32 v253, v253, v12, v10
    v_mul_f32 v252, v50, v252
    v_mul_f32 v253, v51, v253
    v_mfma_f32_16x16x32_bf16 v[140:143], a[172:175], v[188:191], v[140:143]
    ds_read_b64_tr_b16 a[166:167], v26 offset:14336
    v_exp_f32 v252, v252
    s_waitcnt lgkmcnt(8)
    v_mfma_f32_16x16x32_bf16 v[112:115], a[144:147], v[192:195], v[112:115]
    ds_read_b64_tr_b16 a[168:169], v27 offset:12288
    buffer_load_dwordx4 v9, s[12:15], s32 offen offset:2048 lds
    v_exp_f32 v253, v253
    v_mul_f32 v254, v50, v58
    v_mul_f32 v255, v51, v59
    v_mfma_f32_16x16x32_bf16 v[116:119], a[144:147], v[196:199], v[116:119]
    ds_read_b64_tr_b16 a[170:171], v27 offset:14336
    v_fma_f32 v252, v252, v14, v14
    v_fma_f32 v253, v253, v14, v14
    v_mfma_f32_16x16x32_bf16 v[120:123], a[148:151], v[192:195], v[120:123]
    ds_read_b64_tr_b16 a[172:173], v28 offset:12288
    v_rcp_f32 v252, v252
    v_rcp_f32 v253, v253
    v_mfma_f32_16x16x32_bf16 v[124:127], a[148:151], v[196:199], v[124:127]
    ds_read_b64_tr_b16 a[174:175], v28 offset:14336
    s_add_u32 m0, s27, 61440
    s_add_u32 s32, s52, 384
    buffer_load_dwordx4 v7, s[12:15], s32 offen lds
    v_mul_f32 v254, v254, v252
    v_mul_f32 v255, v255, v253
    v_cvt_pk_bf16_f32 v241, v254, v255
    s_waitcnt lgkmcnt(8)
    v_mfma_f32_16x16x32_bf16 v[128:131], a[152:155], v[192:195], v[128:131]
    ds_read_b64_tr_b16 a[144:145], v25 offset:16384
    v_mul_f32 v248, v52, v52
    v_mul_f32 v249, v53, v53
    v_fma_f32 v248, v248, v13, v11
    v_mfma_f32_16x16x32_bf16 v[132:135], a[152:155], v[196:199], v[132:135]
    ds_read_b64_tr_b16 a[146:147], v25 offset:18432
    v_fma_f32 v249, v249, v13, v11
    v_mul_f32 v248, v52, v248
    v_mul_f32 v249, v53, v249
    v_mfma_f32_16x16x32_bf16 v[136:139], a[156:159], v[192:195], v[136:139]
    ds_read_b64_tr_b16 a[148:149], v26 offset:16384
    s_add_u32 s32, s53, 384
    s_nop 0
    buffer_load_dwordx4 v8, s[12:15], s32 offen offset:1024 lds
    v_exp_f32 v248, v248
    v_mfma_f32_16x16x32_bf16 v[140:143], a[156:159], v[196:199], v[140:143]
    ds_read_b64_tr_b16 a[150:151], v26 offset:18432
    v_exp_f32 v249, v249
    v_mul_f32 v250, v52, v60
    v_mul_f32 v251, v53, v61
    s_waitcnt lgkmcnt(8)
    v_mfma_f32_16x16x32_bf16 v[112:115], a[160:163], v[200:203], v[112:115]
    ds_read_b64_tr_b16 a[152:153], v27 offset:16384
    v_fma_f32 v248, v248, v15, v15
    v_fma_f32 v249, v249, v15, v15
    v_mfma_f32_16x16x32_bf16 v[116:119], a[160:163], v[204:207], v[116:119]
    ds_read_b64_tr_b16 a[154:155], v27 offset:18432
    s_add_u32 s32, s54, 384
    s_nop 0
    buffer_load_dwordx4 v9, s[12:15], s32 offen offset:2048 lds
    v_rcp_f32 v248, v248
    v_rcp_f32 v249, v249
    v_mfma_f32_16x16x32_bf16 v[120:123], a[164:167], v[200:203], v[120:123]
    ds_read_b64_tr_b16 a[156:157], v28 offset:16384
    v_mul_f32 v250, v250, v248
    v_mul_f32 v251, v251, v249
    v_cvt_pk_bf16_f32 v244, v250, v251
    v_mfma_f32_16x16x32_bf16 v[124:127], a[164:167], v[204:207], v[124:127]
    ds_read_b64_tr_b16 a[158:159], v28 offset:18432
    v_mul_f32 v252, v54, v54
    v_mul_f32 v253, v55, v55
    v_fma_f32 v252, v252, v13, v11
    s_waitcnt lgkmcnt(8)
    v_mfma_f32_16x16x32_bf16 v[128:131], a[168:171], v[200:203], v[128:131]
    ds_read_b64_tr_b16 a[160:161], v25 offset:20480
    v_fma_f32 v253, v253, v13, v11
    v_mul_f32 v252, v54, v252
    v_mul_f32 v253, v55, v253
    v_mfma_f32_16x16x32_bf16 v[132:135], a[168:171], v[204:207], v[132:135]
    ds_read_b64_tr_b16 a[162:163], v25 offset:22528
    v_exp_f32 v252, v252
    v_mfma_f32_16x16x32_bf16 v[136:139], a[172:175], v[200:203], v[136:139]
    ds_read_b64_tr_b16 a[164:165], v26 offset:20480
    v_exp_f32 v253, v253
    v_mul_f32 v254, v54, v62
    v_mul_f32 v255, v55, v63
    v_mfma_f32_16x16x32_bf16 v[140:143], a[172:175], v[204:207], v[140:143]
    ds_read_b64_tr_b16 a[166:167], v26 offset:22528
    v_fma_f32 v252, v252, v15, v15
    v_fma_f32 v253, v253, v15, v15
    s_waitcnt lgkmcnt(8)
    v_mfma_f32_16x16x32_bf16 v[112:115], a[144:147], v[208:211], v[112:115]
    ds_read_b64_tr_b16 a[168:169], v27 offset:20480
    v_rcp_f32 v252, v252
    v_rcp_f32 v253, v253
    v_mfma_f32_16x16x32_bf16 v[116:119], a[144:147], v[212:215], v[116:119]
    ds_read_b64_tr_b16 a[170:171], v27 offset:22528
    v_mul_f32 v254, v254, v252
    v_mul_f32 v255, v255, v253
    v_cvt_pk_bf16_f32 v245, v254, v255
    v_mfma_f32_16x16x32_bf16 v[120:123], a[148:151], v[208:211], v[120:123]
    ds_read_b64_tr_b16 a[172:173], v28 offset:20480
    v_mul_f32 v248, v64, v64
    v_mul_f32 v249, v65, v65
    v_fma_f32 v248, v248, v12, v10
    v_mfma_f32_16x16x32_bf16 v[124:127], a[148:151], v[212:215], v[124:127]
    ds_read_b64_tr_b16 a[174:175], v28 offset:22528
    v_fma_f32 v249, v249, v12, v10
    v_mul_f32 v248, v64, v248
    v_mul_f32 v249, v65, v249
    s_waitcnt lgkmcnt(8)
    v_mfma_f32_16x16x32_bf16 v[128:131], a[152:155], v[208:211], v[128:131]
    ds_read_b64_tr_b16 a[144:145], v25 offset:24576
    v_exp_f32 v248, v248
    v_mfma_f32_16x16x32_bf16 v[132:135], a[152:155], v[212:215], v[132:135]
    ds_read_b64_tr_b16 a[146:147], v25 offset:26624
    v_exp_f32 v249, v249
    v_mul_f32 v250, v64, v72
    v_mul_f32 v251, v65, v73
    v_mfma_f32_16x16x32_bf16 v[136:139], a[156:159], v[208:211], v[136:139]
    ds_read_b64_tr_b16 a[148:149], v26 offset:24576
    v_fma_f32 v248, v248, v14, v14
    v_fma_f32 v249, v249, v14, v14
    v_mfma_f32_16x16x32_bf16 v[140:143], a[156:159], v[212:215], v[140:143]
    ds_read_b64_tr_b16 a[150:151], v26 offset:26624
    v_rcp_f32 v248, v248
    v_rcp_f32 v249, v249
    s_waitcnt lgkmcnt(8)
    v_mfma_f32_16x16x32_bf16 v[112:115], a[160:163], v[216:219], v[112:115]
    ds_read_b64_tr_b16 a[152:153], v27 offset:24576
    v_mul_f32 v250, v250, v248
    v_mul_f32 v251, v251, v249
    v_cvt_pk_bf16_f32 v242, v250, v251
    v_mfma_f32_16x16x32_bf16 v[116:119], a[160:163], v[220:223], v[116:119]
    ds_read_b64_tr_b16 a[154:155], v27 offset:26624
    v_mul_f32 v252, v66, v66
    v_mul_f32 v253, v67, v67
    v_fma_f32 v252, v252, v12, v10
    v_mfma_f32_16x16x32_bf16 v[120:123], a[164:167], v[216:219], v[120:123]
    ds_read_b64_tr_b16 a[156:157], v28 offset:24576
    v_fma_f32 v253, v253, v12, v10
    v_mul_f32 v252, v66, v252
    v_mul_f32 v253, v67, v253
    v_mfma_f32_16x16x32_bf16 v[124:127], a[164:167], v[220:223], v[124:127]
    ds_read_b64_tr_b16 a[158:159], v28 offset:26624
    v_exp_f32 v252, v252
    s_waitcnt lgkmcnt(8)
    v_mfma_f32_16x16x32_bf16 v[128:131], a[168:171], v[216:219], v[128:131]
    ds_read_b64_tr_b16 a[160:161], v25 offset:28672
    v_exp_f32 v253, v253
    v_mul_f32 v254, v66, v74
    v_mul_f32 v255, v67, v75
    v_mfma_f32_16x16x32_bf16 v[132:135], a[168:171], v[220:223], v[132:135]
    ds_read_b64_tr_b16 a[162:163], v25 offset:30720
    v_fma_f32 v252, v252, v14, v14
    v_fma_f32 v253, v253, v14, v14
    v_mfma_f32_16x16x32_bf16 v[136:139], a[172:175], v[216:219], v[136:139]
    ds_read_b64_tr_b16 a[164:165], v26 offset:28672
    v_rcp_f32 v252, v252
    v_rcp_f32 v253, v253
    v_mfma_f32_16x16x32_bf16 v[140:143], a[172:175], v[220:223], v[140:143]
    ds_read_b64_tr_b16 a[166:167], v26 offset:30720
    v_mul_f32 v254, v254, v252
    v_mul_f32 v255, v255, v253
    v_cvt_pk_bf16_f32 v243, v254, v255
    s_waitcnt lgkmcnt(8)
    v_mfma_f32_16x16x32_bf16 v[112:115], a[144:147], v[224:227], v[112:115]
    ds_read_b64_tr_b16 a[168:169], v27 offset:28672
    v_mul_f32 v248, v68, v68
    v_mul_f32 v249, v69, v69
    v_fma_f32 v248, v248, v13, v11
    v_mfma_f32_16x16x32_bf16 v[116:119], a[144:147], v[228:231], v[116:119]
    ds_read_b64_tr_b16 a[170:171], v27 offset:30720
    v_fma_f32 v249, v249, v13, v11
    v_mul_f32 v248, v68, v248
    v_mul_f32 v249, v69, v249
    v_mfma_f32_16x16x32_bf16 v[120:123], a[148:151], v[224:227], v[120:123]
    ds_read_b64_tr_b16 a[172:173], v28 offset:28672
    v_exp_f32 v248, v248
    v_mfma_f32_16x16x32_bf16 v[124:127], a[148:151], v[228:231], v[124:127]
    ds_read_b64_tr_b16 a[174:175], v28 offset:30720
    v_exp_f32 v249, v249
    v_mul_f32 v250, v68, v76
    v_mul_f32 v251, v69, v77
    s_waitcnt lgkmcnt(8)
    v_mfma_f32_16x16x32_bf16 v[128:131], a[152:155], v[224:227], v[128:131]
    ds_read_b64_tr_b16 a[144:145], v25 offset:32768
    v_fma_f32 v248, v248, v15, v15
    v_fma_f32 v249, v249, v15, v15
    v_mfma_f32_16x16x32_bf16 v[132:135], a[152:155], v[228:231], v[132:135]
    ds_read_b64_tr_b16 a[146:147], v25 offset:34816
    v_rcp_f32 v248, v248
    v_rcp_f32 v249, v249
    v_mfma_f32_16x16x32_bf16 v[136:139], a[156:159], v[224:227], v[136:139]
    ds_read_b64_tr_b16 a[148:149], v26 offset:32768
    v_mul_f32 v250, v250, v248
    v_mul_f32 v251, v251, v249
    v_cvt_pk_bf16_f32 v246, v250, v251
    v_mfma_f32_16x16x32_bf16 v[140:143], a[156:159], v[228:231], v[140:143]
    ds_read_b64_tr_b16 a[150:151], v26 offset:34816
    v_mul_f32 v252, v70, v70
    v_mul_f32 v253, v71, v71
    v_fma_f32 v252, v252, v13, v11
    s_waitcnt lgkmcnt(8)
    v_mfma_f32_16x16x32_bf16 v[112:115], a[160:163], v[232:235], v[112:115]
    ds_read_b64_tr_b16 a[152:153], v27 offset:32768
    v_fma_f32 v253, v253, v13, v11
    v_mul_f32 v252, v70, v252
    v_mul_f32 v253, v71, v253
    v_mfma_f32_16x16x32_bf16 v[116:119], a[160:163], v[236:239], v[116:119]
    ds_read_b64_tr_b16 a[154:155], v27 offset:34816
    v_exp_f32 v252, v252
    v_mfma_f32_16x16x32_bf16 v[120:123], a[164:167], v[232:235], v[120:123]
    ds_read_b64_tr_b16 a[156:157], v28 offset:32768
    v_exp_f32 v253, v253
    v_mul_f32 v254, v70, v78
    v_mul_f32 v255, v71, v79
    v_mfma_f32_16x16x32_bf16 v[124:127], a[164:167], v[236:239], v[124:127]
    ds_read_b64_tr_b16 a[158:159], v28 offset:34816
    v_fma_f32 v252, v252, v15, v15
    v_fma_f32 v253, v253, v15, v15
    s_waitcnt lgkmcnt(8)
    v_mfma_f32_16x16x32_bf16 v[128:131], a[168:171], v[232:235], v[128:131]
    ds_read_b64_tr_b16 a[160:161], v29 offset:0
    v_rcp_f32 v252, v252
    v_rcp_f32 v253, v253
    v_mfma_f32_16x16x32_bf16 v[132:135], a[168:171], v[236:239], v[132:135]
    ds_read_b64_tr_b16 a[162:163], v29 offset:2048
    v_mul_f32 v254, v254, v252
    v_mul_f32 v255, v255, v253
    v_cvt_pk_bf16_f32 v247, v254, v255
    v_mfma_f32_16x16x32_bf16 v[136:139], a[172:175], v[232:235], v[136:139]
    ds_read_b64_tr_b16 a[164:165], v30 offset:0
    v_mfma_f32_16x16x32_bf16 v[140:143], a[172:175], v[236:239], v[140:143]
    ds_read_b64_tr_b16 a[166:167], v30 offset:2048
    s_waitcnt lgkmcnt(8)
    v_mfma_f32_16x16x32_bf16 v[112:115], a[144:147], v[240:243], v[112:115]
    ds_read_b64_tr_b16 a[168:169], v31 offset:0
    v_mfma_f32_16x16x32_bf16 v[116:119], a[144:147], v[244:247], v[116:119]
    ds_read_b64_tr_b16 a[170:171], v31 offset:2048
    v_mfma_f32_16x16x32_bf16 v[120:123], a[148:151], v[240:243], v[120:123]
    ds_read_b64_tr_b16 a[172:173], v32 offset:0
    v_mfma_f32_16x16x32_bf16 v[124:127], a[148:151], v[244:247], v[124:127]
    ds_read_b64_tr_b16 a[174:175], v32 offset:2048
    s_waitcnt lgkmcnt(8)
    v_mfma_f32_16x16x32_bf16 v[128:131], a[152:155], v[240:243], v[128:131]
    ds_read_b64_tr_b16 a[144:145], v29 offset:4096
    v_mfma_f32_16x16x32_bf16 v[132:135], a[152:155], v[244:247], v[132:135]
    ds_read_b64_tr_b16 a[146:147], v29 offset:6144
    v_mfma_f32_16x16x32_bf16 v[136:139], a[156:159], v[240:243], v[136:139]
    ds_read_b64_tr_b16 a[148:149], v30 offset:4096
    v_mfma_f32_16x16x32_bf16 v[140:143], a[156:159], v[244:247], v[140:143]
    ds_read_b64_tr_b16 a[150:151], v30 offset:6144
    s_waitcnt vmcnt(9)
    s_barrier
    s_waitcnt lgkmcnt(8)
    v_mfma_f32_16x16x32_bf16 v[144:147], a[160:163], v[176:179], 0
    ds_read_b64_tr_b16 a[152:153], v31 offset:4096
    v_mfma_f32_16x16x32_bf16 v[148:151], a[160:163], v[180:183], 0
    ds_read_b64_tr_b16 a[154:155], v31 offset:6144
    s_add_u32 m0, s27, 73728
    s_add_u32 s32, s50, 512
    buffer_load_dwordx4 v7, s[12:15], s32 offen lds
    v_mfma_f32_16x16x32_bf16 v[152:155], a[164:167], v[176:179], 0
    ds_read_b64_tr_b16 a[156:157], v32 offset:4096
    v_mfma_f32_16x16x32_bf16 v[156:159], a[164:167], v[180:183], 0
    ds_read_b64_tr_b16 a[158:159], v32 offset:6144
    s_waitcnt lgkmcnt(8)
    v_mfma_f32_16x16x32_bf16 v[160:163], a[168:171], v[176:179], 0
    ds_read_b64_tr_b16 a[160:161], v29 offset:8192
    buffer_load_dwordx4 v8, s[12:15], s32 offen offset:1024 lds
    v_mfma_f32_16x16x32_bf16 v[164:167], a[168:171], v[180:183], 0
    ds_read_b64_tr_b16 a[162:163], v29 offset:10240
    v_mfma_f32_16x16x32_bf16 v[168:171], a[172:175], v[176:179], 0
    ds_read_b64_tr_b16 a[164:165], v30 offset:8192
    v_mfma_f32_16x16x32_bf16 v[172:175], a[172:175], v[180:183], 0
    ds_read_b64_tr_b16 a[166:167], v30 offset:10240
    buffer_load_dwordx4 v9, s[12:15], s32 offen offset:2048 lds
    s_cmp_eq_u32 s21, 0
    s_cbranch_scc1 Lk3_kernel_res0
Lk3_kernel_resb0:
    s_waitcnt lgkmcnt(8)
    v_mfma_f32_16x16x32_bf16 v[144:147], a[144:147], v[184:187], v[144:147]
    ds_read_b64_tr_b16 a[168:169], v31 offset:8192
    v_mfma_f32_16x16x32_bf16 v[148:151], a[144:147], v[188:191], v[148:151]
    ds_read_b64_tr_b16 a[170:171], v31 offset:10240
    v_cvt_pk_bf16_f32 v48, v112, v113
    v_mfma_f32_16x16x32_bf16 v[152:155], a[148:151], v[184:187], v[152:155]
    ds_read_b64_tr_b16 a[172:173], v32 offset:8192
    s_add_u32 m0, s27, 86016
    s_add_u32 s32, s51, 512
    buffer_load_dwordx4 v7, s[12:15], s32 offen lds
    v_cvt_pk_bf16_f32 v49, v114, v115
    v_mfma_f32_16x16x32_bf16 v[156:159], a[148:151], v[188:191], v[156:159]
    ds_read_b64_tr_b16 a[174:175], v32 offset:10240
    s_waitcnt lgkmcnt(8)
    v_mfma_f32_16x16x32_bf16 v[160:163], a[152:155], v[184:187], v[160:163]
    ds_read_b64_tr_b16 a[144:145], v29 offset:12288
    v_cvt_pk_bf16_f32 v50, v120, v121
    v_mfma_f32_16x16x32_bf16 v[164:167], a[152:155], v[188:191], v[164:167]
    ds_read_b64_tr_b16 a[146:147], v29 offset:14336
    buffer_load_dwordx4 v8, s[12:15], s32 offen offset:1024 lds
    v_cvt_pk_bf16_f32 v51, v122, v123
    v_mfma_f32_16x16x32_bf16 v[168:171], a[156:159], v[184:187], v[168:171]
    ds_read_b64_tr_b16 a[148:149], v30 offset:12288
    v_mfma_f32_16x16x32_bf16 v[172:175], a[156:159], v[188:191], v[172:175]
    ds_read_b64_tr_b16 a[150:151], v30 offset:14336
    s_nop 1
    s_waitcnt lgkmcnt(8)
    v_mfma_f32_16x16x32_bf16 v[144:147], a[160:163], v[192:195], v[144:147]
    ds_read_b64_tr_b16 a[152:153], v31 offset:12288
    buffer_load_dwordx4 v9, s[12:15], s32 offen offset:2048 lds
    v_permlane16_swap_b32 v48, v50
    v_mfma_f32_16x16x32_bf16 v[148:151], a[160:163], v[196:199], v[148:151]
    ds_read_b64_tr_b16 a[154:155], v31 offset:14336
    v_mfma_f32_16x16x32_bf16 v[152:155], a[164:167], v[192:195], v[152:155]
    ds_read_b64_tr_b16 a[156:157], v32 offset:12288
    v_permlane16_swap_b32 v49, v51
    v_mfma_f32_16x16x32_bf16 v[156:159], a[164:167], v[196:199], v[156:159]
    ds_read_b64_tr_b16 a[158:159], v32 offset:14336
    s_add_u32 m0, s27, 98304
    s_add_u32 s32, s52, 512
    buffer_load_dwordx4 v7, s[12:15], s32 offen lds
    s_add_u32 s36, s33, 0
    s_waitcnt lgkmcnt(8)
    v_mfma_f32_16x16x32_bf16 v[160:163], a[168:171], v[192:195], v[160:163]
    ds_read_b64_tr_b16 a[160:161], v29 offset:16384
    v_mfma_f32_16x16x32_bf16 v[164:167], a[168:171], v[196:199], v[164:167]
    ds_read_b64_tr_b16 a[162:163], v29 offset:18432
    buffer_store_dwordx4 v[48:51], v16, s[16:19], s36 offen sc1
    v_mfma_f32_16x16x32_bf16 v[168:171], a[172:175], v[192:195], v[168:171]
    ds_read_b64_tr_b16 a[164:165], v30 offset:16384
    s_add_u32 s32, s53, 512
    s_nop 0
    buffer_load_dwordx4 v8, s[12:15], s32 offen offset:1024 lds
    v_cvt_pk_bf16_f32 v52, v116, v117
    v_mfma_f32_16x16x32_bf16 v[172:175], a[172:175], v[196:199], v[172:175]
    ds_read_b64_tr_b16 a[166:167], v30 offset:18432
    s_waitcnt lgkmcnt(8)
    v_mfma_f32_16x16x32_bf16 v[144:147], a[144:147], v[200:203], v[144:147]
    ds_read_b64_tr_b16 a[168:169], v31 offset:16384
    v_cvt_pk_bf16_f32 v53, v118, v119
    v_mfma_f32_16x16x32_bf16 v[148:151], a[144:147], v[204:207], v[148:151]
    ds_read_b64_tr_b16 a[170:171], v31 offset:18432
    s_add_u32 s32, s54, 512
    s_nop 0
    buffer_load_dwordx4 v9, s[12:15], s32 offen offset:2048 lds
    v_cvt_pk_bf16_f32 v54, v124, v125
    v_mfma_f32_16x16x32_bf16 v[152:155], a[148:151], v[200:203], v[152:155]
    ds_read_b64_tr_b16 a[172:173], v32 offset:16384
    v_mfma_f32_16x16x32_bf16 v[156:159], a[148:151], v[204:207], v[156:159]
    ds_read_b64_tr_b16 a[174:175], v32 offset:18432
    v_cvt_pk_bf16_f32 v55, v126, v127
    s_waitcnt lgkmcnt(8)
    v_mfma_f32_16x16x32_bf16 v[160:163], a[152:155], v[200:203], v[160:163]
    ds_read_b64_tr_b16 a[144:145], v29 offset:20480
    s_nop 1
    v_mfma_f32_16x16x32_bf16 v[164:167], a[152:155], v[204:207], v[164:167]
    ds_read_b64_tr_b16 a[146:147], v29 offset:22528
    v_mfma_f32_16x16x32_bf16 v[168:171], a[156:159], v[200:203], v[168:171]
    ds_read_b64_tr_b16 a[148:149], v30 offset:20480
    v_permlane16_swap_b32 v52, v54
    v_mfma_f32_16x16x32_bf16 v[172:175], a[156:159], v[204:207], v[172:175]
    ds_read_b64_tr_b16 a[150:151], v30 offset:22528
    v_permlane16_swap_b32 v53, v55
    s_waitcnt lgkmcnt(8)
    v_mfma_f32_16x16x32_bf16 v[144:147], a[160:163], v[208:211], v[144:147]
    ds_read_b64_tr_b16 a[152:153], v31 offset:20480
    v_mfma_f32_16x16x32_bf16 v[148:151], a[160:163], v[212:215], v[148:151]
    ds_read_b64_tr_b16 a[154:155], v31 offset:22528
    s_add_u32 s36, s33, 1024
    v_mfma_f32_16x16x32_bf16 v[152:155], a[164:167], v[208:211], v[152:155]
    ds_read_b64_tr_b16 a[156:157], v32 offset:20480
    buffer_store_dwordx4 v[52:55], v16, s[16:19], s36 offen sc1
    v_mfma_f32_16x16x32_bf16 v[156:159], a[164:167], v[212:215], v[156:159]
    ds_read_b64_tr_b16 a[158:159], v32 offset:22528
    s_waitcnt lgkmcnt(8)
    v_mfma_f32_16x16x32_bf16 v[160:163], a[168:171], v[208:211], v[160:163]
    ds_read_b64_tr_b16 a[160:161], v29 offset:24576
    v_cvt_pk_bf16_f32 v56, v128, v129
    v_mfma_f32_16x16x32_bf16 v[164:167], a[168:171], v[212:215], v[164:167]
    ds_read_b64_tr_b16 a[162:163], v29 offset:26624
    v_cvt_pk_bf16_f32 v57, v130, v131
    v_mfma_f32_16x16x32_bf16 v[168:171], a[172:175], v[208:211], v[168:171]
    ds_read_b64_tr_b16 a[164:165], v30 offset:24576
    v_mfma_f32_16x16x32_bf16 v[172:175], a[172:175], v[212:215], v[172:175]
    ds_read_b64_tr_b16 a[166:167], v30 offset:26624
    v_cvt_pk_bf16_f32 v58, v136, v137
    s_waitcnt lgkmcnt(8)
    v_mfma_f32_16x16x32_bf16 v[144:147], a[144:147], v[216:219], v[144:147]
    ds_read_b64_tr_b16 a[168:169], v31 offset:24576
    v_cvt_pk_bf16_f32 v59, v138, v139
    v_mfma_f32_16x16x32_bf16 v[148:151], a[144:147], v[220:223], v[148:151]
    ds_read_b64_tr_b16 a[170:171], v31 offset:26624
    v_mfma_f32_16x16x32_bf16 v[152:155], a[148:151], v[216:219], v[152:155]
    ds_read_b64_tr_b16 a[172:173], v32 offset:24576
    s_nop 1
    v_mfma_f32_16x16x32_bf16 v[156:159], a[148:151], v[220:223], v[156:159]
    ds_read_b64_tr_b16 a[174:175], v32 offset:26624
    v_permlane16_swap_b32 v56, v58
    s_waitcnt lgkmcnt(8)
    v_mfma_f32_16x16x32_bf16 v[160:163], a[152:155], v[216:219], v[160:163]
    ds_read_b64_tr_b16 a[144:145], v29 offset:28672
    v_mfma_f32_16x16x32_bf16 v[164:167], a[152:155], v[220:223], v[164:167]
    ds_read_b64_tr_b16 a[146:147], v29 offset:30720
    v_permlane16_swap_b32 v57, v59
    v_mfma_f32_16x16x32_bf16 v[168:171], a[156:159], v[216:219], v[168:171]
    ds_read_b64_tr_b16 a[148:149], v30 offset:28672
    s_add_u32 s36, s33, 2048
    v_mfma_f32_16x16x32_bf16 v[172:175], a[156:159], v[220:223], v[172:175]
    ds_read_b64_tr_b16 a[150:151], v30 offset:30720
    s_waitcnt lgkmcnt(8)
    v_mfma_f32_16x16x32_bf16 v[144:147], a[160:163], v[224:227], v[144:147]
    ds_read_b64_tr_b16 a[152:153], v31 offset:28672
    buffer_store_dwordx4 v[56:59], v16, s[16:19], s36 offen sc1
    v_mfma_f32_16x16x32_bf16 v[148:151], a[160:163], v[228:231], v[148:151]
    ds_read_b64_tr_b16 a[154:155], v31 offset:30720
    v_cvt_pk_bf16_f32 v60, v132, v133
    v_mfma_f32_16x16x32_bf16 v[152:155], a[164:167], v[224:227], v[152:155]
    ds_read_b64_tr_b16 a[156:157], v32 offset:28672
    v_mfma_f32_16x16x32_bf16 v[156:159], a[164:167], v[228:231], v[156:159]
    ds_read_b64_tr_b16 a[158:159], v32 offset:30720
    v_cvt_pk_bf16_f32 v61, v134, v135
    s_waitcnt lgkmcnt(8)
    v_mfma_f32_16x16x32_bf16 v[160:163], a[168:171], v[224:227], v[160:163]
    ds_read_b64_tr_b16 a[160:161], v29 offset:32768
    v_cvt_pk_bf16_f32 v62, v140, v141
    v_mfma_f32_16x16x32_bf16 v[164:167], a[168:171], v[228:231], v[164:167]
    ds_read_b64_tr_b16 a[162:163], v29 offset:34816
    v_mfma_f32_16x16x32_bf16 v[168:171], a[172:175], v[224:227], v[168:171]
    ds_read_b64_tr_b16 a[164:165], v30 offset:32768
    v_cvt_pk_bf16_f32 v63, v142, v143
    v_mfma_f32_16x16x32_bf16 v[172:175], a[172:175], v[228:231], v[172:175]
    ds_read_b64_tr_b16 a[166:167], v30 offset:34816
    s_nop 1
    s_waitcnt lgkmcnt(8)
    v_mfma_f32_16x16x32_bf16 v[144:147], a[144:147], v[232:235], v[144:147]
    ds_read_b64_tr_b16 a[168:169], v31 offset:32768
    v_mfma_f32_16x16x32_bf16 v[148:151], a[144:147], v[236:239], v[148:151]
    ds_read_b64_tr_b16 a[170:171], v31 offset:34816
    v_permlane16_swap_b32 v60, v62
    v_mfma_f32_16x16x32_bf16 v[152:155], a[148:151], v[232:235], v[152:155]
    ds_read_b64_tr_b16 a[172:173], v32 offset:32768
    v_permlane16_swap_b32 v61, v63
    v_mfma_f32_16x16x32_bf16 v[156:159], a[148:151], v[236:239], v[156:159]
    ds_read_b64_tr_b16 a[174:175], v32 offset:34816
    s_waitcnt lgkmcnt(8)
    v_mfma_f32_16x16x32_bf16 v[160:163], a[152:155], v[232:235], v[160:163]
    ds_read_b64_tr_b16 a[144:145], v17 offset:0
    s_add_u32 s36, s33, 3072
    v_mfma_f32_16x16x32_bf16 v[164:167], a[152:155], v[236:239], v[164:167]
    ds_read_b64_tr_b16 a[146:147], v17 offset:2048
    buffer_store_dwordx4 v[60:63], v16, s[16:19], s36 offen sc1
    v_mfma_f32_16x16x32_bf16 v[168:171], a[156:159], v[232:235], v[168:171]
    ds_read_b64_tr_b16 a[148:149], v18 offset:0
    v_mfma_f32_16x16x32_bf16 v[172:175], a[156:159], v[236:239], v[172:175]
    ds_read_b64_tr_b16 a[150:151], v18 offset:2048
    s_waitcnt lgkmcnt(8)
    v_mfma_f32_16x16x32_bf16 v[144:147], a[160:163], v[240:243], v[144:147]
    ds_read_b64_tr_b16 a[152:153], v19 offset:0
    v_mfma_f32_16x16x32_bf16 v[148:151], a[160:163], v[244:247], v[148:151]
    ds_read_b64_tr_b16 a[154:155], v19 offset:2048
    v_mfma_f32_16x16x32_bf16 v[152:155], a[164:167], v[240:243], v[152:155]
    ds_read_b64_tr_b16 a[156:157], v20 offset:0
    v_mfma_f32_16x16x32_bf16 v[156:159], a[164:167], v[244:247], v[156:159]
    ds_read_b64_tr_b16 a[158:159], v20 offset:2048
    s_waitcnt lgkmcnt(8)
    v_mfma_f32_16x16x32_bf16 v[160:163], a[168:171], v[240:243], v[160:163]
    ds_read_b64_tr_b16 a[160:161], v17 offset:4096
    v_mfma_f32_16x16x32_bf16 v[164:167], a[168:171], v[244:247], v[164:167]
    ds_read_b64_tr_b16 a[162:163], v17 offset:6144
    v_mfma_f32_16x16x32_bf16 v[168:171], a[172:175], v[240:243], v[168:171]
    ds_read_b64_tr_b16 a[164:165], v18 offset:4096
    v_mfma_f32_16x16x32_bf16 v[172:175], a[172:175], v[244:247], v[172:175]
    ds_read_b64_tr_b16 a[166:167], v18 offset:6144
    s_waitcnt vmcnt(13)
    s_barrier
    s_waitcnt lgkmcnt(8)
    v_mfma_f32_16x16x32_bf16 v[112:115], a[144:147], v[176:179], 0
    ds_read_b64_tr_b16 a[168:169], v19 offset:4096
    v_mfma_f32_16x16x32_bf16 v[116:119], a[144:147], v[180:183], 0
    ds_read_b64_tr_b16 a[170:171], v19 offset:6144
    s_add_u32 m0, s27, 110592
    s_add_u32 s32, s50, 640
    buffer_load_dwordx4 v7, s[12:15], s32 offen lds
    v_mfma_f32_16x16x32_bf16 v[120:123], a[148:151], v[176:179], 0
    ds_read_b64_tr_b16 a[172:173], v20 offset:4096
    v_mfma_f32_16x16x32_bf16 v[124:127], a[148:151], v[180:183], 0
    ds_read_b64_tr_b16 a[174:175], v20 offset:6144
    s_waitcnt lgkmcnt(8)
    v_mfma_f32_16x16x32_bf16 v[128:131], a[152:155], v[176:179], 0
    ds_read_b64_tr_b16 a[144:145], v17 offset:8192
    buffer_load_dwordx4 v8, s[12:15], s32 offen offset:1024 lds
    v_mfma_f32_16x16x32_bf16 v[132:135], a[152:155], v[180:183], 0
    ds_read_b64_tr_b16 a[146:147], v17 offset:10240
    v_mfma_f32_16x16x32_bf16 v[136:139], a[156:159], v[176:179], 0
    ds_read_b64_tr_b16 a[148:149], v18 offset:8192
    v_mfma_f32_16x16x32_bf16 v[140:143], a[156:159], v[180:183], 0
    ds_read_b64_tr_b16 a[150:151], v18 offset:10240
    buffer_load_dwordx4 v9, s[12:15], s32 offen offset:2048 lds
    s_cmp_eq_u32 s21, 1
    s_cbranch_scc1 Lk3_kernel_res1
Lk3_kernel_resb1:
    s_waitcnt lgkmcnt(8)
    v_mfma_f32_16x16x32_bf16 v[112:115], a[160:163], v[184:187], v[112:115]
    ds_read_b64_tr_b16 a[152:153], v19 offset:8192
    v_mfma_f32_16x16x32_bf16 v[116:119], a[160:163], v[188:191], v[116:119]
    ds_read_b64_tr_b16 a[154:155], v19 offset:10240
    v_cvt_pk_bf16_f32 v48, v144, v145
    v_mfma_f32_16x16x32_bf16 v[120:123], a[164:167], v[184:187], v[120:123]
    ds_read_b64_tr_b16 a[156:157], v20 offset:8192
    s_add_u32 m0, s27, 122880
    s_add_u32 s32, s51, 640
    buffer_load_dwordx4 v7, s[12:15], s32 offen lds
    v_cvt_pk_bf16_f32 v49, v146, v147
    v_mfma_f32_16x16x32_bf16 v[124:127], a[164:167], v[188:191], v[124:127]
    ds_read_b64_tr_b16 a[158:159], v20 offset:10240
    s_waitcnt lgkmcnt(8)
    v_mfma_f32_16x16x32_bf16 v[128:131], a[168:171], v[184:187], v[128:131]
    ds_read_b64_tr_b16 a[160:161], v17 offset:12288
    v_cvt_pk_bf16_f32 v50, v152, v153
    v_mfma_f32_16x16x32_bf16 v[132:135], a[168:171], v[188:191], v[132:135]
    ds_read_b64_tr_b16 a[162:163], v17 offset:14336
    buffer_load_dwordx4 v8, s[12:15], s32 offen offset:1024 lds
    v_cvt_pk_bf16_f32 v51, v154, v155
    v_mfma_f32_16x16x32_bf16 v[136:139], a[172:175], v[184:187], v[136:139]
    ds_read_b64_tr_b16 a[164:165], v18 offset:12288
    v_mfma_f32_16x16x32_bf16 v[140:143], a[172:175], v[188:191], v[140:143]
    ds_read_b64_tr_b16 a[166:167], v18 offset:14336
    s_nop 1
    s_waitcnt lgkmcnt(8)
    v_mfma_f32_16x16x32_bf16 v[112:115], a[144:147], v[192:195], v[112:115]
    ds_read_b64_tr_b16 a[168:169], v19 offset:12288
    buffer_load_dwordx4 v9, s[12:15], s32 offen offset:2048 lds
    v_permlane16_swap_b32 v48, v50
    v_mfma_f32_16x16x32_bf16 v[116:119], a[144:147], v[196:199], v[116:119]
    ds_read_b64_tr_b16 a[170:171], v19 offset:14336
    v_mfma_f32_16x16x32_bf16 v[120:123], a[148:151], v[192:195], v[120:123]
    ds_read_b64_tr_b16 a[172:173], v20 offset:12288
    v_permlane16_swap_b32 v49, v51
    v_mfma_f32_16x16x32_bf16 v[124:127], a[148:151], v[196:199], v[124:127]
    ds_read_b64_tr_b16 a[174:175], v20 offset:14336
    s_add_u32 m0, s27, 135168
    s_add_u32 s32, s52, 640
    buffer_load_dwordx4 v7, s[12:15], s32 offen lds
    s_add_u32 s36, s33, 4096
    s_waitcnt lgkmcnt(8)
    v_mfma_f32_16x16x32_bf16 v[128:131], a[152:155], v[192:195], v[128:131]
    ds_read_b64_tr_b16 a[144:145], v17 offset:16384
    v_mfma_f32_16x16x32_bf16 v[132:135], a[152:155], v[196:199], v[132:135]
    ds_read_b64_tr_b16 a[146:147], v17 offset:18432
    buffer_store_dwordx4 v[48:51], v16, s[16:19], s36 offen sc1
    v_mfma_f32_16x16x32_bf16 v[136:139], a[156:159], v[192:195], v[136:139]
    ds_read_b64_tr_b16 a[148:149], v18 offset:16384
    s_add_u32 s32, s53, 640
    s_nop 0
    buffer_load_dwordx4 v8, s[12:15], s32 offen offset:1024 lds
    v_cvt_pk_bf16_f32 v52, v148, v149
    v_mfma_f32_16x16x32_bf16 v[140:143], a[156:159], v[196:199], v[140:143]
    ds_read_b64_tr_b16 a[150:151], v18 offset:18432
    s_waitcnt lgkmcnt(8)
    v_mfma_f32_16x16x32_bf16 v[112:115], a[160:163], v[200:203], v[112:115]
    ds_read_b64_tr_b16 a[152:153], v19 offset:16384
    v_cvt_pk_bf16_f32 v53, v150, v151
    v_mfma_f32_16x16x32_bf16 v[116:119], a[160:163], v[204:207], v[116:119]
    ds_read_b64_tr_b16 a[154:155], v19 offset:18432
    s_add_u32 s32, s54, 640
    s_nop 0
    buffer_load_dwordx4 v9, s[12:15], s32 offen offset:2048 lds
    v_cvt_pk_bf16_f32 v54, v156, v157
    v_mfma_f32_16x16x32_bf16 v[120:123], a[164:167], v[200:203], v[120:123]
    ds_read_b64_tr_b16 a[156:157], v20 offset:16384
    v_mfma_f32_16x16x32_bf16 v[124:127], a[164:167], v[204:207], v[124:127]
    ds_read_b64_tr_b16 a[158:159], v20 offset:18432
    v_cvt_pk_bf16_f32 v55, v158, v159
    s_waitcnt lgkmcnt(8)
    v_mfma_f32_16x16x32_bf16 v[128:131], a[168:171], v[200:203], v[128:131]
    ds_read_b64_tr_b16 a[160:161], v17 offset:20480
    s_nop 1
    v_mfma_f32_16x16x32_bf16 v[132:135], a[168:171], v[204:207], v[132:135]
    ds_read_b64_tr_b16 a[162:163], v17 offset:22528
    v_mfma_f32_16x16x32_bf16 v[136:139], a[172:175], v[200:203], v[136:139]
    ds_read_b64_tr_b16 a[164:165], v18 offset:20480
    v_permlane16_swap_b32 v52, v54
    v_mfma_f32_16x16x32_bf16 v[140:143], a[172:175], v[204:207], v[140:143]
    ds_read_b64_tr_b16 a[166:167], v18 offset:22528
    v_permlane16_swap_b32 v53, v55
    s_waitcnt lgkmcnt(8)
    v_mfma_f32_16x16x32_bf16 v[112:115], a[144:147], v[208:211], v[112:115]
    ds_read_b64_tr_b16 a[168:169], v19 offset:20480
    v_mfma_f32_16x16x32_bf16 v[116:119], a[144:147], v[212:215], v[116:119]
    ds_read_b64_tr_b16 a[170:171], v19 offset:22528
    s_add_u32 s36, s33, 5120
    v_mfma_f32_16x16x32_bf16 v[120:123], a[148:151], v[208:211], v[120:123]
    ds_read_b64_tr_b16 a[172:173], v20 offset:20480
    buffer_store_dwordx4 v[52:55], v16, s[16:19], s36 offen sc1
    v_mfma_f32_16x16x32_bf16 v[124:127], a[148:151], v[212:215], v[124:127]
    ds_read_b64_tr_b16 a[174:175], v20 offset:22528
    s_waitcnt lgkmcnt(8)
    v_mfma_f32_16x16x32_bf16 v[128:131], a[152:155], v[208:211], v[128:131]
    ds_read_b64_tr_b16 a[144:145], v17 offset:24576
    v_cvt_pk_bf16_f32 v56, v160, v161
    v_mfma_f32_16x16x32_bf16 v[132:135], a[152:155], v[212:215], v[132:135]
    ds_read_b64_tr_b16 a[146:147], v17 offset:26624
    v_cvt_pk_bf16_f32 v57, v162, v163
    v_mfma_f32_16x16x32_bf16 v[136:139], a[156:159], v[208:211], v[136:139]
    ds_read_b64_tr_b16 a[148:149], v18 offset:24576
    v_mfma_f32_16x16x32_bf16 v[140:143], a[156:159], v[212:215], v[140:143]
    ds_read_b64_tr_b16 a[150:151], v18 offset:26624
    v_cvt_pk_bf16_f32 v58, v168, v169
    s_waitcnt lgkmcnt(8)
    v_mfma_f32_16x16x32_bf16 v[112:115], a[160:163], v[216:219], v[112:115]
    ds_read_b64_tr_b16 a[152:153], v19 offset:24576
    v_cvt_pk_bf16_f32 v59, v170, v171
    v_mfma_f32_16x16x32_bf16 v[116:119], a[160:163], v[220:223], v[116:119]
    ds_read_b64_tr_b16 a[154:155], v19 offset:26624
    v_mfma_f32_16x16x32_bf16 v[120:123], a[164:167], v[216:219], v[120:123]
    ds_read_b64_tr_b16 a[156:157], v20 offset:24576
    s_nop 1
    v_mfma_f32_16x16x32_bf16 v[124:127], a[164:167], v[220:223], v[124:127]
    ds_read_b64_tr_b16 a[158:159], v20 offset:26624
    v_permlane16_swap_b32 v56, v58
    s_waitcnt lgkmcnt(8)
    v_mfma_f32_16x16x32_bf16 v[128:131], a[168:171], v[216:219], v[128:131]
    ds_read_b64_tr_b16 a[160:161], v17 offset:28672
    v_mfma_f32_16x16x32_bf16 v[132:135], a[168:171], v[220:223], v[132:135]
    ds_read_b64_tr_b16 a[162:163], v17 offset:30720
    v_permlane16_swap_b32 v57, v59
    v_mfma_f32_16x16x32_bf16 v[136:139], a[172:175], v[216:219], v[136:139]
    ds_read_b64_tr_b16 a[164:165], v18 offset:28672
    s_add_u32 s36, s33, 6144
    v_mfma_f32_16x16x32_bf16 v[140:143], a[172:175], v[220:223], v[140:143]
    ds_read_b64_tr_b16 a[166:167], v18 offset:30720
    s_waitcnt lgkmcnt(8)
    v_mfma_f32_16x16x32_bf16 v[112:115], a[144:147], v[224:227], v[112:115]
    ds_read_b64_tr_b16 a[168:169], v19 offset:28672
    buffer_store_dwordx4 v[56:59], v16, s[16:19], s36 offen sc1
    v_mfma_f32_16x16x32_bf16 v[116:119], a[144:147], v[228:231], v[116:119]
    ds_read_b64_tr_b16 a[170:171], v19 offset:30720
    v_cvt_pk_bf16_f32 v60, v164, v165
    v_mfma_f32_16x16x32_bf16 v[120:123], a[148:151], v[224:227], v[120:123]
    ds_read_b64_tr_b16 a[172:173], v20 offset:28672
    v_mfma_f32_16x16x32_bf16 v[124:127], a[148:151], v[228:231], v[124:127]
    ds_read_b64_tr_b16 a[174:175], v20 offset:30720
    v_cvt_pk_bf16_f32 v61, v166, v167
    s_waitcnt lgkmcnt(8)
    v_mfma_f32_16x16x32_bf16 v[128:131], a[152:155], v[224:227], v[128:131]
    ds_read_b64_tr_b16 a[144:145], v17 offset:32768
    v_cvt_pk_bf16_f32 v62, v172, v173
    v_mfma_f32_16x16x32_bf16 v[132:135], a[152:155], v[228:231], v[132:135]
    ds_read_b64_tr_b16 a[146:147], v17 offset:34816
    v_mfma_f32_16x16x32_bf16 v[136:139], a[156:159], v[224:227], v[136:139]
    ds_read_b64_tr_b16 a[148:149], v18 offset:32768
    v_cvt_pk_bf16_f32 v63, v174, v175
    v_mfma_f32_16x16x32_bf16 v[140:143], a[156:159], v[228:231], v[140:143]
    ds_read_b64_tr_b16 a[150:151], v18 offset:34816
    s_nop 1
    s_waitcnt lgkmcnt(8)
    v_mfma_f32_16x16x32_bf16 v[112:115], a[160:163], v[232:235], v[112:115]
    ds_read_b64_tr_b16 a[152:153], v19 offset:32768
    v_mfma_f32_16x16x32_bf16 v[116:119], a[160:163], v[236:239], v[116:119]
    ds_read_b64_tr_b16 a[154:155], v19 offset:34816
    v_permlane16_swap_b32 v60, v62
    v_mfma_f32_16x16x32_bf16 v[120:123], a[164:167], v[232:235], v[120:123]
    ds_read_b64_tr_b16 a[156:157], v20 offset:32768
    v_permlane16_swap_b32 v61, v63
    v_mfma_f32_16x16x32_bf16 v[124:127], a[164:167], v[236:239], v[124:127]
    ds_read_b64_tr_b16 a[158:159], v20 offset:34816
    s_waitcnt lgkmcnt(8)
    v_mfma_f32_16x16x32_bf16 v[128:131], a[168:171], v[232:235], v[128:131]
    ds_read_b64_tr_b16 a[160:161], v21 offset:0
    s_add_u32 s36, s33, 7168
    v_mfma_f32_16x16x32_bf16 v[132:135], a[168:171], v[236:239], v[132:135]
    ds_read_b64_tr_b16 a[162:163], v21 offset:2048
    buffer_store_dwordx4 v[60:63], v16, s[16:19], s36 offen sc1
    v_mfma_f32_16x16x32_bf16 v[136:139], a[172:175], v[232:235], v[136:139]
    ds_read_b64_tr_b16 a[164:165], v22 offset:0
    v_mfma_f32_16x16x32_bf16 v[140:143], a[172:175], v[236:239], v[140:143]
    ds_read_b64_tr_b16 a[166:167], v22 offset:2048
    s_waitcnt lgkmcnt(8)
    v_mfma_f32_16x16x32_bf16 v[112:115], a[144:147], v[240:243], v[112:115]
    ds_read_b64_tr_b16 a[168:169], v23 offset:0
    v_mfma_f32_16x16x32_bf16 v[116:119], a[144:147], v[244:247], v[116:119]
    ds_read_b64_tr_b16 a[170:171], v23 offset:2048
    v_mfma_f32_16x16x32_bf16 v[120:123], a[148:151], v[240:243], v[120:123]
    ds_read_b64_tr_b16 a[172:173], v24 offset:0
    v_mfma_f32_16x16x32_bf16 v[124:127], a[148:151], v[244:247], v[124:127]
    ds_read_b64_tr_b16 a[174:175], v24 offset:2048
    s_waitcnt lgkmcnt(8)
    v_mfma_f32_16x16x32_bf16 v[128:131], a[152:155], v[240:243], v[128:131]
    ds_read_b64_tr_b16 a[144:145], v21 offset:4096
    v_mfma_f32_16x16x32_bf16 v[132:135], a[152:155], v[244:247], v[132:135]
    ds_read_b64_tr_b16 a[146:147], v21 offset:6144
    v_mfma_f32_16x16x32_bf16 v[136:139], a[156:159], v[240:243], v[136:139]
    ds_read_b64_tr_b16 a[148:149], v22 offset:4096
    v_mfma_f32_16x16x32_bf16 v[140:143], a[156:159], v[244:247], v[140:143]
    ds_read_b64_tr_b16 a[150:151], v22 offset:6144
    s_waitcnt vmcnt(16)
    s_barrier
    s_waitcnt lgkmcnt(8)
    v_mfma_f32_16x16x32_bf16 v[144:147], a[160:163], v[176:179], 0
    ds_read_b64_tr_b16 a[152:153], v23 offset:4096
    v_mfma_f32_16x16x32_bf16 v[148:151], a[160:163], v[180:183], 0
    ds_read_b64_tr_b16 a[154:155], v23 offset:6144
    s_add_u32 m0, s27, 0
    s_add_u32 s32, s50, 768
    buffer_load_dwordx4 v7, s[12:15], s32 offen lds
    v_mfma_f32_16x16x32_bf16 v[152:155], a[164:167], v[176:179], 0
    ds_read_b64_tr_b16 a[156:157], v24 offset:4096
    v_mfma_f32_16x16x32_bf16 v[156:159], a[164:167], v[180:183], 0
    ds_read_b64_tr_b16 a[158:159], v24 offset:6144
    s_waitcnt lgkmcnt(8)
    v_mfma_f32_16x16x32_bf16 v[160:163], a[168:171], v[176:179], 0
    ds_read_b64_tr_b16 a[160:161], v21 offset:8192
    buffer_load_dwordx4 v8, s[12:15], s32 offen offset:1024 lds
    v_mfma_f32_16x16x32_bf16 v[164:167], a[168:171], v[180:183], 0
    ds_read_b64_tr_b16 a[162:163], v21 offset:10240
    v_mfma_f32_16x16x32_bf16 v[168:171], a[172:175], v[176:179], 0
    ds_read_b64_tr_b16 a[164:165], v22 offset:8192
    v_mfma_f32_16x16x32_bf16 v[172:175], a[172:175], v[180:183], 0
    ds_read_b64_tr_b16 a[166:167], v22 offset:10240
    buffer_load_dwordx4 v9, s[12:15], s32 offen offset:2048 lds
    s_cmp_eq_u32 s21, 2
    s_cbranch_scc1 Lk3_kernel_res2
Lk3_kernel_resb2:
    s_waitcnt lgkmcnt(8)
    v_mfma_f32_16x16x32_bf16 v[144:147], a[144:147], v[184:187], v[144:147]
    ds_read_b64_tr_b16 a[168:169], v23 offset:8192
    v_mfma_f32_16x16x32_bf16 v[148:151], a[144:147], v[188:191], v[148:151]
    ds_read_b64_tr_b16 a[170:171], v23 offset:10240
    v_cvt_pk_bf16_f32 v48, v112, v113
    v_mfma_f32_16x16x32_bf16 v[152:155], a[148:151], v[184:187], v[152:155]
    ds_read_b64_tr_b16 a[172:173], v24 offset:8192
    s_add_u32 m0, s27, 12288
    s_add_u32 s32, s51, 768
    buffer_load_dwordx4 v7, s[12:15], s32 offen lds
    v_cvt_pk_bf16_f32 v49, v114, v115
    v_mfma_f32_16x16x32_bf16 v[156:159], a[148:151], v[188:191], v[156:159]
    ds_read_b64_tr_b16 a[174:175], v24 offset:10240
    s_waitcnt lgkmcnt(8)
    v_mfma_f32_16x16x32_bf16 v[160:163], a[152:155], v[184:187], v[160:163]
    ds_read_b64_tr_b16 a[144:145], v21 offset:12288
    v_cvt_pk_bf16_f32 v50, v120, v121
    v_mfma_f32_16x16x32_bf16 v[164:167], a[152:155], v[188:191], v[164:167]
    ds_read_b64_tr_b16 a[146:147], v21 offset:14336
    buffer_load_dwordx4 v8, s[12:15], s32 offen offset:1024 lds
    v_cvt_pk_bf16_f32 v51, v122, v123
    v_mfma_f32_16x16x32_bf16 v[168:171], a[156:159], v[184:187], v[168:171]
    ds_read_b64_tr_b16 a[148:149], v22 offset:12288
    v_mfma_f32_16x16x32_bf16 v[172:175], a[156:159], v[188:191], v[172:175]
    ds_read_b64_tr_b16 a[150:151], v22 offset:14336
    s_nop 1
    s_waitcnt lgkmcnt(8)
    v_mfma_f32_16x16x32_bf16 v[144:147], a[160:163], v[192:195], v[144:147]
    ds_read_b64_tr_b16 a[152:153], v23 offset:12288
    buffer_load_dwordx4 v9, s[12:15], s32 offen offset:2048 lds
    v_permlane16_swap_b32 v48, v50
    v_mfma_f32_16x16x32_bf16 v[148:151], a[160:163], v[196:199], v[148:151]
    ds_read_b64_tr_b16 a[154:155], v23 offset:14336
    v_mfma_f32_16x16x32_bf16 v[152:155], a[164:167], v[192:195], v[152:155]
    ds_read_b64_tr_b16 a[156:157], v24 offset:12288
    v_permlane16_swap_b32 v49, v51
    v_mfma_f32_16x16x32_bf16 v[156:159], a[164:167], v[196:199], v[156:159]
    ds_read_b64_tr_b16 a[158:159], v24 offset:14336
    s_add_u32 m0, s27, 24576
    s_add_u32 s32, s52, 768
    buffer_load_dwordx4 v7, s[12:15], s32 offen lds
    s_add_u32 s36, s33, 8192
    s_waitcnt lgkmcnt(8)
    v_mfma_f32_16x16x32_bf16 v[160:163], a[168:171], v[192:195], v[160:163]
    ds_read_b64_tr_b16 a[160:161], v21 offset:16384
    v_mfma_f32_16x16x32_bf16 v[164:167], a[168:171], v[196:199], v[164:167]
    ds_read_b64_tr_b16 a[162:163], v21 offset:18432
    buffer_store_dwordx4 v[48:51], v16, s[16:19], s36 offen sc1
    v_mfma_f32_16x16x32_bf16 v[168:171], a[172:175], v[192:195], v[168:171]
    ds_read_b64_tr_b16 a[164:165], v22 offset:16384
    s_add_u32 s32, s53, 768
    s_nop 0
    buffer_load_dwordx4 v8, s[12:15], s32 offen offset:1024 lds
    v_cvt_pk_bf16_f32 v52, v116, v117
    v_mfma_f32_16x16x32_bf16 v[172:175], a[172:175], v[196:199], v[172:175]
    ds_read_b64_tr_b16 a[166:167], v22 offset:18432
    s_waitcnt lgkmcnt(8)
    v_mfma_f32_16x16x32_bf16 v[144:147], a[144:147], v[200:203], v[144:147]
    ds_read_b64_tr_b16 a[168:169], v23 offset:16384
    v_cvt_pk_bf16_f32 v53, v118, v119
    v_mfma_f32_16x16x32_bf16 v[148:151], a[144:147], v[204:207], v[148:151]
    ds_read_b64_tr_b16 a[170:171], v23 offset:18432
    s_add_u32 s32, s54, 768
    s_nop 0
    buffer_load_dwordx4 v9, s[12:15], s32 offen offset:2048 lds
    v_cvt_pk_bf16_f32 v54, v124, v125
    v_mfma_f32_16x16x32_bf16 v[152:155], a[148:151], v[200:203], v[152:155]
    ds_read_b64_tr_b16 a[172:173], v24 offset:16384
    v_mfma_f32_16x16x32_bf16 v[156:159], a[148:151], v[204:207], v[156:159]
    ds_read_b64_tr_b16 a[174:175], v24 offset:18432
    v_cvt_pk_bf16_f32 v55, v126, v127
    s_waitcnt lgkmcnt(8)
    v_mfma_f32_16x16x32_bf16 v[160:163], a[152:155], v[200:203], v[160:163]
    ds_read_b64_tr_b16 a[144:145], v21 offset:20480
    s_nop 1
    v_mfma_f32_16x16x32_bf16 v[164:167], a[152:155], v[204:207], v[164:167]
    ds_read_b64_tr_b16 a[146:147], v21 offset:22528
    v_mfma_f32_16x16x32_bf16 v[168:171], a[156:159], v[200:203], v[168:171]
    ds_read_b64_tr_b16 a[148:149], v22 offset:20480
    v_permlane16_swap_b32 v52, v54
    v_mfma_f32_16x16x32_bf16 v[172:175], a[156:159], v[204:207], v[172:175]
    ds_read_b64_tr_b16 a[150:151], v22 offset:22528
    v_permlane16_swap_b32 v53, v55
    s_waitcnt lgkmcnt(8)
    v_mfma_f32_16x16x32_bf16 v[144:147], a[160:163], v[208:211], v[144:147]
    ds_read_b64_tr_b16 a[152:153], v23 offset:20480
    v_mfma_f32_16x16x32_bf16 v[148:151], a[160:163], v[212:215], v[148:151]
    ds_read_b64_tr_b16 a[154:155], v23 offset:22528
    s_add_u32 s36, s33, 9216
    v_mfma_f32_16x16x32_bf16 v[152:155], a[164:167], v[208:211], v[152:155]
    ds_read_b64_tr_b16 a[156:157], v24 offset:20480
    buffer_store_dwordx4 v[52:55], v16, s[16:19], s36 offen sc1
    v_mfma_f32_16x16x32_bf16 v[156:159], a[164:167], v[212:215], v[156:159]
    ds_read_b64_tr_b16 a[158:159], v24 offset:22528
    s_waitcnt lgkmcnt(8)
    v_mfma_f32_16x16x32_bf16 v[160:163], a[168:171], v[208:211], v[160:163]
    ds_read_b64_tr_b16 a[160:161], v21 offset:24576
    v_cvt_pk_bf16_f32 v56, v128, v129
    v_mfma_f32_16x16x32_bf16 v[164:167], a[168:171], v[212:215], v[164:167]
    ds_read_b64_tr_b16 a[162:163], v21 offset:26624
    v_cvt_pk_bf16_f32 v57, v130, v131
    v_mfma_f32_16x16x32_bf16 v[168:171], a[172:175], v[208:211], v[168:171]
    ds_read_b64_tr_b16 a[164:165], v22 offset:24576
    v_mfma_f32_16x16x32_bf16 v[172:175], a[172:175], v[212:215], v[172:175]
    ds_read_b64_tr_b16 a[166:167], v22 offset:26624
    v_cvt_pk_bf16_f32 v58, v136, v137
    s_waitcnt lgkmcnt(8)
    v_mfma_f32_16x16x32_bf16 v[144:147], a[144:147], v[216:219], v[144:147]
    ds_read_b64_tr_b16 a[168:169], v23 offset:24576
    v_cvt_pk_bf16_f32 v59, v138, v139
    v_mfma_f32_16x16x32_bf16 v[148:151], a[144:147], v[220:223], v[148:151]
    ds_read_b64_tr_b16 a[170:171], v23 offset:26624
    v_mfma_f32_16x16x32_bf16 v[152:155], a[148:151], v[216:219], v[152:155]
    ds_read_b64_tr_b16 a[172:173], v24 offset:24576
    s_nop 1
    v_mfma_f32_16x16x32_bf16 v[156:159], a[148:151], v[220:223], v[156:159]
    ds_read_b64_tr_b16 a[174:175], v24 offset:26624
    v_permlane16_swap_b32 v56, v58
    s_waitcnt lgkmcnt(8)
    v_mfma_f32_16x16x32_bf16 v[160:163], a[152:155], v[216:219], v[160:163]
    ds_read_b64_tr_b16 a[144:145], v21 offset:28672
    v_mfma_f32_16x16x32_bf16 v[164:167], a[152:155], v[220:223], v[164:167]
    ds_read_b64_tr_b16 a[146:147], v21 offset:30720
    v_permlane16_swap_b32 v57, v59
    v_mfma_f32_16x16x32_bf16 v[168:171], a[156:159], v[216:219], v[168:171]
    ds_read_b64_tr_b16 a[148:149], v22 offset:28672
    s_add_u32 s36, s33, 10240
    v_mfma_f32_16x16x32_bf16 v[172:175], a[156:159], v[220:223], v[172:175]
    ds_read_b64_tr_b16 a[150:151], v22 offset:30720
    s_waitcnt lgkmcnt(8)
    v_mfma_f32_16x16x32_bf16 v[144:147], a[160:163], v[224:227], v[144:147]
    ds_read_b64_tr_b16 a[152:153], v23 offset:28672
    buffer_store_dwordx4 v[56:59], v16, s[16:19], s36 offen sc1
    v_mfma_f32_16x16x32_bf16 v[148:151], a[160:163], v[228:231], v[148:151]
    ds_read_b64_tr_b16 a[154:155], v23 offset:30720
    v_cvt_pk_bf16_f32 v60, v132, v133
    v_mfma_f32_16x16x32_bf16 v[152:155], a[164:167], v[224:227], v[152:155]
    ds_read_b64_tr_b16 a[156:157], v24 offset:28672
    v_mfma_f32_16x16x32_bf16 v[156:159], a[164:167], v[228:231], v[156:159]
    ds_read_b64_tr_b16 a[158:159], v24 offset:30720
    v_cvt_pk_bf16_f32 v61, v134, v135
    s_waitcnt lgkmcnt(8)
    v_mfma_f32_16x16x32_bf16 v[160:163], a[168:171], v[224:227], v[160:163]
    ds_read_b64_tr_b16 a[160:161], v21 offset:32768
    v_cvt_pk_bf16_f32 v62, v140, v141
    v_mfma_f32_16x16x32_bf16 v[164:167], a[168:171], v[228:231], v[164:167]
    ds_read_b64_tr_b16 a[162:163], v21 offset:34816
    v_mfma_f32_16x16x32_bf16 v[168:171], a[172:175], v[224:227], v[168:171]
    ds_read_b64_tr_b16 a[164:165], v22 offset:32768
    v_cvt_pk_bf16_f32 v63, v142, v143
    v_mfma_f32_16x16x32_bf16 v[172:175], a[172:175], v[228:231], v[172:175]
    ds_read_b64_tr_b16 a[166:167], v22 offset:34816
    s_nop 1
    s_waitcnt lgkmcnt(8)
    v_mfma_f32_16x16x32_bf16 v[144:147], a[144:147], v[232:235], v[144:147]
    ds_read_b64_tr_b16 a[168:169], v23 offset:32768
    v_mfma_f32_16x16x32_bf16 v[148:151], a[144:147], v[236:239], v[148:151]
    ds_read_b64_tr_b16 a[170:171], v23 offset:34816
    v_permlane16_swap_b32 v60, v62
    v_mfma_f32_16x16x32_bf16 v[152:155], a[148:151], v[232:235], v[152:155]
    ds_read_b64_tr_b16 a[172:173], v24 offset:32768
    v_permlane16_swap_b32 v61, v63
    v_mfma_f32_16x16x32_bf16 v[156:159], a[148:151], v[236:239], v[156:159]
    ds_read_b64_tr_b16 a[174:175], v24 offset:34816
    s_waitcnt lgkmcnt(8)
    v_mfma_f32_16x16x32_bf16 v[160:163], a[152:155], v[232:235], v[160:163]
    ds_read_b64_tr_b16 a[144:145], v25 offset:0
    s_add_u32 s36, s33, 11264
    v_mfma_f32_16x16x32_bf16 v[164:167], a[152:155], v[236:239], v[164:167]
    ds_read_b64_tr_b16 a[146:147], v25 offset:2048
    buffer_store_dwordx4 v[60:63], v16, s[16:19], s36 offen sc1
    v_mfma_f32_16x16x32_bf16 v[168:171], a[156:159], v[232:235], v[168:171]
    ds_read_b64_tr_b16 a[148:149], v26 offset:0
    v_mfma_f32_16x16x32_bf16 v[172:175], a[156:159], v[236:239], v[172:175]
    ds_read_b64_tr_b16 a[150:151], v26 offset:2048
    s_waitcnt lgkmcnt(8)
    v_mfma_f32_16x16x32_bf16 v[144:147], a[160:163], v[240:243], v[144:147]
    ds_read_b64_tr_b16 a[152:153], v27 offset:0
    v_mfma_f32_16x16x32_bf16 v[148:151], a[160:163], v[244:247], v[148:151]
    ds_read_b64_tr_b16 a[154:155], v27 offset:2048
    v_mfma_f32_16x16x32_bf16 v[152:155], a[164:167], v[240:243], v[152:155]
    ds_read_b64_tr_b16 a[156:157], v28 offset:0
    v_mfma_f32_16x16x32_bf16 v[156:159], a[164:167], v[244:247], v[156:159]
    ds_read_b64_tr_b16 a[158:159], v28 offset:2048
    s_waitcnt lgkmcnt(8)
    v_mfma_f32_16x16x32_bf16 v[160:163], a[168:171], v[240:243], v[160:163]
    ds_read_b64_tr_b16 a[160:161], v25 offset:4096
    v_mfma_f32_16x16x32_bf16 v[164:167], a[168:171], v[244:247], v[164:167]
    ds_read_b64_tr_b16 a[162:163], v25 offset:6144
    v_mfma_f32_16x16x32_bf16 v[168:171], a[172:175], v[240:243], v[168:171]
    ds_read_b64_tr_b16 a[164:165], v26 offset:4096
    v_mfma_f32_16x16x32_bf16 v[172:175], a[172:175], v[244:247], v[172:175]
    ds_read_b64_tr_b16 a[166:167], v26 offset:6144
    s_waitcnt vmcnt(16)
    s_barrier
    s_waitcnt lgkmcnt(8)
    v_mfma_f32_16x16x32_bf16 v[112:115], a[144:147], v[176:179], 0
    ds_read_b64_tr_b16 a[168:169], v27 offset:4096
    v_mfma_f32_16x16x32_bf16 v[116:119], a[144:147], v[180:183], 0
    ds_read_b64_tr_b16 a[170:171], v27 offset:6144
    s_add_u32 m0, s27, 36864
    s_add_u32 s32, s50, 896
    buffer_load_dwordx4 v7, s[12:15], s32 offen lds
    v_mfma_f32_16x16x32_bf16 v[120:123], a[148:151], v[176:179], 0
    ds_read_b64_tr_b16 a[172:173], v28 offset:4096
    v_mfma_f32_16x16x32_bf16 v[124:127], a[148:151], v[180:183], 0
    ds_read_b64_tr_b16 a[174:175], v28 offset:6144
    s_waitcnt lgkmcnt(8)
    v_mfma_f32_16x16x32_bf16 v[128:131], a[152:155], v[176:179], 0
    ds_read_b64_tr_b16 a[144:145], v25 offset:8192
    buffer_load_dwordx4 v8, s[12:15], s32 offen offset:1024 lds
    v_mfma_f32_16x16x32_bf16 v[132:135], a[152:155], v[180:183], 0
    ds_read_b64_tr_b16 a[146:147], v25 offset:10240
    v_mfma_f32_16x16x32_bf16 v[136:139], a[156:159], v[176:179], 0
    ds_read_b64_tr_b16 a[148:149], v26 offset:8192
    v_mfma_f32_16x16x32_bf16 v[140:143], a[156:159], v[180:183], 0
    ds_read_b64_tr_b16 a[150:151], v26 offset:10240
    buffer_load_dwordx4 v9, s[12:15], s32 offen offset:2048 lds
    s_cmp_eq_u32 s21, 3
    s_cbranch_scc1 Lk3_kernel_res3
Lk3_kernel_resb3:
    s_waitcnt lgkmcnt(8)
    v_mfma_f32_16x16x32_bf16 v[112:115], a[160:163], v[184:187], v[112:115]
    ds_read_b64_tr_b16 a[152:153], v27 offset:8192
    v_mfma_f32_16x16x32_bf16 v[116:119], a[160:163], v[188:191], v[116:119]
    ds_read_b64_tr_b16 a[154:155], v27 offset:10240
    v_cvt_pk_bf16_f32 v48, v144, v145
    v_mfma_f32_16x16x32_bf16 v[120:123], a[164:167], v[184:187], v[120:123]
    ds_read_b64_tr_b16 a[156:157], v28 offset:8192
    s_add_u32 m0, s27, 49152
    s_add_u32 s32, s51, 896
    buffer_load_dwordx4 v7, s[12:15], s32 offen lds
    v_cvt_pk_bf16_f32 v49, v146, v147
    v_mfma_f32_16x16x32_bf16 v[124:127], a[164:167], v[188:191], v[124:127]
    ds_read_b64_tr_b16 a[158:159], v28 offset:10240
    s_waitcnt lgkmcnt(8)
    v_mfma_f32_16x16x32_bf16 v[128:131], a[168:171], v[184:187], v[128:131]
    ds_read_b64_tr_b16 a[160:161], v25 offset:12288
    v_cvt_pk_bf16_f32 v50, v152, v153
    v_mfma_f32_16x16x32_bf16 v[132:135], a[168:171], v[188:191], v[132:135]
    ds_read_b64_tr_b16 a[162:163], v25 offset:14336
    buffer_load_dwordx4 v8, s[12:15], s32 offen offset:1024 lds
    v_cvt_pk_bf16_f32 v51, v154, v155
    v_mfma_f32_16x16x32_bf16 v[136:139], a[172:175], v[184:187], v[136:139]
    ds_read_b64_tr_b16 a[164:165], v26 offset:12288
    v_mfma_f32_16x16x32_bf16 v[140:143], a[172:175], v[188:191], v[140:143]
    ds_read_b64_tr_b16 a[166:167], v26 offset:14336
    s_nop 1
    s_waitcnt lgkmcnt(8)
    v_mfma_f32_16x16x32_bf16 v[112:115], a[144:147], v[192:195], v[112:115]
    ds_read_b64_tr_b16 a[168:169], v27 offset:12288
    buffer_load_dwordx4 v9, s[12:15], s32 offen offset:2048 lds
    v_permlane16_swap_b32 v48, v50
    v_mfma_f32_16x16x32_bf16 v[116:119], a[144:147], v[196:199], v[116:119]
    ds_read_b64_tr_b16 a[170:171], v27 offset:14336
    v_mfma_f32_16x16x32_bf16 v[120:123], a[148:151], v[192:195], v[120:123]
    ds_read_b64_tr_b16 a[172:173], v28 offset:12288
    v_permlane16_swap_b32 v49, v51
    v_mfma_f32_16x16x32_bf16 v[124:127], a[148:151], v[196:199], v[124:127]
    ds_read_b64_tr_b16 a[174:175], v28 offset:14336
    s_add_u32 m0, s27, 61440
    s_add_u32 s32, s52, 896
    buffer_load_dwordx4 v7, s[12:15], s32 offen lds
    s_add_u32 s36, s33, 12288
    s_waitcnt lgkmcnt(8)
    v_mfma_f32_16x16x32_bf16 v[128:131], a[152:155], v[192:195], v[128:131]
    ds_read_b64_tr_b16 a[144:145], v25 offset:16384
    v_mfma_f32_16x16x32_bf16 v[132:135], a[152:155], v[196:199], v[132:135]
    ds_read_b64_tr_b16 a[146:147], v25 offset:18432
    buffer_store_dwordx4 v[48:51], v16, s[16:19], s36 offen sc1
    v_mfma_f32_16x16x32_bf16 v[136:139], a[156:159], v[192:195], v[136:139]
    ds_read_b64_tr_b16 a[148:149], v26 offset:16384
    s_add_u32 s32, s53, 896
    s_nop 0
    buffer_load_dwordx4 v8, s[12:15], s32 offen offset:1024 lds
    v_cvt_pk_bf16_f32 v52, v148, v149
    v_mfma_f32_16x16x32_bf16 v[140:143], a[156:159], v[196:199], v[140:143]
    ds_read_b64_tr_b16 a[150:151], v26 offset:18432
    s_waitcnt lgkmcnt(8)
    v_mfma_f32_16x16x32_bf16 v[112:115], a[160:163], v[200:203], v[112:115]
    ds_read_b64_tr_b16 a[152:153], v27 offset:16384
    v_cvt_pk_bf16_f32 v53, v150, v151
    v_mfma_f32_16x16x32_bf16 v[116:119], a[160:163], v[204:207], v[116:119]
    ds_read_b64_tr_b16 a[154:155], v27 offset:18432
    s_add_u32 s32, s54, 896
    s_nop 0
    buffer_load_dwordx4 v9, s[12:15], s32 offen offset:2048 lds
    v_cvt_pk_bf16_f32 v54, v156, v157
    v_mfma_f32_16x16x32_bf16 v[120:123], a[164:167], v[200:203], v[120:123]
    ds_read_b64_tr_b16 a[156:157], v28 offset:16384
    v_mfma_f32_16x16x32_bf16 v[124:127], a[164:167], v[204:207], v[124:127]
    ds_read_b64_tr_b16 a[158:159], v28 offset:18432
    v_cvt_pk_bf16_f32 v55, v158, v159
    s_waitcnt lgkmcnt(8)
    v_mfma_f32_16x16x32_bf16 v[128:131], a[168:171], v[200:203], v[128:131]
    ds_read_b64_tr_b16 a[160:161], v25 offset:20480
    s_nop 1
    v_mfma_f32_16x16x32_bf16 v[132:135], a[168:171], v[204:207], v[132:135]
    ds_read_b64_tr_b16 a[162:163], v25 offset:22528
    v_mfma_f32_16x16x32_bf16 v[136:139], a[172:175], v[200:203], v[136:139]
    ds_read_b64_tr_b16 a[164:165], v26 offset:20480
    v_permlane16_swap_b32 v52, v54
    v_mfma_f32_16x16x32_bf16 v[140:143], a[172:175], v[204:207], v[140:143]
    ds_read_b64_tr_b16 a[166:167], v26 offset:22528
    v_permlane16_swap_b32 v53, v55
    s_waitcnt lgkmcnt(8)
    v_mfma_f32_16x16x32_bf16 v[112:115], a[144:147], v[208:211], v[112:115]
    ds_read_b64_tr_b16 a[168:169], v27 offset:20480
    v_mfma_f32_16x16x32_bf16 v[116:119], a[144:147], v[212:215], v[116:119]
    ds_read_b64_tr_b16 a[170:171], v27 offset:22528
    s_add_u32 s36, s33, 13312
    v_mfma_f32_16x16x32_bf16 v[120:123], a[148:151], v[208:211], v[120:123]
    ds_read_b64_tr_b16 a[172:173], v28 offset:20480
    buffer_store_dwordx4 v[52:55], v16, s[16:19], s36 offen sc1
    v_mfma_f32_16x16x32_bf16 v[124:127], a[148:151], v[212:215], v[124:127]
    ds_read_b64_tr_b16 a[174:175], v28 offset:22528
    s_waitcnt lgkmcnt(8)
    v_mfma_f32_16x16x32_bf16 v[128:131], a[152:155], v[208:211], v[128:131]
    ds_read_b64_tr_b16 a[144:145], v25 offset:24576
    v_cvt_pk_bf16_f32 v56, v160, v161
    v_mfma_f32_16x16x32_bf16 v[132:135], a[152:155], v[212:215], v[132:135]
    ds_read_b64_tr_b16 a[146:147], v25 offset:26624
    v_cvt_pk_bf16_f32 v57, v162, v163
    v_mfma_f32_16x16x32_bf16 v[136:139], a[156:159], v[208:211], v[136:139]
    ds_read_b64_tr_b16 a[148:149], v26 offset:24576
    v_mfma_f32_16x16x32_bf16 v[140:143], a[156:159], v[212:215], v[140:143]
    ds_read_b64_tr_b16 a[150:151], v26 offset:26624
    v_cvt_pk_bf16_f32 v58, v168, v169
    s_waitcnt lgkmcnt(8)
    v_mfma_f32_16x16x32_bf16 v[112:115], a[160:163], v[216:219], v[112:115]
    ds_read_b64_tr_b16 a[152:153], v27 offset:24576
    v_cvt_pk_bf16_f32 v59, v170, v171
    v_mfma_f32_16x16x32_bf16 v[116:119], a[160:163], v[220:223], v[116:119]
    ds_read_b64_tr_b16 a[154:155], v27 offset:26624
    v_mfma_f32_16x16x32_bf16 v[120:123], a[164:167], v[216:219], v[120:123]
    ds_read_b64_tr_b16 a[156:157], v28 offset:24576
    s_nop 1
    v_mfma_f32_16x16x32_bf16 v[124:127], a[164:167], v[220:223], v[124:127]
    ds_read_b64_tr_b16 a[158:159], v28 offset:26624
    v_permlane16_swap_b32 v56, v58
    s_waitcnt lgkmcnt(8)
    v_mfma_f32_16x16x32_bf16 v[128:131], a[168:171], v[216:219], v[128:131]
    ds_read_b64_tr_b16 a[160:161], v25 offset:28672
    v_mfma_f32_16x16x32_bf16 v[132:135], a[168:171], v[220:223], v[132:135]
    ds_read_b64_tr_b16 a[162:163], v25 offset:30720
    v_permlane16_swap_b32 v57, v59
    v_mfma_f32_16x16x32_bf16 v[136:139], a[172:175], v[216:219], v[136:139]
    ds_read_b64_tr_b16 a[164:165], v26 offset:28672
    s_add_u32 s36, s33, 14336
    v_mfma_f32_16x16x32_bf16 v[140:143], a[172:175], v[220:223], v[140:143]
    ds_read_b64_tr_b16 a[166:167], v26 offset:30720
    s_waitcnt lgkmcnt(8)
    v_mfma_f32_16x16x32_bf16 v[112:115], a[144:147], v[224:227], v[112:115]
    ds_read_b64_tr_b16 a[168:169], v27 offset:28672
    buffer_store_dwordx4 v[56:59], v16, s[16:19], s36 offen sc1
    v_mfma_f32_16x16x32_bf16 v[116:119], a[144:147], v[228:231], v[116:119]
    ds_read_b64_tr_b16 a[170:171], v27 offset:30720
    v_cvt_pk_bf16_f32 v60, v164, v165
    v_mfma_f32_16x16x32_bf16 v[120:123], a[148:151], v[224:227], v[120:123]
    ds_read_b64_tr_b16 a[172:173], v28 offset:28672
    v_mfma_f32_16x16x32_bf16 v[124:127], a[148:151], v[228:231], v[124:127]
    ds_read_b64_tr_b16 a[174:175], v28 offset:30720
    v_cvt_pk_bf16_f32 v61, v166, v167
    s_waitcnt lgkmcnt(8)
    v_mfma_f32_16x16x32_bf16 v[128:131], a[152:155], v[224:227], v[128:131]
    ds_read_b64_tr_b16 a[144:145], v25 offset:32768
    v_cvt_pk_bf16_f32 v62, v172, v173
    v_mfma_f32_16x16x32_bf16 v[132:135], a[152:155], v[228:231], v[132:135]
    ds_read_b64_tr_b16 a[146:147], v25 offset:34816
    v_mfma_f32_16x16x32_bf16 v[136:139], a[156:159], v[224:227], v[136:139]
    ds_read_b64_tr_b16 a[148:149], v26 offset:32768
    v_cvt_pk_bf16_f32 v63, v174, v175
    v_mfma_f32_16x16x32_bf16 v[140:143], a[156:159], v[228:231], v[140:143]
    ds_read_b64_tr_b16 a[150:151], v26 offset:34816
    s_nop 1
    s_waitcnt lgkmcnt(8)
    v_mfma_f32_16x16x32_bf16 v[112:115], a[160:163], v[232:235], v[112:115]
    ds_read_b64_tr_b16 a[152:153], v27 offset:32768
    v_mfma_f32_16x16x32_bf16 v[116:119], a[160:163], v[236:239], v[116:119]
    ds_read_b64_tr_b16 a[154:155], v27 offset:34816
    v_permlane16_swap_b32 v60, v62
    v_mfma_f32_16x16x32_bf16 v[120:123], a[164:167], v[232:235], v[120:123]
    ds_read_b64_tr_b16 a[156:157], v28 offset:32768
    v_permlane16_swap_b32 v61, v63
    v_mfma_f32_16x16x32_bf16 v[124:127], a[164:167], v[236:239], v[124:127]
    ds_read_b64_tr_b16 a[158:159], v28 offset:34816
    s_waitcnt lgkmcnt(8)
    v_mfma_f32_16x16x32_bf16 v[128:131], a[168:171], v[232:235], v[128:131]
    ds_read_b64_tr_b16 a[160:161], v29 offset:0
    s_add_u32 s36, s33, 15360
    v_mfma_f32_16x16x32_bf16 v[132:135], a[168:171], v[236:239], v[132:135]
    ds_read_b64_tr_b16 a[162:163], v29 offset:2048
    buffer_store_dwordx4 v[60:63], v16, s[16:19], s36 offen sc1
    v_mfma_f32_16x16x32_bf16 v[136:139], a[172:175], v[232:235], v[136:139]
    ds_read_b64_tr_b16 a[164:165], v30 offset:0
    v_mfma_f32_16x16x32_bf16 v[140:143], a[172:175], v[236:239], v[140:143]
    ds_read_b64_tr_b16 a[166:167], v30 offset:2048
    s_waitcnt lgkmcnt(8)
    v_mfma_f32_16x16x32_bf16 v[112:115], a[144:147], v[240:243], v[112:115]
    ds_read_b64_tr_b16 a[168:169], v31 offset:0
    v_mfma_f32_16x16x32_bf16 v[116:119], a[144:147], v[244:247], v[116:119]
    ds_read_b64_tr_b16 a[170:171], v31 offset:2048
    v_mfma_f32_16x16x32_bf16 v[120:123], a[148:151], v[240:243], v[120:123]
    ds_read_b64_tr_b16 a[172:173], v32 offset:0
    v_mfma_f32_16x16x32_bf16 v[124:127], a[148:151], v[244:247], v[124:127]
    ds_read_b64_tr_b16 a[174:175], v32 offset:2048
    s_waitcnt lgkmcnt(8)
    v_mfma_f32_16x16x32_bf16 v[128:131], a[152:155], v[240:243], v[128:131]
    ds_read_b64_tr_b16 a[144:145], v29 offset:4096
    v_mfma_f32_16x16x32_bf16 v[132:135], a[152:155], v[244:247], v[132:135]
    ds_read_b64_tr_b16 a[146:147], v29 offset:6144
    v_mfma_f32_16x16x32_bf16 v[136:139], a[156:159], v[240:243], v[136:139]
    ds_read_b64_tr_b16 a[148:149], v30 offset:4096
    v_mfma_f32_16x16x32_bf16 v[140:143], a[156:159], v[244:247], v[140:143]
    ds_read_b64_tr_b16 a[150:151], v30 offset:6144
    s_waitcnt vmcnt(16)
    s_barrier
    s_waitcnt lgkmcnt(8)
    v_mfma_f32_16x16x32_bf16 v[144:147], a[160:163], v[176:179], 0
    ds_read_b64_tr_b16 a[152:153], v31 offset:4096
    v_mfma_f32_16x16x32_bf16 v[148:151], a[160:163], v[180:183], 0
    ds_read_b64_tr_b16 a[154:155], v31 offset:6144
    s_add_u32 m0, s27, 73728
    s_add_u32 s32, s50, 1024
    buffer_load_dwordx4 v7, s[12:15], s32 offen lds
    v_mfma_f32_16x16x32_bf16 v[152:155], a[164:167], v[176:179], 0
    ds_read_b64_tr_b16 a[156:157], v32 offset:4096
    v_mfma_f32_16x16x32_bf16 v[156:159], a[164:167], v[180:183], 0
    ds_read_b64_tr_b16 a[158:159], v32 offset:6144
    s_waitcnt lgkmcnt(8)
    v_mfma_f32_16x16x32_bf16 v[160:163], a[168:171], v[176:179], 0
    ds_read_b64_tr_b16 a[160:161], v29 offset:8192
    buffer_load_dwordx4 v8, s[12:15], s32 offen offset:1024 lds
    v_mfma_f32_16x16x32_bf16 v[164:167], a[168:171], v[180:183], 0
    ds_read_b64_tr_b16 a[162:163], v29 offset:10240
    v_mfma_f32_16x16x32_bf16 v[168:171], a[172:175], v[176:179], 0
    ds_read_b64_tr_b16 a[164:165], v30 offset:8192
    v_mfma_f32_16x16x32_bf16 v[172:175], a[172:175], v[180:183], 0
    ds_read_b64_tr_b16 a[166:167], v30 offset:10240
    buffer_load_dwordx4 v9, s[12:15], s32 offen offset:2048 lds
    s_cmp_eq_u32 s21, 4
    s_cbranch_scc1 Lk3_kernel_res4
Lk3_kernel_resb4:
    s_waitcnt lgkmcnt(8)
    v_mfma_f32_16x16x32_bf16 v[144:147], a[144:147], v[184:187], v[144:147]
    ds_read_b64_tr_b16 a[168:169], v31 offset:8192
    v_mfma_f32_16x16x32_bf16 v[148:151], a[144:147], v[188:191], v[148:151]
    ds_read_b64_tr_b16 a[170:171], v31 offset:10240
    v_cvt_pk_bf16_f32 v48, v112, v113
    v_mfma_f32_16x16x32_bf16 v[152:155], a[148:151], v[184:187], v[152:155]
    ds_read_b64_tr_b16 a[172:173], v32 offset:8192
    s_add_u32 m0, s27, 86016
    s_add_u32 s32, s51, 1024
    buffer_load_dwordx4 v7, s[12:15], s32 offen lds
    v_cvt_pk_bf16_f32 v49, v114, v115
    v_mfma_f32_16x16x32_bf16 v[156:159], a[148:151], v[188:191], v[156:159]
    ds_read_b64_tr_b16 a[174:175], v32 offset:10240
    s_waitcnt lgkmcnt(8)
    v_mfma_f32_16x16x32_bf16 v[160:163], a[152:155], v[184:187], v[160:163]
    ds_read_b64_tr_b16 a[144:145], v29 offset:12288
    v_cvt_pk_bf16_f32 v50, v120, v121
    v_mfma_f32_16x16x32_bf16 v[164:167], a[152:155], v[188:191], v[164:167]
    ds_read_b64_tr_b16 a[146:147], v29 offset:14336
    buffer_load_dwordx4 v8, s[12:15], s32 offen offset:1024 lds
    v_cvt_pk_bf16_f32 v51, v122, v123
    v_mfma_f32_16x16x32_bf16 v[168:171], a[156:159], v[184:187], v[168:171]
    ds_read_b64_tr_b16 a[148:149], v30 offset:12288
    v_mfma_f32_16x16x32_bf16 v[172:175], a[156:159], v[188:191], v[172:175]
    ds_read_b64_tr_b16 a[150:151], v30 offset:14336
    s_nop 1
    s_waitcnt lgkmcnt(8)
    v_mfma_f32_16x16x32_bf16 v[144:147], a[160:163], v[192:195], v[144:147]
    ds_read_b64_tr_b16 a[152:153], v31 offset:12288
    buffer_load_dwordx4 v9, s[12:15], s32 offen offset:2048 lds
    v_permlane16_swap_b32 v48, v50
    v_mfma_f32_16x16x32_bf16 v[148:151], a[160:163], v[196:199], v[148:151]
    ds_read_b64_tr_b16 a[154:155], v31 offset:14336
    v_mfma_f32_16x16x32_bf16 v[152:155], a[164:167], v[192:195], v[152:155]
    ds_read_b64_tr_b16 a[156:157], v32 offset:12288
    v_permlane16_swap_b32 v49, v51
    v_mfma_f32_16x16x32_bf16 v[156:159], a[164:167], v[196:199], v[156:159]
    ds_read_b64_tr_b16 a[158:159], v32 offset:14336
    s_add_u32 m0, s27, 98304
    s_add_u32 s32, s52, 1024
    buffer_load_dwordx4 v7, s[12:15], s32 offen lds
    s_add_u32 s36, s33, 16384
    s_waitcnt lgkmcnt(8)
    v_mfma_f32_16x16x32_bf16 v[160:163], a[168:171], v[192:195], v[160:163]
    ds_read_b64_tr_b16 a[160:161], v29 offset:16384
    v_mfma_f32_16x16x32_bf16 v[164:167], a[168:171], v[196:199], v[164:167]
    ds_read_b64_tr_b16 a[162:163], v29 offset:18432
    buffer_store_dwordx4 v[48:51], v16, s[16:19], s36 offen sc1
    v_mfma_f32_16x16x32_bf16 v[168:171], a[172:175], v[192:195], v[168:171]
    ds_read_b64_tr_b16 a[164:165], v30 offset:16384
    s_add_u32 s32, s53, 1024
    s_nop 0
    buffer_load_dwordx4 v8, s[12:15], s32 offen offset:1024 lds
    v_cvt_pk_bf16_f32 v52, v116, v117
    v_mfma_f32_16x16x32_bf16 v[172:175], a[172:175], v[196:199], v[172:175]
    ds_read_b64_tr_b16 a[166:167], v30 offset:18432
    s_waitcnt lgkmcnt(8)
    v_mfma_f32_16x16x32_bf16 v[144:147], a[144:147], v[200:203], v[144:147]
    ds_read_b64_tr_b16 a[168:169], v31 offset:16384
    v_cvt_pk_bf16_f32 v53, v118, v119
    v_mfma_f32_16x16x32_bf16 v[148:151], a[144:147], v[204:207], v[148:151]
    ds_read_b64_tr_b16 a[170:171], v31 offset:18432
    s_add_u32 s32, s54, 1024
    s_nop 0
    buffer_load_dwordx4 v9, s[12:15], s32 offen offset:2048 lds
    v_cvt_pk_bf16_f32 v54, v124, v125
    v_mfma_f32_16x16x32_bf16 v[152:155], a[148:151], v[200:203], v[152:155]
    ds_read_b64_tr_b16 a[172:173], v32 offset:16384
    v_mfma_f32_16x16x32_bf16 v[156:159], a[148:151], v[204:207], v[156:159]
    ds_read_b64_tr_b16 a[174:175], v32 offset:18432
    v_cvt_pk_bf16_f32 v55, v126, v127
    s_waitcnt lgkmcnt(8)
    v_mfma_f32_16x16x32_bf16 v[160:163], a[152:155], v[200:203], v[160:163]
    ds_read_b64_tr_b16 a[144:145], v29 offset:20480
    s_nop 1
    v_mfma_f32_16x16x32_bf16 v[164:167], a[152:155], v[204:207], v[164:167]
    ds_read_b64_tr_b16 a[146:147], v29 offset:22528
    v_mfma_f32_16x16x32_bf16 v[168:171], a[156:159], v[200:203], v[168:171]
    ds_read_b64_tr_b16 a[148:149], v30 offset:20480
    v_permlane16_swap_b32 v52, v54
    v_mfma_f32_16x16x32_bf16 v[172:175], a[156:159], v[204:207], v[172:175]
    ds_read_b64_tr_b16 a[150:151], v30 offset:22528
    v_permlane16_swap_b32 v53, v55
    s_waitcnt lgkmcnt(8)
    v_mfma_f32_16x16x32_bf16 v[144:147], a[160:163], v[208:211], v[144:147]
    ds_read_b64_tr_b16 a[152:153], v31 offset:20480
    v_mfma_f32_16x16x32_bf16 v[148:151], a[160:163], v[212:215], v[148:151]
    ds_read_b64_tr_b16 a[154:155], v31 offset:22528
    s_add_u32 s36, s33, 17408
    v_mfma_f32_16x16x32_bf16 v[152:155], a[164:167], v[208:211], v[152:155]
    ds_read_b64_tr_b16 a[156:157], v32 offset:20480
    buffer_store_dwordx4 v[52:55], v16, s[16:19], s36 offen sc1
    v_mfma_f32_16x16x32_bf16 v[156:159], a[164:167], v[212:215], v[156:159]
    ds_read_b64_tr_b16 a[158:159], v32 offset:22528
    s_waitcnt lgkmcnt(8)
    v_mfma_f32_16x16x32_bf16 v[160:163], a[168:171], v[208:211], v[160:163]
    ds_read_b64_tr_b16 a[160:161], v29 offset:24576
    v_cvt_pk_bf16_f32 v56, v128, v129
    v_mfma_f32_16x16x32_bf16 v[164:167], a[168:171], v[212:215], v[164:167]
    ds_read_b64_tr_b16 a[162:163], v29 offset:26624
    v_cvt_pk_bf16_f32 v57, v130, v131
    v_mfma_f32_16x16x32_bf16 v[168:171], a[172:175], v[208:211], v[168:171]
    ds_read_b64_tr_b16 a[164:165], v30 offset:24576
    v_mfma_f32_16x16x32_bf16 v[172:175], a[172:175], v[212:215], v[172:175]
    ds_read_b64_tr_b16 a[166:167], v30 offset:26624
    v_cvt_pk_bf16_f32 v58, v136, v137
    s_waitcnt lgkmcnt(8)
    v_mfma_f32_16x16x32_bf16 v[144:147], a[144:147], v[216:219], v[144:147]
    ds_read_b64_tr_b16 a[168:169], v31 offset:24576
    v_cvt_pk_bf16_f32 v59, v138, v139
    v_mfma_f32_16x16x32_bf16 v[148:151], a[144:147], v[220:223], v[148:151]
    ds_read_b64_tr_b16 a[170:171], v31 offset:26624
    v_mfma_f32_16x16x32_bf16 v[152:155], a[148:151], v[216:219], v[152:155]
    ds_read_b64_tr_b16 a[172:173], v32 offset:24576
    s_nop 1
    v_mfma_f32_16x16x32_bf16 v[156:159], a[148:151], v[220:223], v[156:159]
    ds_read_b64_tr_b16 a[174:175], v32 offset:26624
    v_permlane16_swap_b32 v56, v58
    s_waitcnt lgkmcnt(8)
    v_mfma_f32_16x16x32_bf16 v[160:163], a[152:155], v[216:219], v[160:163]
    ds_read_b64_tr_b16 a[144:145], v29 offset:28672
    v_mfma_f32_16x16x32_bf16 v[164:167], a[152:155], v[220:223], v[164:167]
    ds_read_b64_tr_b16 a[146:147], v29 offset:30720
    v_permlane16_swap_b32 v57, v59
    v_mfma_f32_16x16x32_bf16 v[168:171], a[156:159], v[216:219], v[168:171]
    ds_read_b64_tr_b16 a[148:149], v30 offset:28672
    s_add_u32 s36, s33, 18432
    v_mfma_f32_16x16x32_bf16 v[172:175], a[156:159], v[220:223], v[172:175]
    ds_read_b64_tr_b16 a[150:151], v30 offset:30720
    s_waitcnt lgkmcnt(8)
    v_mfma_f32_16x16x32_bf16 v[144:147], a[160:163], v[224:227], v[144:147]
    ds_read_b64_tr_b16 a[152:153], v31 offset:28672
    buffer_store_dwordx4 v[56:59], v16, s[16:19], s36 offen sc1
    v_mfma_f32_16x16x32_bf16 v[148:151], a[160:163], v[228:231], v[148:151]
    ds_read_b64_tr_b16 a[154:155], v31 offset:30720
    v_cvt_pk_bf16_f32 v60, v132, v133
    v_mfma_f32_16x16x32_bf16 v[152:155], a[164:167], v[224:227], v[152:155]
    ds_read_b64_tr_b16 a[156:157], v32 offset:28672
    v_mfma_f32_16x16x32_bf16 v[156:159], a[164:167], v[228:231], v[156:159]
    ds_read_b64_tr_b16 a[158:159], v32 offset:30720
    v_cvt_pk_bf16_f32 v61, v134, v135
    s_waitcnt lgkmcnt(8)
    v_mfma_f32_16x16x32_bf16 v[160:163], a[168:171], v[224:227], v[160:163]
    ds_read_b64_tr_b16 a[160:161], v29 offset:32768
    v_cvt_pk_bf16_f32 v62, v140, v141
    v_mfma_f32_16x16x32_bf16 v[164:167], a[168:171], v[228:231], v[164:167]
    ds_read_b64_tr_b16 a[162:163], v29 offset:34816
    v_mfma_f32_16x16x32_bf16 v[168:171], a[172:175], v[224:227], v[168:171]
    ds_read_b64_tr_b16 a[164:165], v30 offset:32768
    v_cvt_pk_bf16_f32 v63, v142, v143
    v_mfma_f32_16x16x32_bf16 v[172:175], a[172:175], v[228:231], v[172:175]
    ds_read_b64_tr_b16 a[166:167], v30 offset:34816
    s_nop 1
    s_waitcnt lgkmcnt(8)
    v_mfma_f32_16x16x32_bf16 v[144:147], a[144:147], v[232:235], v[144:147]
    ds_read_b64_tr_b16 a[168:169], v31 offset:32768
    v_mfma_f32_16x16x32_bf16 v[148:151], a[144:147], v[236:239], v[148:151]
    ds_read_b64_tr_b16 a[170:171], v31 offset:34816
    v_permlane16_swap_b32 v60, v62
    v_mfma_f32_16x16x32_bf16 v[152:155], a[148:151], v[232:235], v[152:155]
    ds_read_b64_tr_b16 a[172:173], v32 offset:32768
    v_permlane16_swap_b32 v61, v63
    v_mfma_f32_16x16x32_bf16 v[156:159], a[148:151], v[236:239], v[156:159]
    ds_read_b64_tr_b16 a[174:175], v32 offset:34816
    s_waitcnt lgkmcnt(8)
    v_mfma_f32_16x16x32_bf16 v[160:163], a[152:155], v[232:235], v[160:163]
    ds_read_b64_tr_b16 a[144:145], v17 offset:0
    s_add_u32 s36, s33, 19456
    v_mfma_f32_16x16x32_bf16 v[164:167], a[152:155], v[236:239], v[164:167]
    ds_read_b64_tr_b16 a[146:147], v17 offset:2048
    buffer_store_dwordx4 v[60:63], v16, s[16:19], s36 offen sc1
    v_mfma_f32_16x16x32_bf16 v[168:171], a[156:159], v[232:235], v[168:171]
    ds_read_b64_tr_b16 a[148:149], v18 offset:0
    v_mfma_f32_16x16x32_bf16 v[172:175], a[156:159], v[236:239], v[172:175]
    ds_read_b64_tr_b16 a[150:151], v18 offset:2048
    s_waitcnt lgkmcnt(8)
    v_mfma_f32_16x16x32_bf16 v[144:147], a[160:163], v[240:243], v[144:147]
    ds_read_b64_tr_b16 a[152:153], v19 offset:0
    v_mfma_f32_16x16x32_bf16 v[148:151], a[160:163], v[244:247], v[148:151]
    ds_read_b64_tr_b16 a[154:155], v19 offset:2048
    v_mfma_f32_16x16x32_bf16 v[152:155], a[164:167], v[240:243], v[152:155]
    ds_read_b64_tr_b16 a[156:157], v20 offset:0
    v_mfma_f32_16x16x32_bf16 v[156:159], a[164:167], v[244:247], v[156:159]
    ds_read_b64_tr_b16 a[158:159], v20 offset:2048
    s_waitcnt lgkmcnt(8)
    v_mfma_f32_16x16x32_bf16 v[160:163], a[168:171], v[240:243], v[160:163]
    ds_read_b64_tr_b16 a[160:161], v17 offset:4096
    v_mfma_f32_16x16x32_bf16 v[164:167], a[168:171], v[244:247], v[164:167]
    ds_read_b64_tr_b16 a[162:163], v17 offset:6144
    v_mfma_f32_16x16x32_bf16 v[168:171], a[172:175], v[240:243], v[168:171]
    ds_read_b64_tr_b16 a[164:165], v18 offset:4096
    v_mfma_f32_16x16x32_bf16 v[172:175], a[172:175], v[244:247], v[172:175]
    ds_read_b64_tr_b16 a[166:167], v18 offset:6144
    s_waitcnt vmcnt(16)
    s_barrier
    s_waitcnt lgkmcnt(8)
    v_mfma_f32_16x16x32_bf16 v[112:115], a[144:147], v[176:179], 0
    ds_read_b64_tr_b16 a[168:169], v19 offset:4096
    v_mfma_f32_16x16x32_bf16 v[116:119], a[144:147], v[180:183], 0
    ds_read_b64_tr_b16 a[170:171], v19 offset:6144
    v_mfma_f32_16x16x32_bf16 v[120:123], a[148:151], v[176:179], 0
    ds_read_b64_tr_b16 a[172:173], v20 offset:4096
    v_mfma_f32_16x16x32_bf16 v[124:127], a[148:151], v[180:183], 0
    ds_read_b64_tr_b16 a[174:175], v20 offset:6144
    s_waitcnt lgkmcnt(8)
    v_mfma_f32_16x16x32_bf16 v[128:131], a[152:155], v[176:179], 0
    ds_read_b64_tr_b16 a[144:145], v17 offset:8192
    v_mfma_f32_16x16x32_bf16 v[132:135], a[152:155], v[180:183], 0
    ds_read_b64_tr_b16 a[146:147], v17 offset:10240
    v_mfma_f32_16x16x32_bf16 v[136:139], a[156:159], v[176:179], 0
    ds_read_b64_tr_b16 a[148:149], v18 offset:8192
    v_mfma_f32_16x16x32_bf16 v[140:143], a[156:159], v[180:183], 0
    ds_read_b64_tr_b16 a[150:151], v18 offset:10240
    s_cmp_eq_u32 s21, 5
    s_cbranch_scc1 Lk3_kernel_res5
Lk3_kernel_resb5:
    s_waitcnt lgkmcnt(8)
    v_mfma_f32_16x16x32_bf16 v[112:115], a[160:163], v[184:187], v[112:115]
    ds_read_b64_tr_b16 a[152:153], v19 offset:8192
    v_mfma_f32_16x16x32_bf16 v[116:119], a[160:163], v[188:191], v[116:119]
    ds_read_b64_tr_b16 a[154:155], v19 offset:10240
    v_cvt_pk_bf16_f32 v48, v144, v145
    v_mfma_f32_16x16x32_bf16 v[120:123], a[164:167], v[184:187], v[120:123]
    ds_read_b64_tr_b16 a[156:157], v20 offset:8192
    v_cvt_pk_bf16_f32 v49, v146, v147
    v_mfma_f32_16x16x32_bf16 v[124:127], a[164:167], v[188:191], v[124:127]
    ds_read_b64_tr_b16 a[158:159], v20 offset:10240
    s_waitcnt lgkmcnt(8)
    v_mfma_f32_16x16x32_bf16 v[128:131], a[168:171], v[184:187], v[128:131]
    ds_read_b64_tr_b16 a[160:161], v17 offset:12288
    v_cvt_pk_bf16_f32 v50, v152, v153
    v_mfma_f32_16x16x32_bf16 v[132:135], a[168:171], v[188:191], v[132:135]
    ds_read_b64_tr_b16 a[162:163], v17 offset:14336
    v_cvt_pk_bf16_f32 v51, v154, v155
    v_mfma_f32_16x16x32_bf16 v[136:139], a[172:175], v[184:187], v[136:139]
    ds_read_b64_tr_b16 a[164:165], v18 offset:12288
    v_mfma_f32_16x16x32_bf16 v[140:143], a[172:175], v[188:191], v[140:143]
    ds_read_b64_tr_b16 a[166:167], v18 offset:14336
    s_nop 1
    s_waitcnt lgkmcnt(8)
    v_mfma_f32_16x16x32_bf16 v[112:115], a[144:147], v[192:195], v[112:115]
    ds_read_b64_tr_b16 a[168:169], v19 offset:12288
    v_permlane16_swap_b32 v48, v50
    v_mfma_f32_16x16x32_bf16 v[116:119], a[144:147], v[196:199], v[116:119]
    ds_read_b64_tr_b16 a[170:171], v19 offset:14336
    v_mfma_f32_16x16x32_bf16 v[120:123], a[148:151], v[192:195], v[120:123]
    ds_read_b64_tr_b16 a[172:173], v20 offset:12288
    v_permlane16_swap_b32 v49, v51
    v_mfma_f32_16x16x32_bf16 v[124:127], a[148:151], v[196:199], v[124:127]
    ds_read_b64_tr_b16 a[174:175], v20 offset:14336
    s_add_u32 s36, s33, 20480
    s_waitcnt lgkmcnt(8)
    v_mfma_f32_16x16x32_bf16 v[128:131], a[152:155], v[192:195], v[128:131]
    ds_read_b64_tr_b16 a[144:145], v17 offset:16384
    v_mfma_f32_16x16x32_bf16 v[132:135], a[152:155], v[196:199], v[132:135]
    ds_read_b64_tr_b16 a[146:147], v17 offset:18432
    buffer_store_dwordx4 v[48:51], v16, s[16:19], s36 offen sc1
    v_mfma_f32_16x16x32_bf16 v[136:139], a[156:159], v[192:195], v[136:139]
    ds_read_b64_tr_b16 a[148:149], v18 offset:16384
    v_cvt_pk_bf16_f32 v52, v148, v149
    v_mfma_f32_16x16x32_bf16 v[140:143], a[156:159], v[196:199], v[140:143]
    ds_read_b64_tr_b16 a[150:151], v18 offset:18432
    s_waitcnt lgkmcnt(8)
    v_mfma_f32_16x16x32_bf16 v[112:115], a[160:163], v[200:203], v[112:115]
    ds_read_b64_tr_b16 a[152:153], v19 offset:16384
    v_cvt_pk_bf16_f32 v53, v150, v151
    v_mfma_f32_16x16x32_bf16 v[116:119], a[160:163], v[204:207], v[116:119]
    ds_read_b64_tr_b16 a[154:155], v19 offset:18432
    v_cvt_pk_bf16_f32 v54, v156, v157
    v_mfma_f32_16x16x32_bf16 v[120:123], a[164:167], v[200:203], v[120:123]
    ds_read_b64_tr_b16 a[156:157], v20 offset:16384
    v_mfma_f32_16x16x32_bf16 v[124:127], a[164:167], v[204:207], v[124:127]
    ds_read_b64_tr_b16 a[158:159], v20 offset:18432
    v_cvt_pk_bf16_f32 v55, v158, v159
    s_waitcnt lgkmcnt(8)
    v_mfma_f32_16x16x32_bf16 v[128:131], a[168:171], v[200:203], v[128:131]
    ds_read_b64_tr_b16 a[160:161], v17 offset:20480
    s_nop 1
    v_mfma_f32_16x16x32_bf16 v[132:135], a[168:171], v[204:207], v[132:135]
    ds_read_b64_tr_b16 a[162:163], v17 offset:22528
    v_mfma_f32_16x16x32_bf16 v[136:139], a[172:175], v[200:203], v[136:139]
    ds_read_b64_tr_b16 a[164:165], v18 offset:20480
    v_permlane16_swap_b32 v52, v54
    v_mfma_f32_16x16x32_bf16 v[140:143], a[172:175], v[204:207], v[140:143]
    ds_read_b64_tr_b16 a[166:167], v18 offset:22528
    v_permlane16_swap_b32 v53, v55
    s_waitcnt lgkmcnt(8)
    v_mfma_f32_16x16x32_bf16 v[112:115], a[144:147], v[208:211], v[112:115]
    ds_read_b64_tr_b16 a[168:169], v19 offset:20480
    v_mfma_f32_16x16x32_bf16 v[116:119], a[144:147], v[212:215], v[116:119]
    ds_read_b64_tr_b16 a[170:171], v19 offset:22528
    s_add_u32 s36, s33, 21504
    v_mfma_f32_16x16x32_bf16 v[120:123], a[148:151], v[208:211], v[120:123]
    ds_read_b64_tr_b16 a[172:173], v20 offset:20480
    buffer_store_dwordx4 v[52:55], v16, s[16:19], s36 offen sc1
    v_mfma_f32_16x16x32_bf16 v[124:127], a[148:151], v[212:215], v[124:127]
    ds_read_b64_tr_b16 a[174:175], v20 offset:22528
    s_waitcnt lgkmcnt(8)
    v_mfma_f32_16x16x32_bf16 v[128:131], a[152:155], v[208:211], v[128:131]
    ds_read_b64_tr_b16 a[144:145], v17 offset:24576
    v_cvt_pk_bf16_f32 v56, v160, v161
    v_mfma_f32_16x16x32_bf16 v[132:135], a[152:155], v[212:215], v[132:135]
    ds_read_b64_tr_b16 a[146:147], v17 offset:26624
    v_cvt_pk_bf16_f32 v57, v162, v163
    v_mfma_f32_16x16x32_bf16 v[136:139], a[156:159], v[208:211], v[136:139]
    ds_read_b64_tr_b16 a[148:149], v18 offset:24576
    v_mfma_f32_16x16x32_bf16 v[140:143], a[156:159], v[212:215], v[140:143]
    ds_read_b64_tr_b16 a[150:151], v18 offset:26624
    v_cvt_pk_bf16_f32 v58, v168, v169
    s_waitcnt lgkmcnt(8)
    v_mfma_f32_16x16x32_bf16 v[112:115], a[160:163], v[216:219], v[112:115]
    ds_read_b64_tr_b16 a[152:153], v19 offset:24576
    v_cvt_pk_bf16_f32 v59, v170, v171
    v_mfma_f32_16x16x32_bf16 v[116:119], a[160:163], v[220:223], v[116:119]
    ds_read_b64_tr_b16 a[154:155], v19 offset:26624
    v_mfma_f32_16x16x32_bf16 v[120:123], a[164:167], v[216:219], v[120:123]
    ds_read_b64_tr_b16 a[156:157], v20 offset:24576
    s_nop 1
    v_mfma_f32_16x16x32_bf16 v[124:127], a[164:167], v[220:223], v[124:127]
    ds_read_b64_tr_b16 a[158:159], v20 offset:26624
    v_permlane16_swap_b32 v56, v58
    s_waitcnt lgkmcnt(8)
    v_mfma_f32_16x16x32_bf16 v[128:131], a[168:171], v[216:219], v[128:131]
    ds_read_b64_tr_b16 a[160:161], v17 offset:28672
    v_mfma_f32_16x16x32_bf16 v[132:135], a[168:171], v[220:223], v[132:135]
    ds_read_b64_tr_b16 a[162:163], v17 offset:30720
    v_permlane16_swap_b32 v57, v59
    v_mfma_f32_16x16x32_bf16 v[136:139], a[172:175], v[216:219], v[136:139]
    ds_read_b64_tr_b16 a[164:165], v18 offset:28672
    s_add_u32 s36, s33, 22528
    v_mfma_f32_16x16x32_bf16 v[140:143], a[172:175], v[220:223], v[140:143]
    ds_read_b64_tr_b16 a[166:167], v18 offset:30720
    s_waitcnt lgkmcnt(8)
    v_mfma_f32_16x16x32_bf16 v[112:115], a[144:147], v[224:227], v[112:115]
    ds_read_b64_tr_b16 a[168:169], v19 offset:28672
    buffer_store_dwordx4 v[56:59], v16, s[16:19], s36 offen sc1
    v_mfma_f32_16x16x32_bf16 v[116:119], a[144:147], v[228:231], v[116:119]
    ds_read_b64_tr_b16 a[170:171], v19 offset:30720
    v_cvt_pk_bf16_f32 v60, v164, v165
    v_mfma_f32_16x16x32_bf16 v[120:123], a[148:151], v[224:227], v[120:123]
    ds_read_b64_tr_b16 a[172:173], v20 offset:28672
    v_mfma_f32_16x16x32_bf16 v[124:127], a[148:151], v[228:231], v[124:127]
    ds_read_b64_tr_b16 a[174:175], v20 offset:30720
    v_cvt_pk_bf16_f32 v61, v166, v167
    s_waitcnt lgkmcnt(8)
    v_mfma_f32_16x16x32_bf16 v[128:131], a[152:155], v[224:227], v[128:131]
    ds_read_b64_tr_b16 a[144:145], v17 offset:32768
    v_cvt_pk_bf16_f32 v62, v172, v173
    v_mfma_f32_16x16x32_bf16 v[132:135], a[152:155], v[228:231], v[132:135]
    ds_read_b64_tr_b16 a[146:147], v17 offset:34816
    v_mfma_f32_16x16x32_bf16 v[136:139], a[156:159], v[224:227], v[136:139]
    ds_read_b64_tr_b16 a[148:149], v18 offset:32768
    v_cvt_pk_bf16_f32 v63, v174, v175
    v_mfma_f32_16x16x32_bf16 v[140:143], a[156:159], v[228:231], v[140:143]
    ds_read_b64_tr_b16 a[150:151], v18 offset:34816
    s_nop 1
    s_waitcnt lgkmcnt(8)
    v_mfma_f32_16x16x32_bf16 v[112:115], a[160:163], v[232:235], v[112:115]
    ds_read_b64_tr_b16 a[152:153], v19 offset:32768
    v_mfma_f32_16x16x32_bf16 v[116:119], a[160:163], v[236:239], v[116:119]
    ds_read_b64_tr_b16 a[154:155], v19 offset:34816
    v_permlane16_swap_b32 v60, v62
    v_mfma_f32_16x16x32_bf16 v[120:123], a[164:167], v[232:235], v[120:123]
    ds_read_b64_tr_b16 a[156:157], v20 offset:32768
    v_permlane16_swap_b32 v61, v63
    v_mfma_f32_16x16x32_bf16 v[124:127], a[164:167], v[236:239], v[124:127]
    ds_read_b64_tr_b16 a[158:159], v20 offset:34816
    s_waitcnt lgkmcnt(8)
    v_mfma_f32_16x16x32_bf16 v[128:131], a[168:171], v[232:235], v[128:131]
    ds_read_b64_tr_b16 a[160:161], v21 offset:0
    s_add_u32 s36, s33, 23552
    v_mfma_f32_16x16x32_bf16 v[132:135], a[168:171], v[236:239], v[132:135]
    ds_read_b64_tr_b16 a[162:163], v21 offset:2048
    buffer_store_dwordx4 v[60:63], v16, s[16:19], s36 offen sc1
    v_mfma_f32_16x16x32_bf16 v[136:139], a[172:175], v[232:235], v[136:139]
    ds_read_b64_tr_b16 a[164:165], v22 offset:0
    v_mfma_f32_16x16x32_bf16 v[140:143], a[172:175], v[236:239], v[140:143]
    ds_read_b64_tr_b16 a[166:167], v22 offset:2048
    s_waitcnt lgkmcnt(8)
    v_mfma_f32_16x16x32_bf16 v[112:115], a[144:147], v[240:243], v[112:115]
    ds_read_b64_tr_b16 a[168:169], v23 offset:0
    v_mfma_f32_16x16x32_bf16 v[116:119], a[144:147], v[244:247], v[116:119]
    ds_read_b64_tr_b16 a[170:171], v23 offset:2048
    v_mfma_f32_16x16x32_bf16 v[120:123], a[148:151], v[240:243], v[120:123]
    ds_read_b64_tr_b16 a[172:173], v24 offset:0
    v_mfma_f32_16x16x32_bf16 v[124:127], a[148:151], v[244:247], v[124:127]
    ds_read_b64_tr_b16 a[174:175], v24 offset:2048
    s_waitcnt lgkmcnt(8)
    v_mfma_f32_16x16x32_bf16 v[128:131], a[152:155], v[240:243], v[128:131]
    ds_read_b64_tr_b16 a[144:145], v21 offset:4096
    v_mfma_f32_16x16x32_bf16 v[132:135], a[152:155], v[244:247], v[132:135]
    ds_read_b64_tr_b16 a[146:147], v21 offset:6144
    v_mfma_f32_16x16x32_bf16 v[136:139], a[156:159], v[240:243], v[136:139]
    ds_read_b64_tr_b16 a[148:149], v22 offset:4096
    v_mfma_f32_16x16x32_bf16 v[140:143], a[156:159], v[244:247], v[140:143]
    ds_read_b64_tr_b16 a[150:151], v22 offset:6144
    s_waitcnt vmcnt(7)
    s_barrier
    s_waitcnt lgkmcnt(8)
    v_mfma_f32_16x16x32_bf16 v[144:147], a[160:163], v[176:179], 0
    ds_read_b64_tr_b16 a[152:153], v23 offset:4096
    v_mfma_f32_16x16x32_bf16 v[148:151], a[160:163], v[180:183], 0
    ds_read_b64_tr_b16 a[154:155], v23 offset:6144
    v_mfma_f32_16x16x32_bf16 v[152:155], a[164:167], v[176:179], 0
    ds_read_b64_tr_b16 a[156:157], v24 offset:4096
    v_mfma_f32_16x16x32_bf16 v[156:159], a[164:167], v[180:183], 0
    ds_read_b64_tr_b16 a[158:159], v24 offset:6144
    s_waitcnt lgkmcnt(8)
    v_mfma_f32_16x16x32_bf16 v[160:163], a[168:171], v[176:179], 0
    ds_read_b64_tr_b16 a[160:161], v21 offset:8192
    v_mfma_f32_16x16x32_bf16 v[164:167], a[168:171], v[180:183], 0
    ds_read_b64_tr_b16 a[162:163], v21 offset:10240
    v_mfma_f32_16x16x32_bf16 v[168:171], a[172:175], v[176:179], 0
    ds_read_b64_tr_b16 a[164:165], v22 offset:8192
    v_mfma_f32_16x16x32_bf16 v[172:175], a[172:175], v[180:183], 0
    ds_read_b64_tr_b16 a[166:167], v22 offset:10240
    s_cmp_eq_u32 s21, 6
    s_cbranch_scc1 Lk3_kernel_res6
Lk3_kernel_resb6:
    s_waitcnt lgkmcnt(8)
    v_mfma_f32_16x16x32_bf16 v[144:147], a[144:147], v[184:187], v[144:147]
    ds_read_b64_tr_b16 a[168:169], v23 offset:8192
    v_mfma_f32_16x16x32_bf16 v[148:151], a[144:147], v[188:191], v[148:151]
    ds_read_b64_tr_b16 a[170:171], v23 offset:10240
    v_cvt_pk_bf16_f32 v48, v112, v113
    v_mfma_f32_16x16x32_bf16 v[152:155], a[148:151], v[184:187], v[152:155]
    ds_read_b64_tr_b16 a[172:173], v24 offset:8192
    v_cvt_pk_bf16_f32 v49, v114, v115
    v_mfma_f32_16x16x32_bf16 v[156:159], a[148:151], v[188:191], v[156:159]
    ds_read_b64_tr_b16 a[174:175], v24 offset:10240
    s_waitcnt lgkmcnt(8)
    v_mfma_f32_16x16x32_bf16 v[160:163], a[152:155], v[184:187], v[160:163]
    ds_read_b64_tr_b16 a[144:145], v21 offset:12288
    v_cvt_pk_bf16_f32 v50, v120, v121
    v_mfma_f32_16x16x32_bf16 v[164:167], a[152:155], v[188:191], v[164:167]
    ds_read_b64_tr_b16 a[146:147], v21 offset:14336
    v_cvt_pk_bf16_f32 v51, v122, v123
    v_mfma_f32_16x16x32_bf16 v[168:171], a[156:159], v[184:187], v[168:171]
    ds_read_b64_tr_b16 a[148:149], v22 offset:12288
    v_mfma_f32_16x16x32_bf16 v[172:175], a[156:159], v[188:191], v[172:175]
    ds_read_b64_tr_b16 a[150:151], v22 offset:14336
    s_nop 1
    s_waitcnt lgkmcnt(8)
    v_mfma_f32_16x16x32_bf16 v[144:147], a[160:163], v[192:195], v[144:147]
    ds_read_b64_tr_b16 a[152:153], v23 offset:12288
    v_permlane16_swap_b32 v48, v50
    v_mfma_f32_16x16x32_bf16 v[148:151], a[160:163], v[196:199], v[148:151]
    ds_read_b64_tr_b16 a[154:155], v23 offset:14336
    v_mfma_f32_16x16x32_bf16 v[152:155], a[164:167], v[192:195], v[152:155]
    ds_read_b64_tr_b16 a[156:157], v24 offset:12288
    v_permlane16_swap_b32 v49, v51
    v_mfma_f32_16x16x32_bf16 v[156:159], a[164:167], v[196:199], v[156:159]
    ds_read_b64_tr_b16 a[158:159], v24 offset:14336
    s_add_u32 s36, s33, 24576
    s_waitcnt lgkmcnt(8)
    v_mfma_f32_16x16x32_bf16 v[160:163], a[168:171], v[192:195], v[160:163]
    ds_read_b64_tr_b16 a[160:161], v21 offset:16384
    v_mfma_f32_16x16x32_bf16 v[164:167], a[168:171], v[196:199], v[164:167]
    ds_read_b64_tr_b16 a[162:163], v21 offset:18432
    buffer_store_dwordx4 v[48:51], v16, s[16:19], s36 offen sc1
    v_mfma_f32_16x16x32_bf16 v[168:171], a[172:175], v[192:195], v[168:171]
    ds_read_b64_tr_b16 a[164:165], v22 offset:16384
    v_cvt_pk_bf16_f32 v52, v116, v117
    v_mfma_f32_16x16x32_bf16 v[172:175], a[172:175], v[196:199], v[172:175]
    ds_read_b64_tr_b16 a[166:167], v22 offset:18432
    s_waitcnt lgkmcnt(8)
    v_mfma_f32_16x16x32_bf16 v[144:147], a[144:147], v[200:203], v[144:147]
    ds_read_b64_tr_b16 a[168:169], v23 offset:16384
    v_cvt_pk_bf16_f32 v53, v118, v119
    v_mfma_f32_16x16x32_bf16 v[148:151], a[144:147], v[204:207], v[148:151]
    ds_read_b64_tr_b16 a[170:171], v23 offset:18432
    v_cvt_pk_bf16_f32 v54, v124, v125
    v_mfma_f32_16x16x32_bf16 v[152:155], a[148:151], v[200:203], v[152:155]
    ds_read_b64_tr_b16 a[172:173], v24 offset:16384
    v_mfma_f32_16x16x32_bf16 v[156:159], a[148:151], v[204:207], v[156:159]
    ds_read_b64_tr_b16 a[174:175], v24 offset:18432
    v_cvt_pk_bf16_f32 v55, v126, v127
    s_waitcnt lgkmcnt(8)
    v_mfma_f32_16x16x32_bf16 v[160:163], a[152:155], v[200:203], v[160:163]
    ds_read_b64_tr_b16 a[144:145], v21 offset:20480
    s_nop 1
    v_mfma_f32_16x16x32_bf16 v[164:167], a[152:155], v[204:207], v[164:167]
    ds_read_b64_tr_b16 a[146:147], v21 offset:22528
    v_mfma_f32_16x16x32_bf16 v[168:171], a[156:159], v[200:203], v[168:171]
    ds_read_b64_tr_b16 a[148:149], v22 offset:20480
    v_permlane16_swap_b32 v52, v54
    v_mfma_f32_16x16x32_bf16 v[172:175], a[156:159], v[204:207], v[172:175]
    ds_read_b64_tr_b16 a[150:151], v22 offset:22528
    v_permlane16_swap_b32 v53, v55
    s_waitcnt lgkmcnt(8)
    v_mfma_f32_16x16x32_bf16 v[144:147], a[160:163], v[208:211], v[144:147]
    ds_read_b64_tr_b16 a[152:153], v23 offset:20480
    v_mfma_f32_16x16x32_bf16 v[148:151], a[160:163], v[212:215], v[148:151]
    ds_read_b64_tr_b16 a[154:155], v23 offset:22528
    s_add_u32 s36, s33, 25600
    v_mfma_f32_16x16x32_bf16 v[152:155], a[164:167], v[208:211], v[152:155]
    ds_read_b64_tr_b16 a[156:157], v24 offset:20480
    buffer_store_dwordx4 v[52:55], v16, s[16:19], s36 offen sc1
    v_mfma_f32_16x16x32_bf16 v[156:159], a[164:167], v[212:215], v[156:159]
    ds_read_b64_tr_b16 a[158:159], v24 offset:22528
    s_waitcnt lgkmcnt(8)
    v_mfma_f32_16x16x32_bf16 v[160:163], a[168:171], v[208:211], v[160:163]
    ds_read_b64_tr_b16 a[160:161], v21 offset:24576
    v_cvt_pk_bf16_f32 v56, v128, v129
    v_mfma_f32_16x16x32_bf16 v[164:167], a[168:171], v[212:215], v[164:167]
    ds_read_b64_tr_b16 a[162:163], v21 offset:26624
    v_cvt_pk_bf16_f32 v57, v130, v131
    v_mfma_f32_16x16x32_bf16 v[168:171], a[172:175], v[208:211], v[168:171]
    ds_read_b64_tr_b16 a[164:165], v22 offset:24576
    v_mfma_f32_16x16x32_bf16 v[172:175], a[172:175], v[212:215], v[172:175]
    ds_read_b64_tr_b16 a[166:167], v22 offset:26624
    v_cvt_pk_bf16_f32 v58, v136, v137
    s_waitcnt lgkmcnt(8)
    v_mfma_f32_16x16x32_bf16 v[144:147], a[144:147], v[216:219], v[144:147]
    ds_read_b64_tr_b16 a[168:169], v23 offset:24576
    v_cvt_pk_bf16_f32 v59, v138, v139
    v_mfma_f32_16x16x32_bf16 v[148:151], a[144:147], v[220:223], v[148:151]
    ds_read_b64_tr_b16 a[170:171], v23 offset:26624
    v_mfma_f32_16x16x32_bf16 v[152:155], a[148:151], v[216:219], v[152:155]
    ds_read_b64_tr_b16 a[172:173], v24 offset:24576
    s_nop 1
    v_mfma_f32_16x16x32_bf16 v[156:159], a[148:151], v[220:223], v[156:159]
    ds_read_b64_tr_b16 a[174:175], v24 offset:26624
    v_permlane16_swap_b32 v56, v58
    s_waitcnt lgkmcnt(8)
    v_mfma_f32_16x16x32_bf16 v[160:163], a[152:155], v[216:219], v[160:163]
    ds_read_b64_tr_b16 a[144:145], v21 offset:28672
    v_mfma_f32_16x16x32_bf16 v[164:167], a[152:155], v[220:223], v[164:167]
    ds_read_b64_tr_b16 a[146:147], v21 offset:30720
    v_permlane16_swap_b32 v57, v59
    v_mfma_f32_16x16x32_bf16 v[168:171], a[156:159], v[216:219], v[168:171]
    ds_read_b64_tr_b16 a[148:149], v22 offset:28672
    s_add_u32 s36, s33, 26624
    v_mfma_f32_16x16x32_bf16 v[172:175], a[156:159], v[220:223], v[172:175]
    ds_read_b64_tr_b16 a[150:151], v22 offset:30720
    s_waitcnt lgkmcnt(8)
    v_mfma_f32_16x16x32_bf16 v[144:147], a[160:163], v[224:227], v[144:147]
    ds_read_b64_tr_b16 a[152:153], v23 offset:28672
    buffer_store_dwordx4 v[56:59], v16, s[16:19], s36 offen sc1
    v_mfma_f32_16x16x32_bf16 v[148:151], a[160:163], v[228:231], v[148:151]
    ds_read_b64_tr_b16 a[154:155], v23 offset:30720
    v_cvt_pk_bf16_f32 v60, v132, v133
    v_mfma_f32_16x16x32_bf16 v[152:155], a[164:167], v[224:227], v[152:155]
    ds_read_b64_tr_b16 a[156:157], v24 offset:28672
    v_mfma_f32_16x16x32_bf16 v[156:159], a[164:167], v[228:231], v[156:159]
    ds_read_b64_tr_b16 a[158:159], v24 offset:30720
    v_cvt_pk_bf16_f32 v61, v134, v135
    s_waitcnt lgkmcnt(8)
    v_mfma_f32_16x16x32_bf16 v[160:163], a[168:171], v[224:227], v[160:163]
    ds_read_b64_tr_b16 a[160:161], v21 offset:32768
    v_cvt_pk_bf16_f32 v62, v140, v141
    v_mfma_f32_16x16x32_bf16 v[164:167], a[168:171], v[228:231], v[164:167]
    ds_read_b64_tr_b16 a[162:163], v21 offset:34816
    v_mfma_f32_16x16x32_bf16 v[168:171], a[172:175], v[224:227], v[168:171]
    ds_read_b64_tr_b16 a[164:165], v22 offset:32768
    v_cvt_pk_bf16_f32 v63, v142, v143
    v_mfma_f32_16x16x32_bf16 v[172:175], a[172:175], v[228:231], v[172:175]
    ds_read_b64_tr_b16 a[166:167], v22 offset:34816
    s_nop 1
    s_waitcnt lgkmcnt(8)
    v_mfma_f32_16x16x32_bf16 v[144:147], a[144:147], v[232:235], v[144:147]
    ds_read_b64_tr_b16 a[168:169], v23 offset:32768
    v_mfma_f32_16x16x32_bf16 v[148:151], a[144:147], v[236:239], v[148:151]
    ds_read_b64_tr_b16 a[170:171], v23 offset:34816
    v_permlane16_swap_b32 v60, v62
    v_mfma_f32_16x16x32_bf16 v[152:155], a[148:151], v[232:235], v[152:155]
    ds_read_b64_tr_b16 a[172:173], v24 offset:32768
    v_permlane16_swap_b32 v61, v63
    v_mfma_f32_16x16x32_bf16 v[156:159], a[148:151], v[236:239], v[156:159]
    ds_read_b64_tr_b16 a[174:175], v24 offset:34816
    s_waitcnt lgkmcnt(8)
    v_mfma_f32_16x16x32_bf16 v[160:163], a[152:155], v[232:235], v[160:163]
    ds_read_b64_tr_b16 a[144:145], v25 offset:0
    s_add_u32 s36, s33, 27648
    v_mfma_f32_16x16x32_bf16 v[164:167], a[152:155], v[236:239], v[164:167]
    ds_read_b64_tr_b16 a[146:147], v25 offset:2048
    buffer_store_dwordx4 v[60:63], v16, s[16:19], s36 offen sc1
    v_mfma_f32_16x16x32_bf16 v[168:171], a[156:159], v[232:235], v[168:171]
    ds_read_b64_tr_b16 a[148:149], v26 offset:0
    v_mfma_f32_16x16x32_bf16 v[172:175], a[156:159], v[236:239], v[172:175]
    ds_read_b64_tr_b16 a[150:151], v26 offset:2048
    s_waitcnt lgkmcnt(8)
    v_mfma_f32_16x16x32_bf16 v[144:147], a[160:163], v[240:243], v[144:147]
    ds_read_b64_tr_b16 a[152:153], v27 offset:0
    v_mfma_f32_16x16x32_bf16 v[148:151], a[160:163], v[244:247], v[148:151]
    ds_read_b64_tr_b16 a[154:155], v27 offset:2048
    v_mfma_f32_16x16x32_bf16 v[152:155], a[164:167], v[240:243], v[152:155]
    ds_read_b64_tr_b16 a[156:157], v28 offset:0
    v_mfma_f32_16x16x32_bf16 v[156:159], a[164:167], v[244:247], v[156:159]
    ds_read_b64_tr_b16 a[158:159], v28 offset:2048
    s_waitcnt lgkmcnt(8)
    v_mfma_f32_16x16x32_bf16 v[160:163], a[168:171], v[240:243], v[160:163]
    ds_read_b64_tr_b16 a[160:161], v25 offset:4096
    v_mfma_f32_16x16x32_bf16 v[164:167], a[168:171], v[244:247], v[164:167]
    ds_read_b64_tr_b16 a[162:163], v25 offset:6144
    v_mfma_f32_16x16x32_bf16 v[168:171], a[172:175], v[240:243], v[168:171]
    ds_read_b64_tr_b16 a[164:165], v26 offset:4096
    v_mfma_f32_16x16x32_bf16 v[172:175], a[172:175], v[244:247], v[172:175]
    ds_read_b64_tr_b16 a[166:167], v26 offset:6144
    s_barrier
    s_waitcnt lgkmcnt(8)
    v_mfma_f32_16x16x32_bf16 v[112:115], a[144:147], v[176:179], 0
    ds_read_b64_tr_b16 a[168:169], v27 offset:4096
    v_mfma_f32_16x16x32_bf16 v[116:119], a[144:147], v[180:183], 0
    ds_read_b64_tr_b16 a[170:171], v27 offset:6144
    v_mfma_f32_16x16x32_bf16 v[120:123], a[148:151], v[176:179], 0
    ds_read_b64_tr_b16 a[172:173], v28 offset:4096
    v_mfma_f32_16x16x32_bf16 v[124:127], a[148:151], v[180:183], 0
    ds_read_b64_tr_b16 a[174:175], v28 offset:6144
    s_waitcnt lgkmcnt(8)
    v_mfma_f32_16x16x32_bf16 v[128:131], a[152:155], v[176:179], 0
    ds_read_b64_tr_b16 a[144:145], v25 offset:8192
    v_mfma_f32_16x16x32_bf16 v[132:135], a[152:155], v[180:183], 0
    ds_read_b64_tr_b16 a[146:147], v25 offset:10240
    v_mfma_f32_16x16x32_bf16 v[136:139], a[156:159], v[176:179], 0
    ds_read_b64_tr_b16 a[148:149], v26 offset:8192
    v_mfma_f32_16x16x32_bf16 v[140:143], a[156:159], v[180:183], 0
    ds_read_b64_tr_b16 a[150:151], v26 offset:10240
    s_cmp_eq_u32 s21, 7
    s_cbranch_scc1 Lk3_kernel_res7
Lk3_kernel_resb7:
    s_waitcnt lgkmcnt(8)
    v_mfma_f32_16x16x32_bf16 v[112:115], a[160:163], v[184:187], v[112:115]
    ds_read_b64_tr_b16 a[152:153], v27 offset:8192
    v_mfma_f32_16x16x32_bf16 v[116:119], a[160:163], v[188:191], v[116:119]
    ds_read_b64_tr_b16 a[154:155], v27 offset:10240
    v_cvt_pk_bf16_f32 v48, v144, v145
    v_mfma_f32_16x16x32_bf16 v[120:123], a[164:167], v[184:187], v[120:123]
    ds_read_b64_tr_b16 a[156:157], v28 offset:8192
    v_cvt_pk_bf16_f32 v49, v146, v147
    v_mfma_f32_16x16x32_bf16 v[124:127], a[164:167], v[188:191], v[124:127]
    ds_read_b64_tr_b16 a[158:159], v28 offset:10240
    s_waitcnt lgkmcnt(8)
    v_mfma_f32_16x16x32_bf16 v[128:131], a[168:171], v[184:187], v[128:131]
    ds_read_b64_tr_b16 a[160:161], v25 offset:12288
    v_cvt_pk_bf16_f32 v50, v152, v153
    v_mfma_f32_16x16x32_bf16 v[132:135], a[168:171], v[188:191], v[132:135]
    ds_read_b64_tr_b16 a[162:163], v25 offset:14336
    v_cvt_pk_bf16_f32 v51, v154, v155
    v_mfma_f32_16x16x32_bf16 v[136:139], a[172:175], v[184:187], v[136:139]
    ds_read_b64_tr_b16 a[164:165], v26 offset:12288
    v_mfma_f32_16x16x32_bf16 v[140:143], a[172:175], v[188:191], v[140:143]
    ds_read_b64_tr_b16 a[166:167], v26 offset:14336
    s_nop 1
    s_waitcnt lgkmcnt(8)
    v_mfma_f32_16x16x32_bf16 v[112:115], a[144:147], v[192:195], v[112:115]
    ds_read_b64_tr_b16 a[168:169], v27 offset:12288
    v_permlane16_swap_b32 v48, v50
    v_mfma_f32_16x16x32_bf16 v[116:119], a[144:147], v[196:199], v[116:119]
    ds_read_b64_tr_b16 a[170:171], v27 offset:14336
    v_mfma_f32_16x16x32_bf16 v[120:123], a[148:151], v[192:195], v[120:123]
    ds_read_b64_tr_b16 a[172:173], v28 offset:12288
    v_permlane16_swap_b32 v49, v51
    v_mfma_f32_16x16x32_bf16 v[124:127], a[148:151], v[196:199], v[124:127]
    ds_read_b64_tr_b16 a[174:175], v28 offset:14336
    s_add_u32 s36, s33, 28672
    s_waitcnt lgkmcnt(8)
    v_mfma_f32_16x16x32_bf16 v[128:131], a[152:155], v[192:195], v[128:131]
    ds_read_b64_tr_b16 a[144:145], v25 offset:16384
    v_mfma_f32_16x16x32_bf16 v[132:135], a[152:155], v[196:199], v[132:135]
    ds_read_b64_tr_b16 a[146:147], v25 offset:18432
    buffer_store_dwordx4 v[48:51], v16, s[16:19], s36 offen sc1
    v_mfma_f32_16x16x32_bf16 v[136:139], a[156:159], v[192:195], v[136:139]
    ds_read_b64_tr_b16 a[148:149], v26 offset:16384
    v_cvt_pk_bf16_f32 v52, v148, v149
    v_mfma_f32_16x16x32_bf16 v[140:143], a[156:159], v[196:199], v[140:143]
    ds_read_b64_tr_b16 a[150:151], v26 offset:18432
    s_waitcnt lgkmcnt(8)
    v_mfma_f32_16x16x32_bf16 v[112:115], a[160:163], v[200:203], v[112:115]
    ds_read_b64_tr_b16 a[152:153], v27 offset:16384
    v_cvt_pk_bf16_f32 v53, v150, v151
    v_mfma_f32_16x16x32_bf16 v[116:119], a[160:163], v[204:207], v[116:119]
    ds_read_b64_tr_b16 a[154:155], v27 offset:18432
    v_cvt_pk_bf16_f32 v54, v156, v157
    v_mfma_f32_16x16x32_bf16 v[120:123], a[164:167], v[200:203], v[120:123]
    ds_read_b64_tr_b16 a[156:157], v28 offset:16384
    v_mfma_f32_16x16x32_bf16 v[124:127], a[164:167], v[204:207], v[124:127]
    ds_read_b64_tr_b16 a[158:159], v28 offset:18432
    v_cvt_pk_bf16_f32 v55, v158, v159
    s_waitcnt lgkmcnt(8)
    v_mfma_f32_16x16x32_bf16 v[128:131], a[168:171], v[200:203], v[128:131]
    ds_read_b64_tr_b16 a[160:161], v25 offset:20480
    s_nop 1
    v_mfma_f32_16x16x32_bf16 v[132:135], a[168:171], v[204:207], v[132:135]
    ds_read_b64_tr_b16 a[162:163], v25 offset:22528
    v_mfma_f32_16x16x32_bf16 v[136:139], a[172:175], v[200:203], v[136:139]
    ds_read_b64_tr_b16 a[164:165], v26 offset:20480
    v_permlane16_swap_b32 v52, v54
    v_mfma_f32_16x16x32_bf16 v[140:143], a[172:175], v[204:207], v[140:143]
    ds_read_b64_tr_b16 a[166:167], v26 offset:22528
    v_permlane16_swap_b32 v53, v55
    s_waitcnt lgkmcnt(8)
    v_mfma_f32_16x16x32_bf16 v[112:115], a[144:147], v[208:211], v[112:115]
    ds_read_b64_tr_b16 a[168:169], v27 offset:20480
    v_mfma_f32_16x16x32_bf16 v[116:119], a[144:147], v[212:215], v[116:119]
    ds_read_b64_tr_b16 a[170:171], v27 offset:22528
    s_add_u32 s36, s33, 29696
    v_mfma_f32_16x16x32_bf16 v[120:123], a[148:151], v[208:211], v[120:123]
    ds_read_b64_tr_b16 a[172:173], v28 offset:20480
    buffer_store_dwordx4 v[52:55], v16, s[16:19], s36 offen sc1
    v_mfma_f32_16x16x32_bf16 v[124:127], a[148:151], v[212:215], v[124:127]
    ds_read_b64_tr_b16 a[174:175], v28 offset:22528
    s_waitcnt lgkmcnt(8)
    v_mfma_f32_16x16x32_bf16 v[128:131], a[152:155], v[208:211], v[128:131]
    ds_read_b64_tr_b16 a[144:145], v25 offset:24576
    v_cvt_pk_bf16_f32 v56, v160, v161
    v_mfma_f32_16x16x32_bf16 v[132:135], a[152:155], v[212:215], v[132:135]
    ds_read_b64_tr_b16 a[146:147], v25 offset:26624
    v_cvt_pk_bf16_f32 v57, v162, v163
    v_mfma_f32_16x16x32_bf16 v[136:139], a[156:159], v[208:211], v[136:139]
    ds_read_b64_tr_b16 a[148:149], v26 offset:24576
    v_mfma_f32_16x16x32_bf16 v[140:143], a[156:159], v[212:215], v[140:143]
    ds_read_b64_tr_b16 a[150:151], v26 offset:26624
    v_cvt_pk_bf16_f32 v58, v168, v169
    s_waitcnt lgkmcnt(8)
    v_mfma_f32_16x16x32_bf16 v[112:115], a[160:163], v[216:219], v[112:115]
    ds_read_b64_tr_b16 a[152:153], v27 offset:24576
    v_cvt_pk_bf16_f32 v59, v170, v171
    v_mfma_f32_16x16x32_bf16 v[116:119], a[160:163], v[220:223], v[116:119]
    ds_read_b64_tr_b16 a[154:155], v27 offset:26624
    v_mfma_f32_16x16x32_bf16 v[120:123], a[164:167], v[216:219], v[120:123]
    ds_read_b64_tr_b16 a[156:157], v28 offset:24576
    s_nop 1
    v_mfma_f32_16x16x32_bf16 v[124:127], a[164:167], v[220:223], v[124:127]
    ds_read_b64_tr_b16 a[158:159], v28 offset:26624
    v_permlane16_swap_b32 v56, v58
    s_waitcnt lgkmcnt(8)
    v_mfma_f32_16x16x32_bf16 v[128:131], a[168:171], v[216:219], v[128:131]
    ds_read_b64_tr_b16 a[160:161], v25 offset:28672
    v_mfma_f32_16x16x32_bf16 v[132:135], a[168:171], v[220:223], v[132:135]
    ds_read_b64_tr_b16 a[162:163], v25 offset:30720
    v_permlane16_swap_b32 v57, v59
    v_mfma_f32_16x16x32_bf16 v[136:139], a[172:175], v[216:219], v[136:139]
    ds_read_b64_tr_b16 a[164:165], v26 offset:28672
    s_add_u32 s36, s33, 30720
    v_mfma_f32_16x16x32_bf16 v[140:143], a[172:175], v[220:223], v[140:143]
    ds_read_b64_tr_b16 a[166:167], v26 offset:30720
    s_waitcnt lgkmcnt(8)
    v_mfma_f32_16x16x32_bf16 v[112:115], a[144:147], v[224:227], v[112:115]
    ds_read_b64_tr_b16 a[168:169], v27 offset:28672
    buffer_store_dwordx4 v[56:59], v16, s[16:19], s36 offen sc1
    v_mfma_f32_16x16x32_bf16 v[116:119], a[144:147], v[228:231], v[116:119]
    ds_read_b64_tr_b16 a[170:171], v27 offset:30720
    v_cvt_pk_bf16_f32 v60, v164, v165
    v_mfma_f32_16x16x32_bf16 v[120:123], a[148:151], v[224:227], v[120:123]
    ds_read_b64_tr_b16 a[172:173], v28 offset:28672
    v_mfma_f32_16x16x32_bf16 v[124:127], a[148:151], v[228:231], v[124:127]
    ds_read_b64_tr_b16 a[174:175], v28 offset:30720
    v_cvt_pk_bf16_f32 v61, v166, v167
    s_waitcnt lgkmcnt(8)
    v_mfma_f32_16x16x32_bf16 v[128:131], a[152:155], v[224:227], v[128:131]
    ds_read_b64_tr_b16 a[144:145], v25 offset:32768
    v_cvt_pk_bf16_f32 v62, v172, v173
    v_mfma_f32_16x16x32_bf16 v[132:135], a[152:155], v[228:231], v[132:135]
    ds_read_b64_tr_b16 a[146:147], v25 offset:34816
    v_mfma_f32_16x16x32_bf16 v[136:139], a[156:159], v[224:227], v[136:139]
    ds_read_b64_tr_b16 a[148:149], v26 offset:32768
    v_cvt_pk_bf16_f32 v63, v174, v175
    v_mfma_f32_16x16x32_bf16 v[140:143], a[156:159], v[228:231], v[140:143]
    ds_read_b64_tr_b16 a[150:151], v26 offset:34816
    s_nop 1
    s_waitcnt lgkmcnt(8)
    v_mfma_f32_16x16x32_bf16 v[112:115], a[160:163], v[232:235], v[112:115]
    ds_read_b64_tr_b16 a[152:153], v27 offset:32768
    v_mfma_f32_16x16x32_bf16 v[116:119], a[160:163], v[236:239], v[116:119]
    ds_read_b64_tr_b16 a[154:155], v27 offset:34816
    v_permlane16_swap_b32 v60, v62
    v_mfma_f32_16x16x32_bf16 v[120:123], a[164:167], v[232:235], v[120:123]
    ds_read_b64_tr_b16 a[156:157], v28 offset:32768
    v_permlane16_swap_b32 v61, v63
    v_mfma_f32_16x16x32_bf16 v[124:127], a[164:167], v[236:239], v[124:127]
    ds_read_b64_tr_b16 a[158:159], v28 offset:34816
    s_waitcnt lgkmcnt(8)
    v_mfma_f32_16x16x32_bf16 v[128:131], a[168:171], v[232:235], v[128:131]
    s_add_u32 s36, s33, 31744
    v_mfma_f32_16x16x32_bf16 v[132:135], a[168:171], v[236:239], v[132:135]
    buffer_store_dwordx4 v[60:63], v16, s[16:19], s36 offen sc1
    v_mfma_f32_16x16x32_bf16 v[136:139], a[172:175], v[232:235], v[136:139]
    v_mfma_f32_16x16x32_bf16 v[140:143], a[172:175], v[236:239], v[140:143]
    s_waitcnt lgkmcnt(4)
    v_mfma_f32_16x16x32_bf16 v[112:115], a[144:147], v[240:243], v[112:115]
    v_mfma_f32_16x16x32_bf16 v[116:119], a[144:147], v[244:247], v[116:119]
    v_mfma_f32_16x16x32_bf16 v[120:123], a[148:151], v[240:243], v[120:123]
    v_mfma_f32_16x16x32_bf16 v[124:127], a[148:151], v[244:247], v[124:127]
    s_waitcnt lgkmcnt(0)
    v_mfma_f32_16x16x32_bf16 v[128:131], a[152:155], v[240:243], v[128:131]
    v_mfma_f32_16x16x32_bf16 v[132:135], a[152:155], v[244:247], v[132:135]
    v_mfma_f32_16x16x32_bf16 v[136:139], a[156:159], v[240:243], v[136:139]
    v_mfma_f32_16x16x32_bf16 v[140:143], a[156:159], v[244:247], v[140:143]
    s_nop 7
    s_cmp_eq_u32 s21, 8
    s_cbranch_scc1 Lk3_kernel_res8
Lk3_kernel_resb8:
    v_cvt_pk_bf16_f32 v48, v112, v113
    v_cvt_pk_bf16_f32 v49, v114, v115
    v_cvt_pk_bf16_f32 v50, v120, v121
    v_cvt_pk_bf16_f32 v51, v122, v123
    s_nop 1
    v_permlane16_swap_b32 v48, v50
    v_permlane16_swap_b32 v49, v51
    s_add_u32 s36, s33, 32768
    buffer_store_dwordx4 v[48:51], v16, s[16:19], s36 offen sc1
    v_cvt_pk_bf16_f32 v52, v116, v117
    v_cvt_pk_bf16_f32 v53, v118, v119
    v_cvt_pk_bf16_f32 v54, v124, v125
    v_cvt_pk_bf16_f32 v55, v126, v127
    s_nop 1
    v_permlane16_swap_b32 v52, v54
    v_permlane16_swap_b32 v53, v55
    s_add_u32 s36, s33, 33792
    buffer_store_dwordx4 v[52:55], v16, s[16:19], s36 offen sc1
    v_cvt_pk_bf16_f32 v56, v128, v129
    v_cvt_pk_bf16_f32 v57, v130, v131
    v_cvt_pk_bf16_f32 v58, v136, v137
    v_cvt_pk_bf16_f32 v59, v138, v139
    s_nop 1
    v_permlane16_swap_b32 v56, v58
    v_permlane16_swap_b32 v57, v59
    s_add_u32 s36, s33, 34816
    buffer_store_dwordx4 v[56:59], v16, s[16:19], s36 offen sc1
    v_cvt_pk_bf16_f32 v60, v132, v133
    v_cvt_pk_bf16_f32 v61, v134, v135
    v_cvt_pk_bf16_f32 v62, v140, v141
    v_cvt_pk_bf16_f32 v63, v142, v143
    s_nop 1
    v_permlane16_swap_b32 v60, v62
    v_permlane16_swap_b32 v61, v63
    s_add_u32 s36, s33, 35840
    buffer_store_dwordx4 v[60:63], v16, s[16:19], s36 offen sc1
    s_waitcnt vmcnt(0)
Lk3_kernel_end:
    s_endpgm
Lk3_kernel_res0:
    v_accvgpr_read_b32 v248, a0
    v_accvgpr_read_b32 v249, a1
    v_lshlrev_b32 v250, 16, v248
    v_and_b32 v248, 0xffff0000, v248
    v_lshlrev_b32 v251, 16, v249
    v_and_b32 v249, 0xffff0000, v249
    v_add_f32 v112, v112, v250
    v_add_f32 v113, v113, v248
    v_add_f32 v114, v114, v251
    v_add_f32 v115, v115, v249

    v_accvgpr_read_b32 v248, a4
    v_accvgpr_read_b32 v249, a5
    v_lshlrev_b32 v250, 16, v248
    v_and_b32 v248, 0xffff0000, v248
    v_lshlrev_b32 v251, 16, v249
    v_and_b32 v249, 0xffff0000, v249
    v_add_f32 v116, v116, v250
    v_add_f32 v117, v117, v248
    v_add_f32 v118, v118, v251
    v_add_f32 v119, v119, v249

    v_accvgpr_read_b32 v248, a2
    v_accvgpr_read_b32 v249, a3
    v_lshlrev_b32 v250, 16, v248
    v_and_b32 v248, 0xffff0000, v248
    v_lshlrev_b32 v251, 16, v249
    v_and_b32 v249, 0xffff0000, v249
    v_add_f32 v120, v120, v250
    v_add_f32 v121, v121, v248
    v_add_f32 v122, v122, v251
    v_add_f32 v123, v123, v249

    v_accvgpr_read_b32 v248, a6
    v_accvgpr_read_b32 v249, a7
    v_lshlrev_b32 v250, 16, v248
    v_and_b32 v248, 0xffff0000, v248
    v_lshlrev_b32 v251, 16, v249
    v_and_b32 v249, 0xffff0000, v249
    v_add_f32 v124, v124, v250
    v_add_f32 v125, v125, v248
    v_add_f32 v126, v126, v251
    v_add_f32 v127, v127, v249

    v_accvgpr_read_b32 v248, a8
    v_accvgpr_read_b32 v249, a9
    v_lshlrev_b32 v250, 16, v248
    v_and_b32 v248, 0xffff0000, v248
    v_lshlrev_b32 v251, 16, v249
    v_and_b32 v249, 0xffff0000, v249
    v_add_f32 v128, v128, v250
    v_add_f32 v129, v129, v248
    v_add_f32 v130, v130, v251
    v_add_f32 v131, v131, v249

    v_accvgpr_read_b32 v248, a12
    v_accvgpr_read_b32 v249, a13
    v_lshlrev_b32 v250, 16, v248
    v_and_b32 v248, 0xffff0000, v248
    v_lshlrev_b32 v251, 16, v249
    v_and_b32 v249, 0xffff0000, v249
    v_add_f32 v132, v132, v250
    v_add_f32 v133, v133, v248
    v_add_f32 v134, v134, v251
    v_add_f32 v135, v135, v249

    v_accvgpr_read_b32 v248, a10
    v_accvgpr_read_b32 v249, a11
    v_lshlrev_b32 v250, 16, v248
    v_and_b32 v248, 0xffff0000, v248
    v_lshlrev_b32 v251, 16, v249
    v_and_b32 v249, 0xffff0000, v249
    v_add_f32 v136, v136, v250
    v_add_f32 v137, v137, v248
    v_add_f32 v138, v138, v251
    v_add_f32 v139, v139, v249

    v_accvgpr_read_b32 v248, a14
    v_accvgpr_read_b32 v249, a15
    v_lshlrev_b32 v250, 16, v248
    v_and_b32 v248, 0xffff0000, v248
    v_lshlrev_b32 v251, 16, v249
    v_and_b32 v249, 0xffff0000, v249
    v_add_f32 v140, v140, v250
    v_add_f32 v141, v141, v248
    v_add_f32 v142, v142, v251
    v_add_f32 v143, v143, v249

    s_branch Lk3_kernel_resb0
Lk3_kernel_res1:
    v_accvgpr_read_b32 v248, a16
    v_accvgpr_read_b32 v249, a17
    v_lshlrev_b32 v250, 16, v248
    v_and_b32 v248, 0xffff0000, v248
    v_lshlrev_b32 v251, 16, v249
    v_and_b32 v249, 0xffff0000, v249
    v_add_f32 v144, v144, v250
    v_add_f32 v145, v145, v248
    v_add_f32 v146, v146, v251
    v_add_f32 v147, v147, v249

    v_accvgpr_read_b32 v248, a20
    v_accvgpr_read_b32 v249, a21
    v_lshlrev_b32 v250, 16, v248
    v_and_b32 v248, 0xffff0000, v248
    v_lshlrev_b32 v251, 16, v249
    v_and_b32 v249, 0xffff0000, v249
    v_add_f32 v148, v148, v250
    v_add_f32 v149, v149, v248
    v_add_f32 v150, v150, v251
    v_add_f32 v151, v151, v249

    v_accvgpr_read_b32 v248, a18
    v_accvgpr_read_b32 v249, a19
    v_lshlrev_b32 v250, 16, v248
    v_and_b32 v248, 0xffff0000, v248
    v_lshlrev_b32 v251, 16, v249
    v_and_b32 v249, 0xffff0000, v249
    v_add_f32 v152, v152, v250
    v_add_f32 v153, v153, v248
    v_add_f32 v154, v154, v251
    v_add_f32 v155, v155, v249

    v_accvgpr_read_b32 v248, a22
    v_accvgpr_read_b32 v249, a23
    v_lshlrev_b32 v250, 16, v248
    v_and_b32 v248, 0xffff0000, v248
    v_lshlrev_b32 v251, 16, v249
    v_and_b32 v249, 0xffff0000, v249
    v_add_f32 v156, v156, v250
    v_add_f32 v157, v157, v248
    v_add_f32 v158, v158, v251
    v_add_f32 v159, v159, v249

    v_accvgpr_read_b32 v248, a24
    v_accvgpr_read_b32 v249, a25
    v_lshlrev_b32 v250, 16, v248
    v_and_b32 v248, 0xffff0000, v248
    v_lshlrev_b32 v251, 16, v249
    v_and_b32 v249, 0xffff0000, v249
    v_add_f32 v160, v160, v250
    v_add_f32 v161, v161, v248
    v_add_f32 v162, v162, v251
    v_add_f32 v163, v163, v249

    v_accvgpr_read_b32 v248, a28
    v_accvgpr_read_b32 v249, a29
    v_lshlrev_b32 v250, 16, v248
    v_and_b32 v248, 0xffff0000, v248
    v_lshlrev_b32 v251, 16, v249
    v_and_b32 v249, 0xffff0000, v249
    v_add_f32 v164, v164, v250
    v_add_f32 v165, v165, v248
    v_add_f32 v166, v166, v251
    v_add_f32 v167, v167, v249

    v_accvgpr_read_b32 v248, a26
    v_accvgpr_read_b32 v249, a27
    v_lshlrev_b32 v250, 16, v248
    v_and_b32 v248, 0xffff0000, v248
    v_lshlrev_b32 v251, 16, v249
    v_and_b32 v249, 0xffff0000, v249
    v_add_f32 v168, v168, v250
    v_add_f32 v169, v169, v248
    v_add_f32 v170, v170, v251
    v_add_f32 v171, v171, v249

    v_accvgpr_read_b32 v248, a30
    v_accvgpr_read_b32 v249, a31
    v_lshlrev_b32 v250, 16, v248
    v_and_b32 v248, 0xffff0000, v248
    v_lshlrev_b32 v251, 16, v249
    v_and_b32 v249, 0xffff0000, v249
    v_add_f32 v172, v172, v250
    v_add_f32 v173, v173, v248
    v_add_f32 v174, v174, v251
    v_add_f32 v175, v175, v249

    s_branch Lk3_kernel_resb1
Lk3_kernel_res2:
    v_accvgpr_read_b32 v248, a32
    v_accvgpr_read_b32 v249, a33
    v_lshlrev_b32 v250, 16, v248
    v_and_b32 v248, 0xffff0000, v248
    v_lshlrev_b32 v251, 16, v249
    v_and_b32 v249, 0xffff0000, v249
    v_add_f32 v112, v112, v250
    v_add_f32 v113, v113, v248
    v_add_f32 v114, v114, v251
    v_add_f32 v115, v115, v249

    v_accvgpr_read_b32 v248, a36
    v_accvgpr_read_b32 v249, a37
    v_lshlrev_b32 v250, 16, v248
    v_and_b32 v248, 0xffff0000, v248
    v_lshlrev_b32 v251, 16, v249
    v_and_b32 v249, 0xffff0000, v249
    v_add_f32 v116, v116, v250
    v_add_f32 v117, v117, v248
    v_add_f32 v118, v118, v251
    v_add_f32 v119, v119, v249

    v_accvgpr_read_b32 v248, a34
    v_accvgpr_read_b32 v249, a35
    v_lshlrev_b32 v250, 16, v248
    v_and_b32 v248, 0xffff0000, v248
    v_lshlrev_b32 v251, 16, v249
    v_and_b32 v249, 0xffff0000, v249
    v_add_f32 v120, v120, v250
    v_add_f32 v121, v121, v248
    v_add_f32 v122, v122, v251
    v_add_f32 v123, v123, v249

    v_accvgpr_read_b32 v248, a38
    v_accvgpr_read_b32 v249, a39
    v_lshlrev_b32 v250, 16, v248
    v_and_b32 v248, 0xffff0000, v248
    v_lshlrev_b32 v251, 16, v249
    v_and_b32 v249, 0xffff0000, v249
    v_add_f32 v124, v124, v250
    v_add_f32 v125, v125, v248
    v_add_f32 v126, v126, v251
    v_add_f32 v127, v127, v249

    v_accvgpr_read_b32 v248, a40
    v_accvgpr_read_b32 v249, a41
    v_lshlrev_b32 v250, 16, v248
    v_and_b32 v248, 0xffff0000, v248
    v_lshlrev_b32 v251, 16, v249
    v_and_b32 v249, 0xffff0000, v249
    v_add_f32 v128, v128, v250
    v_add_f32 v129, v129, v248
    v_add_f32 v130, v130, v251
    v_add_f32 v131, v131, v249

    v_accvgpr_read_b32 v248, a44
    v_accvgpr_read_b32 v249, a45
    v_lshlrev_b32 v250, 16, v248
    v_and_b32 v248, 0xffff0000, v248
    v_lshlrev_b32 v251, 16, v249
    v_and_b32 v249, 0xffff0000, v249
    v_add_f32 v132, v132, v250
    v_add_f32 v133, v133, v248
    v_add_f32 v134, v134, v251
    v_add_f32 v135, v135, v249

    v_accvgpr_read_b32 v248, a42
    v_accvgpr_read_b32 v249, a43
    v_lshlrev_b32 v250, 16, v248
    v_and_b32 v248, 0xffff0000, v248
    v_lshlrev_b32 v251, 16, v249
    v_and_b32 v249, 0xffff0000, v249
    v_add_f32 v136, v136, v250
    v_add_f32 v137, v137, v248
    v_add_f32 v138, v138, v251
    v_add_f32 v139, v139, v249

    v_accvgpr_read_b32 v248, a46
    v_accvgpr_read_b32 v249, a47
    v_lshlrev_b32 v250, 16, v248
    v_and_b32 v248, 0xffff0000, v248
    v_lshlrev_b32 v251, 16, v249
    v_and_b32 v249, 0xffff0000, v249
    v_add_f32 v140, v140, v250
    v_add_f32 v141, v141, v248
    v_add_f32 v142, v142, v251
    v_add_f32 v143, v143, v249

    s_branch Lk3_kernel_resb2
Lk3_kernel_res3:
    v_accvgpr_read_b32 v248, a48
    v_accvgpr_read_b32 v249, a49
    v_lshlrev_b32 v250, 16, v248
    v_and_b32 v248, 0xffff0000, v248
    v_lshlrev_b32 v251, 16, v249
    v_and_b32 v249, 0xffff0000, v249
    v_add_f32 v144, v144, v250
    v_add_f32 v145, v145, v248
    v_add_f32 v146, v146, v251
    v_add_f32 v147, v147, v249

    v_accvgpr_read_b32 v248, a52
    v_accvgpr_read_b32 v249, a53
    v_lshlrev_b32 v250, 16, v248
    v_and_b32 v248, 0xffff0000, v248
    v_lshlrev_b32 v251, 16, v249
    v_and_b32 v249, 0xffff0000, v249
    v_add_f32 v148, v148, v250
    v_add_f32 v149, v149, v248
    v_add_f32 v150, v150, v251
    v_add_f32 v151, v151, v249

    v_accvgpr_read_b32 v248, a50
    v_accvgpr_read_b32 v249, a51
    v_lshlrev_b32 v250, 16, v248
    v_and_b32 v248, 0xffff0000, v248
    v_lshlrev_b32 v251, 16, v249
    v_and_b32 v249, 0xffff0000, v249
    v_add_f32 v152, v152, v250
    v_add_f32 v153, v153, v248
    v_add_f32 v154, v154, v251
    v_add_f32 v155, v155, v249

    v_accvgpr_read_b32 v248, a54
    v_accvgpr_read_b32 v249, a55
    v_lshlrev_b32 v250, 16, v248
    v_and_b32 v248, 0xffff0000, v248
    v_lshlrev_b32 v251, 16, v249
    v_and_b32 v249, 0xffff0000, v249
    v_add_f32 v156, v156, v250
    v_add_f32 v157, v157, v248
    v_add_f32 v158, v158, v251
    v_add_f32 v159, v159, v249

    v_accvgpr_read_b32 v248, a56
    v_accvgpr_read_b32 v249, a57
    v_lshlrev_b32 v250, 16, v248
    v_and_b32 v248, 0xffff0000, v248
    v_lshlrev_b32 v251, 16, v249
    v_and_b32 v249, 0xffff0000, v249
    v_add_f32 v160, v160, v250
    v_add_f32 v161, v161, v248
    v_add_f32 v162, v162, v251
    v_add_f32 v163, v163, v249

    v_accvgpr_read_b32 v248, a60
    v_accvgpr_read_b32 v249, a61
    v_lshlrev_b32 v250, 16, v248
    v_and_b32 v248, 0xffff0000, v248
    v_lshlrev_b32 v251, 16, v249
    v_and_b32 v249, 0xffff0000, v249
    v_add_f32 v164, v164, v250
    v_add_f32 v165, v165, v248
    v_add_f32 v166, v166, v251
    v_add_f32 v167, v167, v249

    v_accvgpr_read_b32 v248, a58
    v_accvgpr_read_b32 v249, a59
    v_lshlrev_b32 v250, 16, v248
    v_and_b32 v248, 0xffff0000, v248
    v_lshlrev_b32 v251, 16, v249
    v_and_b32 v249, 0xffff0000, v249
    v_add_f32 v168, v168, v250
    v_add_f32 v169, v169, v248
    v_add_f32 v170, v170, v251
    v_add_f32 v171, v171, v249

    v_accvgpr_read_b32 v248, a62
    v_accvgpr_read_b32 v249, a63
    v_lshlrev_b32 v250, 16, v248
    v_and_b32 v248, 0xffff0000, v248
    v_lshlrev_b32 v251, 16, v249
    v_and_b32 v249, 0xffff0000, v249
    v_add_f32 v172, v172, v250
    v_add_f32 v173, v173, v248
    v_add_f32 v174, v174, v251
    v_add_f32 v175, v175, v249

    s_branch Lk3_kernel_resb3
Lk3_kernel_res4:
    v_accvgpr_read_b32 v248, a64
    v_accvgpr_read_b32 v249, a65
    v_lshlrev_b32 v250, 16, v248
    v_and_b32 v248, 0xffff0000, v248
    v_lshlrev_b32 v251, 16, v249
    v_and_b32 v249, 0xffff0000, v249
    v_add_f32 v112, v112, v250
    v_add_f32 v113, v113, v248
    v_add_f32 v114, v114, v251
    v_add_f32 v115, v115, v249

    v_accvgpr_read_b32 v248, a68
    v_accvgpr_read_b32 v249, a69
    v_lshlrev_b32 v250, 16, v248
    v_and_b32 v248, 0xffff0000, v248
    v_lshlrev_b32 v251, 16, v249
    v_and_b32 v249, 0xffff0000, v249
    v_add_f32 v116, v116, v250
    v_add_f32 v117, v117, v248
    v_add_f32 v118, v118, v251
    v_add_f32 v119, v119, v249

    v_accvgpr_read_b32 v248, a66
    v_accvgpr_read_b32 v249, a67
    v_lshlrev_b32 v250, 16, v248
    v_and_b32 v248, 0xffff0000, v248
    v_lshlrev_b32 v251, 16, v249
    v_and_b32 v249, 0xffff0000, v249
    v_add_f32 v120, v120, v250
    v_add_f32 v121, v121, v248
    v_add_f32 v122, v122, v251
    v_add_f32 v123, v123, v249

    v_accvgpr_read_b32 v248, a70
    v_accvgpr_read_b32 v249, a71
    v_lshlrev_b32 v250, 16, v248
    v_and_b32 v248, 0xffff0000, v248
    v_lshlrev_b32 v251, 16, v249
    v_and_b32 v249, 0xffff0000, v249
    v_add_f32 v124, v124, v250
    v_add_f32 v125, v125, v248
    v_add_f32 v126, v126, v251
    v_add_f32 v127, v127, v249

    v_accvgpr_read_b32 v248, a72
    v_accvgpr_read_b32 v249, a73
    v_lshlrev_b32 v250, 16, v248
    v_and_b32 v248, 0xffff0000, v248
    v_lshlrev_b32 v251, 16, v249
    v_and_b32 v249, 0xffff0000, v249
    v_add_f32 v128, v128, v250
    v_add_f32 v129, v129, v248
    v_add_f32 v130, v130, v251
    v_add_f32 v131, v131, v249

    v_accvgpr_read_b32 v248, a76
    v_accvgpr_read_b32 v249, a77
    v_lshlrev_b32 v250, 16, v248
    v_and_b32 v248, 0xffff0000, v248
    v_lshlrev_b32 v251, 16, v249
    v_and_b32 v249, 0xffff0000, v249
    v_add_f32 v132, v132, v250
    v_add_f32 v133, v133, v248
    v_add_f32 v134, v134, v251
    v_add_f32 v135, v135, v249

    v_accvgpr_read_b32 v248, a74
    v_accvgpr_read_b32 v249, a75
    v_lshlrev_b32 v250, 16, v248
    v_and_b32 v248, 0xffff0000, v248
    v_lshlrev_b32 v251, 16, v249
    v_and_b32 v249, 0xffff0000, v249
    v_add_f32 v136, v136, v250
    v_add_f32 v137, v137, v248
    v_add_f32 v138, v138, v251
    v_add_f32 v139, v139, v249

    v_accvgpr_read_b32 v248, a78
    v_accvgpr_read_b32 v249, a79
    v_lshlrev_b32 v250, 16, v248
    v_and_b32 v248, 0xffff0000, v248
    v_lshlrev_b32 v251, 16, v249
    v_and_b32 v249, 0xffff0000, v249
    v_add_f32 v140, v140, v250
    v_add_f32 v141, v141, v248
    v_add_f32 v142, v142, v251
    v_add_f32 v143, v143, v249

    s_branch Lk3_kernel_resb4
Lk3_kernel_res5:
    v_accvgpr_read_b32 v248, a80
    v_accvgpr_read_b32 v249, a81
    v_lshlrev_b32 v250, 16, v248
    v_and_b32 v248, 0xffff0000, v248
    v_lshlrev_b32 v251, 16, v249
    v_and_b32 v249, 0xffff0000, v249
    v_add_f32 v144, v144, v250
    v_add_f32 v145, v145, v248
    v_add_f32 v146, v146, v251
    v_add_f32 v147, v147, v249

    v_accvgpr_read_b32 v248, a84
    v_accvgpr_read_b32 v249, a85
    v_lshlrev_b32 v250, 16, v248
    v_and_b32 v248, 0xffff0000, v248
    v_lshlrev_b32 v251, 16, v249
    v_and_b32 v249, 0xffff0000, v249
    v_add_f32 v148, v148, v250
    v_add_f32 v149, v149, v248
    v_add_f32 v150, v150, v251
    v_add_f32 v151, v151, v249

    v_accvgpr_read_b32 v248, a82
    v_accvgpr_read_b32 v249, a83
    v_lshlrev_b32 v250, 16, v248
    v_and_b32 v248, 0xffff0000, v248
    v_lshlrev_b32 v251, 16, v249
    v_and_b32 v249, 0xffff0000, v249
    v_add_f32 v152, v152, v250
    v_add_f32 v153, v153, v248
    v_add_f32 v154, v154, v251
    v_add_f32 v155, v155, v249

    v_accvgpr_read_b32 v248, a86
    v_accvgpr_read_b32 v249, a87
    v_lshlrev_b32 v250, 16, v248
    v_and_b32 v248, 0xffff0000, v248
    v_lshlrev_b32 v251, 16, v249
    v_and_b32 v249, 0xffff0000, v249
    v_add_f32 v156, v156, v250
    v_add_f32 v157, v157, v248
    v_add_f32 v158, v158, v251
    v_add_f32 v159, v159, v249

    v_accvgpr_read_b32 v248, a88
    v_accvgpr_read_b32 v249, a89
    v_lshlrev_b32 v250, 16, v248
    v_and_b32 v248, 0xffff0000, v248
    v_lshlrev_b32 v251, 16, v249
    v_and_b32 v249, 0xffff0000, v249
    v_add_f32 v160, v160, v250
    v_add_f32 v161, v161, v248
    v_add_f32 v162, v162, v251
    v_add_f32 v163, v163, v249

    v_accvgpr_read_b32 v248, a92
    v_accvgpr_read_b32 v249, a93
    v_lshlrev_b32 v250, 16, v248
    v_and_b32 v248, 0xffff0000, v248
    v_lshlrev_b32 v251, 16, v249
    v_and_b32 v249, 0xffff0000, v249
    v_add_f32 v164, v164, v250
    v_add_f32 v165, v165, v248
    v_add_f32 v166, v166, v251
    v_add_f32 v167, v167, v249

    v_accvgpr_read_b32 v248, a90
    v_accvgpr_read_b32 v249, a91
    v_lshlrev_b32 v250, 16, v248
    v_and_b32 v248, 0xffff0000, v248
    v_lshlrev_b32 v251, 16, v249
    v_and_b32 v249, 0xffff0000, v249
    v_add_f32 v168, v168, v250
    v_add_f32 v169, v169, v248
    v_add_f32 v170, v170, v251
    v_add_f32 v171, v171, v249

    v_accvgpr_read_b32 v248, a94
    v_accvgpr_read_b32 v249, a95
    v_lshlrev_b32 v250, 16, v248
    v_and_b32 v248, 0xffff0000, v248
    v_lshlrev_b32 v251, 16, v249
    v_and_b32 v249, 0xffff0000, v249
    v_add_f32 v172, v172, v250
    v_add_f32 v173, v173, v248
    v_add_f32 v174, v174, v251
    v_add_f32 v175, v175, v249

    s_branch Lk3_kernel_resb5
Lk3_kernel_res6:
    v_accvgpr_read_b32 v248, a96
    v_accvgpr_read_b32 v249, a97
    v_lshlrev_b32 v250, 16, v248
    v_and_b32 v248, 0xffff0000, v248
    v_lshlrev_b32 v251, 16, v249
    v_and_b32 v249, 0xffff0000, v249
    v_add_f32 v112, v112, v250
    v_add_f32 v113, v113, v248
    v_add_f32 v114, v114, v251
    v_add_f32 v115, v115, v249

    v_accvgpr_read_b32 v248, a100
    v_accvgpr_read_b32 v249, a101
    v_lshlrev_b32 v250, 16, v248
    v_and_b32 v248, 0xffff0000, v248
    v_lshlrev_b32 v251, 16, v249
    v_and_b32 v249, 0xffff0000, v249
    v_add_f32 v116, v116, v250
    v_add_f32 v117, v117, v248
    v_add_f32 v118, v118, v251
    v_add_f32 v119, v119, v249

    v_accvgpr_read_b32 v248, a98
    v_accvgpr_read_b32 v249, a99
    v_lshlrev_b32 v250, 16, v248
    v_and_b32 v248, 0xffff0000, v248
    v_lshlrev_b32 v251, 16, v249
    v_and_b32 v249, 0xffff0000, v249
    v_add_f32 v120, v120, v250
    v_add_f32 v121, v121, v248
    v_add_f32 v122, v122, v251
    v_add_f32 v123, v123, v249

    v_accvgpr_read_b32 v248, a102
    v_accvgpr_read_b32 v249, a103
    v_lshlrev_b32 v250, 16, v248
    v_and_b32 v248, 0xffff0000, v248
    v_lshlrev_b32 v251, 16, v249
    v_and_b32 v249, 0xffff0000, v249
    v_add_f32 v124, v124, v250
    v_add_f32 v125, v125, v248
    v_add_f32 v126, v126, v251
    v_add_f32 v127, v127, v249

    v_accvgpr_read_b32 v248, a104
    v_accvgpr_read_b32 v249, a105
    v_lshlrev_b32 v250, 16, v248
    v_and_b32 v248, 0xffff0000, v248
    v_lshlrev_b32 v251, 16, v249
    v_and_b32 v249, 0xffff0000, v249
    v_add_f32 v128, v128, v250
    v_add_f32 v129, v129, v248
    v_add_f32 v130, v130, v251
    v_add_f32 v131, v131, v249

    v_accvgpr_read_b32 v248, a108
    v_accvgpr_read_b32 v249, a109
    v_lshlrev_b32 v250, 16, v248
    v_and_b32 v248, 0xffff0000, v248
    v_lshlrev_b32 v251, 16, v249
    v_and_b32 v249, 0xffff0000, v249
    v_add_f32 v132, v132, v250
    v_add_f32 v133, v133, v248
    v_add_f32 v134, v134, v251
    v_add_f32 v135, v135, v249

    v_accvgpr_read_b32 v248, a106
    v_accvgpr_read_b32 v249, a107
    v_lshlrev_b32 v250, 16, v248
    v_and_b32 v248, 0xffff0000, v248
    v_lshlrev_b32 v251, 16, v249
    v_and_b32 v249, 0xffff0000, v249
    v_add_f32 v136, v136, v250
    v_add_f32 v137, v137, v248
    v_add_f32 v138, v138, v251
    v_add_f32 v139, v139, v249

    v_accvgpr_read_b32 v248, a110
    v_accvgpr_read_b32 v249, a111
    v_lshlrev_b32 v250, 16, v248
    v_and_b32 v248, 0xffff0000, v248
    v_lshlrev_b32 v251, 16, v249
    v_and_b32 v249, 0xffff0000, v249
    v_add_f32 v140, v140, v250
    v_add_f32 v141, v141, v248
    v_add_f32 v142, v142, v251
    v_add_f32 v143, v143, v249

    s_branch Lk3_kernel_resb6
Lk3_kernel_res7:
    v_accvgpr_read_b32 v248, a112
    v_accvgpr_read_b32 v249, a113
    v_lshlrev_b32 v250, 16, v248
    v_and_b32 v248, 0xffff0000, v248
    v_lshlrev_b32 v251, 16, v249
    v_and_b32 v249, 0xffff0000, v249
    v_add_f32 v144, v144, v250
    v_add_f32 v145, v145, v248
    v_add_f32 v146, v146, v251
    v_add_f32 v147, v147, v249

    v_accvgpr_read_b32 v248, a116
    v_accvgpr_read_b32 v249, a117
    v_lshlrev_b32 v250, 16, v248
    v_and_b32 v248, 0xffff0000, v248
    v_lshlrev_b32 v251, 16, v249
    v_and_b32 v249, 0xffff0000, v249
    v_add_f32 v148, v148, v250
    v_add_f32 v149, v149, v248
    v_add_f32 v150, v150, v251
    v_add_f32 v151, v151, v249

    v_accvgpr_read_b32 v248, a114
    v_accvgpr_read_b32 v249, a115
    v_lshlrev_b32 v250, 16, v248
    v_and_b32 v248, 0xffff0000, v248
    v_lshlrev_b32 v251, 16, v249
    v_and_b32 v249, 0xffff0000, v249
    v_add_f32 v152, v152, v250
    v_add_f32 v153, v153, v248
    v_add_f32 v154, v154, v251
    v_add_f32 v155, v155, v249

    v_accvgpr_read_b32 v248, a118
    v_accvgpr_read_b32 v249, a119
    v_lshlrev_b32 v250, 16, v248
    v_and_b32 v248, 0xffff0000, v248
    v_lshlrev_b32 v251, 16, v249
    v_and_b32 v249, 0xffff0000, v249
    v_add_f32 v156, v156, v250
    v_add_f32 v157, v157, v248
    v_add_f32 v158, v158, v251
    v_add_f32 v159, v159, v249

    v_accvgpr_read_b32 v248, a120
    v_accvgpr_read_b32 v249, a121
    v_lshlrev_b32 v250, 16, v248
    v_and_b32 v248, 0xffff0000, v248
    v_lshlrev_b32 v251, 16, v249
    v_and_b32 v249, 0xffff0000, v249
    v_add_f32 v160, v160, v250
    v_add_f32 v161, v161, v248
    v_add_f32 v162, v162, v251
    v_add_f32 v163, v163, v249

    v_accvgpr_read_b32 v248, a124
    v_accvgpr_read_b32 v249, a125
    v_lshlrev_b32 v250, 16, v248
    v_and_b32 v248, 0xffff0000, v248
    v_lshlrev_b32 v251, 16, v249
    v_and_b32 v249, 0xffff0000, v249
    v_add_f32 v164, v164, v250
    v_add_f32 v165, v165, v248
    v_add_f32 v166, v166, v251
    v_add_f32 v167, v167, v249

    v_accvgpr_read_b32 v248, a122
    v_accvgpr_read_b32 v249, a123
    v_lshlrev_b32 v250, 16, v248
    v_and_b32 v248, 0xffff0000, v248
    v_lshlrev_b32 v251, 16, v249
    v_and_b32 v249, 0xffff0000, v249
    v_add_f32 v168, v168, v250
    v_add_f32 v169, v169, v248
    v_add_f32 v170, v170, v251
    v_add_f32 v171, v171, v249

    v_accvgpr_read_b32 v248, a126
    v_accvgpr_read_b32 v249, a127
    v_lshlrev_b32 v250, 16, v248
    v_and_b32 v248, 0xffff0000, v248
    v_lshlrev_b32 v251, 16, v249
    v_and_b32 v249, 0xffff0000, v249
    v_add_f32 v172, v172, v250
    v_add_f32 v173, v173, v248
    v_add_f32 v174, v174, v251
    v_add_f32 v175, v175, v249

    s_branch Lk3_kernel_resb7
Lk3_kernel_res8:
    v_accvgpr_read_b32 v248, a128
    v_accvgpr_read_b32 v249, a129
    v_lshlrev_b32 v250, 16, v248
    v_and_b32 v248, 0xffff0000, v248
    v_lshlrev_b32 v251, 16, v249
    v_and_b32 v249, 0xffff0000, v249
    v_add_f32 v112, v112, v250
    v_add_f32 v113, v113, v248
    v_add_f32 v114, v114, v251
    v_add_f32 v115, v115, v249

    v_accvgpr_read_b32 v248, a132
    v_accvgpr_read_b32 v249, a133
    v_lshlrev_b32 v250, 16, v248
    v_and_b32 v248, 0xffff0000, v248
    v_lshlrev_b32 v251, 16, v249
    v_and_b32 v249, 0xffff0000, v249
    v_add_f32 v116, v116, v250
    v_add_f32 v117, v117, v248
    v_add_f32 v118, v118, v251
    v_add_f32 v119, v119, v249

    v_accvgpr_read_b32 v248, a130
    v_accvgpr_read_b32 v249, a131
    v_lshlrev_b32 v250, 16, v248
    v_and_b32 v248, 0xffff0000, v248
    v_lshlrev_b32 v251, 16, v249
    v_and_b32 v249, 0xffff0000, v249
    v_add_f32 v120, v120, v250
    v_add_f32 v121, v121, v248
    v_add_f32 v122, v122, v251
    v_add_f32 v123, v123, v249

    v_accvgpr_read_b32 v248, a134
    v_accvgpr_read_b32 v249, a135
    v_lshlrev_b32 v250, 16, v248
    v_and_b32 v248, 0xffff0000, v248
    v_lshlrev_b32 v251, 16, v249
    v_and_b32 v249, 0xffff0000, v249
    v_add_f32 v124, v124, v250
    v_add_f32 v125, v125, v248
    v_add_f32 v126, v126, v251
    v_add_f32 v127, v127, v249

    v_accvgpr_read_b32 v248, a136
    v_accvgpr_read_b32 v249, a137
    v_lshlrev_b32 v250, 16, v248
    v_and_b32 v248, 0xffff0000, v248
    v_lshlrev_b32 v251, 16, v249
    v_and_b32 v249, 0xffff0000, v249
    v_add_f32 v128, v128, v250
    v_add_f32 v129, v129, v248
    v_add_f32 v130, v130, v251
    v_add_f32 v131, v131, v249

    v_accvgpr_read_b32 v248, a140
    v_accvgpr_read_b32 v249, a141
    v_lshlrev_b32 v250, 16, v248
    v_and_b32 v248, 0xffff0000, v248
    v_lshlrev_b32 v251, 16, v249
    v_and_b32 v249, 0xffff0000, v249
    v_add_f32 v132, v132, v250
    v_add_f32 v133, v133, v248
    v_add_f32 v134, v134, v251
    v_add_f32 v135, v135, v249

    v_accvgpr_read_b32 v248, a138
    v_accvgpr_read_b32 v249, a139
    v_lshlrev_b32 v250, 16, v248
    v_and_b32 v248, 0xffff0000, v248
    v_lshlrev_b32 v251, 16, v249
    v_and_b32 v249, 0xffff0000, v249
    v_add_f32 v136, v136, v250
    v_add_f32 v137, v137, v248
    v_add_f32 v138, v138, v251
    v_add_f32 v139, v139, v249

    v_accvgpr_read_b32 v248, a142
    v_accvgpr_read_b32 v249, a143
    v_lshlrev_b32 v250, 16, v248
    v_and_b32 v248, 0xffff0000, v248
    v_lshlrev_b32 v251, 16, v249
    v_and_b32 v249, 0xffff0000, v249
    v_add_f32 v140, v140, v250
    v_add_f32 v141, v141, v248
    v_add_f32 v142, v142, v251
    v_add_f32 v143, v143, v249

    s_branch Lk3_kernel_resb8
.globl k4_kernel
.p2align 8
.type k4_kernel,@function
k4_kernel:
    s_getpc_b64 s[4:5]
    v_lshlrev_b32 v1, 7, v0
    v_min_u32 v1, 3328, v1
    global_load_dword v100, v1, s[4:5]
    s_cmp_ge_u32 s2, 256
    s_cbranch_scc1 Lk4_kernel_end
    s_load_dwordx2 s[4:5], s[0:1], 88
    s_load_dwordx2 s[6:7], s[0:1], 104
    v_lshrrev_b32 v1, 6, v0
    v_and_b32 v2, 63, v0
    s_nop 0
    v_readfirstlane_b32 s16, v1
    s_lshr_b32 s17, s2, 2
    s_mul_i32 s17, s17, 36
    s_lshl_b32 s18, s16, 2
    s_add_u32 s17, s17, s18
    s_and_b32 s18, s2, 3
    s_add_u32 s17, s17, s18
    s_mul_hi_u32 s18, s17, 119304648
    s_mul_i32 s19, s18, 36
    s_sub_u32 s19, s17, s19
    s_waitcnt lgkmcnt(0)
    s_mov_b32 s8, s6
    s_mov_b32 s9, s7
    s_mov_b32 s10, 48107520
    s_mov_b32 s11, 0x20000
    s_mov_b32 s12, s4
    s_mov_b32 s13, s5
    s_mov_b32 s14, 2359296
    s_mov_b32 s15, 0x20000
    v_lshlrev_b32 v3, 4, v2
    s_lshl_b32 s20, s17, 10
    s_add_u32 s20, s20, 10096640

    buffer_load_dwordx4 v[16:19], v3, s[8:11], s20 offen
    s_add_u32 s20, s20, 2359296
    buffer_load_dwordx4 v[20:23], v3, s[8:11], s20 offen
    s_add_u32 s20, s20, 2359296
    buffer_load_dwordx4 v[24:27], v3, s[8:11], s20 offen
    s_add_u32 s20, s20, 2359296
    buffer_load_dwordx4 v[28:31], v3, s[8:11], s20 offen
    s_add_u32 s20, s20, 2359296
    buffer_load_dwordx4 v[32:35], v3, s[8:11], s20 offen
    s_add_u32 s20, s20, 2359296
    buffer_load_dwordx4 v[36:39], v3, s[8:11], s20 offen
    s_add_u32 s20, s20, 2359296
    buffer_load_dwordx4 v[40:43], v3, s[8:11], s20 offen
    s_add_u32 s20, s20, 2359296
    buffer_load_dwordx4 v[44:47], v3, s[8:11], s20 offen
    s_add_u32 s20, s20, 2359296
    buffer_load_dwordx4 v[48:51], v3, s[8:11], s20 offen
    s_add_u32 s20, s20, 2359296
    buffer_load_dwordx4 v[52:55], v3, s[8:11], s20 offen
    s_add_u32 s20, s20, 2359296
    buffer_load_dwordx4 v[56:59], v3, s[8:11], s20 offen
    s_add_u32 s20, s20, 2359296
    buffer_load_dwordx4 v[60:63], v3, s[8:11], s20 offen
    s_add_u32 s20, s20, 2359296
    buffer_load_dwordx4 v[64:67], v3, s[8:11], s20 offen
    s_add_u32 s20, s20, 2359296
    buffer_load_dwordx4 v[68:71], v3, s[8:11], s20 offen
    s_add_u32 s20, s20, 2359296
    buffer_load_dwordx4 v[72:75], v3, s[8:11], s20 offen
    s_add_u32 s20, s20, 2359296
    buffer_load_dwordx4 v[76:79], v3, s[8:11], s20 offen
    v_and_b32 v4, 15, v2
    v_bfe_u32 v5, v2, 4, 1
    v_lshlrev_b32 v5, 1, v5
    v_lshrrev_b32 v8, 5, v2
    v_add_u32 v5, v5, v8
    v_lshlrev_b32 v6, 15, v5
    v_lshl_add_u32 v6, v4, 1, v6
    s_and_b32 s24, s19, 1
    s_lshr_b32 s25, s19, 1
    s_lshl_b32 s21, s18, 6
    s_lshl_b32 s22, s24, 5
    s_add_u32 s21, s21, s22
    s_lshl_b32 s22, s25, 17
    s_add_u32 s21, s21, s22
    s_add_u32 s21, s21, 7671808

    v_mul_u32_u24 v7, 1152, v4
    v_lshl_add_u32 v7, v5, 4, v7
    s_mul_i32 s23, s18, 36864
    s_mul_i32 s24, s24, 18432
    s_add_u32 s23, s23, s24
    s_lshl_b32 s25, s25, 6
    s_add_u32 s23, s23, s25

    s_waitcnt vmcnt(15)
    v_lshlrev_b32 v80, 16, v16
    v_and_b32 v81, 0xffff0000, v16
    v_lshlrev_b32 v82, 16, v17
    v_and_b32 v83, 0xffff0000, v17
    v_lshlrev_b32 v84, 16, v18
    v_and_b32 v85, 0xffff0000, v18
    v_lshlrev_b32 v86, 16, v19
    v_and_b32 v87, 0xffff0000, v19
    s_waitcnt vmcnt(14)
    v_lshlrev_b32 v12, 16, v20
    v_and_b32 v13, 0xffff0000, v20
    v_add_f32 v80, v80, v12
    v_add_f32 v81, v81, v13
    v_lshlrev_b32 v12, 16, v21
    v_and_b32 v13, 0xffff0000, v21
    v_add_f32 v82, v82, v12
    v_add_f32 v83, v83, v13
    v_lshlrev_b32 v12, 16, v22
    v_and_b32 v13, 0xffff0000, v22
    v_add_f32 v84, v84, v12
    v_add_f32 v85, v85, v13
    v_lshlrev_b32 v12, 16, v23
    v_and_b32 v13, 0xffff0000, v23
    v_add_f32 v86, v86, v12
    v_add_f32 v87, v87, v13
    s_waitcnt vmcnt(13)
    v_lshlrev_b32 v12, 16, v24
    v_and_b32 v13, 0xffff0000, v24
    v_add_f32 v80, v80, v12
    v_add_f32 v81, v81, v13
    v_lshlrev_b32 v12, 16, v25
    v_and_b32 v13, 0xffff0000, v25
    v_add_f32 v82, v82, v12
    v_add_f32 v83, v83, v13
    v_lshlrev_b32 v12, 16, v26
    v_and_b32 v13, 0xffff0000, v26
    v_add_f32 v84, v84, v12
    v_add_f32 v85, v85, v13
    v_lshlrev_b32 v12, 16, v27
    v_and_b32 v13, 0xffff0000, v27
    v_add_f32 v86, v86, v12
    v_add_f32 v87, v87, v13
    s_waitcnt vmcnt(12)
    v_lshlrev_b32 v12, 16, v28
    v_and_b32 v13, 0xffff0000, v28
    v_add_f32 v80, v80, v12
    v_add_f32 v81, v81, v13
    v_lshlrev_b32 v12, 16, v29
    v_and_b32 v13, 0xffff0000, v29
    v_add_f32 v82, v82, v12
    v_add_f32 v83, v83, v13
    v_lshlrev_b32 v12, 16, v30
    v_and_b32 v13, 0xffff0000, v30
    v_add_f32 v84, v84, v12
    v_add_f32 v85, v85, v13
    v_lshlrev_b32 v12, 16, v31
    v_and_b32 v13, 0xffff0000, v31
    v_add_f32 v86, v86, v12
    v_add_f32 v87, v87, v13
    s_waitcnt vmcnt(11)
    v_lshlrev_b32 v12, 16, v32
    v_and_b32 v13, 0xffff0000, v32
    v_add_f32 v80, v80, v12
    v_add_f32 v81, v81, v13
    v_lshlrev_b32 v12, 16, v33
    v_and_b32 v13, 0xffff0000, v33
    v_add_f32 v82, v82, v12
    v_add_f32 v83, v83, v13
    v_lshlrev_b32 v12, 16, v34
    v_and_b32 v13, 0xffff0000, v34
    v_add_f32 v84, v84, v12
    v_add_f32 v85, v85, v13
    v_lshlrev_b32 v12, 16, v35
    v_and_b32 v13, 0xffff0000, v35
    v_add_f32 v86, v86, v12
    v_add_f32 v87, v87, v13
    s_waitcnt vmcnt(10)
    v_lshlrev_b32 v12, 16, v36
    v_and_b32 v13, 0xffff0000, v36
    v_add_f32 v80, v80, v12
    v_add_f32 v81, v81, v13
    v_lshlrev_b32 v12, 16, v37
    v_and_b32 v13, 0xffff0000, v37
    v_add_f32 v82, v82, v12
    v_add_f32 v83, v83, v13
    v_lshlrev_b32 v12, 16, v38
    v_and_b32 v13, 0xffff0000, v38
    v_add_f32 v84, v84, v12
    v_add_f32 v85, v85, v13
    v_lshlrev_b32 v12, 16, v39
    v_and_b32 v13, 0xffff0000, v39
    v_add_f32 v86, v86, v12
    v_add_f32 v87, v87, v13
    s_waitcnt vmcnt(9)
    v_lshlrev_b32 v12, 16, v40
    v_and_b32 v13, 0xffff0000, v40
    v_add_f32 v80, v80, v12
    v_add_f32 v81, v81, v13
    v_lshlrev_b32 v12, 16, v41
    v_and_b32 v13, 0xffff0000, v41
    v_add_f32 v82, v82, v12
    v_add_f32 v83, v83, v13
    v_lshlrev_b32 v12, 16, v42
    v_and_b32 v13, 0xffff0000, v42
    v_add_f32 v84, v84, v12
    v_add_f32 v85, v85, v13
    v_lshlrev_b32 v12, 16, v43
    v_and_b32 v13, 0xffff0000, v43
    v_add_f32 v86, v86, v12
    v_add_f32 v87, v87, v13
    s_waitcnt vmcnt(8)
    v_lshlrev_b32 v12, 16, v44
    v_and_b32 v13, 0xffff0000, v44
    v_add_f32 v80, v80, v12
    v_add_f32 v81, v81, v13
    v_lshlrev_b32 v12, 16, v45
    v_and_b32 v13, 0xffff0000, v45
    v_add_f32 v82, v82, v12
    v_add_f32 v83, v83, v13
    v_lshlrev_b32 v12, 16, v46
    v_and_b32 v13, 0xffff0000, v46
    v_add_f32 v84, v84, v12
    v_add_f32 v85, v85, v13
    v_lshlrev_b32 v12, 16, v47
    v_and_b32 v13, 0xffff0000, v47
    v_add_f32 v86, v86, v12
    v_add_f32 v87, v87, v13
    s_waitcnt vmcnt(7)
    v_lshlrev_b32 v12, 16, v48
    v_and_b32 v13, 0xffff0000, v48
    v_add_f32 v80, v80, v12
    v_add_f32 v81, v81, v13
    v_lshlrev_b32 v12, 16, v49
    v_and_b32 v13, 0xffff0000, v49
    v_add_f32 v82, v82, v12
    v_add_f32 v83, v83, v13
    v_lshlrev_b32 v12, 16, v50
    v_and_b32 v13, 0xffff0000, v50
    v_add_f32 v84, v84, v12
    v_add_f32 v85, v85, v13
    v_lshlrev_b32 v12, 16, v51
    v_and_b32 v13, 0xffff0000, v51
    v_add_f32 v86, v86, v12
    v_add_f32 v87, v87, v13
    s_waitcnt vmcnt(6)
    v_lshlrev_b32 v12, 16, v52
    v_and_b32 v13, 0xffff0000, v52
    v_add_f32 v80, v80, v12
    v_add_f32 v81, v81, v13
    v_lshlrev_b32 v12, 16, v53
    v_and_b32 v13, 0xffff0000, v53
    v_add_f32 v82, v82, v12
    v_add_f32 v83, v83, v13
    v_lshlrev_b32 v12, 16, v54
    v_and_b32 v13, 0xffff0000, v54
    v_add_f32 v84, v84, v12
    v_add_f32 v85, v85, v13
    v_lshlrev_b32 v12, 16, v55
    v_and_b32 v13, 0xffff0000, v55
    v_add_f32 v86, v86, v12
    v_add_f32 v87, v87, v13
    s_waitcnt vmcnt(5)
    v_lshlrev_b32 v12, 16, v56
    v_and_b32 v13, 0xffff0000, v56
    v_add_f32 v80, v80, v12
    v_add_f32 v81, v81, v13
    v_lshlrev_b32 v12, 16, v57
    v_and_b32 v13, 0xffff0000, v57
    v_add_f32 v82, v82, v12
    v_add_f32 v83, v83, v13
    v_lshlrev_b32 v12, 16, v58
    v_and_b32 v13, 0xffff0000, v58
    v_add_f32 v84, v84, v12
    v_add_f32 v85, v85, v13
    v_lshlrev_b32 v12, 16, v59
    v_and_b32 v13, 0xffff0000, v59
    v_add_f32 v86, v86, v12
    v_add_f32 v87, v87, v13
    s_waitcnt vmcnt(4)
    v_lshlrev_b32 v12, 16, v60
    v_and_b32 v13, 0xffff0000, v60
    v_add_f32 v80, v80, v12
    v_add_f32 v81, v81, v13
    v_lshlrev_b32 v12, 16, v61
    v_and_b32 v13, 0xffff0000, v61
    v_add_f32 v82, v82, v12
    v_add_f32 v83, v83, v13
    v_lshlrev_b32 v12, 16, v62
    v_and_b32 v13, 0xffff0000, v62
    v_add_f32 v84, v84, v12
    v_add_f32 v85, v85, v13
    v_lshlrev_b32 v12, 16, v63
    v_and_b32 v13, 0xffff0000, v63
    v_add_f32 v86, v86, v12
    v_add_f32 v87, v87, v13
    s_waitcnt vmcnt(3)
    v_lshlrev_b32 v12, 16, v64
    v_and_b32 v13, 0xffff0000, v64
    v_add_f32 v80, v80, v12
    v_add_f32 v81, v81, v13
    v_lshlrev_b32 v12, 16, v65
    v_and_b32 v13, 0xffff0000, v65
    v_add_f32 v82, v82, v12
    v_add_f32 v83, v83, v13
    v_lshlrev_b32 v12, 16, v66
    v_and_b32 v13, 0xffff0000, v66
    v_add_f32 v84, v84, v12
    v_add_f32 v85, v85, v13
    v_lshlrev_b32 v12, 16, v67
    v_and_b32 v13, 0xffff0000, v67
    v_add_f32 v86, v86, v12
    v_add_f32 v87, v87, v13
    s_waitcnt vmcnt(2)
    v_lshlrev_b32 v12, 16, v68
    v_and_b32 v13, 0xffff0000, v68
    v_add_f32 v80, v80, v12
    v_add_f32 v81, v81, v13
    v_lshlrev_b32 v12, 16, v69
    v_and_b32 v13, 0xffff0000, v69
    v_add_f32 v82, v82, v12
    v_add_f32 v83, v83, v13
    v_lshlrev_b32 v12, 16, v70
    v_and_b32 v13, 0xffff0000, v70
    v_add_f32 v84, v84, v12
    v_add_f32 v85, v85, v13
    v_lshlrev_b32 v12, 16, v71
    v_and_b32 v13, 0xffff0000, v71
    v_add_f32 v86, v86, v12
    v_add_f32 v87, v87, v13
    s_waitcnt vmcnt(1)
    v_lshlrev_b32 v12, 16, v72
    v_and_b32 v13, 0xffff0000, v72
    v_add_f32 v80, v80, v12
    v_add_f32 v81, v81, v13
    v_lshlrev_b32 v12, 16, v73
    v_and_b32 v13, 0xffff0000, v73
    v_add_f32 v82, v82, v12
    v_add_f32 v83, v83, v13
    v_lshlrev_b32 v12, 16, v74
    v_and_b32 v13, 0xffff0000, v74
    v_add_f32 v84, v84, v12
    v_add_f32 v85, v85, v13
    v_lshlrev_b32 v12, 16, v75
    v_and_b32 v13, 0xffff0000, v75
    v_add_f32 v86, v86, v12
    v_add_f32 v87, v87, v13
    s_waitcnt vmcnt(0)
    v_lshlrev_b32 v12, 16, v76
    v_and_b32 v13, 0xffff0000, v76
    v_add_f32 v80, v80, v12
    v_add_f32 v81, v81, v13
    v_lshlrev_b32 v12, 16, v77
    v_and_b32 v13, 0xffff0000, v77
    v_add_f32 v82, v82, v12
    v_add_f32 v83, v83, v13
    v_lshlrev_b32 v12, 16, v78
    v_and_b32 v13, 0xffff0000, v78
    v_add_f32 v84, v84, v12
    v_add_f32 v85, v85, v13
    v_lshlrev_b32 v12, 16, v79
    v_and_b32 v13, 0xffff0000, v79
    v_add_f32 v86, v86, v12
    v_add_f32 v87, v87, v13
    s_waitcnt vmcnt(0)
    v_cvt_pk_bf16_f32 v88, v80, v81
    v_cvt_pk_bf16_f32 v89, v82, v83
    v_cvt_pk_bf16_f32 v90, v84, v85
    v_cvt_pk_bf16_f32 v91, v86, v87
    buffer_store_dwordx4 v[88:91], v7, s[12:15], s23 offen
    s_waitcnt vmcnt(0)

Lk4_kernel_end:
    s_endpgm
.section .rodata,"a"
.p2align 6
Lkd_start:
.p2align 6
.amdhsa_kernel ka_kernel
  .amdhsa_next_free_vgpr 128
  .amdhsa_next_free_sgpr 80
  .amdhsa_accum_offset 128
  .amdhsa_group_segment_fixed_size 0
  .amdhsa_kernarg_size 112
  .amdhsa_user_sgpr_count 2
  .amdhsa_user_sgpr_kernarg_segment_ptr 1
  .amdhsa_system_sgpr_workgroup_id_x 1
  .amdhsa_float_denorm_mode_32 3
  .amdhsa_float_denorm_mode_16_64 3
.end_amdhsa_kernel
.p2align 6
.amdhsa_kernel k3_kernel
  .amdhsa_next_free_vgpr 512
  .amdhsa_next_free_sgpr 102
  .amdhsa_accum_offset 256
  .amdhsa_group_segment_fixed_size 0
  .amdhsa_kernarg_size 112
  .amdhsa_user_sgpr_count 2
  .amdhsa_user_sgpr_kernarg_segment_ptr 1
  .amdhsa_system_sgpr_workgroup_id_x 1
  .amdhsa_float_denorm_mode_32 3
  .amdhsa_float_denorm_mode_16_64 3
.end_amdhsa_kernel
.p2align 6
.amdhsa_kernel k4_kernel
  .amdhsa_next_free_vgpr 104
  .amdhsa_next_free_sgpr 48
  .amdhsa_accum_offset 104
  .amdhsa_group_segment_fixed_size 0
  .amdhsa_kernarg_size 112
  .amdhsa_user_sgpr_count 2
  .amdhsa_user_sgpr_kernarg_segment_ptr 1
  .amdhsa_system_sgpr_workgroup_id_x 1
  .amdhsa_float_denorm_mode_32 3
  .amdhsa_float_denorm_mode_16_64 3
.end_amdhsa_kernel
```
